```python
import torch

def _softmax(x, axis=-1):
    return torch.softmax(x, dim=axis)
def _gelu(x):
    return torch.nn.functional.gelu(x, approximate="tanh")
def _silu(x):
    return torch.nn.functional.silu(x)
def _sigmoid(x):
    return torch.sigmoid(x)
def _layernorm(x, axis=-1, eps=1e-5):
    m = x.mean(dim=axis, keepdim=True)
    v = x.var(dim=axis, keepdim=True, unbiased=False)
    return (x - m) / torch.sqrt(v + eps)
def _scatter_add(tgt, idx, src, axis=0):
    return tgt.clone().index_add_(axis, idx, src)
def _segment_sum(src, seg, n):
    out = torch.zeros((n,) + src.shape[1:], dtype=src.dtype)
    return out.index_add_(0, seg, src)
def _pad(x, pw):
    flat = tuple(v for pair in reversed(pw) for v in pair)
    return torch.nn.functional.pad(x, flat)

kernel_name = 'recurrent_scan__sliding_block_cached__dense_activation_gelu__prompt'

def setup_inputs():

    _w = (lambda a: (lambda t: t.to(torch.bfloat16) if t.is_floating_point() else t)(torch.as_tensor(a)))
    def _A_setup():
        B, Sq, D = 1, 2048, 1024
        Hq, Hkv, Sk, Dh = 32, 4, 2048, 128
        assert Hq % Hkv == 0, (Hq, Hkv)
        return {
            "x": _w((lambda *s: torch.randn(*s, dtype=torch.bfloat16) * 0.05)(B, Sq, D)),
            "k_cache": _w((lambda *s: torch.randn(*s, dtype=torch.bfloat16) * 1.6)(B, Hkv, Sk, Dh)),
            "v_cache": _w((lambda *s: torch.randn(*s, dtype=torch.bfloat16) * 0.8)(B, Hkv, Sk, Dh)),
            "wq": _w((lambda *s: torch.randn(*s, dtype=torch.bfloat16) * 1.6)(D, Hq * Dh) * (D ** -0.5)),
            "wo": _w((lambda *s: torch.randn(*s, dtype=torch.bfloat16) * 0.8)(Hq * Dh, D) * ((Hq * Dh) ** -0.5)),
        }
    _A_in = _A_setup()

    def _B_setup():
        B, S, D, F = 1, 2048, 1024, 3584
        return {
            "x": _w((lambda *s: torch.randn(*s, dtype=torch.bfloat16) * 0.05)(B, S, D)),
            "w1": _w((lambda *s: torch.randn(*s, dtype=torch.bfloat16) * 1.6)(D, F) * (D ** -0.5)),
            "b1": _w((lambda *s: torch.randn(*s, dtype=torch.bfloat16) * 1.6)(F) * 0.01),
            "w2": _w((lambda *s: torch.randn(*s, dtype=torch.bfloat16) * 0.2)(F, D) * (F ** -0.5)),
            "b2": _w((lambda *s: torch.randn(*s, dtype=torch.bfloat16) * 0.2)(D) * 0.01),
        }
    _B_in = _B_setup()

    return {
        "A_x": _A_in["x"],
        "A_k_cache": _A_in["k_cache"],
        "A_v_cache": _A_in["v_cache"],
        "A_wq": _A_in["wq"],
        "A_wo": _A_in["wo"],
        "B_x": _B_in["x"],
        "B_w1": _B_in["w1"],
        "B_b1": _B_in["b1"],
        "B_w2": _B_in["w2"],
        "B_b2": _B_in["b2"],
    }

def reference(A_x, A_k_cache, A_v_cache, A_wq, A_wo, B_x, B_w1, B_b1, B_w2, B_b2):
    def _A_ref(x, k_cache, v_cache, wq, wo):
        B, Sq, D = x.shape
        Hq, Dh = 32, 128
        Hkv, Sk = k_cache.shape[1], k_cache.shape[2]
        W = min(4096, max(256, Sk // 4))
        rep = Hq // Hkv
        q = (lambda x, *d: x.permute(*d))((x @ wq).reshape(B, Sq, Hq, Dh), 0, 2, 1, 3)
        k = (lambda x, n, axis: torch.repeat_interleave(x, n, dim=axis))(k_cache[:, :, Sk - W:, :], rep, axis=1)
        v = (lambda x, n, axis: torch.repeat_interleave(x, n, dim=axis))(v_cache[:, :, Sk - W:, :], rep, axis=1)
        scores = torch.einsum("bhqd,bhkd->bhqk", q, k) * (Dh ** -0.5)
        p = _softmax(scores, axis=-1)
        o = torch.einsum("bhqk,bhkd->bhqd", p, v)
        return (lambda x, *d: x.permute(*d))(o, 0, 2, 1, 3).reshape(B, Sq, Hq * Dh) @ wo

    def _B_ref(x, w1, b1, w2, b2):
        h = torch.einsum("bsd,df->bsf", x, w1) + b1
        h = _gelu(h)
        return torch.einsum("bsf,fd->bsd", h, w2) + b2

    x = A_x
    xn = _layernorm(x, axis=-1)
    s = _A_ref(xn, A_k_cache, A_v_cache, A_wq, A_wo)
    g = _silu(_B_ref(xn, B_w1, B_b1, B_w2, B_b2))
    return x + s * g
```

```asm
; @launch grid=(256,1,1) block=(256,1,1) lds=152064
.amdgcn_target "amdgcn-amd-amdhsa--gfx950"
.text
.globl recurrent_scan__sliding_block_cached__dense_activation_gelu__prompt_kernel
.p2align 12
.p2align 8
.type recurrent_scan__sliding_block_cached__dense_activation_gelu__prompt_kernel,@function
recurrent_scan__sliding_block_cached__dense_activation_gelu__prompt_kernel:
 s_cmp_ge_u32 s2, 256
 s_cbranch_scc1 L_end
 s_load_dwordx16 s[64:79], s[0:1], 0
 s_load_dwordx8 s[80:87], s[0:1], 64
 s_load_dwordx2 s[88:89], s[0:1], 96
 s_and_b32 s4, s2, 1
 s_lshl_b32 s4, s4, 7
 s_lshr_b32 s5, s2, 6
 s_lshl_b32 s5, s5, 5
 s_or_b32 s4, s4, s5
 s_bfe_u32 s5, s2, 0x20001
 s_lshl_b32 s5, s5, 3
 s_or_b32 s4, s4, s5
 s_bfe_u32 s5, s2, 0x30003
 s_or_b32 s2, s4, s5
 v_and_b32 v1, 63, v0
 v_lshrrev_b32 v2, 6, v0
 s_nop 0
 v_readfirstlane_b32 s3, v2
 v_lshrrev_b32 v243, 5, v0
 s_lshl_b32 s4, s2, 3
 v_add_u32 v243, s4, v243
 v_and_b32 v244, 31, v0
 v_lshlrev_b32 v240, 11, v243
 v_lshl_add_u32 v240, v244, 4, v240
 s_bfe_u32 s4, s2, 0x20005
 s_lshl_b32 s4, s4, 3
 s_and_b32 s90, s2, 7
 s_add_u32 s90, s90, s4
 s_lshl_b32 s90, s90, 2
 s_add_u32 s90, s90, s3
 s_and_b32 s94, s90, 127
 s_lshl_b32 s94, s94, 10
 v_min_u32 v121, 7, v1
 v_lshl_add_u32 v120, v121, 7, s94
 s_getpc_b64 s[100:101]
L_pcb:
 s_add_u32 s100, s100, L_p0_a-L_pcb
 s_addc_u32 s101, s101, 0
 v_min_u32 v120, L_chk_slow-L_p0_a-4, v120
 v_mov_b32 v121, s101
 v_add_co_u32 v120, vcc, s100, v120
 v_addc_co_u32 v121, vcc, 0, v121, vcc
 global_load_dword a190, v[120:121], off
 v_and_b32 v4, 7, v1
 v_lshrrev_b32 v5, 3, v1
 v_lshlrev_b32 v246, 11, v4
 v_lshl_add_u32 v246, v5, 7, v246
 v_lshlrev_b32 v4, 7, v4
 v_lshl_add_u32 v253, v5, 19, v4
 v_mul_u32_u24 v252, 458752, v5
 v_add_u32 v252, v252, v4
 s_bfe_u32 s5, s2, 0x20003
 s_lshr_b32 s4, s90, 1
 s_lshl_b32 s4, s4, 2
 s_add_u32 s4, s4, s5
 s_lshl_b32 s4, s4, 1
 s_and_b32 s6, s3, 1
 s_add_u32 s4, s4, s6
 s_lshl_b32 s62, s4, 10
 s_mul_i32 s63, s4, 896
 s_and_b32 s4, s2, 128
 s_add_u32 s4, s4, s90
 s_lshl_b32 s95, s4, 14
 s_waitcnt lgkmcnt(0)
 s_mov_b32 s28, s64
 s_mov_b32 s29, s65
 s_mov_b32 s30, 0x400000
 s_mov_b32 s31, 0x20000
 buffer_load_dwordx4 v[16:19], v240, s[28:31], 0 offen offset:0
 buffer_load_dwordx4 v[20:23], v240, s[28:31], 0 offen offset:512
 buffer_load_dwordx4 v[24:27], v240, s[28:31], 0 offen offset:1024
 buffer_load_dwordx4 v[28:31], v240, s[28:31], 0 offen offset:1536
 s_sub_u32 s8, s70, 4096
 s_subb_u32 s9, s71, 0
 s_mov_b32 s10, 0x801000
 s_mov_b32 s11, 0x20000
 s_sub_u32 s12, s76, 4096
 s_subb_u32 s13, s77, 0
 s_mov_b32 s14, 0x701000
 s_mov_b32 s15, 0x20000
 s_bfm_b64 exec, 16, 0
 buffer_load_dword a191, v246, s[28:31], s95 offen
 s_add_u32 s62, s62, 4096
 s_add_u32 s63, s63, 4096
 buffer_load_dword a191, v253, s[8:11], s62 offen
 buffer_load_dword a191, v252, s[12:15], s63 offen
 s_mov_b64 exec, -1
L_p0_a:
 s_and_b32 s56, s2, 31
 s_lshr_b32 s57, s2, 5
 s_lshl_b32 s58, s57, 2
 s_add_u32 s58, s58, s3
 s_mov_b32 s16, s88
 s_mov_b32 s17, s89
 s_mov_b32 s18, 0x10000000
 s_mov_b32 s19, 0x20000
 s_mul_i32 s4, s58, 1152
 s_add_u32 s4, s4, 58851328
 v_lshl_add_u32 v3, v1, 5, s4
 s_lshr_b32 s4, s2, 3
 s_mul_i32 s4, s4, 1152
 s_and_b32 s5, s90, 31
 s_lshl_b32 s5, s5, 5
 s_add_u32 s4, s4, s5
 s_add_u32 s4, s4, 58851328
 v_mov_b32 v4, s4
 v_cmp_gt_u32 vcc, 32, v1
 s_nop 1
 v_cndmask_b32 v3, v4, v3, vcc
 buffer_load_dword v2, v3, s[16:19], 0 offen sc0 sc1
 s_xor_b32 s60, s56, 2
 s_lshr_b32 s59, s60, 1
 s_and_b32 s60, s60, 1
 s_mul_i32 s4, s59, 448
 s_mul_i32 s92, s60, 192
 s_add_u32 s92, s92, s4
 s_lshl_b32 s93, s60, 4
 s_add_u32 s93, s93, s4
 s_add_u32 s93, s93, 384
 v_lshrrev_b32 v10, 5, v1
 v_lshlrev_b32 v10, 4, v10
 v_bfe_u32 v9, v1, 4, 1
 v_lshl_add_u32 v10, v9, 2, v10
 s_lshr_b32 s4, s3, 1
 s_lshl_b32 s4, s4, 3
 s_and_b32 s5, s3, 1
 s_lshl_b32 s5, s5, 1
 s_add_u32 s4, s4, s5
 v_add_u32 v10, s4, v10
 v_and_b32 v12, 15, v1
 v_lshlrev_b32 v4, 13, v10
 v_lshl_add_u32 v4, v12, 4, v4
 s_lshl_b32 s4, s56, 8
 s_add_u32 s4, s4, 4096
 v_add_u32 v4, s4, v4
 v_add_u32 v5, 7136, v4
 v_mul_u32_u24 v6, 7168, v10
 v_lshl_add_u32 v6, v12, 4, v6
 s_sub_u32 s5, s93, 384
 v_mov_b32 v8, s92
 v_lshl_add_u32 v9, v12, 4, s5
 v_cmp_gt_u32 vcc, 12, v12
 s_nop 1
 v_cndmask_b32 v8, v9, v8, vcc
 v_mov_b32 v9, 0x80000000
 v_cmp_gt_u32 vcc, 14, v12
 s_nop 1
 v_cndmask_b32 v8, v9, v8, vcc
 v_add_u32 v6, v6, v8
 v_add_u32 v6, 2016, v6
 v_add_u32 v7, 6112, v6
 s_mul_i32 s61, s3, 4160
 s_lshl_b32 s71, s58, 17
 v_lshrrev_b32 v13, 4, v1
 v_and_b32 v8, 7, v1
 v_xor_b32 v13, v13, v8
 v_lshlrev_b32 v13, 4, v13
 v_lshrrev_b32 v8, 3, v1
 v_lshl_add_u32 v13, v8, 11, v13
 s_lshr_b32 s4, s90, 2
 s_lshl_b32 s4, s4, 1
 s_and_b32 s6, s3, 1
 s_add_u32 s4, s4, s6
 s_bfe_u32 s5, s2, 0x20003
 s_lshr_b32 s6, s2, 7
 s_lshl_b32 s6, s6, 6
 s_add_u32 s6, s6, s4
 s_lshl_b32 s95, s6, 15
 s_lshl_b32 s4, s4, 2
 s_add_u32 s4, s4, s5
 s_lshl_b32 s100, s4, 11
 s_mul_i32 s101, s4, 1792
 s_lshl_b32 s4, s90, 2
 s_add_u32 s4, s4, s5
 s_lshl_b32 s62, s4, 11
 s_add_u32 s62, s62, 2625536
 s_mul_i32 s63, s4, 1792
 s_add_u32 s63, s63, 2297856
 v_lshlrev_b32 v245, 7, v1
 v_and_b32 v246, 15, v1
 v_lshlrev_b32 v246, 11, v246
 v_lshrrev_b32 v12, 4, v1
 v_lshl_add_u32 v246, v12, 7, v246
 s_and_b32 s4, s3, 1
 s_lshl_b32 s5, s2, 1
 s_add_u32 s5, s5, s4
 s_lshr_b32 s6, s5, 7
 s_lshr_b32 s7, s5, 3
 s_and_b32 s7, s7, 15
 s_and_b32 s5, s5, 7
 s_lshl_b32 s90, s6, 19
 s_lshl_b32 s4, s7, 13
 s_add_u32 s90, s90, s4
 s_add_u32 s90, s90, 393216
 s_mul_i32 s91, s6, 278528
 s_lshl_b32 s4, s7, 14
 s_add_u32 s91, s91, s4
 s_lshl_b32 s4, s5, 10
 s_add_u32 s91, s91, s4
 s_add_u32 s91, s91, 4194304
 v_lshrrev_b32 v12, 4, v1
 s_cmp_lt_u32 s3, 2
 s_cbranch_scc1 L_p0_v
 s_mov_b32 s24, s66
 s_mov_b32 s25, s67
 s_mov_b32 s26, 0x200000
 s_mov_b32 s27, 0x20000
 v_bfe_u32 v11, v1, 2, 2
 v_and_b32 v242, 3, v1
 v_lshl_add_u32 v242, v11, 3, v242
 v_lshlrev_b32 v242, 8, v242
 v_lshl_add_u32 v242, v12, 3, v242
 s_and_b32 s4, s5, 3
 s_lshl_b32 s4, s4, 6
 s_add_u32 s90, s90, s4
 s_lshr_b32 s4, s5, 2
 s_lshl_b32 s4, s4, 10
 s_add_u32 s90, s90, s4
 v_accvgpr_write_b32 a196, 0
 v_accvgpr_write_b32 a197, 0
 v_accvgpr_write_b32 a198, 0
 v_accvgpr_write_b32 a199, 0
 s_branch L_p0_kvd
L_p0_v:
 s_mov_b32 s24, s68
 s_mov_b32 s25, s69
 s_mov_b32 s26, 0x200000
 s_mov_b32 s27, 0x20000
 v_and_b32 v242, 15, v1
 v_lshlrev_b32 v242, 1, v242
 v_lshl_add_u32 v242, v12, 11, v242
 s_lshl_b32 s4, s5, 5
 s_add_u32 s90, s90, s4
 s_add_u32 s91, s91, 24576
L_p0_kvd:
 s_mov_b32 s20, s78
 s_mov_b32 s21, s79
 s_mov_b32 s22, 0x1c00
 s_mov_b32 s23, 0x20000
 s_mov_b32 s32, s84
 s_mov_b32 s33, s85
 s_mov_b32 s34, 0x400000
 s_mov_b32 s35, 0x20000
 s_mov_b32 s36, s86
 s_mov_b32 s37, s87
 s_mov_b32 s38, 0x100
 s_mov_b32 s39, 0x20000
 s_mov_b32 s44, s72
 s_mov_b32 s45, s73
 s_mov_b32 s46, 0x800000
 s_mov_b32 s47, 0x20000
 s_mov_b32 s48, s80
 s_mov_b32 s49, s81
 s_mov_b32 s50, 0x700000
 s_mov_b32 s51, 0x20000
 s_mov_b32 s52, s82
 s_mov_b32 s53, s83
 s_mov_b32 s54, 0x800
 s_mov_b32 s55, 0x20000
 s_lshr_b32 s4, s56, 3
 s_mul_i32 s4, s4, 278528
 s_add_u32 s4, s4, 4194304
 s_add_u32 s88, s88, s4
 s_addc_u32 s89, s89, 0
 s_mov_b32 s40, s88
 s_mov_b32 s41, s89
 s_mov_b32 s42, 0x44000
 s_mov_b32 s43, 0x20000
 s_lshl_b32 s67, s3, 12
 s_add_u32 s4, s57, s56
 s_and_b32 s4, s4, 3
 s_cmp_eq_u32 s4, 0
 s_cselect_b32 s72, 4, 0
 s_cmp_eq_u32 s4, 1
 s_cselect_b32 s73, 4, 0
 s_cmp_eq_u32 s4, 2
 s_cselect_b32 s74, 4, 0
 s_cmp_eq_u32 s4, 3
 s_cselect_b32 s75, 4, 0
 s_lshl_b32 s4, s3, 5
 s_add_u32 s92, s92, s4
 s_add_u32 s4, s92, 128
 s_cmp_lt_u32 s3, 2
 s_cselect_b32 s93, s4, s93
 v_and_b32 v12, 15, v1
 v_lshlrev_b32 v248, 1, v12
 s_cselect_b32 s4, 0, 8
 v_and_b32 v240, s4, v12
 v_lshl_add_u32 v240, v240, 1, v248
 v_lshrrev_b32 v8, 4, v1
 v_bfe_u32 v9, v1, 1, 2
 v_xor_b32 v8, v8, v9
 v_lshlrev_b32 v15, 4, v8
 v_and_b32_e64 v8, 7, v1
 v_lshl_add_u32 v15, v8, 7, v15
 v_bfe_u32 v9, v1, 3, 1
 v_mul_u32_u24 v9, 2112, v9
 s_add_u32 s4, s61, 84480
 v_add3_u32 v15, v15, v9, s4
 v_mul_u32_u24 v241, 144, v244
 v_and_b32 v9, 7, v243
 v_lshl_add_u32 v241, v9, 4, v241
 v_add_u32 v241, 67584, v241
 v_lshrrev_b32 v9, 3, v1
 v_lshl_add_u32 v9, s3, 3, v9
 v_mul_u32_u24 v247, 144, v9
 v_lshl_add_u32 v247, v8, 4, v247
 v_add_u32 v247, 67584, v247
 v_lshlrev_b32 v11, 4, v8
 v_bfe_u32 v9, v1, 3, 2
 v_lshl_add_u32 v11, v9, 8, v11
 v_lshrrev_b32 v9, 5, v1
 v_lshl_add_u32 v11, v9, 12, v11
 s_lshr_b32 s84, s2, 3
 s_lshl_b32 s84, s84, 17
 s_bfe_u32 s4, s2, 0x20001
 s_lshl_b32 s4, s4, 10
 s_add_u32 s84, s84, s4
 s_and_b32 s4, s2, 1
 s_lshl_b32 s4, s4, 7
 s_add_u32 s84, s84, s4
 s_lshl_b32 s4, s3, 13
 s_add_u32 s84, s84, s4
 v_bfe_u32 v9, v1, 3, 2
 v_mul_u32_u24 v9, 4160, v9
 v_bfe_u32 v10, v1, 2, 1
 v_mul_u32_u24 v10, 1056, v10
 v_add_u32 v9, v9, v10
 v_lshrrev_b32 v10, 5, v1
 v_lshl_add_u32 v9, v10, 9, v9
 v_and_b32 v10, 3, v1
 v_lshl_add_u32 v9, v10, 3, v9
 v_add_u32 v10, 67584, v9
 v_lshl_add_u32 v14, s3, 5, v9
 v_lshlrev_b32 v8, 4, v1
 s_bfe_u32 s4, s2, 0x20003
 s_lshl_b32 s4, s4, 3
 s_add_u32 s4, s4, s57
 s_lshl_b32 s4, s4, 3
 s_and_b32 s5, s2, 7
 s_add_u32 s4, s4, s5
 s_lshl_b32 s4, s4, 2
 s_add_u32 s4, s4, s3
 s_mul_i32 s88, s4, 7168
 s_lshl_b32 s89, s4, 13
 s_mul_i32 s4, s57, 4352
 s_lshl_b32 s5, s56, 7
 s_add_u32 s4, s4, s5
 s_lshl_b32 s5, s57, 3
 s_and_b32 s6, s2, 7
 s_add_u32 s5, s5, s6
 s_lshl_b32 s5, s5, 11
 s_bfe_u32 s6, s2, 0x20003
 s_lshl_b32 s6, s6, 7
 s_add_u32 s5, s5, s6
 s_add_u32 s5, s5, 392192
 s_add_u32 s6, s3, 2
 s_lshl_b32 s6, s6, 9
 s_add_u32 s5, s5, s6
 s_lshl_b32 s6, s3, 16
 s_add_u32 s4, s4, s6
 s_sub_u32 s4, s4, 128
 s_cmp_lt_u32 s3, 2
 s_cselect_b32 s4, s4, 0x80000000
 v_mov_b32 v250, s4
 v_mov_b32 v251, s5
 v_cmp_gt_u32 vcc, 32, v1
 s_nop 1
 v_cndmask_b32 v250, v250, v251, vcc
 v_lshl_add_u32 v250, v1, 2, v250
 v_mov_b32 v249, 0x80000000
 v_mov_b32 v251, 0
 s_mov_b32 s94, 0x03030303
 s_mov_b32 s85, 58720256
 v_lshlrev_b32_e64 v243, 4, v243
 v_cmp_eq_u32 vcc, 0, v244
 s_nop 1
 v_cndmask_b32 v243, v249, v243, vcc
 s_mov_b32 s86, 6291456
 v_mov_b32 v12, 0x3f803f80
 v_accvgpr_write_b32 a184, v12
 v_accvgpr_write_b32 a185, v12
 v_accvgpr_write_b32 a186, v12
 v_accvgpr_write_b32 a187, v12
 s_mov_b32 s69, 5
 s_add_u32 m0, s61, 0
 s_nop 0
 buffer_load_dwordx4 v4, s[8:11], 0 offen offset:0 lds
 buffer_load_dwordx4 v5, s[8:11], 0 offen offset:1056 lds
 buffer_load_dwordx4 v6, s[12:15], 0 offen offset:2080 lds
 buffer_load_dwordx4 v7, s[12:15], 0 offen offset:3136 lds
L_ic0s:
 s_cmp_eq_u32 s3, 0
 s_cbranch_scc1 L_ic0w0
 s_cmp_eq_u32 s3, 1
 s_cbranch_scc1 L_ic0w1
 s_cmp_eq_u32 s3, 2
 s_cbranch_scc1 L_ic0w2
 s_branch L_ic0w3
L_ic0r:
L_ic0w0:
L_ic0w1:
 s_waitcnt vmcnt(8)
 v_lshlrev_b32 v32, 16, v16
 v_and_b32 v33, 0xffff0000, v16
 s_add_u32 m0, s61, 118272
 s_add_u32 s4, s71, 0
 buffer_load_dwordx4 v13, s[28:31], s4 offen lds
 v_lshlrev_b32 v34, 16, v17
 v_and_b32 v35, 0xffff0000, v17
 v_lshlrev_b32 v36, 16, v18
 v_and_b32 v37, 0xffff0000, v18
 v_lshlrev_b32 v38, 16, v19
 s_add_u32 m0, s61, 120384
 s_add_u32 s4, s71, 16384
 buffer_load_dwordx4 v13, s[28:31], s4 offen lds
 v_and_b32 v39, 0xffff0000, v19
 v_lshlrev_b32 v40, 16, v20
 v_and_b32 v41, 0xffff0000, v20
 v_lshlrev_b32 v42, 16, v21
 v_and_b32 v43, 0xffff0000, v21
 s_add_u32 m0, s61, 119296
 s_add_u32 s4, s71, 32768
 buffer_load_dwordx4 v13, s[28:31], s4 offen lds
 v_lshlrev_b32 v44, 16, v22
 v_and_b32 v45, 0xffff0000, v22
 v_lshlrev_b32 v46, 16, v23
 v_and_b32 v47, 0xffff0000, v23
 v_lshlrev_b32 v48, 16, v24
 s_add_u32 m0, s61, 121408
 s_add_u32 s4, s71, 49152
 buffer_load_dwordx4 v13, s[28:31], s4 offen lds
 v_and_b32 v49, 0xffff0000, v24
 v_lshlrev_b32 v50, 16, v25
 v_and_b32 v51, 0xffff0000, v25
 v_lshlrev_b32 v52, 16, v26
 v_and_b32 v53, 0xffff0000, v26
 s_add_u32 m0, s61, 135168
 s_add_u32 s4, s71, 65536
 buffer_load_dwordx4 v13, s[28:31], s4 offen lds
 v_lshlrev_b32 v54, 16, v27
 v_and_b32 v55, 0xffff0000, v27
 v_lshlrev_b32 v56, 16, v28
 v_and_b32 v57, 0xffff0000, v28
 v_lshlrev_b32 v58, 16, v29
 s_add_u32 m0, s61, 137280
 s_add_u32 s4, s71, 81920
 buffer_load_dwordx4 v13, s[28:31], s4 offen lds
 v_and_b32 v59, 0xffff0000, v29
 v_lshlrev_b32 v60, 16, v30
 v_and_b32 v61, 0xffff0000, v30
 v_lshlrev_b32 v62, 16, v31
 v_and_b32 v63, 0xffff0000, v31
 s_add_u32 m0, s61, 136192
 s_add_u32 s4, s71, 98304
 buffer_load_dwordx4 v13, s[28:31], s4 offen lds
 v_pk_add_f32 v[64:65], v[32:33], v[34:35]
 v_pk_add_f32 v[66:67], v[36:37], v[38:39]
 v_pk_add_f32 v[64:65], v[64:65], v[40:41]
 v_pk_add_f32 v[66:67], v[66:67], v[42:43]
 v_pk_add_f32 v[64:65], v[64:65], v[44:45]
 s_add_u32 m0, s61, 138304
 s_add_u32 s4, s71, 114688
 buffer_load_dwordx4 v13, s[28:31], s4 offen lds
 v_pk_add_f32 v[66:67], v[66:67], v[46:47]
 v_pk_add_f32 v[64:65], v[64:65], v[48:49]
 v_pk_add_f32 v[66:67], v[66:67], v[50:51]
 v_pk_add_f32 v[64:65], v[64:65], v[52:53]
 v_pk_add_f32 v[66:67], v[66:67], v[54:55]
 s_mov_b32 s65, 262144
 s_mov_b32 s66, 229376
 s_add_u32 m0, s61, 16896
 s_nop 0
 buffer_load_dwordx4 v4, s[8:11], s65 offen offset:0 lds
 v_pk_add_f32 v[64:65], v[64:65], v[56:57]
 v_pk_add_f32 v[66:67], v[66:67], v[58:59]
 v_pk_add_f32 v[64:65], v[64:65], v[60:61]
 v_pk_add_f32 v[66:67], v[66:67], v[62:63]
 v_pk_add_f32 v[64:65], v[64:65], v[66:67]
 buffer_load_dwordx4 v5, s[8:11], s65 offen offset:1056 lds
 v_add_f32 v64, v64, v65
 s_nop 1
 v_add_f32_dpp v64, v64, v64 row_ror:8 row_mask:0xf bank_mask:0xf
 s_nop 1
 v_add_f32_dpp v64, v64, v64 row_ror:4 row_mask:0xf bank_mask:0xf
 s_nop 1
 v_add_f32_dpp v64, v64, v64 row_ror:2 row_mask:0xf bank_mask:0xf
 s_nop 1
 v_add_f32_dpp v64, v64, v64 row_ror:1 row_mask:0xf bank_mask:0xf
 buffer_load_dwordx4 v6, s[12:15], s66 offen offset:2080 lds
 v_mov_b32 v65, v64
 s_nop 1
 v_permlane16_swap_b32 v64, v65
 s_nop 1
 v_add_f32 v64, v64, v65
 v_mul_f32 v64, 0x3a800000, v64
 buffer_load_dwordx4 v7, s[12:15], s66 offen offset:3136 lds
 v_cvt_pk_bf16_f32 v65, v64, v64
 v_lshlrev_b32 v65, 16, v65
 v_pk_add_f32 v[72:73], v[40:41], v[64:65] op_sel:[0,1] op_sel_hi:[1,1] neg_lo:[0,1] neg_hi:[0,1]
 v_pk_add_f32 v[74:75], v[42:43], v[64:65] op_sel:[0,1] op_sel_hi:[1,1] neg_lo:[0,1] neg_hi:[0,1]
 v_cvt_pk_bf16_f32 v88, v72, v73
 s_add_u32 m0, s61, 84480
 s_add_u32 s4, s71, 128
 buffer_load_dwordx4 v13, s[28:31], s4 offen lds
 v_cvt_pk_bf16_f32 v89, v74, v75
 v_pk_add_f32 v[76:77], v[44:45], v[64:65] op_sel:[0,1] op_sel_hi:[1,1] neg_lo:[0,1] neg_hi:[0,1]
 v_pk_add_f32 v[78:79], v[46:47], v[64:65] op_sel:[0,1] op_sel_hi:[1,1] neg_lo:[0,1] neg_hi:[0,1]
 v_cvt_pk_bf16_f32 v90, v76, v77
 v_cvt_pk_bf16_f32 v91, v78, v79
 s_add_u32 m0, s61, 86592
 s_add_u32 s4, s71, 16512
 buffer_load_dwordx4 v13, s[28:31], s4 offen lds
 ds_write_b128 v241, v[88:91] offset:0
 v_pk_add_f32 v[72:73], v[48:49], v[64:65] op_sel:[0,1] op_sel_hi:[1,1] neg_lo:[0,1] neg_hi:[0,1]
 v_pk_add_f32 v[74:75], v[50:51], v[64:65] op_sel:[0,1] op_sel_hi:[1,1] neg_lo:[0,1] neg_hi:[0,1]
 v_cvt_pk_bf16_f32 v92, v72, v73
 v_cvt_pk_bf16_f32 v93, v74, v75
 s_add_u32 m0, s61, 85504
 s_add_u32 s4, s71, 32896
 buffer_load_dwordx4 v13, s[28:31], s4 offen lds
 v_pk_add_f32 v[76:77], v[52:53], v[64:65] op_sel:[0,1] op_sel_hi:[1,1] neg_lo:[0,1] neg_hi:[0,1]
 v_pk_add_f32 v[78:79], v[54:55], v[64:65] op_sel:[0,1] op_sel_hi:[1,1] neg_lo:[0,1] neg_hi:[0,1]
 v_cvt_pk_bf16_f32 v94, v76, v77
 v_cvt_pk_bf16_f32 v95, v78, v79
 ds_write_b128 v241, v[92:95] offset:4608
 s_add_u32 m0, s61, 87616
 s_add_u32 s4, s71, 49280
 buffer_load_dwordx4 v13, s[28:31], s4 offen lds
 v_pk_add_f32 v[72:73], v[56:57], v[64:65] op_sel:[0,1] op_sel_hi:[1,1] neg_lo:[0,1] neg_hi:[0,1]
 v_pk_add_f32 v[74:75], v[58:59], v[64:65] op_sel:[0,1] op_sel_hi:[1,1] neg_lo:[0,1] neg_hi:[0,1]
 v_cvt_pk_bf16_f32 v96, v72, v73
 v_cvt_pk_bf16_f32 v97, v74, v75
 v_pk_add_f32 v[76:77], v[60:61], v[64:65] op_sel:[0,1] op_sel_hi:[1,1] neg_lo:[0,1] neg_hi:[0,1]
 s_add_u32 m0, s61, 101376
 s_add_u32 s4, s71, 65664
 buffer_load_dwordx4 v13, s[28:31], s4 offen lds
 v_pk_add_f32 v[78:79], v[62:63], v[64:65] op_sel:[0,1] op_sel_hi:[1,1] neg_lo:[0,1] neg_hi:[0,1]
 v_cvt_pk_bf16_f32 v98, v76, v77
 v_cvt_pk_bf16_f32 v99, v78, v79
 ds_write_b128 v241, v[96:99] offset:9216
 v_pk_add_f32 v[32:33], v[32:33], v[64:65] op_sel_hi:[1,0] neg_lo:[0,1] neg_hi:[0,1]
 s_add_u32 m0, s61, 103488
 s_add_u32 s4, s71, 82048
 buffer_load_dwordx4 v13, s[28:31], s4 offen lds
 v_pk_add_f32 v[34:35], v[34:35], v[64:65] op_sel_hi:[1,0] neg_lo:[0,1] neg_hi:[0,1]
 v_pk_add_f32 v[36:37], v[36:37], v[64:65] op_sel_hi:[1,0] neg_lo:[0,1] neg_hi:[0,1]
 v_pk_add_f32 v[38:39], v[38:39], v[64:65] op_sel_hi:[1,0] neg_lo:[0,1] neg_hi:[0,1]
 v_pk_add_f32 v[40:41], v[40:41], v[64:65] op_sel_hi:[1,0] neg_lo:[0,1] neg_hi:[0,1]
 v_pk_add_f32 v[42:43], v[42:43], v[64:65] op_sel_hi:[1,0] neg_lo:[0,1] neg_hi:[0,1]
 s_add_u32 m0, s61, 102400
 s_add_u32 s4, s71, 98432
 buffer_load_dwordx4 v13, s[28:31], s4 offen lds
 v_pk_add_f32 v[44:45], v[44:45], v[64:65] op_sel_hi:[1,0] neg_lo:[0,1] neg_hi:[0,1]
 v_pk_add_f32 v[46:47], v[46:47], v[64:65] op_sel_hi:[1,0] neg_lo:[0,1] neg_hi:[0,1]
 v_pk_add_f32 v[48:49], v[48:49], v[64:65] op_sel_hi:[1,0] neg_lo:[0,1] neg_hi:[0,1]
 v_pk_add_f32 v[50:51], v[50:51], v[64:65] op_sel_hi:[1,0] neg_lo:[0,1] neg_hi:[0,1]
 v_pk_add_f32 v[52:53], v[52:53], v[64:65] op_sel_hi:[1,0] neg_lo:[0,1] neg_hi:[0,1]
 s_add_u32 m0, s61, 104512
 s_add_u32 s4, s71, 114816
 buffer_load_dwordx4 v13, s[28:31], s4 offen lds
 v_pk_add_f32 v[54:55], v[54:55], v[64:65] op_sel_hi:[1,0] neg_lo:[0,1] neg_hi:[0,1]
 v_pk_add_f32 v[56:57], v[56:57], v[64:65] op_sel_hi:[1,0] neg_lo:[0,1] neg_hi:[0,1]
 v_pk_add_f32 v[58:59], v[58:59], v[64:65] op_sel_hi:[1,0] neg_lo:[0,1] neg_hi:[0,1]
 v_pk_add_f32 v[60:61], v[60:61], v[64:65] op_sel_hi:[1,0] neg_lo:[0,1] neg_hi:[0,1]
 v_pk_add_f32 v[62:63], v[62:63], v[64:65] op_sel_hi:[1,0] neg_lo:[0,1] neg_hi:[0,1]
 s_mov_b32 s65, 524288
 s_mov_b32 s66, 458752
 s_add_u32 m0, s61, 33792
 s_nop 0
 s_nop 0
 buffer_load_dwordx4 v4, s[8:11], s65 offen offset:0 lds
 v_pk_mul_f32 v[68:69], v[32:33], v[32:33]
 v_pk_mul_f32 v[70:71], v[34:35], v[34:35]
 v_pk_fma_f32 v[68:69], v[36:37], v[36:37], v[68:69]
 v_pk_fma_f32 v[70:71], v[38:39], v[38:39], v[70:71]
 v_pk_fma_f32 v[68:69], v[40:41], v[40:41], v[68:69]
 buffer_load_dwordx4 v5, s[8:11], s65 offen offset:1056 lds
 v_pk_fma_f32 v[70:71], v[42:43], v[42:43], v[70:71]
 v_pk_fma_f32 v[68:69], v[44:45], v[44:45], v[68:69]
 v_pk_fma_f32 v[70:71], v[46:47], v[46:47], v[70:71]
 v_pk_fma_f32 v[68:69], v[48:49], v[48:49], v[68:69]
 v_pk_fma_f32 v[70:71], v[50:51], v[50:51], v[70:71]
 buffer_load_dwordx4 v6, s[12:15], s66 offen offset:2080 lds
 v_pk_fma_f32 v[68:69], v[52:53], v[52:53], v[68:69]
 v_pk_fma_f32 v[70:71], v[54:55], v[54:55], v[70:71]
 v_pk_fma_f32 v[68:69], v[56:57], v[56:57], v[68:69]
 v_pk_fma_f32 v[70:71], v[58:59], v[58:59], v[70:71]
 v_pk_fma_f32 v[68:69], v[60:61], v[60:61], v[68:69]
 buffer_load_dwordx4 v7, s[12:15], s66 offen offset:3136 lds
 v_pk_fma_f32 v[70:71], v[62:63], v[62:63], v[70:71]
 v_pk_add_f32 v[68:69], v[68:69], v[70:71]
 v_add_f32 v68, v68, v69
 s_nop 1
 v_add_f32_dpp v68, v68, v68 row_ror:8 row_mask:0xf bank_mask:0xf
 s_nop 1
 v_add_f32_dpp v68, v68, v68 row_ror:4 row_mask:0xf bank_mask:0xf
 s_nop 1
 v_add_f32_dpp v68, v68, v68 row_ror:2 row_mask:0xf bank_mask:0xf
 s_nop 1
 v_add_f32_dpp v68, v68, v68 row_ror:1 row_mask:0xf bank_mask:0xf
 v_mov_b32 v69, v68
 s_nop 1
 v_permlane16_swap_b32 v68, v69
 s_nop 1
 v_add_f32 v68, v68, v69
 v_mul_f32 v68, 0x3a800000, v68
 v_cvt_pk_bf16_f32 v68, v68, v68
 v_lshlrev_b32 v68, 16, v68
 v_add_f32 v68, 0x3727c5ac, v68
 v_cvt_pk_bf16_f32 v68, v68, v68
 v_lshlrev_b32 v68, 16, v68
 v_sqrt_f32 v68, v68
 s_nop 0
 v_cvt_pk_bf16_f32 v68, v68, v68
 v_lshlrev_b32 v68, 16, v68
 v_rcp_f32_e64 v255, v68
 v_cvt_pk_bf16_f32 v252, -v65, -v65
 v_cvt_pk_bf16_f32 v253, -v65, v68
 v_mul_f32 v254, 0x3e0293ee, v255
 s_waitcnt vmcnt(16)
 ds_read_b128 a[0:3], v15 offset:33792
 ds_read_b128 a[16:19], v15 offset:33856
 ds_read_b128 a[4:7], v15 offset:34816
 ds_read_b128 a[20:23], v15 offset:34880
 ds_read_b128 a[8:11], v15 offset:50688
 ds_read_b128 a[24:27], v15 offset:50752
 ds_read_b128 a[12:15], v15 offset:51712
 ds_read_b128 a[28:31], v15 offset:51776
 s_waitcnt lgkmcnt(8)
 s_barrier
 ds_read_b64_tr_b16 a[160:161], v9 offset:0
 ds_read_b64_tr_b16 a[162:163], v9 offset:256
 ds_read_b64_tr_b16 a[164:165], v9 offset:32
 ds_read_b64_tr_b16 a[166:167], v9 offset:288
 ds_read_b64_tr_b16 a[168:169], v9 offset:64
 ds_read_b64_tr_b16 a[170:171], v9 offset:320
 ds_read_b64_tr_b16 a[172:173], v9 offset:96
 ds_read_b64_tr_b16 a[174:175], v9 offset:352
 ds_read_b128 a[200:203], v247 offset:0
 ds_read_b128 a[204:207], v247 offset:4608
 ds_read_b128 a[208:211], v247 offset:9216
 s_waitcnt vmcnt(63) lgkmcnt(9)
 v_mfma_f32_16x16x32_bf16 v[16:19], a[160:163], a[0:3], 0
 ds_read_b64_tr_b16 a[176:177], v9 offset:128
 v_mfma_f32_16x16x32_bf16 v[20:23], a[160:163], a[4:7], 0
 ds_read_b64_tr_b16 a[178:179], v9 offset:384
 v_mfma_f32_16x16x32_bf16 v[80:83], a[160:163], a[8:11], 0
 v_mfma_f32_16x16x32_bf16 v[84:87], a[160:163], a[12:15], 0
 ds_read_b64_tr_b16 a[144:145], v14 offset:0
 s_waitcnt lgkmcnt(10)
 v_mfma_f32_16x16x32_bf16 v[24:27], a[164:167], a[0:3], 0
 ds_read_b64_tr_b16 a[180:181], v9 offset:160
 v_mfma_f32_16x16x32_bf16 v[28:31], a[164:167], a[4:7], 0
 ds_read_b64_tr_b16 a[182:183], v9 offset:416
 s_mov_b32 s65, 786432
 s_mov_b32 s66, 688128
 s_add_u32 m0, s61, 50688
 v_mfma_f32_16x16x32_bf16 v[88:91], a[164:167], a[8:11], 0
 buffer_load_dwordx4 v4, s[8:11], s65 offen offset:0 lds
 v_mfma_f32_16x16x32_bf16 v[92:95], a[164:167], a[12:15], 0
 ds_read_b64_tr_b16 a[146:147], v14 offset:256
 s_waitcnt lgkmcnt(11)
 v_mfma_f32_16x16x32_bf16 v[32:35], a[168:171], a[0:3], 0
 ds_read_b64_tr_b16 a[160:161], v9 offset:192
 v_mfma_f32_16x16x32_bf16 v[36:39], a[168:171], a[4:7], 0
 ds_read_b64_tr_b16 a[162:163], v9 offset:448
 v_mfma_f32_16x16x32_bf16 v[96:99], a[168:171], a[8:11], 0
 s_branch L_pg1k
L_pg1:
L_ic0w3:
 s_branch L_ic0r
L_pg1k:
 buffer_load_dwordx4 v5, s[8:11], s65 offen offset:1056 lds
 v_mfma_f32_16x16x32_bf16 v[100:103], a[168:171], a[12:15], 0
 ds_read_b64_tr_b16 a[148:149], v14 offset:128
 s_add_u32 s69, s69, 1
 s_waitcnt lgkmcnt(12)
 v_mfma_f32_16x16x32_bf16 v[40:43], a[172:175], a[0:3], 0
 ds_read_b64_tr_b16 a[164:165], v9 offset:224
 v_mfma_f32_16x16x32_bf16 v[44:47], a[172:175], a[4:7], 0
 ds_read_b64_tr_b16 a[166:167], v9 offset:480
 v_mfma_f32_16x16x32_bf16 v[104:107], a[172:175], a[8:11], 0
 buffer_load_dwordx4 v6, s[12:15], s66 offen offset:2080 lds
 v_mfma_f32_16x16x32_bf16 v[108:111], a[172:175], a[12:15], 0
 ds_read_b64_tr_b16 a[150:151], v14 offset:384
 s_waitcnt lgkmcnt(10)
 v_mfma_f32_16x16x32_bf16 v[48:51], a[176:179], a[0:3], 0
 ds_read_b64_tr_b16 a[168:169], v9 offset:2080
 v_mfma_f32_16x16x32_bf16 v[52:55], a[176:179], a[4:7], 0
 ds_read_b64_tr_b16 a[170:171], v9 offset:2336
 v_mfma_f32_16x16x32_bf16 v[112:115], a[176:179], a[8:11], 0
 buffer_load_dwordx4 v7, s[12:15], s66 offen offset:3136 lds
 v_mfma_f32_16x16x32_bf16 v[116:119], a[176:179], a[12:15], 0
 ds_read_b64_tr_b16 a[152:153], v14 offset:2080
 s_waitcnt lgkmcnt(10)
 v_mfma_f32_16x16x32_bf16 v[56:59], a[180:183], a[0:3], 0
 ds_read_b64_tr_b16 a[172:173], v9 offset:2112
 v_mfma_f32_16x16x32_bf16 v[60:63], a[180:183], a[4:7], 0
 ds_read_b64_tr_b16 a[174:175], v9 offset:2368
 s_waitcnt lgkmcnt(15)
 v_mfma_f32_16x16x32_bf16 v[120:123], a[180:183], a[8:11], 0
 s_add_u32 s84, s84, 32768
 buffer_store_dwordx4 a[200:203], v11, s[16:19], s84 offen sc0 sc1
 v_mfma_f32_16x16x32_bf16 v[124:127], a[180:183], a[12:15], 0
 ds_read_b64_tr_b16 a[154:155], v14 offset:2336
 s_waitcnt lgkmcnt(10)
 v_mfma_f32_16x16x32_bf16 v[64:67], a[160:163], a[0:3], 0
 ds_read_b64_tr_b16 a[176:177], v9 offset:2144
 v_mfma_f32_16x16x32_bf16 v[68:71], a[160:163], a[4:7], 0
 ds_read_b64_tr_b16 a[178:179], v9 offset:2400
 v_mfma_f32_16x16x32_bf16 v[128:131], a[160:163], a[8:11], 0
 s_add_u32 s84, s84, 32768
 buffer_store_dwordx4 a[204:207], v11, s[16:19], s84 offen sc0 sc1
 v_mfma_f32_16x16x32_bf16 v[132:135], a[160:163], a[12:15], 0
 ds_read_b64_tr_b16 a[156:157], v14 offset:2208
 s_waitcnt lgkmcnt(10)
 v_mfma_f32_16x16x32_bf16 v[72:75], a[164:167], a[0:3], 0
 ds_read_b64_tr_b16 a[180:181], v9 offset:2176
 v_mfma_f32_16x16x32_bf16 v[76:79], a[164:167], a[4:7], 0
 ds_read_b64_tr_b16 a[182:183], v9 offset:2432
 v_mfma_f32_16x16x32_bf16 v[136:139], a[164:167], a[8:11], 0
 s_add_u32 s84, s84, 32768
 buffer_store_dwordx4 a[208:211], v11, s[16:19], s84 offen sc0 sc1
 v_mfma_f32_16x16x32_bf16 v[140:143], a[164:167], a[12:15], 0
 ds_read_b64_tr_b16 a[158:159], v14 offset:2464
 s_waitcnt lgkmcnt(10)
 v_mfma_f32_16x16x32_bf16 v[144:147], a[168:171], a[0:3], 0
 ds_read_b64_tr_b16 a[160:161], v9 offset:2208
 v_mfma_f32_16x16x32_bf16 v[148:151], a[168:171], a[4:7], 0
 ds_read_b64_tr_b16 a[162:163], v9 offset:2464
 v_mfma_f32_16x16x32_bf16 v[152:155], a[168:171], a[8:11], 0
 buffer_store_dwordx4 v[252:255], v243, s[16:19], s86 offen sc0 sc1
 buffer_store_dword v251, v250, s[16:19], s85 offen sc0 sc1
 v_mfma_f32_16x16x32_bf16 v[156:159], a[168:171], a[12:15], 0
 s_waitcnt lgkmcnt(9)
 v_mfma_f32_16x16x32_bf16 v[160:163], a[172:175], a[0:3], 0
 ds_read_b64_tr_b16 a[164:165], v9 offset:2240
 v_mfma_f32_16x16x32_bf16 v[164:167], a[172:175], a[4:7], 0
 ds_read_b64_tr_b16 a[166:167], v9 offset:2496
 v_mfma_f32_16x16x32_bf16 v[168:171], a[172:175], a[8:11], 0
 buffer_load_ushort a188, v248, s[20:23], s92 offen
 buffer_load_ushort a189, v240, s[20:23], s93 offen
 s_cmp_lt_u32 s3, 2
 s_cbranch_scc1 L_kv_v
 s_bfm_b64 exec, 32, 0
 buffer_load_dword a191, v246, s[28:31], s95 offen offset:256
 s_bfm_b64 exec, 16, 0
 s_add_u32 s4, s100, 1052672
 s_add_u32 s5, s101, 921600
 buffer_load_dword a191, v245, s[8:11], s4 offen
 buffer_load_dword a191, v245, s[12:15], s5 offen
 s_add_u32 s4, s100, 1576960
 s_add_u32 s5, s101, 1380352
 buffer_load_dword a191, v245, s[8:11], s4 offen
 buffer_load_dword a191, v245, s[12:15], s5 offen
 s_add_u32 s4, s100, 2101248
 s_add_u32 s5, s101, 1839104
 buffer_load_dword a191, v245, s[8:11], s4 offen
 buffer_load_dword a191, v245, s[12:15], s5 offen
 s_mov_b64 exec, -1
 buffer_load_dwordx2 a[192:193], v242, s[24:27], s90 offen
 buffer_load_dwordx2 a[194:195], v242, s[24:27], s90 offen offset:32
 s_branch L_kv_d
L_kv_v:
 buffer_load_ushort a192, v242, s[24:27], s90 offen offset:0
 buffer_load_ushort a196, v242, s[24:27], s90 offen offset:256
 buffer_load_ushort a193, v242, s[24:27], s90 offen offset:512
 buffer_load_ushort a197, v242, s[24:27], s90 offen offset:768
 buffer_load_ushort a194, v242, s[24:27], s90 offen offset:1024
 buffer_load_ushort a198, v242, s[24:27], s90 offen offset:1280
 buffer_load_ushort a195, v242, s[24:27], s90 offen offset:1536
 buffer_load_ushort a199, v242, s[24:27], s90 offen offset:1792
L_kv_d:
 v_mfma_f32_16x16x32_bf16 v[172:175], a[172:175], a[12:15], 0
 s_waitcnt lgkmcnt(8)
 v_mfma_f32_16x16x32_bf16 v[176:179], a[176:179], a[0:3], 0
 ds_read_b64_tr_b16 a[168:169], v9 offset:2272
 v_mfma_f32_16x16x32_bf16 v[180:183], a[176:179], a[4:7], 0
 ds_read_b64_tr_b16 a[170:171], v9 offset:2528
 v_mfma_f32_16x16x32_bf16 v[184:187], a[176:179], a[8:11], 0
 s_waitcnt vmcnt(31)
 v_mfma_f32_16x16x32_bf16 v[188:191], a[176:179], a[12:15], 0
 s_barrier
 s_waitcnt lgkmcnt(7)
 v_mfma_f32_16x16x32_bf16 v[192:195], a[180:183], a[0:3], 0
 ds_read_b64_tr_b16 a[172:173], v9 offset:16896
 v_mfma_f32_16x16x32_bf16 v[196:199], a[180:183], a[4:7], 0
 ds_read_b64_tr_b16 a[174:175], v9 offset:17152
 v_mfma_f32_16x16x32_bf16 v[200:203], a[180:183], a[8:11], 0
 v_mfma_f32_16x16x32_bf16 v[204:207], a[180:183], a[12:15], 0
 s_waitcnt lgkmcnt(6)
 v_mfma_f32_16x16x32_bf16 v[208:211], a[160:163], a[0:3], 0
 ds_read_b64_tr_b16 a[176:177], v9 offset:16928
 v_mfma_f32_16x16x32_bf16 v[212:215], a[160:163], a[4:7], 0
 ds_read_b64_tr_b16 a[178:179], v9 offset:17184
 v_mfma_f32_16x16x32_bf16 v[216:219], a[160:163], a[8:11], 0
 v_mfma_f32_16x16x32_bf16 v[220:223], a[160:163], a[12:15], 0
 s_waitcnt lgkmcnt(6)
 v_mfma_f32_16x16x32_bf16 v[224:227], a[164:167], a[0:3], 0
 ds_read_b64_tr_b16 a[180:181], v9 offset:16960
 v_mfma_f32_16x16x32_bf16 v[228:231], a[164:167], a[4:7], 0
 ds_read_b64_tr_b16 a[182:183], v9 offset:17216
 v_mfma_f32_16x16x32_bf16 v[232:235], a[164:167], a[8:11], 0
 v_mfma_f32_16x16x32_bf16 v[236:239], a[164:167], a[12:15], 0
 s_waitcnt lgkmcnt(6)
 v_mfma_f32_16x16x32_bf16 v[240:243], a[168:171], a[0:3], 0
 ds_read_b64_tr_b16 a[160:161], v9 offset:16992
 v_mfma_f32_16x16x32_bf16 v[244:247], a[168:171], a[4:7], 0
 ds_read_b64_tr_b16 a[162:163], v9 offset:17248
 v_mfma_f32_16x16x32_bf16 v[248:251], a[168:171], a[8:11], 0
 v_mfma_f32_16x16x32_bf16 v[252:255], a[168:171], a[12:15], 0
 s_waitcnt lgkmcnt(15)
 v_mfma_f32_16x16x32_bf16 a[128:131], a[184:187], a[144:147], 0
 s_waitcnt lgkmcnt(15)
 v_mfma_f32_16x16x32_bf16 a[132:135], a[184:187], a[148:151], 0
 s_waitcnt lgkmcnt(15)
 v_mfma_f32_16x16x32_bf16 a[136:139], a[184:187], a[152:155], 0
 s_waitcnt lgkmcnt(14)
 v_mfma_f32_16x16x32_bf16 a[140:143], a[184:187], a[156:159], 0
 s_waitcnt vmcnt(63) lgkmcnt(6)
 v_mfma_f32_16x16x32_bf16 v[16:19], a[172:175], a[16:19], v[16:19]
 ds_read_b64_tr_b16 a[164:165], v9 offset:17024
 v_mfma_f32_16x16x32_bf16 v[20:23], a[172:175], a[20:23], v[20:23]
 ds_read_b64_tr_b16 a[166:167], v9 offset:17280
 v_mfma_f32_16x16x32_bf16 v[80:83], a[172:175], a[24:27], v[80:83]
 v_mfma_f32_16x16x32_bf16 v[84:87], a[172:175], a[28:31], v[84:87]
 s_waitcnt vmcnt(29)
 ds_read_b128 a[32:35], v15 offset:0
 s_waitcnt lgkmcnt(7)
 v_mfma_f32_16x16x32_bf16 v[24:27], a[176:179], a[16:19], v[24:27]
 ds_read_b64_tr_b16 a[168:169], v9 offset:17056
 v_mfma_f32_16x16x32_bf16 v[28:31], a[176:179], a[20:23], v[28:31]
 ds_read_b64_tr_b16 a[170:171], v9 offset:17312
 v_mfma_f32_16x16x32_bf16 v[88:91], a[176:179], a[24:27], v[88:91]
 v_mfma_f32_16x16x32_bf16 v[92:95], a[176:179], a[28:31], v[92:95]
 ds_read_b128 a[48:51], v15 offset:64
 s_waitcnt lgkmcnt(8)
 v_mfma_f32_16x16x32_bf16 v[32:35], a[180:183], a[16:19], v[32:35]
 ds_read_b64_tr_b16 a[172:173], v9 offset:17088
 v_mfma_f32_16x16x32_bf16 v[36:39], a[180:183], a[20:23], v[36:39]
 ds_read_b64_tr_b16 a[174:175], v9 offset:17344
 v_mfma_f32_16x16x32_bf16 v[96:99], a[180:183], a[24:27], v[96:99]
 v_mfma_f32_16x16x32_bf16 v[100:103], a[180:183], a[28:31], v[100:103]
 s_waitcnt vmcnt(27)
 ds_read_b128 a[36:39], v15 offset:1024
 s_add_u32 s69, s69, 1
 s_waitcnt lgkmcnt(9)
 v_mfma_f32_16x16x32_bf16 v[40:43], a[160:163], a[16:19], v[40:43]
 ds_read_b64_tr_b16 a[176:177], v9 offset:17120
 v_mfma_f32_16x16x32_bf16 v[44:47], a[160:163], a[20:23], v[44:47]
 ds_read_b64_tr_b16 a[178:179], v9 offset:17376
 v_mfma_f32_16x16x32_bf16 v[104:107], a[160:163], a[24:27], v[104:107]
 v_mfma_f32_16x16x32_bf16 v[108:111], a[160:163], a[28:31], v[108:111]
 ds_read_b128 a[52:55], v15 offset:1088
 s_waitcnt lgkmcnt(10)
 v_mfma_f32_16x16x32_bf16 v[48:51], a[164:167], a[16:19], v[48:51]
 ds_read_b64_tr_b16 a[180:181], v9 offset:18976
 v_mfma_f32_16x16x32_bf16 v[52:55], a[164:167], a[20:23], v[52:55]
 ds_read_b64_tr_b16 a[182:183], v9 offset:19232
 v_mfma_f32_16x16x32_bf16 v[112:115], a[164:167], a[24:27], v[112:115]
 v_mfma_f32_16x16x32_bf16 v[116:119], a[164:167], a[28:31], v[116:119]
 s_waitcnt vmcnt(25)
 ds_read_b128 a[40:43], v15 offset:16896
 s_waitcnt lgkmcnt(10)
 v_mfma_f32_16x16x32_bf16 v[56:59], a[168:171], a[16:19], v[56:59]
 ds_read_b64_tr_b16 a[160:161], v9 offset:19008
 v_mfma_f32_16x16x32_bf16 v[60:63], a[168:171], a[20:23], v[60:63]
 ds_read_b64_tr_b16 a[162:163], v9 offset:19264
 v_mfma_f32_16x16x32_bf16 v[120:123], a[168:171], a[24:27], v[120:123]
 v_mfma_f32_16x16x32_bf16 v[124:127], a[168:171], a[28:31], v[124:127]
 ds_read_b128 a[56:59], v15 offset:16960
 s_waitcnt lgkmcnt(10)
 v_mfma_f32_16x16x32_bf16 v[64:67], a[172:175], a[16:19], v[64:67]
 ds_read_b64_tr_b16 a[164:165], v9 offset:19040
 v_mfma_f32_16x16x32_bf16 v[68:71], a[172:175], a[20:23], v[68:71]
 ds_read_b64_tr_b16 a[166:167], v9 offset:19296
 v_mfma_f32_16x16x32_bf16 v[128:131], a[172:175], a[24:27], v[128:131]
 v_mfma_f32_16x16x32_bf16 v[132:135], a[172:175], a[28:31], v[132:135]
 s_waitcnt vmcnt(23)
 ds_read_b128 a[44:47], v15 offset:17920
 s_waitcnt lgkmcnt(10)
 v_mfma_f32_16x16x32_bf16 v[72:75], a[176:179], a[16:19], v[72:75]
 ds_read_b64_tr_b16 a[168:169], v9 offset:19072
 v_mfma_f32_16x16x32_bf16 v[76:79], a[176:179], a[20:23], v[76:79]
 ds_read_b64_tr_b16 a[170:171], v9 offset:19328
 v_mfma_f32_16x16x32_bf16 v[136:139], a[176:179], a[24:27], v[136:139]
 v_mfma_f32_16x16x32_bf16 v[140:143], a[176:179], a[28:31], v[140:143]
 ds_read_b128 a[60:63], v15 offset:17984
 s_waitcnt lgkmcnt(10)
 v_mfma_f32_16x16x32_bf16 v[144:147], a[180:183], a[16:19], v[144:147]
 ds_read_b64_tr_b16 a[172:173], v9 offset:19104
 v_mfma_f32_16x16x32_bf16 v[148:151], a[180:183], a[20:23], v[148:151]
 ds_read_b64_tr_b16 a[174:175], v9 offset:19360
 v_mfma_f32_16x16x32_bf16 v[152:155], a[180:183], a[24:27], v[152:155]
 v_mfma_f32_16x16x32_bf16 v[156:159], a[180:183], a[28:31], v[156:159]
 ds_read_b64_tr_b16 a[144:145], v14 offset:16896
 s_waitcnt lgkmcnt(10)
 v_mfma_f32_16x16x32_bf16 v[160:163], a[160:163], a[16:19], v[160:163]
 ds_read_b64_tr_b16 a[176:177], v9 offset:19136
 v_mfma_f32_16x16x32_bf16 v[164:167], a[160:163], a[20:23], v[164:167]
 ds_read_b64_tr_b16 a[178:179], v9 offset:19392
 v_mfma_f32_16x16x32_bf16 v[168:171], a[160:163], a[24:27], v[168:171]
 v_mfma_f32_16x16x32_bf16 v[172:175], a[160:163], a[28:31], v[172:175]
 ds_read_b64_tr_b16 a[146:147], v14 offset:17152
 s_waitcnt lgkmcnt(10)
 v_mfma_f32_16x16x32_bf16 v[176:179], a[164:167], a[16:19], v[176:179]
 ds_read_b64_tr_b16 a[180:181], v9 offset:19168
 v_mfma_f32_16x16x32_bf16 v[180:183], a[164:167], a[20:23], v[180:183]
 ds_read_b64_tr_b16 a[182:183], v9 offset:19424
 v_mfma_f32_16x16x32_bf16 v[184:187], a[164:167], a[24:27], v[184:187]
 s_waitcnt vmcnt(19)
 v_mfma_f32_16x16x32_bf16 v[188:191], a[164:167], a[28:31], v[188:191]
 s_barrier
 s_waitcnt lgkmcnt(9)
 v_mfma_f32_16x16x32_bf16 v[192:195], a[168:171], a[16:19], v[192:195]
 ds_read_b64_tr_b16 a[160:161], v9 offset:33792
 v_mfma_f32_16x16x32_bf16 v[196:199], a[168:171], a[20:23], v[196:199]
 ds_read_b64_tr_b16 a[162:163], v9 offset:34048
 v_mfma_f32_16x16x32_bf16 v[200:203], a[168:171], a[24:27], v[200:203]
 v_mfma_f32_16x16x32_bf16 v[204:207], a[168:171], a[28:31], v[204:207]
 ds_read_b64_tr_b16 a[148:149], v14 offset:17024
 s_waitcnt lgkmcnt(9)
 v_mfma_f32_16x16x32_bf16 v[208:211], a[172:175], a[16:19], v[208:211]
 ds_read_b64_tr_b16 a[164:165], v9 offset:33824
 v_mfma_f32_16x16x32_bf16 v[212:215], a[172:175], a[20:23], v[212:215]
 ds_read_b64_tr_b16 a[166:167], v9 offset:34080
 v_mfma_f32_16x16x32_bf16 v[216:219], a[172:175], a[24:27], v[216:219]
 v_mfma_f32_16x16x32_bf16 v[220:223], a[172:175], a[28:31], v[220:223]
 ds_read_b64_tr_b16 a[150:151], v14 offset:17280
 s_waitcnt lgkmcnt(9)
 v_mfma_f32_16x16x32_bf16 v[224:227], a[176:179], a[16:19], v[224:227]
 ds_read_b64_tr_b16 a[168:169], v9 offset:33856
 ds_read_b64_tr_b16 a[152:153], v14 offset:18976
 v_mfma_f32_16x16x32_bf16 v[228:231], a[176:179], a[20:23], v[228:231]
 ds_read_b64_tr_b16 a[170:171], v9 offset:34112
 ds_read_b64_tr_b16 a[154:155], v14 offset:19232
 v_mfma_f32_16x16x32_bf16 v[232:235], a[176:179], a[24:27], v[232:235]
 v_mfma_f32_16x16x32_bf16 v[236:239], a[176:179], a[28:31], v[236:239]
 ds_read_b64_tr_b16 a[156:157], v14 offset:19104
 ds_read_b64_tr_b16 a[158:159], v14 offset:19360
 s_waitcnt lgkmcnt(12)
 v_mfma_f32_16x16x32_bf16 v[240:243], a[180:183], a[16:19], v[240:243]
 ds_read_b64_tr_b16 a[172:173], v9 offset:33888
 v_mfma_f32_16x16x32_bf16 v[244:247], a[180:183], a[20:23], v[244:247]
 ds_read_b64_tr_b16 a[174:175], v9 offset:34144
 v_mfma_f32_16x16x32_bf16 v[248:251], a[180:183], a[24:27], v[248:251]
 v_mfma_f32_16x16x32_bf16 v[252:255], a[180:183], a[28:31], v[252:255]
 s_waitcnt lgkmcnt(15)
 v_mfma_f32_16x16x32_bf16 a[128:131], a[184:187], a[144:147], a[128:131]
 s_waitcnt lgkmcnt(8)
 v_mfma_f32_16x16x32_bf16 a[132:135], a[184:187], a[148:151], a[132:135]
 s_waitcnt lgkmcnt(4)
 v_mfma_f32_16x16x32_bf16 a[136:139], a[184:187], a[152:155], a[136:139]
 s_waitcnt lgkmcnt(2)
 v_mfma_f32_16x16x32_bf16 a[140:143], a[184:187], a[156:159], a[140:143]
 s_waitcnt vmcnt(63) lgkmcnt(12)
 v_mfma_f32_16x16x32_bf16 v[16:19], a[160:163], a[32:35], v[16:19]
 ds_read_b64_tr_b16 a[176:177], v9 offset:33920
 v_mfma_f32_16x16x32_bf16 v[20:23], a[160:163], a[36:39], v[20:23]
 ds_read_b64_tr_b16 a[178:179], v9 offset:34176
 v_mfma_f32_16x16x32_bf16 v[80:83], a[160:163], a[40:43], v[80:83]
L_ic1s:
 s_cmp_eq_u32 s3, 0
 s_cbranch_scc1 L_ic1w0
 s_cmp_eq_u32 s3, 1
 s_cbranch_scc1 L_ic1w1
 s_cmp_eq_u32 s3, 2
 s_cbranch_scc1 L_ic1w2
 s_branch L_ic1w3
L_ic1r:
 v_mfma_f32_16x16x32_bf16 v[84:87], a[160:163], a[44:47], v[84:87]
 ds_read_b64_tr_b16 a[144:145], v14 offset:33792
 s_waitcnt vmcnt(10)
 v_add_u32 v12, 1, v2
 s_waitcnt lgkmcnt(12)
 v_mfma_f32_16x16x32_bf16 v[24:27], a[164:167], a[32:35], v[24:27]
 ds_read_b64_tr_b16 a[180:181], v9 offset:33952
 s_bfm_b64 exec, 1, 32
 buffer_store_dword v12, v3, s[16:19], 0 offen sc0 sc1
 s_mov_b64 exec, -1
 v_mfma_f32_16x16x32_bf16 v[28:31], a[164:167], a[36:39], v[28:31]
 ds_read_b64_tr_b16 a[182:183], v9 offset:34208
 s_mov_b32 s65, 1048576
 s_mov_b32 s66, 917504
 s_add_u32 m0, s61, 67584
 v_mfma_f32_16x16x32_bf16 v[88:91], a[164:167], a[40:43], v[88:91]
 buffer_load_dwordx4 v4, s[8:11], s65 offen offset:0 lds
 v_mfma_f32_16x16x32_bf16 v[92:95], a[164:167], a[44:47], v[92:95]
 ds_read_b64_tr_b16 a[146:147], v14 offset:34048
 s_waitcnt lgkmcnt(11)
 v_mfma_f32_16x16x32_bf16 v[32:35], a[168:171], a[32:35], v[32:35]
 ds_read_b64_tr_b16 a[160:161], v9 offset:33984
 v_mfma_f32_16x16x32_bf16 v[36:39], a[168:171], a[36:39], v[36:39]
 ds_read_b64_tr_b16 a[162:163], v9 offset:34240
 v_mfma_f32_16x16x32_bf16 v[96:99], a[168:171], a[40:43], v[96:99]
 buffer_load_dwordx4 v5, s[8:11], s65 offen offset:1056 lds
 v_mfma_f32_16x16x32_bf16 v[100:103], a[168:171], a[44:47], v[100:103]
 ds_read_b64_tr_b16 a[148:149], v14 offset:33920
 s_add_u32 s69, s69, 1
 s_waitcnt lgkmcnt(9)
 v_mfma_f32_16x16x32_bf16 v[40:43], a[172:175], a[32:35], v[40:43]
 ds_read_b64_tr_b16 a[164:165], v9 offset:34016
 v_mfma_f32_16x16x32_bf16 v[44:47], a[172:175], a[36:39], v[44:47]
 ds_read_b64_tr_b16 a[166:167], v9 offset:34272
 v_mfma_f32_16x16x32_bf16 v[104:107], a[172:175], a[40:43], v[104:107]
 buffer_load_dwordx4 v6, s[12:15], s66 offen offset:2080 lds
 v_mfma_f32_16x16x32_bf16 v[108:111], a[172:175], a[44:47], v[108:111]
 ds_read_b64_tr_b16 a[150:151], v14 offset:34176
 s_waitcnt lgkmcnt(10)
 v_mfma_f32_16x16x32_bf16 v[48:51], a[176:179], a[32:35], v[48:51]
 ds_read_b64_tr_b16 a[168:169], v9 offset:35872
 v_mfma_f32_16x16x32_bf16 v[52:55], a[176:179], a[36:39], v[52:55]
 ds_read_b64_tr_b16 a[170:171], v9 offset:36128
 v_mfma_f32_16x16x32_bf16 v[112:115], a[176:179], a[40:43], v[112:115]
 buffer_load_dwordx4 v7, s[12:15], s66 offen offset:3136 lds
 v_mfma_f32_16x16x32_bf16 v[116:119], a[176:179], a[44:47], v[116:119]
 ds_read_b64_tr_b16 a[152:153], v14 offset:35872
 s_waitcnt lgkmcnt(10)
 v_mfma_f32_16x16x32_bf16 v[56:59], a[180:183], a[32:35], v[56:59]
 ds_read_b64_tr_b16 a[172:173], v9 offset:35904
 v_mfma_f32_16x16x32_bf16 v[60:63], a[180:183], a[36:39], v[60:63]
 ds_read_b64_tr_b16 a[174:175], v9 offset:36160
 s_waitcnt lgkmcnt(15)
 v_mfma_f32_16x16x32_bf16 v[120:123], a[180:183], a[40:43], v[120:123]
 s_add_u32 m0, s61, 118272
 s_add_u32 s4, s71, 256
 buffer_load_dwordx4 v13, s[28:31], s4 offen lds
 v_mfma_f32_16x16x32_bf16 v[124:127], a[180:183], a[44:47], v[124:127]
 ds_read_b64_tr_b16 a[154:155], v14 offset:36128
 s_waitcnt lgkmcnt(10)
 v_mfma_f32_16x16x32_bf16 v[64:67], a[160:163], a[32:35], v[64:67]
 ds_read_b64_tr_b16 a[176:177], v9 offset:35936
 v_mfma_f32_16x16x32_bf16 v[68:71], a[160:163], a[36:39], v[68:71]
 ds_read_b64_tr_b16 a[178:179], v9 offset:36192
 v_mfma_f32_16x16x32_bf16 v[128:131], a[160:163], a[40:43], v[128:131]
 s_add_u32 m0, s61, 120384
 s_add_u32 s4, s71, 16640
 buffer_load_dwordx4 v13, s[28:31], s4 offen lds
 v_mfma_f32_16x16x32_bf16 v[132:135], a[160:163], a[44:47], v[132:135]
 ds_read_b64_tr_b16 a[156:157], v14 offset:36000
 s_waitcnt lgkmcnt(10)
 v_mfma_f32_16x16x32_bf16 v[72:75], a[164:167], a[32:35], v[72:75]
 ds_read_b64_tr_b16 a[180:181], v9 offset:35968
 v_mfma_f32_16x16x32_bf16 v[76:79], a[164:167], a[36:39], v[76:79]
 ds_read_b64_tr_b16 a[182:183], v9 offset:36224
 s_waitcnt lgkmcnt(15)
 v_mfma_f32_16x16x32_bf16 v[136:139], a[164:167], a[40:43], v[136:139]
 s_add_u32 m0, s61, 119296
 s_add_u32 s4, s71, 33024
 buffer_load_dwordx4 v13, s[28:31], s4 offen lds
 v_mfma_f32_16x16x32_bf16 v[140:143], a[164:167], a[44:47], v[140:143]
 ds_read_b64_tr_b16 a[158:159], v14 offset:36256
 s_waitcnt lgkmcnt(10)
 v_mfma_f32_16x16x32_bf16 v[144:147], a[168:171], a[32:35], v[144:147]
 ds_read_b64_tr_b16 a[160:161], v9 offset:36000
 v_mfma_f32_16x16x32_bf16 v[148:151], a[168:171], a[36:39], v[148:151]
 ds_read_b64_tr_b16 a[162:163], v9 offset:36256
 v_mfma_f32_16x16x32_bf16 v[152:155], a[168:171], a[40:43], v[152:155]
 s_add_u32 m0, s61, 121408
 s_add_u32 s4, s71, 49408
 buffer_load_dwordx4 v13, s[28:31], s4 offen lds
 v_mfma_f32_16x16x32_bf16 v[156:159], a[168:171], a[44:47], v[156:159]
 s_waitcnt lgkmcnt(9)
 v_mfma_f32_16x16x32_bf16 v[160:163], a[172:175], a[32:35], v[160:163]
 ds_read_b64_tr_b16 a[164:165], v9 offset:36032
 v_mfma_f32_16x16x32_bf16 v[164:167], a[172:175], a[36:39], v[164:167]
 ds_read_b64_tr_b16 a[166:167], v9 offset:36288
 s_waitcnt lgkmcnt(15)
 v_mfma_f32_16x16x32_bf16 v[168:171], a[172:175], a[40:43], v[168:171]
 s_add_u32 m0, s61, 135168
 s_add_u32 s4, s71, 65792
 buffer_load_dwordx4 v13, s[28:31], s4 offen lds
 v_mfma_f32_16x16x32_bf16 v[172:175], a[172:175], a[44:47], v[172:175]
 s_waitcnt lgkmcnt(8)
 v_mfma_f32_16x16x32_bf16 v[176:179], a[176:179], a[32:35], v[176:179]
 ds_read_b64_tr_b16 a[168:169], v9 offset:36064
 v_mfma_f32_16x16x32_bf16 v[180:183], a[176:179], a[36:39], v[180:183]
 ds_read_b64_tr_b16 a[170:171], v9 offset:36320
 v_mfma_f32_16x16x32_bf16 v[184:187], a[176:179], a[40:43], v[184:187]
 s_waitcnt vmcnt(20)
 s_add_u32 m0, s61, 137280
 s_add_u32 s4, s71, 82176
 buffer_load_dwordx4 v13, s[28:31], s4 offen lds
 v_mfma_f32_16x16x32_bf16 v[188:191], a[176:179], a[44:47], v[188:191]
 s_barrier
 s_waitcnt lgkmcnt(7)
 v_mfma_f32_16x16x32_bf16 v[192:195], a[180:183], a[32:35], v[192:195]
 ds_read_b64_tr_b16 a[172:173], v9 offset:50688
 v_mfma_f32_16x16x32_bf16 v[196:199], a[180:183], a[36:39], v[196:199]
 ds_read_b64_tr_b16 a[174:175], v9 offset:50944
 s_waitcnt lgkmcnt(15)
 v_mfma_f32_16x16x32_bf16 v[200:203], a[180:183], a[40:43], v[200:203]
 s_add_u32 m0, s61, 136192
 s_add_u32 s4, s71, 98560
 buffer_load_dwordx4 v13, s[28:31], s4 offen lds
 v_mfma_f32_16x16x32_bf16 v[204:207], a[180:183], a[44:47], v[204:207]
 s_waitcnt lgkmcnt(6)
 v_mfma_f32_16x16x32_bf16 v[208:211], a[160:163], a[32:35], v[208:211]
 ds_read_b64_tr_b16 a[176:177], v9 offset:50720
 v_mfma_f32_16x16x32_bf16 v[212:215], a[160:163], a[36:39], v[212:215]
 ds_read_b64_tr_b16 a[178:179], v9 offset:50976
 v_mfma_f32_16x16x32_bf16 v[216:219], a[160:163], a[40:43], v[216:219]
 s_add_u32 m0, s61, 138304
 s_add_u32 s4, s71, 114944
 buffer_load_dwordx4 v13, s[28:31], s4 offen lds
 v_mfma_f32_16x16x32_bf16 v[220:223], a[160:163], a[44:47], v[220:223]
 s_waitcnt lgkmcnt(6)
 v_mfma_f32_16x16x32_bf16 v[224:227], a[164:167], a[32:35], v[224:227]
 ds_read_b64_tr_b16 a[180:181], v9 offset:50752
 v_mfma_f32_16x16x32_bf16 v[228:231], a[164:167], a[36:39], v[228:231]
 ds_read_b64_tr_b16 a[182:183], v9 offset:51008
 v_mfma_f32_16x16x32_bf16 v[232:235], a[164:167], a[40:43], v[232:235]
 v_mfma_f32_16x16x32_bf16 v[236:239], a[164:167], a[44:47], v[236:239]
 s_waitcnt lgkmcnt(6)
 v_mfma_f32_16x16x32_bf16 v[240:243], a[168:171], a[32:35], v[240:243]
 ds_read_b64_tr_b16 a[160:161], v9 offset:50784
 v_mfma_f32_16x16x32_bf16 v[244:247], a[168:171], a[36:39], v[244:247]
 ds_read_b64_tr_b16 a[162:163], v9 offset:51040
 v_mfma_f32_16x16x32_bf16 v[248:251], a[168:171], a[40:43], v[248:251]
 v_mfma_f32_16x16x32_bf16 v[252:255], a[168:171], a[44:47], v[252:255]
 s_waitcnt lgkmcnt(15)
 v_mfma_f32_16x16x32_bf16 a[128:131], a[184:187], a[144:147], a[128:131]
 s_waitcnt lgkmcnt(15)
 v_mfma_f32_16x16x32_bf16 a[132:135], a[184:187], a[148:151], a[132:135]
 s_waitcnt lgkmcnt(15)
 v_mfma_f32_16x16x32_bf16 a[136:139], a[184:187], a[152:155], a[136:139]
 s_waitcnt lgkmcnt(14)
 v_mfma_f32_16x16x32_bf16 a[140:143], a[184:187], a[156:159], a[140:143]
 s_waitcnt vmcnt(63) lgkmcnt(6)
 v_mfma_f32_16x16x32_bf16 v[16:19], a[172:175], a[48:51], v[16:19]
 ds_read_b64_tr_b16 a[164:165], v9 offset:50816
 v_mfma_f32_16x16x32_bf16 v[20:23], a[172:175], a[52:55], v[20:23]
 ds_read_b64_tr_b16 a[166:167], v9 offset:51072
 v_mfma_f32_16x16x32_bf16 v[80:83], a[172:175], a[56:59], v[80:83]
 s_waitcnt vmcnt(13)
 v_mfma_f32_16x16x32_bf16 v[84:87], a[172:175], a[60:63], v[84:87]
 ds_read_b64_tr_b16 a[144:145], v14 offset:50688
 s_waitcnt lgkmcnt(7)
 v_mfma_f32_16x16x32_bf16 v[24:27], a[176:179], a[48:51], v[24:27]
 ds_read_b64_tr_b16 a[168:169], v9 offset:50848
 v_accvgpr_read_b32 v11, a192
 v_mfma_f32_16x16x32_bf16 v[28:31], a[176:179], a[52:55], v[28:31]
 ds_read_b64_tr_b16 a[170:171], v9 offset:51104
 s_waitcnt lgkmcnt(15)
 s_mov_b32 s65, 1310720
 s_mov_b32 s66, 1146880
 s_add_u32 m0, s61, 84480
 v_accvgpr_read_b32 v12, a196
 v_mfma_f32_16x16x32_bf16 v[88:91], a[176:179], a[56:59], v[88:91]
 buffer_load_dwordx4 v4, s[8:11], s65 offen offset:0 lds
 v_mfma_f32_16x16x32_bf16 v[92:95], a[176:179], a[60:63], v[92:95]
 ds_read_b64_tr_b16 a[146:147], v14 offset:50944
 s_waitcnt lgkmcnt(8)
 v_mfma_f32_16x16x32_bf16 v[32:35], a[180:183], a[48:51], v[32:35]
 ds_read_b64_tr_b16 a[172:173], v9 offset:50880
 v_lshl_or_b32 v11, v12, 16, v11
 v_mfma_f32_16x16x32_bf16 v[36:39], a[180:183], a[52:55], v[36:39]
 ds_read_b64_tr_b16 a[174:175], v9 offset:51136
 v_accvgpr_write_b32 a192, v11
 v_mfma_f32_16x16x32_bf16 v[96:99], a[180:183], a[56:59], v[96:99]
 buffer_load_dwordx4 v5, s[8:11], s65 offen offset:1056 lds
 v_mfma_f32_16x16x32_bf16 v[100:103], a[180:183], a[60:63], v[100:103]
 ds_read_b64_tr_b16 a[148:149], v14 offset:50816
 s_add_u32 s69, s69, 1
 s_waitcnt lgkmcnt(9)
 v_mfma_f32_16x16x32_bf16 v[40:43], a[160:163], a[48:51], v[40:43]
 ds_read_b64_tr_b16 a[176:177], v9 offset:50912
 v_accvgpr_read_b32 v11, a193
 v_mfma_f32_16x16x32_bf16 v[44:47], a[160:163], a[52:55], v[44:47]
 ds_read_b64_tr_b16 a[178:179], v9 offset:51168
 v_accvgpr_read_b32 v12, a197
 v_mfma_f32_16x16x32_bf16 v[104:107], a[160:163], a[56:59], v[104:107]
 buffer_load_dwordx4 v6, s[12:15], s66 offen offset:2080 lds
 v_mfma_f32_16x16x32_bf16 v[108:111], a[160:163], a[60:63], v[108:111]
 ds_read_b64_tr_b16 a[150:151], v14 offset:51072
 s_waitcnt lgkmcnt(10)
 v_mfma_f32_16x16x32_bf16 v[48:51], a[164:167], a[48:51], v[48:51]
 ds_read_b64_tr_b16 a[180:181], v9 offset:52768
 v_lshl_or_b32 v11, v12, 16, v11
 v_mfma_f32_16x16x32_bf16 v[52:55], a[164:167], a[52:55], v[52:55]
 ds_read_b64_tr_b16 a[182:183], v9 offset:53024
 v_accvgpr_write_b32 a193, v11
 v_mfma_f32_16x16x32_bf16 v[112:115], a[164:167], a[56:59], v[112:115]
 buffer_load_dwordx4 v7, s[12:15], s66 offen offset:3136 lds
 v_mfma_f32_16x16x32_bf16 v[116:119], a[164:167], a[60:63], v[116:119]
 ds_read_b64_tr_b16 a[152:153], v14 offset:52768
 s_waitcnt lgkmcnt(10)
 v_mfma_f32_16x16x32_bf16 v[56:59], a[168:171], a[48:51], v[56:59]
 ds_read_b64_tr_b16 a[160:161], v9 offset:52800
 v_accvgpr_read_b32 v11, a194
 v_mfma_f32_16x16x32_bf16 v[60:63], a[168:171], a[52:55], v[60:63]
 ds_read_b64_tr_b16 a[162:163], v9 offset:53056
 s_waitcnt lgkmcnt(15)
 s_mov_b32 s65, 1572864
 s_mov_b32 s66, 1376256
 s_add_u32 m0, s61, 101376
 v_accvgpr_read_b32 v12, a198
 v_mfma_f32_16x16x32_bf16 v[120:123], a[168:171], a[56:59], v[120:123]
 buffer_load_dwordx4 v4, s[8:11], s65 offen offset:0 lds
 v_mfma_f32_16x16x32_bf16 v[124:127], a[168:171], a[60:63], v[124:127]
 ds_read_b64_tr_b16 a[154:155], v14 offset:53024
 s_waitcnt lgkmcnt(10)
 v_mfma_f32_16x16x32_bf16 v[64:67], a[172:175], a[48:51], v[64:67]
 ds_read_b64_tr_b16 a[164:165], v9 offset:52832
 v_lshl_or_b32 v11, v12, 16, v11
 v_mfma_f32_16x16x32_bf16 v[68:71], a[172:175], a[52:55], v[68:71]
 ds_read_b64_tr_b16 a[166:167], v9 offset:53088
 v_accvgpr_write_b32 a194, v11
 v_mfma_f32_16x16x32_bf16 v[128:131], a[172:175], a[56:59], v[128:131]
 buffer_load_dwordx4 v5, s[8:11], s65 offen offset:1056 lds
 v_mfma_f32_16x16x32_bf16 v[132:135], a[172:175], a[60:63], v[132:135]
 ds_read_b64_tr_b16 a[156:157], v14 offset:52896
 s_waitcnt lgkmcnt(10)
 v_mfma_f32_16x16x32_bf16 v[72:75], a[176:179], a[48:51], v[72:75]
 ds_read_b64_tr_b16 a[168:169], v9 offset:52864
 v_accvgpr_read_b32 v11, a195
 v_mfma_f32_16x16x32_bf16 v[76:79], a[176:179], a[52:55], v[76:79]
 ds_read_b64_tr_b16 a[170:171], v9 offset:53120
 v_accvgpr_read_b32 v12, a199
 v_mfma_f32_16x16x32_bf16 v[136:139], a[176:179], a[56:59], v[136:139]
 buffer_load_dwordx4 v6, s[12:15], s66 offen offset:2080 lds
 v_mfma_f32_16x16x32_bf16 v[140:143], a[176:179], a[60:63], v[140:143]
 ds_read_b64_tr_b16 a[158:159], v14 offset:53152
 s_waitcnt lgkmcnt(10)
 v_mfma_f32_16x16x32_bf16 v[144:147], a[180:183], a[48:51], v[144:147]
 ds_read_b64_tr_b16 a[172:173], v9 offset:52896
 v_lshl_or_b32 v11, v12, 16, v11
 v_mfma_f32_16x16x32_bf16 v[148:151], a[180:183], a[52:55], v[148:151]
 ds_read_b64_tr_b16 a[174:175], v9 offset:53152
 v_accvgpr_write_b32 a195, v11
 v_mfma_f32_16x16x32_bf16 v[152:155], a[180:183], a[56:59], v[152:155]
 buffer_load_dwordx4 v7, s[12:15], s66 offen offset:3136 lds
 v_mfma_f32_16x16x32_bf16 v[156:159], a[180:183], a[60:63], v[156:159]
 s_waitcnt vmcnt(14)
 ds_read_b128 a[64:67], v15 offset:33792
 s_waitcnt lgkmcnt(10)
 v_mfma_f32_16x16x32_bf16 v[160:163], a[160:163], a[48:51], v[160:163]
 ds_read_b64_tr_b16 a[176:177], v9 offset:52928
 v_mfma_f32_16x16x32_bf16 v[164:167], a[160:163], a[52:55], v[164:167]
 s_branch L_pg2k
L_pg2:
L_ic0w2:
 s_branch L_ic0r
L_pg2k:
 ds_read_b64_tr_b16 a[178:179], v9 offset:53184
 s_add_u32 s70, s72, 8
 s_lshl_b32 s65, s70, 18
 s_mul_i32 s66, s70, 229376
 s_add_u32 m0, s61, 0
 v_mfma_f32_16x16x32_bf16 v[168:171], a[160:163], a[56:59], v[168:171]
 buffer_load_dwordx4 v4, s[8:11], s65 offen offset:0 lds
 v_mfma_f32_16x16x32_bf16 v[172:175], a[160:163], a[60:63], v[172:175]
 ds_read_b128 a[80:83], v15 offset:33856
 s_waitcnt lgkmcnt(10)
 v_mfma_f32_16x16x32_bf16 v[176:179], a[164:167], a[48:51], v[176:179]
 ds_read_b64_tr_b16 a[180:181], v9 offset:52960
 v_mfma_f32_16x16x32_bf16 v[180:183], a[164:167], a[52:55], v[180:183]
 ds_read_b64_tr_b16 a[182:183], v9 offset:53216
 v_mfma_f32_16x16x32_bf16 v[184:187], a[164:167], a[56:59], v[184:187]
 s_waitcnt vmcnt(17)
 buffer_load_dwordx4 v5, s[8:11], s65 offen offset:1056 lds
 v_mfma_f32_16x16x32_bf16 v[188:191], a[164:167], a[60:63], v[188:191]
 s_barrier
 s_waitcnt lgkmcnt(9)
 v_mfma_f32_16x16x32_bf16 v[192:195], a[168:171], a[48:51], v[192:195]
 ds_read_b64_tr_b16 a[160:161], v10 offset:0
 v_mfma_f32_16x16x32_bf16 v[196:199], a[168:171], a[52:55], v[196:199]
 ds_read_b64_tr_b16 a[162:163], v10 offset:256
 v_mfma_f32_16x16x32_bf16 v[200:203], a[168:171], a[56:59], v[200:203]
 buffer_load_dwordx4 v6, s[12:15], s66 offen offset:2080 lds
 v_mfma_f32_16x16x32_bf16 v[204:207], a[168:171], a[60:63], v[204:207]
 s_waitcnt vmcnt(15)
 ds_read_b128 a[68:71], v15 offset:34816
 s_waitcnt lgkmcnt(9)
 v_mfma_f32_16x16x32_bf16 v[208:211], a[172:175], a[48:51], v[208:211]
 ds_read_b64_tr_b16 a[164:165], v10 offset:32
 v_mfma_f32_16x16x32_bf16 v[212:215], a[172:175], a[52:55], v[212:215]
 ds_read_b64_tr_b16 a[166:167], v10 offset:288
 v_mfma_f32_16x16x32_bf16 v[216:219], a[172:175], a[56:59], v[216:219]
 buffer_load_dwordx4 v7, s[12:15], s66 offen offset:3136 lds
 v_mfma_f32_16x16x32_bf16 v[220:223], a[172:175], a[60:63], v[220:223]
 ds_read_b128 a[84:87], v15 offset:34880
 s_waitcnt lgkmcnt(9)
 v_mfma_f32_16x16x32_bf16 v[224:227], a[176:179], a[48:51], v[224:227]
 ds_read_b64_tr_b16 a[168:169], v10 offset:64
 v_mfma_f32_16x16x32_bf16 v[228:231], a[176:179], a[52:55], v[228:231]
 ds_read_b64_tr_b16 a[170:171], v10 offset:320
 v_mfma_f32_16x16x32_bf16 v[232:235], a[176:179], a[56:59], v[232:235]
 v_mfma_f32_16x16x32_bf16 v[236:239], a[176:179], a[60:63], v[236:239]
 s_waitcnt vmcnt(14)
 ds_read_b128 a[72:75], v15 offset:50688
 s_waitcnt lgkmcnt(9)
 v_mfma_f32_16x16x32_bf16 v[240:243], a[180:183], a[48:51], v[240:243]
 ds_read_b64_tr_b16 a[172:173], v10 offset:96
 v_mfma_f32_16x16x32_bf16 v[244:247], a[180:183], a[52:55], v[244:247]
 ds_read_b64_tr_b16 a[174:175], v10 offset:352
 v_mfma_f32_16x16x32_bf16 v[248:251], a[180:183], a[56:59], v[248:251]
 v_mfma_f32_16x16x32_bf16 v[252:255], a[180:183], a[60:63], v[252:255]
 ds_read_b128 a[88:91], v15 offset:50752
 v_add_u32 v14, 67584, v14
 s_waitcnt lgkmcnt(15)
 v_mfma_f32_16x16x32_bf16 a[128:131], a[184:187], a[144:147], a[128:131]
 s_waitcnt vmcnt(12)
 ds_read_b128 a[76:79], v15 offset:51712
 s_waitcnt lgkmcnt(15)
 v_mfma_f32_16x16x32_bf16 a[132:135], a[184:187], a[148:151], a[132:135]
 ds_read_b128 a[92:95], v15 offset:51776
 s_waitcnt lgkmcnt(15)
 v_mfma_f32_16x16x32_bf16 a[136:139], a[184:187], a[152:155], a[136:139]
 s_waitcnt lgkmcnt(15)
 v_mfma_f32_16x16x32_bf16 a[140:143], a[184:187], a[156:159], a[140:143]
 s_waitcnt vmcnt(63) lgkmcnt(0)
 v_mfma_f32_16x16x32_bf16 v[16:19], a[160:163], a[64:67], v[16:19]
 ds_read_b64_tr_b16 a[176:177], v10 offset:128
 v_mfma_f32_16x16x32_bf16 v[20:23], a[160:163], a[68:71], v[20:23]
 ds_read_b64_tr_b16 a[178:179], v10 offset:384
 v_mfma_f32_16x16x32_bf16 v[80:83], a[160:163], a[72:75], v[80:83]
 v_mfma_f32_16x16x32_bf16 v[84:87], a[160:163], a[76:79], v[84:87]
 ds_read_b64_tr_b16 a[144:145], v14 offset:0
 s_waitcnt lgkmcnt(12)
 v_mfma_f32_16x16x32_bf16 v[24:27], a[164:167], a[64:67], v[24:27]
 ds_read_b64_tr_b16 a[180:181], v10 offset:160
 v_mfma_f32_16x16x32_bf16 v[28:31], a[164:167], a[68:71], v[28:31]
 ds_read_b64_tr_b16 a[182:183], v10 offset:416
 s_waitcnt lgkmcnt(15)
 v_mfma_f32_16x16x32_bf16 v[88:91], a[164:167], a[72:75], v[88:91]
 s_add_u32 m0, s61, 118272
 s_add_u32 s4, s71, 384
 buffer_load_dwordx4 v13, s[28:31], s4 offen lds
 v_mfma_f32_16x16x32_bf16 v[92:95], a[164:167], a[76:79], v[92:95]
 ds_read_b64_tr_b16 a[146:147], v14 offset:256
 s_waitcnt lgkmcnt(12)
 v_mfma_f32_16x16x32_bf16 v[32:35], a[168:171], a[64:67], v[32:35]
 ds_read_b64_tr_b16 a[160:161], v10 offset:192
 v_mfma_f32_16x16x32_bf16 v[36:39], a[168:171], a[68:71], v[36:39]
 ds_read_b64_tr_b16 a[162:163], v10 offset:448
 v_mfma_f32_16x16x32_bf16 v[96:99], a[168:171], a[72:75], v[96:99]
 s_add_u32 m0, s61, 120384
 s_add_u32 s4, s71, 16768
 buffer_load_dwordx4 v13, s[28:31], s4 offen lds
 v_mfma_f32_16x16x32_bf16 v[100:103], a[168:171], a[76:79], v[100:103]
 ds_read_b64_tr_b16 a[148:149], v14 offset:128
 s_add_u32 s69, s69, 1
 s_waitcnt lgkmcnt(12)
 v_mfma_f32_16x16x32_bf16 v[40:43], a[172:175], a[64:67], v[40:43]
 ds_read_b64_tr_b16 a[164:165], v10 offset:224
 v_mfma_f32_16x16x32_bf16 v[44:47], a[172:175], a[68:71], v[44:47]
 ds_read_b64_tr_b16 a[166:167], v10 offset:480
 s_waitcnt lgkmcnt(15)
 v_mfma_f32_16x16x32_bf16 v[104:107], a[172:175], a[72:75], v[104:107]
 s_add_u32 m0, s61, 119296
 s_add_u32 s4, s71, 33152
 buffer_load_dwordx4 v13, s[28:31], s4 offen lds
 v_mfma_f32_16x16x32_bf16 v[108:111], a[172:175], a[76:79], v[108:111]
 ds_read_b64_tr_b16 a[150:151], v14 offset:384
 s_waitcnt lgkmcnt(10)
 v_mfma_f32_16x16x32_bf16 v[48:51], a[176:179], a[64:67], v[48:51]
 ds_read_b64_tr_b16 a[168:169], v10 offset:2080
 v_mfma_f32_16x16x32_bf16 v[52:55], a[176:179], a[68:71], v[52:55]
 ds_read_b64_tr_b16 a[170:171], v10 offset:2336
 v_mfma_f32_16x16x32_bf16 v[112:115], a[176:179], a[72:75], v[112:115]
 s_add_u32 m0, s61, 121408
 s_add_u32 s4, s71, 49536
 buffer_load_dwordx4 v13, s[28:31], s4 offen lds
 v_mfma_f32_16x16x32_bf16 v[116:119], a[176:179], a[76:79], v[116:119]
 ds_read_b64_tr_b16 a[152:153], v14 offset:2080
 s_waitcnt lgkmcnt(10)
 v_mfma_f32_16x16x32_bf16 v[56:59], a[180:183], a[64:67], v[56:59]
 ds_read_b64_tr_b16 a[172:173], v10 offset:2112
 v_mfma_f32_16x16x32_bf16 v[60:63], a[180:183], a[68:71], v[60:63]
 ds_read_b64_tr_b16 a[174:175], v10 offset:2368
 s_waitcnt lgkmcnt(15)
 v_mfma_f32_16x16x32_bf16 v[120:123], a[180:183], a[72:75], v[120:123]
 s_add_u32 m0, s61, 135168
 s_add_u32 s4, s71, 65920
 buffer_load_dwordx4 v13, s[28:31], s4 offen lds
 v_mfma_f32_16x16x32_bf16 v[124:127], a[180:183], a[76:79], v[124:127]
 ds_read_b64_tr_b16 a[154:155], v14 offset:2336
 s_waitcnt lgkmcnt(10)
 v_mfma_f32_16x16x32_bf16 v[64:67], a[160:163], a[64:67], v[64:67]
 ds_read_b64_tr_b16 a[176:177], v10 offset:2144
 v_mfma_f32_16x16x32_bf16 v[68:71], a[160:163], a[68:71], v[68:71]
 ds_read_b64_tr_b16 a[178:179], v10 offset:2400
 v_mfma_f32_16x16x32_bf16 v[128:131], a[160:163], a[72:75], v[128:131]
 s_add_u32 m0, s61, 137280
 s_add_u32 s4, s71, 82304
 buffer_load_dwordx4 v13, s[28:31], s4 offen lds
 v_mfma_f32_16x16x32_bf16 v[132:135], a[160:163], a[76:79], v[132:135]
 ds_read_b64_tr_b16 a[156:157], v14 offset:2208
 s_waitcnt lgkmcnt(10)
 v_mfma_f32_16x16x32_bf16 v[72:75], a[164:167], a[64:67], v[72:75]
 ds_read_b64_tr_b16 a[180:181], v10 offset:2176
 v_mfma_f32_16x16x32_bf16 v[76:79], a[164:167], a[68:71], v[76:79]
 ds_read_b64_tr_b16 a[182:183], v10 offset:2432
 s_waitcnt lgkmcnt(15)
 v_mfma_f32_16x16x32_bf16 v[136:139], a[164:167], a[72:75], v[136:139]
 s_add_u32 m0, s61, 136192
 s_add_u32 s4, s71, 98688
 buffer_load_dwordx4 v13, s[28:31], s4 offen lds
 v_mfma_f32_16x16x32_bf16 v[140:143], a[164:167], a[76:79], v[140:143]
 ds_read_b64_tr_b16 a[158:159], v14 offset:2464
 s_waitcnt lgkmcnt(10)
 v_mfma_f32_16x16x32_bf16 v[144:147], a[168:171], a[64:67], v[144:147]
 ds_read_b64_tr_b16 a[160:161], v10 offset:2208
 v_mfma_f32_16x16x32_bf16 v[148:151], a[168:171], a[68:71], v[148:151]
 ds_read_b64_tr_b16 a[162:163], v10 offset:2464
 v_mfma_f32_16x16x32_bf16 v[152:155], a[168:171], a[72:75], v[152:155]
 s_add_u32 m0, s61, 138304
 s_add_u32 s4, s71, 115072
 buffer_load_dwordx4 v13, s[28:31], s4 offen lds
 v_mfma_f32_16x16x32_bf16 v[156:159], a[168:171], a[76:79], v[156:159]
 s_waitcnt lgkmcnt(9)
 v_mfma_f32_16x16x32_bf16 v[160:163], a[172:175], a[64:67], v[160:163]
 ds_read_b64_tr_b16 a[164:165], v10 offset:2240
 v_mfma_f32_16x16x32_bf16 v[164:167], a[172:175], a[68:71], v[164:167]
 ds_read_b64_tr_b16 a[166:167], v10 offset:2496
 v_mfma_f32_16x16x32_bf16 v[168:171], a[172:175], a[72:75], v[168:171]
 buffer_load_dword v11, v3, s[16:19], 0 offen sc0 sc1
 buffer_store_dwordx4 a[192:195], v8, s[16:19], s91 offen sc0 sc1
 v_mfma_f32_16x16x32_bf16 v[172:175], a[172:175], a[76:79], v[172:175]
 s_waitcnt lgkmcnt(8)
 v_mfma_f32_16x16x32_bf16 v[176:179], a[176:179], a[64:67], v[176:179]
 ds_read_b64_tr_b16 a[168:169], v10 offset:2272
 v_mfma_f32_16x16x32_bf16 v[180:183], a[176:179], a[68:71], v[180:183]
 ds_read_b64_tr_b16 a[170:171], v10 offset:2528
 s_add_u32 s70, s73, 9
 s_lshl_b32 s65, s70, 18
 s_mul_i32 s66, s70, 229376
 s_add_u32 m0, s61, 16896
 v_mfma_f32_16x16x32_bf16 v[184:187], a[176:179], a[72:75], v[184:187]
 s_waitcnt vmcnt(18)
 buffer_load_dwordx4 v4, s[8:11], s65 offen offset:0 lds
 v_mfma_f32_16x16x32_bf16 v[188:191], a[176:179], a[76:79], v[188:191]
 s_barrier
 s_waitcnt lgkmcnt(7)
 v_mfma_f32_16x16x32_bf16 v[192:195], a[180:183], a[64:67], v[192:195]
 ds_read_b64_tr_b16 a[172:173], v10 offset:16896
 v_mfma_f32_16x16x32_bf16 v[196:199], a[180:183], a[68:71], v[196:199]
 ds_read_b64_tr_b16 a[174:175], v10 offset:17152
 v_mfma_f32_16x16x32_bf16 v[200:203], a[180:183], a[72:75], v[200:203]
 buffer_load_dwordx4 v5, s[8:11], s65 offen offset:1056 lds
 v_mfma_f32_16x16x32_bf16 v[204:207], a[180:183], a[76:79], v[204:207]
 s_waitcnt lgkmcnt(6)
 v_mfma_f32_16x16x32_bf16 v[208:211], a[160:163], a[64:67], v[208:211]
 ds_read_b64_tr_b16 a[176:177], v10 offset:16928
 v_mfma_f32_16x16x32_bf16 v[212:215], a[160:163], a[68:71], v[212:215]
 ds_read_b64_tr_b16 a[178:179], v10 offset:17184
 v_mfma_f32_16x16x32_bf16 v[216:219], a[160:163], a[72:75], v[216:219]
 buffer_load_dwordx4 v6, s[12:15], s66 offen offset:2080 lds
 v_mfma_f32_16x16x32_bf16 v[220:223], a[160:163], a[76:79], v[220:223]
 s_waitcnt lgkmcnt(6)
 v_mfma_f32_16x16x32_bf16 v[224:227], a[164:167], a[64:67], v[224:227]
 ds_read_b64_tr_b16 a[180:181], v10 offset:16960
 v_mfma_f32_16x16x32_bf16 v[228:231], a[164:167], a[68:71], v[228:231]
 ds_read_b64_tr_b16 a[182:183], v10 offset:17216
 v_mfma_f32_16x16x32_bf16 v[232:235], a[164:167], a[72:75], v[232:235]
 buffer_load_dwordx4 v7, s[12:15], s66 offen offset:3136 lds
 v_mfma_f32_16x16x32_bf16 v[236:239], a[164:167], a[76:79], v[236:239]
 s_waitcnt lgkmcnt(6)
 v_mfma_f32_16x16x32_bf16 v[240:243], a[168:171], a[64:67], v[240:243]
 ds_read_b64_tr_b16 a[160:161], v10 offset:16992
 v_mfma_f32_16x16x32_bf16 v[244:247], a[168:171], a[68:71], v[244:247]
 ds_read_b64_tr_b16 a[162:163], v10 offset:17248
 v_mfma_f32_16x16x32_bf16 v[248:251], a[168:171], a[72:75], v[248:251]
 v_mfma_f32_16x16x32_bf16 v[252:255], a[168:171], a[76:79], v[252:255]
 s_waitcnt lgkmcnt(15)
 v_mfma_f32_16x16x32_bf16 a[128:131], a[184:187], a[144:147], a[128:131]
 s_waitcnt lgkmcnt(15)
 v_mfma_f32_16x16x32_bf16 a[132:135], a[184:187], a[148:151], a[132:135]
 s_waitcnt lgkmcnt(15)
 v_mfma_f32_16x16x32_bf16 a[136:139], a[184:187], a[152:155], a[136:139]
 s_waitcnt lgkmcnt(14)
 v_mfma_f32_16x16x32_bf16 a[140:143], a[184:187], a[156:159], a[140:143]
 s_waitcnt vmcnt(63) lgkmcnt(6)
 v_mfma_f32_16x16x32_bf16 v[16:19], a[172:175], a[80:83], v[16:19]
 ds_read_b64_tr_b16 a[164:165], v10 offset:17024
 v_mfma_f32_16x16x32_bf16 v[20:23], a[172:175], a[84:87], v[20:23]
 ds_read_b64_tr_b16 a[166:167], v10 offset:17280
 v_mfma_f32_16x16x32_bf16 v[80:83], a[172:175], a[88:91], v[80:83]
 v_mfma_f32_16x16x32_bf16 v[84:87], a[172:175], a[92:95], v[84:87]
 s_waitcnt vmcnt(12)
 ds_read_b128 a[96:99], v15 offset:33792
 s_waitcnt lgkmcnt(7)
 v_mfma_f32_16x16x32_bf16 v[24:27], a[176:179], a[80:83], v[24:27]
 ds_read_b64_tr_b16 a[168:169], v10 offset:17056
 v_mfma_f32_16x16x32_bf16 v[28:31], a[176:179], a[84:87], v[28:31]
 ds_read_b64_tr_b16 a[170:171], v10 offset:17312
 v_mfma_f32_16x16x32_bf16 v[88:91], a[176:179], a[88:91], v[88:91]
 v_mfma_f32_16x16x32_bf16 v[92:95], a[176:179], a[92:95], v[92:95]
 ds_read_b128 a[112:115], v15 offset:33856
 s_waitcnt lgkmcnt(8)
 v_mfma_f32_16x16x32_bf16 v[32:35], a[180:183], a[80:83], v[32:35]
 ds_read_b64_tr_b16 a[172:173], v10 offset:17088
 v_mfma_f32_16x16x32_bf16 v[36:39], a[180:183], a[84:87], v[36:39]
 ds_read_b64_tr_b16 a[174:175], v10 offset:17344
 v_mfma_f32_16x16x32_bf16 v[96:99], a[180:183], a[88:91], v[96:99]
 v_mfma_f32_16x16x32_bf16 v[100:103], a[180:183], a[92:95], v[100:103]
 s_waitcnt vmcnt(10)
 ds_read_b128 a[100:103], v15 offset:34816
 s_add_u32 s69, s69, 1
 s_waitcnt lgkmcnt(9)
 v_mfma_f32_16x16x32_bf16 v[40:43], a[160:163], a[80:83], v[40:43]
 ds_read_b64_tr_b16 a[176:177], v10 offset:17120
 v_mfma_f32_16x16x32_bf16 v[44:47], a[160:163], a[84:87], v[44:47]
 ds_read_b64_tr_b16 a[178:179], v10 offset:17376
 v_mfma_f32_16x16x32_bf16 v[104:107], a[160:163], a[88:91], v[104:107]
 v_mfma_f32_16x16x32_bf16 v[108:111], a[160:163], a[92:95], v[108:111]
 ds_read_b128 a[116:119], v15 offset:34880
 s_waitcnt lgkmcnt(10)
 v_mfma_f32_16x16x32_bf16 v[48:51], a[164:167], a[80:83], v[48:51]
 ds_read_b64_tr_b16 a[180:181], v10 offset:18976
 v_mfma_f32_16x16x32_bf16 v[52:55], a[164:167], a[84:87], v[52:55]
 ds_read_b64_tr_b16 a[182:183], v10 offset:19232
 v_mfma_f32_16x16x32_bf16 v[112:115], a[164:167], a[88:91], v[112:115]
 v_mfma_f32_16x16x32_bf16 v[116:119], a[164:167], a[92:95], v[116:119]
 s_waitcnt vmcnt(8)
 ds_read_b128 a[104:107], v15 offset:50688
 s_waitcnt lgkmcnt(10)
 v_mfma_f32_16x16x32_bf16 v[56:59], a[168:171], a[80:83], v[56:59]
 ds_read_b64_tr_b16 a[160:161], v10 offset:19008
 v_mfma_f32_16x16x32_bf16 v[60:63], a[168:171], a[84:87], v[60:63]
 ds_read_b64_tr_b16 a[162:163], v10 offset:19264
 s_waitcnt lgkmcnt(5)
 s_mov_b32 s65, 1835008
 s_mov_b32 s66, 1605632
 s_add_u32 m0, s61, 118272
 v_mfma_f32_16x16x32_bf16 v[120:123], a[168:171], a[88:91], v[120:123]
 buffer_load_dwordx4 v4, s[8:11], s65 offen offset:0 lds
 v_mfma_f32_16x16x32_bf16 v[124:127], a[168:171], a[92:95], v[124:127]
 ds_read_b128 a[120:123], v15 offset:50752
 s_waitcnt lgkmcnt(10)
 v_mfma_f32_16x16x32_bf16 v[64:67], a[172:175], a[80:83], v[64:67]
 ds_read_b64_tr_b16 a[164:165], v10 offset:19040
 v_mfma_f32_16x16x32_bf16 v[68:71], a[172:175], a[84:87], v[68:71]
 ds_read_b64_tr_b16 a[166:167], v10 offset:19296
 v_mfma_f32_16x16x32_bf16 v[128:131], a[172:175], a[88:91], v[128:131]
 buffer_load_dwordx4 v5, s[8:11], s65 offen offset:1056 lds
 v_mfma_f32_16x16x32_bf16 v[132:135], a[172:175], a[92:95], v[132:135]
 s_waitcnt vmcnt(8)
 ds_read_b128 a[108:111], v15 offset:51712
 s_waitcnt lgkmcnt(10)
 v_mfma_f32_16x16x32_bf16 v[72:75], a[176:179], a[80:83], v[72:75]
 ds_read_b64_tr_b16 a[168:169], v10 offset:19072
 v_mfma_f32_16x16x32_bf16 v[76:79], a[176:179], a[84:87], v[76:79]
 ds_read_b64_tr_b16 a[170:171], v10 offset:19328
 v_mfma_f32_16x16x32_bf16 v[136:139], a[176:179], a[88:91], v[136:139]
 s_waitcnt vmcnt(7)
 buffer_load_dwordx4 v6, s[12:15], s66 offen offset:2080 lds
 v_cmp_eq_u32 vcc, v2, v11
 v_mfma_f32_16x16x32_bf16 v[140:143], a[176:179], a[92:95], v[140:143]
 ds_read_b128 a[124:127], v15 offset:51776
 s_waitcnt lgkmcnt(10)
 v_mfma_f32_16x16x32_bf16 v[144:147], a[180:183], a[80:83], v[144:147]
 ds_read_b64_tr_b16 a[172:173], v10 offset:19104
 s_cbranch_vccnz L_xslow
L_xok:
 v_mfma_f32_16x16x32_bf16 v[148:151], a[180:183], a[84:87], v[148:151]
 ds_read_b64_tr_b16 a[174:175], v10 offset:19360
 v_mfma_f32_16x16x32_bf16 v[152:155], a[180:183], a[88:91], v[152:155]
 buffer_load_dwordx4 v7, s[12:15], s66 offen offset:3136 lds
 v_mfma_f32_16x16x32_bf16 v[156:159], a[180:183], a[92:95], v[156:159]
 ds_read_b64_tr_b16 a[144:145], v14 offset:16896
 s_mul_i32 s92, s2, 3
 s_lshr_b32 s92, s92, 6
 s_waitcnt lgkmcnt(10)
 v_mfma_f32_16x16x32_bf16 v[160:163], a[160:163], a[80:83], v[160:163]
 ds_read_b64_tr_b16 a[176:177], v10 offset:19136
 v_min_u32 v11, 1, v1
 v_mfma_f32_16x16x32_bf16 v[164:167], a[160:163], a[84:87], v[164:167]
 ds_read_b64_tr_b16 a[178:179], v10 offset:19392
 s_add_u32 s70, s72, 8
 s_lshl_b32 s64, s70, 12
 s_add_u32 s64, s64, s71
 v_lshlrev_b32 v11, 31, v11
 v_mfma_f32_16x16x32_bf16 v[168:171], a[160:163], a[88:91], v[168:171]
 buffer_load_dwordx4 a[0:3], v8, s[16:19], s64 offen offset:0
 v_mfma_f32_16x16x32_bf16 v[172:175], a[160:163], a[92:95], v[172:175]
 ds_read_b64_tr_b16 a[146:147], v14 offset:17152
 s_add_u32 s92, s92, 12
 s_waitcnt lgkmcnt(10)
 v_mfma_f32_16x16x32_bf16 v[176:179], a[164:167], a[80:83], v[176:179]
 ds_read_b64_tr_b16 a[180:181], v10 offset:19168
 v_add_u32 v11, s2, v11
 v_mfma_f32_16x16x32_bf16 v[180:183], a[164:167], a[84:87], v[180:183]
 ds_read_b64_tr_b16 a[182:183], v10 offset:19424
 v_mov_b32 v12, 3
 v_mfma_f32_16x16x32_bf16 v[184:187], a[164:167], a[88:91], v[184:187]
 s_waitcnt vmcnt(9)
 buffer_load_dwordx4 a[4:7], v8, s[16:19], s64 offen offset:1024
 v_mfma_f32_16x16x32_bf16 v[188:191], a[164:167], a[92:95], v[188:191]
 s_barrier
 s_waitcnt lgkmcnt(9)
 v_mfma_f32_16x16x32_bf16 v[192:195], a[168:171], a[80:83], v[192:195]
 ds_read_b64_tr_b16 a[160:161], v10 offset:33792
 v_lshlrev_b32 v3, 2, v1
 v_mfma_f32_16x16x32_bf16 v[196:199], a[168:171], a[84:87], v[196:199]
 ds_read_b64_tr_b16 a[162:163], v10 offset:34048
 v_mov_b32 v2, s94
 v_mfma_f32_16x16x32_bf16 v[200:203], a[168:171], a[88:91], v[200:203]
 buffer_load_dwordx4 a[8:11], v8, s[16:19], s64 offen offset:2048
 v_mfma_f32_16x16x32_bf16 v[204:207], a[168:171], a[92:95], v[204:207]
 ds_read_b64_tr_b16 a[148:149], v14 offset:17024
 s_cmp_eq_u32 s3, 2
 s_cselect_b32 s92, s92, -1
 s_waitcnt lgkmcnt(9)
 v_mfma_f32_16x16x32_bf16 v[208:211], a[172:175], a[80:83], v[208:211]
 ds_read_b64_tr_b16 a[164:165], v10 offset:33824
 v_mfma_f32_16x16x32_bf16 v[212:215], a[172:175], a[84:87], v[212:215]
 ds_read_b64_tr_b16 a[166:167], v10 offset:34080
 v_mfma_f32_16x16x32_bf16 v[216:219], a[172:175], a[88:91], v[216:219]
 buffer_load_dwordx4 a[12:15], v8, s[16:19], s64 offen offset:3072
 v_mfma_f32_16x16x32_bf16 v[220:223], a[172:175], a[92:95], v[220:223]
 ds_read_b64_tr_b16 a[150:151], v14 offset:17280
 s_cmp_eq_u32 s3, 3
 s_cselect_b32 s93, 26, -1
 s_waitcnt lgkmcnt(9)
 v_mfma_f32_16x16x32_bf16 v[224:227], a[176:179], a[80:83], v[224:227]
 ds_read_b64_tr_b16 a[168:169], v10 offset:33856
 ds_read_b64_tr_b16 a[152:153], v14 offset:18976
 v_mfma_f32_16x16x32_bf16 v[228:231], a[176:179], a[84:87], v[228:231]
 ds_read_b64_tr_b16 a[170:171], v10 offset:34112
 ds_read_b64_tr_b16 a[154:155], v14 offset:19232
 v_mfma_f32_16x16x32_bf16 v[232:235], a[176:179], a[88:91], v[232:235]
 v_mfma_f32_16x16x32_bf16 v[236:239], a[176:179], a[92:95], v[236:239]
 ds_read_b64_tr_b16 a[156:157], v14 offset:19104
 ds_read_b64_tr_b16 a[158:159], v14 offset:19360
 s_waitcnt lgkmcnt(12)
 v_mfma_f32_16x16x32_bf16 v[240:243], a[180:183], a[80:83], v[240:243]
 ds_read_b64_tr_b16 a[172:173], v10 offset:33888
 v_mfma_f32_16x16x32_bf16 v[244:247], a[180:183], a[84:87], v[244:247]
 ds_read_b64_tr_b16 a[174:175], v10 offset:34144
 v_mfma_f32_16x16x32_bf16 v[248:251], a[180:183], a[88:91], v[248:251]
 v_mfma_f32_16x16x32_bf16 v[252:255], a[180:183], a[92:95], v[252:255]
 s_waitcnt lgkmcnt(15)
 v_mfma_f32_16x16x32_bf16 a[128:131], a[184:187], a[144:147], a[128:131]
 s_waitcnt lgkmcnt(8)
 v_mfma_f32_16x16x32_bf16 a[132:135], a[184:187], a[148:151], a[132:135]
 s_waitcnt lgkmcnt(4)
 v_mfma_f32_16x16x32_bf16 a[136:139], a[184:187], a[152:155], a[136:139]
 s_waitcnt lgkmcnt(2)
 v_mfma_f32_16x16x32_bf16 a[140:143], a[184:187], a[156:159], a[140:143]
 s_waitcnt vmcnt(63) lgkmcnt(12)
 v_mfma_f32_16x16x32_bf16 v[16:19], a[160:163], a[96:99], v[16:19]
 ds_read_b64_tr_b16 a[176:177], v10 offset:33920
 v_mfma_f32_16x16x32_bf16 v[20:23], a[160:163], a[100:103], v[20:23]
 ds_read_b64_tr_b16 a[178:179], v10 offset:34176
 s_add_u32 s70, s73, 9
 s_lshl_b32 s64, s70, 12
 s_add_u32 s64, s64, s71
 v_mfma_f32_16x16x32_bf16 v[80:83], a[160:163], a[104:107], v[80:83]
 buffer_load_dwordx4 a[16:19], v8, s[16:19], s64 offen offset:0
 v_mfma_f32_16x16x32_bf16 v[84:87], a[160:163], a[108:111], v[84:87]
 ds_read_b64_tr_b16 a[144:145], v14 offset:33792
 s_waitcnt lgkmcnt(12)
 v_mfma_f32_16x16x32_bf16 v[24:27], a[164:167], a[96:99], v[24:27]
 ds_read_b64_tr_b16 a[180:181], v10 offset:33952
 v_mfma_f32_16x16x32_bf16 v[28:31], a[164:167], a[100:103], v[28:31]
 ds_read_b64_tr_b16 a[182:183], v10 offset:34208
 v_mfma_f32_16x16x32_bf16 v[88:91], a[164:167], a[104:107], v[88:91]
 buffer_load_dwordx4 a[20:23], v8, s[16:19], s64 offen offset:1024
 v_mfma_f32_16x16x32_bf16 v[92:95], a[164:167], a[108:111], v[92:95]
 ds_read_b64_tr_b16 a[146:147], v14 offset:34048
 s_waitcnt lgkmcnt(11)
 v_mfma_f32_16x16x32_bf16 v[32:35], a[168:171], a[96:99], v[32:35]
 ds_read_b64_tr_b16 a[160:161], v10 offset:33984
 v_mfma_f32_16x16x32_bf16 v[36:39], a[168:171], a[100:103], v[36:39]
 ds_read_b64_tr_b16 a[162:163], v10 offset:34240
 v_mfma_f32_16x16x32_bf16 v[96:99], a[168:171], a[104:107], v[96:99]
 buffer_load_dwordx4 a[24:27], v8, s[16:19], s64 offen offset:2048
 v_mfma_f32_16x16x32_bf16 v[100:103], a[168:171], a[108:111], v[100:103]
 ds_read_b64_tr_b16 a[148:149], v14 offset:33920
 s_add_u32 s69, s69, 1
 s_waitcnt lgkmcnt(9)
 v_mfma_f32_16x16x32_bf16 v[40:43], a[172:175], a[96:99], v[40:43]
 ds_read_b64_tr_b16 a[164:165], v10 offset:34016
 v_mfma_f32_16x16x32_bf16 v[44:47], a[172:175], a[100:103], v[44:47]
 ds_read_b64_tr_b16 a[166:167], v10 offset:34272
 v_mfma_f32_16x16x32_bf16 v[104:107], a[172:175], a[104:107], v[104:107]
 buffer_load_dwordx4 a[28:31], v8, s[16:19], s64 offen offset:3072
 v_mfma_f32_16x16x32_bf16 v[108:111], a[172:175], a[108:111], v[108:111]
 ds_read_b64_tr_b16 a[150:151], v14 offset:34176
 s_waitcnt lgkmcnt(10)
 v_mfma_f32_16x16x32_bf16 v[48:51], a[176:179], a[96:99], v[48:51]
 ds_read_b64_tr_b16 a[168:169], v10 offset:35872
 v_mfma_f32_16x16x32_bf16 v[52:55], a[176:179], a[100:103], v[52:55]
 ds_read_b64_tr_b16 a[170:171], v10 offset:36128
 s_add_u32 s70, s74, 10
 s_lshl_b32 s65, s70, 18
 s_mul_i32 s66, s70, 229376
 s_add_u32 m0, s61, 33792
 v_mfma_f32_16x16x32_bf16 v[112:115], a[176:179], a[104:107], v[112:115]
 buffer_load_dwordx4 v4, s[8:11], s65 offen offset:0 lds
 v_mfma_f32_16x16x32_bf16 v[116:119], a[176:179], a[108:111], v[116:119]
 ds_read_b64_tr_b16 a[152:153], v14 offset:35872
 s_waitcnt lgkmcnt(10)
 v_mfma_f32_16x16x32_bf16 v[56:59], a[180:183], a[96:99], v[56:59]
 ds_read_b64_tr_b16 a[172:173], v10 offset:35904
 v_mfma_f32_16x16x32_bf16 v[60:63], a[180:183], a[100:103], v[60:63]
 ds_read_b64_tr_b16 a[174:175], v10 offset:36160
 v_mfma_f32_16x16x32_bf16 v[120:123], a[180:183], a[104:107], v[120:123]
 buffer_load_dwordx4 v5, s[8:11], s65 offen offset:1056 lds
 v_mfma_f32_16x16x32_bf16 v[124:127], a[180:183], a[108:111], v[124:127]
 ds_read_b64_tr_b16 a[154:155], v14 offset:36128
 s_waitcnt lgkmcnt(10)
 v_mfma_f32_16x16x32_bf16 v[64:67], a[160:163], a[96:99], v[64:67]
 ds_read_b64_tr_b16 a[176:177], v10 offset:35936
 v_mfma_f32_16x16x32_bf16 v[68:71], a[160:163], a[100:103], v[68:71]
 ds_read_b64_tr_b16 a[178:179], v10 offset:36192
 v_mfma_f32_16x16x32_bf16 v[128:131], a[160:163], a[104:107], v[128:131]
 buffer_load_dwordx4 v6, s[12:15], s66 offen offset:2080 lds
 v_mfma_f32_16x16x32_bf16 v[132:135], a[160:163], a[108:111], v[132:135]
 ds_read_b64_tr_b16 a[156:157], v14 offset:36000
 s_waitcnt lgkmcnt(10)
 v_mfma_f32_16x16x32_bf16 v[72:75], a[164:167], a[96:99], v[72:75]
 ds_read_b64_tr_b16 a[180:181], v10 offset:35968
 v_mfma_f32_16x16x32_bf16 v[76:79], a[164:167], a[100:103], v[76:79]
 ds_read_b64_tr_b16 a[182:183], v10 offset:36224
 v_mfma_f32_16x16x32_bf16 v[136:139], a[164:167], a[104:107], v[136:139]
 buffer_load_dwordx4 v7, s[12:15], s66 offen offset:3136 lds
 v_mfma_f32_16x16x32_bf16 v[140:143], a[164:167], a[108:111], v[140:143]
 ds_read_b64_tr_b16 a[158:159], v14 offset:36256
 s_waitcnt lgkmcnt(10)
 v_mfma_f32_16x16x32_bf16 v[144:147], a[168:171], a[96:99], v[144:147]
 ds_read_b64_tr_b16 a[160:161], v10 offset:36000
 v_mfma_f32_16x16x32_bf16 v[148:151], a[168:171], a[100:103], v[148:151]
 ds_read_b64_tr_b16 a[162:163], v10 offset:36256
 s_add_u32 s70, s74, 10
 s_lshl_b32 s64, s70, 12
 s_add_u32 s64, s64, s71
 v_mfma_f32_16x16x32_bf16 v[152:155], a[168:171], a[104:107], v[152:155]
 buffer_load_dwordx4 a[32:35], v8, s[16:19], s64 offen offset:0
 v_mfma_f32_16x16x32_bf16 v[156:159], a[168:171], a[108:111], v[156:159]
 s_waitcnt lgkmcnt(9)
 v_mfma_f32_16x16x32_bf16 v[160:163], a[172:175], a[96:99], v[160:163]
 ds_read_b64_tr_b16 a[164:165], v10 offset:36032
 v_mfma_f32_16x16x32_bf16 v[164:167], a[172:175], a[100:103], v[164:167]
 ds_read_b64_tr_b16 a[166:167], v10 offset:36288
 v_mfma_f32_16x16x32_bf16 v[168:171], a[172:175], a[104:107], v[168:171]
 buffer_load_dwordx4 a[36:39], v8, s[16:19], s64 offen offset:1024
 v_mfma_f32_16x16x32_bf16 v[172:175], a[172:175], a[108:111], v[172:175]
 s_waitcnt lgkmcnt(8)
 v_mfma_f32_16x16x32_bf16 v[176:179], a[176:179], a[96:99], v[176:179]
 ds_read_b64_tr_b16 a[168:169], v10 offset:36064
 v_mfma_f32_16x16x32_bf16 v[180:183], a[176:179], a[100:103], v[180:183]
 ds_read_b64_tr_b16 a[170:171], v10 offset:36320
 v_mfma_f32_16x16x32_bf16 v[184:187], a[176:179], a[104:107], v[184:187]
 s_waitcnt vmcnt(14)
 buffer_load_dwordx4 a[40:43], v8, s[16:19], s64 offen offset:2048
 v_mfma_f32_16x16x32_bf16 v[188:191], a[176:179], a[108:111], v[188:191]
 s_barrier
 s_waitcnt lgkmcnt(7)
 v_mfma_f32_16x16x32_bf16 v[192:195], a[180:183], a[96:99], v[192:195]
 ds_read_b64_tr_b16 a[172:173], v10 offset:50688
 v_mfma_f32_16x16x32_bf16 v[196:199], a[180:183], a[100:103], v[196:199]
 ds_read_b64_tr_b16 a[174:175], v10 offset:50944
 v_mfma_f32_16x16x32_bf16 v[200:203], a[180:183], a[104:107], v[200:203]
 buffer_load_dwordx4 a[44:47], v8, s[16:19], s64 offen offset:3072
 v_mfma_f32_16x16x32_bf16 v[204:207], a[180:183], a[108:111], v[204:207]
 s_waitcnt lgkmcnt(6)
 v_mfma_f32_16x16x32_bf16 v[208:211], a[160:163], a[96:99], v[208:211]
 ds_read_b64_tr_b16 a[176:177], v10 offset:50720
 v_mfma_f32_16x16x32_bf16 v[212:215], a[160:163], a[100:103], v[212:215]
 ds_read_b64_tr_b16 a[178:179], v10 offset:50976
 s_add_u32 s70, s75, 11
 s_lshl_b32 s65, s70, 18
 s_mul_i32 s66, s70, 229376
 s_add_u32 m0, s61, 50688
 v_mfma_f32_16x16x32_bf16 v[216:219], a[160:163], a[104:107], v[216:219]
 buffer_load_dwordx4 v4, s[8:11], s65 offen offset:0 lds
 v_mfma_f32_16x16x32_bf16 v[220:223], a[160:163], a[108:111], v[220:223]
 s_waitcnt lgkmcnt(6)
 v_mfma_f32_16x16x32_bf16 v[224:227], a[164:167], a[96:99], v[224:227]
 ds_read_b64_tr_b16 a[180:181], v10 offset:50752
 v_mfma_f32_16x16x32_bf16 v[228:231], a[164:167], a[100:103], v[228:231]
 ds_read_b64_tr_b16 a[182:183], v10 offset:51008
 v_mfma_f32_16x16x32_bf16 v[232:235], a[164:167], a[104:107], v[232:235]
 s_cmp_eq_u32 s69, s92
 s_cbranch_scc1 L_arr6d
L_arr6:
 buffer_load_dwordx4 v5, s[8:11], s65 offen offset:1056 lds
 v_mfma_f32_16x16x32_bf16 v[236:239], a[164:167], a[108:111], v[236:239]
 s_waitcnt lgkmcnt(6)
 v_mfma_f32_16x16x32_bf16 v[240:243], a[168:171], a[96:99], v[240:243]
 ds_read_b64_tr_b16 a[160:161], v10 offset:50784
 v_mfma_f32_16x16x32_bf16 v[244:247], a[168:171], a[100:103], v[244:247]
 ds_read_b64_tr_b16 a[162:163], v10 offset:51040
 v_mfma_f32_16x16x32_bf16 v[248:251], a[168:171], a[104:107], v[248:251]
 buffer_load_dwordx4 v6, s[12:15], s66 offen offset:2080 lds
 v_mfma_f32_16x16x32_bf16 v[252:255], a[168:171], a[108:111], v[252:255]
 s_waitcnt lgkmcnt(15)
 v_mfma_f32_16x16x32_bf16 a[128:131], a[184:187], a[144:147], a[128:131]
 s_waitcnt lgkmcnt(15)
 v_mfma_f32_16x16x32_bf16 a[132:135], a[184:187], a[148:151], a[132:135]
 s_waitcnt lgkmcnt(15)
 v_mfma_f32_16x16x32_bf16 a[136:139], a[184:187], a[152:155], a[136:139]
 buffer_load_dwordx4 v7, s[12:15], s66 offen offset:3136 lds
 s_waitcnt lgkmcnt(14)
 v_mfma_f32_16x16x32_bf16 a[140:143], a[184:187], a[156:159], a[140:143]
 s_waitcnt vmcnt(63) lgkmcnt(6)
 v_mfma_f32_16x16x32_bf16 v[16:19], a[172:175], a[112:115], v[16:19]
 ds_read_b64_tr_b16 a[164:165], v10 offset:50816
 v_mfma_f32_16x16x32_bf16 v[20:23], a[172:175], a[116:119], v[20:23]
 ds_read_b64_tr_b16 a[166:167], v10 offset:51072
 v_mfma_f32_16x16x32_bf16 v[80:83], a[172:175], a[120:123], v[80:83]
 v_mfma_f32_16x16x32_bf16 v[84:87], a[172:175], a[124:127], v[84:87]
 ds_read_b64_tr_b16 a[144:145], v14 offset:50688
 s_waitcnt lgkmcnt(7)
 v_mfma_f32_16x16x32_bf16 v[24:27], a[176:179], a[112:115], v[24:27]
 ds_read_b64_tr_b16 a[168:169], v10 offset:50848
 v_mfma_f32_16x16x32_bf16 v[28:31], a[176:179], a[116:119], v[28:31]
 ds_read_b64_tr_b16 a[170:171], v10 offset:51104
 s_add_u32 s70, s75, 11
 s_lshl_b32 s64, s70, 12
 s_add_u32 s64, s64, s71
 v_mfma_f32_16x16x32_bf16 v[88:91], a[176:179], a[120:123], v[88:91]
 buffer_load_dwordx4 a[48:51], v8, s[16:19], s64 offen offset:0
 v_mfma_f32_16x16x32_bf16 v[92:95], a[176:179], a[124:127], v[92:95]
 ds_read_b64_tr_b16 a[146:147], v14 offset:50944
 s_waitcnt lgkmcnt(8)
 v_mfma_f32_16x16x32_bf16 v[32:35], a[180:183], a[112:115], v[32:35]
 ds_read_b64_tr_b16 a[172:173], v10 offset:50880
 v_mfma_f32_16x16x32_bf16 v[36:39], a[180:183], a[116:119], v[36:39]
 ds_read_b64_tr_b16 a[174:175], v10 offset:51136
 v_mfma_f32_16x16x32_bf16 v[96:99], a[180:183], a[120:123], v[96:99]
 s_branch L_pg3k
L_pg3:
L_ic1w3:
 s_branch L_pg7
L_pg3k:
 buffer_load_dwordx4 a[52:55], v8, s[16:19], s64 offen offset:1024
 v_mfma_f32_16x16x32_bf16 v[100:103], a[180:183], a[124:127], v[100:103]
 ds_read_b64_tr_b16 a[148:149], v14 offset:50816
 s_add_u32 s69, s69, 1
 s_waitcnt lgkmcnt(9)
 v_mfma_f32_16x16x32_bf16 v[40:43], a[160:163], a[112:115], v[40:43]
 ds_read_b64_tr_b16 a[176:177], v10 offset:50912
 v_mfma_f32_16x16x32_bf16 v[44:47], a[160:163], a[116:119], v[44:47]
 ds_read_b64_tr_b16 a[178:179], v10 offset:51168
 v_mfma_f32_16x16x32_bf16 v[104:107], a[160:163], a[120:123], v[104:107]
 buffer_load_dwordx4 a[56:59], v8, s[16:19], s64 offen offset:2048
 v_mfma_f32_16x16x32_bf16 v[108:111], a[160:163], a[124:127], v[108:111]
 ds_read_b64_tr_b16 a[150:151], v14 offset:51072
 s_waitcnt lgkmcnt(10)
 v_mfma_f32_16x16x32_bf16 v[48:51], a[164:167], a[112:115], v[48:51]
 ds_read_b64_tr_b16 a[180:181], v10 offset:52768
 v_mfma_f32_16x16x32_bf16 v[52:55], a[164:167], a[116:119], v[52:55]
 ds_read_b64_tr_b16 a[182:183], v10 offset:53024
 v_mfma_f32_16x16x32_bf16 v[112:115], a[164:167], a[120:123], v[112:115]
 buffer_load_dwordx4 a[60:63], v8, s[16:19], s64 offen offset:3072
 v_mfma_f32_16x16x32_bf16 v[116:119], a[164:167], a[124:127], v[116:119]
 ds_read_b64_tr_b16 a[152:153], v14 offset:52768
 s_waitcnt lgkmcnt(10)
 v_mfma_f32_16x16x32_bf16 v[56:59], a[168:171], a[112:115], v[56:59]
 ds_read_b64_tr_b16 a[160:161], v10 offset:52800
 v_mfma_f32_16x16x32_bf16 v[60:63], a[168:171], a[116:119], v[60:63]
 ds_read_b64_tr_b16 a[162:163], v10 offset:53056
 s_add_u32 s70, s72, 12
 s_lshl_b32 s65, s70, 18
 s_mul_i32 s66, s70, 229376
 s_add_u32 m0, s61, 67584
 v_mfma_f32_16x16x32_bf16 v[120:123], a[168:171], a[120:123], v[120:123]
 buffer_load_dwordx4 v4, s[8:11], s65 offen offset:0 lds
 v_mfma_f32_16x16x32_bf16 v[124:127], a[168:171], a[124:127], v[124:127]
 ds_read_b64_tr_b16 a[154:155], v14 offset:53024
 s_waitcnt lgkmcnt(10)
 v_mfma_f32_16x16x32_bf16 v[64:67], a[172:175], a[112:115], v[64:67]
 ds_read_b64_tr_b16 a[164:165], v10 offset:52832
 v_mfma_f32_16x16x32_bf16 v[68:71], a[172:175], a[116:119], v[68:71]
 ds_read_b64_tr_b16 a[166:167], v10 offset:53088
 v_mfma_f32_16x16x32_bf16 v[128:131], a[172:175], a[120:123], v[128:131]
 buffer_load_dwordx4 v5, s[8:11], s65 offen offset:1056 lds
 v_mfma_f32_16x16x32_bf16 v[132:135], a[172:175], a[124:127], v[132:135]
 ds_read_b64_tr_b16 a[156:157], v14 offset:52896
 s_waitcnt lgkmcnt(10)
 v_mfma_f32_16x16x32_bf16 v[72:75], a[176:179], a[112:115], v[72:75]
 ds_read_b64_tr_b16 a[168:169], v10 offset:52864
 v_mfma_f32_16x16x32_bf16 v[76:79], a[176:179], a[116:119], v[76:79]
 ds_read_b64_tr_b16 a[170:171], v10 offset:53120
 v_mfma_f32_16x16x32_bf16 v[136:139], a[176:179], a[120:123], v[136:139]
 buffer_load_dwordx4 v6, s[12:15], s66 offen offset:2080 lds
 v_mfma_f32_16x16x32_bf16 v[140:143], a[176:179], a[124:127], v[140:143]
 ds_read_b64_tr_b16 a[158:159], v14 offset:53152
 s_waitcnt lgkmcnt(10)
 v_mfma_f32_16x16x32_bf16 v[144:147], a[180:183], a[112:115], v[144:147]
 ds_read_b64_tr_b16 a[172:173], v10 offset:52896
 v_mfma_f32_16x16x32_bf16 v[148:151], a[180:183], a[116:119], v[148:151]
 ds_read_b64_tr_b16 a[174:175], v10 offset:53152
 v_mfma_f32_16x16x32_bf16 v[152:155], a[180:183], a[120:123], v[152:155]
 buffer_load_dwordx4 v7, s[12:15], s66 offen offset:3136 lds
 v_mfma_f32_16x16x32_bf16 v[156:159], a[180:183], a[124:127], v[156:159]
 s_waitcnt lgkmcnt(9)
 v_mfma_f32_16x16x32_bf16 v[160:163], a[160:163], a[112:115], v[160:163]
 ds_read_b64_tr_b16 a[176:177], v10 offset:52928
 v_mfma_f32_16x16x32_bf16 v[164:167], a[160:163], a[116:119], v[164:167]
 ds_read_b64_tr_b16 a[178:179], v10 offset:53184
 s_add_u32 s70, s72, 12
 s_lshl_b32 s64, s70, 12
 s_add_u32 s64, s64, s71
 v_mfma_f32_16x16x32_bf16 v[168:171], a[160:163], a[120:123], v[168:171]
 buffer_load_dwordx4 a[64:67], v8, s[16:19], s64 offen offset:0
 v_mfma_f32_16x16x32_bf16 v[172:175], a[160:163], a[124:127], v[172:175]
 s_waitcnt lgkmcnt(8)
 v_mfma_f32_16x16x32_bf16 v[176:179], a[164:167], a[112:115], v[176:179]
 ds_read_b64_tr_b16 a[180:181], v10 offset:52960
 v_mfma_f32_16x16x32_bf16 v[180:183], a[164:167], a[116:119], v[180:183]
 ds_read_b64_tr_b16 a[182:183], v10 offset:53216
 v_mfma_f32_16x16x32_bf16 v[184:187], a[164:167], a[120:123], v[184:187]
 s_waitcnt vmcnt(29)
 buffer_load_dwordx4 a[68:71], v8, s[16:19], s64 offen offset:1024
 v_mfma_f32_16x16x32_bf16 v[188:191], a[164:167], a[124:127], v[188:191]
 s_barrier
 s_waitcnt lgkmcnt(7)
 v_mfma_f32_16x16x32_bf16 v[192:195], a[168:171], a[112:115], v[192:195]
 ds_read_b64_tr_b16 a[160:161], v9 offset:0
 v_mfma_f32_16x16x32_bf16 v[196:199], a[168:171], a[116:119], v[196:199]
 ds_read_b64_tr_b16 a[162:163], v9 offset:256
 v_mfma_f32_16x16x32_bf16 v[200:203], a[168:171], a[120:123], v[200:203]
 buffer_load_dwordx4 a[72:75], v8, s[16:19], s64 offen offset:2048
 v_mfma_f32_16x16x32_bf16 v[204:207], a[168:171], a[124:127], v[204:207]
 s_waitcnt lgkmcnt(6)
 v_mfma_f32_16x16x32_bf16 v[208:211], a[172:175], a[112:115], v[208:211]
 ds_read_b64_tr_b16 a[164:165], v9 offset:16896
 v_mfma_f32_16x16x32_bf16 v[212:215], a[172:175], a[116:119], v[212:215]
 ds_read_b64_tr_b16 a[166:167], v9 offset:17152
 v_mfma_f32_16x16x32_bf16 v[216:219], a[172:175], a[120:123], v[216:219]
 buffer_load_dwordx4 a[76:79], v8, s[16:19], s64 offen offset:3072
 v_mfma_f32_16x16x32_bf16 v[220:223], a[172:175], a[124:127], v[220:223]
 s_waitcnt lgkmcnt(6)
 v_mfma_f32_16x16x32_bf16 v[224:227], a[176:179], a[112:115], v[224:227]
 ds_read_b64_tr_b16 a[168:169], v9 offset:32
 v_mfma_f32_16x16x32_bf16 v[228:231], a[176:179], a[116:119], v[228:231]
 ds_read_b64_tr_b16 a[170:171], v9 offset:288
 v_mfma_f32_16x16x32_bf16 v[232:235], a[176:179], a[120:123], v[232:235]
 s_cmp_eq_u32 s69, s92
 s_cbranch_scc1 L_arr7d
L_arr7:
 v_mfma_f32_16x16x32_bf16 v[236:239], a[176:179], a[124:127], v[236:239]
 s_waitcnt lgkmcnt(6)
 v_mfma_f32_16x16x32_bf16 v[240:243], a[180:183], a[112:115], v[240:243]
 ds_read_b64_tr_b16 a[172:173], v9 offset:16928
 v_mfma_f32_16x16x32_bf16 v[244:247], a[180:183], a[116:119], v[244:247]
 ds_read_b64_tr_b16 a[174:175], v9 offset:17184
 v_mfma_f32_16x16x32_bf16 v[248:251], a[180:183], a[120:123], v[248:251]
 v_mfma_f32_16x16x32_bf16 v[252:255], a[180:183], a[124:127], v[252:255]
 s_waitcnt lgkmcnt(15)
 v_mfma_f32_16x16x32_bf16 a[128:131], a[184:187], a[144:147], a[128:131]
 s_waitcnt lgkmcnt(15)
 v_mfma_f32_16x16x32_bf16 a[132:135], a[184:187], a[148:151], a[132:135]
 s_waitcnt lgkmcnt(15)
 v_mfma_f32_16x16x32_bf16 a[136:139], a[184:187], a[152:155], a[136:139]
 s_waitcnt lgkmcnt(14)
 v_mfma_f32_16x16x32_bf16 a[140:143], a[184:187], a[156:159], a[140:143]
 s_mov_b32 s68, 2
 s_branch L_g1
L_arr6d:
 buffer_store_byte v12, v11, s[36:39], 0 offen sc0 sc1
 s_branch L_arr6
L_arr7d:
 buffer_store_byte v12, v11, s[36:39], 0 offen sc0 sc1
 s_branch L_arr7
L_arr8d:
 buffer_store_byte v12, v11, s[36:39], 0 offen sc0 sc1
 s_branch L_arr8
L_arr9d:
 buffer_store_byte v12, v11, s[36:39], 0 offen sc0 sc1
 s_branch L_arr9
L_arr10d:
 buffer_store_byte v12, v11, s[36:39], 0 offen sc0 sc1
 s_branch L_arr10
L_arr11d:
 buffer_store_byte v12, v11, s[36:39], 0 offen sc0 sc1
 s_branch L_arr11
L_dochk:
 buffer_load_dword v2, v3, s[36:39], 0 offen sc0 sc1
 s_branch L_nochk
L_arr12d:
 buffer_store_byte v12, v11, s[36:39], 0 offen sc0 sc1
 s_branch L_arr12
L_arr13d:
 buffer_store_byte v12, v11, s[36:39], 0 offen sc0 sc1
 s_branch L_arr13
L_arr14d:
 buffer_store_byte v12, v11, s[36:39], 0 offen sc0 sc1
 s_branch L_arr14
L_arr15d:
 buffer_store_byte v12, v11, s[36:39], 0 offen sc0 sc1
 s_branch L_arr15
L_g1:
 s_waitcnt vmcnt(24) lgkmcnt(4)
 v_mfma_f32_16x16x32_bf16 v[16:19], a[160:163], a[0:3], v[16:19]
 ds_read_b64_tr_b16 a[176:177], v9 offset:64
 s_add_u32 s70, s69, s73
 v_mfma_f32_16x16x32_bf16 v[16:19], a[164:167], a[16:19], v[16:19]
 ds_read_b64_tr_b16 a[178:179], v9 offset:320
 v_mfma_f32_16x16x32_bf16 v[20:23], a[164:167], a[20:23], v[20:23]
 v_mfma_f32_16x16x32_bf16 v[20:23], a[160:163], a[4:7], v[20:23]
 s_lshl_b32 s65, s70, 18
 s_lshl_b32 s64, s70, 12
 v_mfma_f32_16x16x32_bf16 v[80:83], a[160:163], a[8:11], v[80:83]
 ds_read_b64_tr_b16 a[180:181], v9 offset:16960
 s_add_u32 s64, s64, s71
 v_mfma_f32_16x16x32_bf16 v[80:83], a[164:167], a[24:27], v[80:83]
 ds_read_b64_tr_b16 a[182:183], v9 offset:17216
 s_mul_i32 s66, s70, 229376
 v_mfma_f32_16x16x32_bf16 v[84:87], a[164:167], a[28:31], v[84:87]
 buffer_load_dwordx4 a[80:83], v8, s[16:19], s64 offen offset:0
 v_mfma_f32_16x16x32_bf16 v[84:87], a[160:163], a[12:15], v[84:87]
 s_add_u32 s69, s69, 1
 s_waitcnt lgkmcnt(4)
 v_mfma_f32_16x16x32_bf16 v[92:95], a[168:171], a[12:15], v[92:95]
 ds_read_b64_tr_b16 a[160:161], v9 offset:96
 s_add_u32 m0, s61, 84480
 v_mfma_f32_16x16x32_bf16 v[92:95], a[172:175], a[28:31], v[92:95]
 ds_read_b64_tr_b16 a[162:163], v9 offset:352
 v_mfma_f32_16x16x32_bf16 v[88:91], a[172:175], a[24:27], v[88:91]
 buffer_load_dwordx4 v4, s[8:11], s65 offen offset:0 lds
 v_mfma_f32_16x16x32_bf16 v[88:91], a[168:171], a[8:11], v[88:91]
 v_mfma_f32_16x16x32_bf16 v[28:31], a[168:171], a[4:7], v[28:31]
 ds_read_b64_tr_b16 a[164:165], v9 offset:16992
 v_mfma_f32_16x16x32_bf16 v[28:31], a[172:175], a[20:23], v[28:31]
 ds_read_b64_tr_b16 a[166:167], v9 offset:17248
 v_mfma_f32_16x16x32_bf16 v[24:27], a[172:175], a[16:19], v[24:27]
 buffer_load_dwordx4 a[84:87], v8, s[16:19], s64 offen offset:1024
 v_mfma_f32_16x16x32_bf16 v[24:27], a[168:171], a[0:3], v[24:27]
 s_waitcnt lgkmcnt(4)
 v_mfma_f32_16x16x32_bf16 v[32:35], a[176:179], a[0:3], v[32:35]
 ds_read_b64_tr_b16 a[168:169], v9 offset:128
 v_mfma_f32_16x16x32_bf16 v[32:35], a[180:183], a[16:19], v[32:35]
 ds_read_b64_tr_b16 a[170:171], v9 offset:384
 v_mfma_f32_16x16x32_bf16 v[36:39], a[180:183], a[20:23], v[36:39]
 buffer_load_dwordx4 v5, s[8:11], s65 offen offset:1056 lds
 v_mfma_f32_16x16x32_bf16 v[36:39], a[176:179], a[4:7], v[36:39]
 v_mfma_f32_16x16x32_bf16 v[96:99], a[176:179], a[8:11], v[96:99]
 ds_read_b64_tr_b16 a[172:173], v9 offset:17024
 v_mfma_f32_16x16x32_bf16 v[96:99], a[180:183], a[24:27], v[96:99]
 ds_read_b64_tr_b16 a[174:175], v9 offset:17280
 v_mfma_f32_16x16x32_bf16 v[100:103], a[180:183], a[28:31], v[100:103]
 buffer_load_dwordx4 a[88:91], v8, s[16:19], s64 offen offset:2048
 v_mfma_f32_16x16x32_bf16 v[100:103], a[176:179], a[12:15], v[100:103]
 s_waitcnt lgkmcnt(4)
 v_mfma_f32_16x16x32_bf16 v[108:111], a[160:163], a[12:15], v[108:111]
 ds_read_b64_tr_b16 a[176:177], v9 offset:160
 v_mfma_f32_16x16x32_bf16 v[108:111], a[164:167], a[28:31], v[108:111]
 ds_read_b64_tr_b16 a[178:179], v9 offset:416
 v_mfma_f32_16x16x32_bf16 v[104:107], a[164:167], a[24:27], v[104:107]
 buffer_load_dwordx4 v6, s[12:15], s66 offen offset:2080 lds
 v_mfma_f32_16x16x32_bf16 v[104:107], a[160:163], a[8:11], v[104:107]
 v_mfma_f32_16x16x32_bf16 v[44:47], a[160:163], a[4:7], v[44:47]
 ds_read_b64_tr_b16 a[180:181], v9 offset:17056
 v_mfma_f32_16x16x32_bf16 v[44:47], a[164:167], a[20:23], v[44:47]
 ds_read_b64_tr_b16 a[182:183], v9 offset:17312
 v_mfma_f32_16x16x32_bf16 v[40:43], a[164:167], a[16:19], v[40:43]
 buffer_load_dwordx4 a[92:95], v8, s[16:19], s64 offen offset:3072
 v_mfma_f32_16x16x32_bf16 v[40:43], a[160:163], a[0:3], v[40:43]
 s_waitcnt lgkmcnt(4)
 v_mfma_f32_16x16x32_bf16 v[48:51], a[168:171], a[0:3], v[48:51]
 ds_read_b64_tr_b16 a[160:161], v9 offset:192
 v_mfma_f32_16x16x32_bf16 v[48:51], a[172:175], a[16:19], v[48:51]
 ds_read_b64_tr_b16 a[162:163], v9 offset:448
 v_mfma_f32_16x16x32_bf16 v[52:55], a[172:175], a[20:23], v[52:55]
 buffer_load_dwordx4 v7, s[12:15], s66 offen offset:3136 lds
 v_mfma_f32_16x16x32_bf16 v[52:55], a[168:171], a[4:7], v[52:55]
 v_mfma_f32_16x16x32_bf16 v[112:115], a[168:171], a[8:11], v[112:115]
 ds_read_b64_tr_b16 a[164:165], v9 offset:17088
 v_mfma_f32_16x16x32_bf16 v[112:115], a[172:175], a[24:27], v[112:115]
 ds_read_b64_tr_b16 a[166:167], v9 offset:17344
 v_mfma_f32_16x16x32_bf16 v[116:119], a[172:175], a[28:31], v[116:119]
 v_mfma_f32_16x16x32_bf16 v[116:119], a[168:171], a[12:15], v[116:119]
 s_waitcnt lgkmcnt(4)
 v_mfma_f32_16x16x32_bf16 v[124:127], a[176:179], a[12:15], v[124:127]
 ds_read_b64_tr_b16 a[168:169], v9 offset:224
 v_mfma_f32_16x16x32_bf16 v[124:127], a[180:183], a[28:31], v[124:127]
 ds_read_b64_tr_b16 a[170:171], v9 offset:480
 v_mfma_f32_16x16x32_bf16 v[120:123], a[180:183], a[24:27], v[120:123]
 v_mfma_f32_16x16x32_bf16 v[120:123], a[176:179], a[8:11], v[120:123]
 v_mfma_f32_16x16x32_bf16 v[60:63], a[176:179], a[4:7], v[60:63]
 ds_read_b64_tr_b16 a[172:173], v9 offset:17120
 v_mfma_f32_16x16x32_bf16 v[60:63], a[180:183], a[20:23], v[60:63]
 ds_read_b64_tr_b16 a[174:175], v9 offset:17376
 v_mfma_f32_16x16x32_bf16 v[56:59], a[180:183], a[16:19], v[56:59]
 v_mfma_f32_16x16x32_bf16 v[56:59], a[176:179], a[0:3], v[56:59]
 s_waitcnt lgkmcnt(4)
 v_mfma_f32_16x16x32_bf16 v[64:67], a[160:163], a[0:3], v[64:67]
 ds_read_b64_tr_b16 a[176:177], v9 offset:2080
 v_mfma_f32_16x16x32_bf16 v[64:67], a[164:167], a[16:19], v[64:67]
 ds_read_b64_tr_b16 a[178:179], v9 offset:2336
 v_mfma_f32_16x16x32_bf16 v[68:71], a[164:167], a[20:23], v[68:71]
 v_mfma_f32_16x16x32_bf16 v[68:71], a[160:163], a[4:7], v[68:71]
 v_mfma_f32_16x16x32_bf16 v[128:131], a[160:163], a[8:11], v[128:131]
 ds_read_b64_tr_b16 a[180:181], v9 offset:18976
 v_mfma_f32_16x16x32_bf16 v[128:131], a[164:167], a[24:27], v[128:131]
 ds_read_b64_tr_b16 a[182:183], v9 offset:19232
 v_mfma_f32_16x16x32_bf16 v[132:135], a[164:167], a[28:31], v[132:135]
 s_cmp_eq_u32 s69, s92
 s_cbranch_scc1 L_arr8d
L_arr8:
 v_mfma_f32_16x16x32_bf16 v[132:135], a[160:163], a[12:15], v[132:135]
 s_waitcnt lgkmcnt(4)
 v_mfma_f32_16x16x32_bf16 v[140:143], a[168:171], a[12:15], v[140:143]
 ds_read_b64_tr_b16 a[160:161], v9 offset:2112
 v_mfma_f32_16x16x32_bf16 v[140:143], a[172:175], a[28:31], v[140:143]
 ds_read_b64_tr_b16 a[162:163], v9 offset:2368
 v_mfma_f32_16x16x32_bf16 v[136:139], a[172:175], a[24:27], v[136:139]
 v_mfma_f32_16x16x32_bf16 v[136:139], a[168:171], a[8:11], v[136:139]
 v_mfma_f32_16x16x32_bf16 v[76:79], a[168:171], a[4:7], v[76:79]
 ds_read_b64_tr_b16 a[164:165], v9 offset:19008
 s_add_u32 s70, s69, s74
 v_mfma_f32_16x16x32_bf16 v[76:79], a[172:175], a[20:23], v[76:79]
 ds_read_b64_tr_b16 a[166:167], v9 offset:19264
 v_mfma_f32_16x16x32_bf16 v[72:75], a[172:175], a[16:19], v[72:75]
 v_mfma_f32_16x16x32_bf16 v[72:75], a[168:171], a[0:3], v[72:75]
 s_lshl_b32 s65, s70, 18
 s_lshl_b32 s64, s70, 12
 s_waitcnt lgkmcnt(4)
 v_mfma_f32_16x16x32_bf16 v[144:147], a[176:179], a[0:3], v[144:147]
 ds_read_b64_tr_b16 a[168:169], v9 offset:2144
 s_add_u32 s64, s64, s71
 v_mfma_f32_16x16x32_bf16 v[144:147], a[180:183], a[16:19], v[144:147]
 ds_read_b64_tr_b16 a[170:171], v9 offset:2400
 s_mul_i32 s66, s70, 229376
 v_mfma_f32_16x16x32_bf16 v[148:151], a[180:183], a[20:23], v[148:151]
 buffer_load_dwordx4 a[96:99], v8, s[16:19], s64 offen offset:0
 v_mfma_f32_16x16x32_bf16 v[148:151], a[176:179], a[4:7], v[148:151]
 s_add_u32 s69, s69, 1
 v_mfma_f32_16x16x32_bf16 v[152:155], a[176:179], a[8:11], v[152:155]
 ds_read_b64_tr_b16 a[172:173], v9 offset:19040
 s_add_u32 m0, s61, 101376
 v_mfma_f32_16x16x32_bf16 v[152:155], a[180:183], a[24:27], v[152:155]
 ds_read_b64_tr_b16 a[174:175], v9 offset:19296
 v_mfma_f32_16x16x32_bf16 v[156:159], a[180:183], a[28:31], v[156:159]
 buffer_load_dwordx4 v4, s[8:11], s65 offen offset:0 lds
 v_mfma_f32_16x16x32_bf16 v[156:159], a[176:179], a[12:15], v[156:159]
 s_waitcnt lgkmcnt(4)
 v_mfma_f32_16x16x32_bf16 v[172:175], a[160:163], a[12:15], v[172:175]
 ds_read_b64_tr_b16 a[176:177], v9 offset:2176
 v_mfma_f32_16x16x32_bf16 v[172:175], a[164:167], a[28:31], v[172:175]
 ds_read_b64_tr_b16 a[178:179], v9 offset:2432
 v_mfma_f32_16x16x32_bf16 v[168:171], a[164:167], a[24:27], v[168:171]
 buffer_load_dwordx4 a[100:103], v8, s[16:19], s64 offen offset:1024
 v_mfma_f32_16x16x32_bf16 v[168:171], a[160:163], a[8:11], v[168:171]
 v_mfma_f32_16x16x32_bf16 v[164:167], a[160:163], a[4:7], v[164:167]
 ds_read_b64_tr_b16 a[180:181], v9 offset:19072
 v_mfma_f32_16x16x32_bf16 v[164:167], a[164:167], a[20:23], v[164:167]
 ds_read_b64_tr_b16 a[182:183], v9 offset:19328
 v_mfma_f32_16x16x32_bf16 v[160:163], a[164:167], a[16:19], v[160:163]
 buffer_load_dwordx4 v5, s[8:11], s65 offen offset:1056 lds
 v_mfma_f32_16x16x32_bf16 v[160:163], a[160:163], a[0:3], v[160:163]
 s_waitcnt lgkmcnt(4)
 v_mfma_f32_16x16x32_bf16 v[176:179], a[168:171], a[0:3], v[176:179]
 ds_read_b64_tr_b16 a[160:161], v9 offset:2208
 v_mfma_f32_16x16x32_bf16 v[176:179], a[172:175], a[16:19], v[176:179]
 ds_read_b64_tr_b16 a[162:163], v9 offset:2464
 v_mfma_f32_16x16x32_bf16 v[180:183], a[172:175], a[20:23], v[180:183]
 buffer_load_dwordx4 a[104:107], v8, s[16:19], s64 offen offset:2048
 v_mfma_f32_16x16x32_bf16 v[180:183], a[168:171], a[4:7], v[180:183]
 v_mfma_f32_16x16x32_bf16 v[184:187], a[168:171], a[8:11], v[184:187]
 ds_read_b64_tr_b16 a[164:165], v9 offset:19104
 v_mfma_f32_16x16x32_bf16 v[184:187], a[172:175], a[24:27], v[184:187]
 ds_read_b64_tr_b16 a[166:167], v9 offset:19360
 v_mfma_f32_16x16x32_bf16 v[188:191], a[172:175], a[28:31], v[188:191]
 buffer_load_dwordx4 v6, s[12:15], s66 offen offset:2080 lds
 v_mfma_f32_16x16x32_bf16 v[188:191], a[168:171], a[12:15], v[188:191]
 s_waitcnt lgkmcnt(4)
 v_mfma_f32_16x16x32_bf16 v[204:207], a[176:179], a[12:15], v[204:207]
 ds_read_b64_tr_b16 a[168:169], v9 offset:2240
 v_mfma_f32_16x16x32_bf16 v[204:207], a[180:183], a[28:31], v[204:207]
 ds_read_b64_tr_b16 a[170:171], v9 offset:2496
 v_mfma_f32_16x16x32_bf16 v[200:203], a[180:183], a[24:27], v[200:203]
 buffer_load_dwordx4 a[108:111], v8, s[16:19], s64 offen offset:3072
 v_mfma_f32_16x16x32_bf16 v[200:203], a[176:179], a[8:11], v[200:203]
 v_mfma_f32_16x16x32_bf16 v[196:199], a[176:179], a[4:7], v[196:199]
 ds_read_b64_tr_b16 a[172:173], v9 offset:19136
 v_mfma_f32_16x16x32_bf16 v[196:199], a[180:183], a[20:23], v[196:199]
 ds_read_b64_tr_b16 a[174:175], v9 offset:19392
 v_mfma_f32_16x16x32_bf16 v[192:195], a[180:183], a[16:19], v[192:195]
 buffer_load_dwordx4 v7, s[12:15], s66 offen offset:3136 lds
 v_mfma_f32_16x16x32_bf16 v[192:195], a[176:179], a[0:3], v[192:195]
 s_waitcnt lgkmcnt(4)
 v_mfma_f32_16x16x32_bf16 v[208:211], a[160:163], a[0:3], v[208:211]
 ds_read_b64_tr_b16 a[176:177], v9 offset:2272
 v_mfma_f32_16x16x32_bf16 v[208:211], a[164:167], a[16:19], v[208:211]
 ds_read_b64_tr_b16 a[178:179], v9 offset:2528
 v_mfma_f32_16x16x32_bf16 v[212:215], a[164:167], a[20:23], v[212:215]
 ds_read_b64_tr_b16 a[180:181], v9 offset:19168
 v_mfma_f32_16x16x32_bf16 v[212:215], a[160:163], a[4:7], v[212:215]
 ds_read_b64_tr_b16 a[182:183], v9 offset:19424
 v_mfma_f32_16x16x32_bf16 v[216:219], a[160:163], a[8:11], v[216:219]
 v_mfma_f32_16x16x32_bf16 v[216:219], a[164:167], a[24:27], v[216:219]
 v_mfma_f32_16x16x32_bf16 v[220:223], a[164:167], a[28:31], v[220:223]
 v_mfma_f32_16x16x32_bf16 v[220:223], a[160:163], a[12:15], v[220:223]
 s_waitcnt lgkmcnt(4)
 v_mfma_f32_16x16x32_bf16 v[236:239], a[168:171], a[12:15], v[236:239]
 s_waitcnt vmcnt(24) lgkmcnt(0)
 v_mfma_f32_16x16x32_bf16 v[236:239], a[172:175], a[28:31], v[236:239]
 s_barrier
 v_mfma_f32_16x16x32_bf16 v[232:235], a[172:175], a[24:27], v[232:235]
 ds_read_b64_tr_b16 a[160:161], v9 offset:33792
 v_mfma_f32_16x16x32_bf16 v[232:235], a[168:171], a[8:11], v[232:235]
 ds_read_b64_tr_b16 a[162:163], v9 offset:34048
 v_mfma_f32_16x16x32_bf16 v[228:231], a[168:171], a[4:7], v[228:231]
 ds_read_b64_tr_b16 a[164:165], v9 offset:50688
 v_mfma_f32_16x16x32_bf16 v[228:231], a[172:175], a[20:23], v[228:231]
 ds_read_b64_tr_b16 a[166:167], v9 offset:50944
 v_mfma_f32_16x16x32_bf16 v[224:227], a[172:175], a[16:19], v[224:227]
 v_mfma_f32_16x16x32_bf16 v[224:227], a[168:171], a[0:3], v[224:227]
 s_waitcnt lgkmcnt(4)
 v_mfma_f32_16x16x32_bf16 v[240:243], a[176:179], a[0:3], v[240:243]
 ds_read_b64_tr_b16 a[168:169], v9 offset:33824
 v_mfma_f32_16x16x32_bf16 v[240:243], a[180:183], a[16:19], v[240:243]
 ds_read_b64_tr_b16 a[170:171], v9 offset:34080
 v_mfma_f32_16x16x32_bf16 v[244:247], a[180:183], a[20:23], v[244:247]
 s_cmp_eq_u32 s69, s92
 s_cbranch_scc1 L_arr9d
L_arr9:
 v_mfma_f32_16x16x32_bf16 v[244:247], a[176:179], a[4:7], v[244:247]
 v_mfma_f32_16x16x32_bf16 v[248:251], a[176:179], a[8:11], v[248:251]
 ds_read_b64_tr_b16 a[172:173], v9 offset:50720
 v_mfma_f32_16x16x32_bf16 v[248:251], a[180:183], a[24:27], v[248:251]
 ds_read_b64_tr_b16 a[174:175], v9 offset:50976
 v_mfma_f32_16x16x32_bf16 v[252:255], a[180:183], a[28:31], v[252:255]
 v_mfma_f32_16x16x32_bf16 v[252:255], a[176:179], a[12:15], v[252:255]
 s_waitcnt vmcnt(24) lgkmcnt(4)
 v_mfma_f32_16x16x32_bf16 v[16:19], a[160:163], a[32:35], v[16:19]
 ds_read_b64_tr_b16 a[176:177], v9 offset:33856
 s_add_u32 s70, s69, s75
 v_mfma_f32_16x16x32_bf16 v[16:19], a[164:167], a[48:51], v[16:19]
 ds_read_b64_tr_b16 a[178:179], v9 offset:34112
 v_mfma_f32_16x16x32_bf16 v[20:23], a[164:167], a[52:55], v[20:23]
 v_mfma_f32_16x16x32_bf16 v[20:23], a[160:163], a[36:39], v[20:23]
 s_lshl_b32 s65, s70, 18
 s_lshl_b32 s64, s70, 12
 v_mfma_f32_16x16x32_bf16 v[80:83], a[160:163], a[40:43], v[80:83]
 ds_read_b64_tr_b16 a[180:181], v9 offset:50752
 s_add_u32 s64, s64, s71
 v_mfma_f32_16x16x32_bf16 v[80:83], a[164:167], a[56:59], v[80:83]
 ds_read_b64_tr_b16 a[182:183], v9 offset:51008
 s_mul_i32 s66, s70, 229376
 v_mfma_f32_16x16x32_bf16 v[84:87], a[164:167], a[60:63], v[84:87]
 buffer_load_dwordx4 a[112:115], v8, s[16:19], s64 offen offset:0
 v_mfma_f32_16x16x32_bf16 v[84:87], a[160:163], a[44:47], v[84:87]
 s_add_u32 s69, s69, 1
 s_waitcnt lgkmcnt(4)
 v_mfma_f32_16x16x32_bf16 v[92:95], a[168:171], a[44:47], v[92:95]
 ds_read_b64_tr_b16 a[160:161], v9 offset:33888
 s_add_u32 m0, s61, 118272
 v_mfma_f32_16x16x32_bf16 v[92:95], a[172:175], a[60:63], v[92:95]
 ds_read_b64_tr_b16 a[162:163], v9 offset:34144
 v_mfma_f32_16x16x32_bf16 v[88:91], a[172:175], a[56:59], v[88:91]
 buffer_load_dwordx4 v4, s[8:11], s65 offen offset:0 lds
 v_mfma_f32_16x16x32_bf16 v[88:91], a[168:171], a[40:43], v[88:91]
 v_mfma_f32_16x16x32_bf16 v[28:31], a[168:171], a[36:39], v[28:31]
 ds_read_b64_tr_b16 a[164:165], v9 offset:50784
 v_mfma_f32_16x16x32_bf16 v[28:31], a[172:175], a[52:55], v[28:31]
 ds_read_b64_tr_b16 a[166:167], v9 offset:51040
 v_mfma_f32_16x16x32_bf16 v[24:27], a[172:175], a[48:51], v[24:27]
 buffer_load_dwordx4 a[116:119], v8, s[16:19], s64 offen offset:1024
 v_mfma_f32_16x16x32_bf16 v[24:27], a[168:171], a[32:35], v[24:27]
 s_waitcnt lgkmcnt(4)
 v_mfma_f32_16x16x32_bf16 v[32:35], a[176:179], a[32:35], v[32:35]
 ds_read_b64_tr_b16 a[168:169], v9 offset:33920
 v_mfma_f32_16x16x32_bf16 v[32:35], a[180:183], a[48:51], v[32:35]
 ds_read_b64_tr_b16 a[170:171], v9 offset:34176
 v_mfma_f32_16x16x32_bf16 v[36:39], a[180:183], a[52:55], v[36:39]
 buffer_load_dwordx4 v5, s[8:11], s65 offen offset:1056 lds
 v_mfma_f32_16x16x32_bf16 v[36:39], a[176:179], a[36:39], v[36:39]
 v_mfma_f32_16x16x32_bf16 v[96:99], a[176:179], a[40:43], v[96:99]
 ds_read_b64_tr_b16 a[172:173], v9 offset:50816
 v_mfma_f32_16x16x32_bf16 v[96:99], a[180:183], a[56:59], v[96:99]
 ds_read_b64_tr_b16 a[174:175], v9 offset:51072
 v_mfma_f32_16x16x32_bf16 v[100:103], a[180:183], a[60:63], v[100:103]
 buffer_load_dwordx4 a[120:123], v8, s[16:19], s64 offen offset:2048
 v_mfma_f32_16x16x32_bf16 v[100:103], a[176:179], a[44:47], v[100:103]
 s_waitcnt lgkmcnt(4)
 v_mfma_f32_16x16x32_bf16 v[108:111], a[160:163], a[44:47], v[108:111]
 ds_read_b64_tr_b16 a[176:177], v9 offset:33952
 v_mfma_f32_16x16x32_bf16 v[108:111], a[164:167], a[60:63], v[108:111]
 ds_read_b64_tr_b16 a[178:179], v9 offset:34208
 v_mfma_f32_16x16x32_bf16 v[104:107], a[164:167], a[56:59], v[104:107]
 buffer_load_dwordx4 v6, s[12:15], s66 offen offset:2080 lds
 v_mfma_f32_16x16x32_bf16 v[104:107], a[160:163], a[40:43], v[104:107]
 v_mfma_f32_16x16x32_bf16 v[44:47], a[160:163], a[36:39], v[44:47]
 ds_read_b64_tr_b16 a[180:181], v9 offset:50848
 v_mfma_f32_16x16x32_bf16 v[44:47], a[164:167], a[52:55], v[44:47]
 ds_read_b64_tr_b16 a[182:183], v9 offset:51104
 v_mfma_f32_16x16x32_bf16 v[40:43], a[164:167], a[48:51], v[40:43]
 buffer_load_dwordx4 a[124:127], v8, s[16:19], s64 offen offset:3072
 v_mfma_f32_16x16x32_bf16 v[40:43], a[160:163], a[32:35], v[40:43]
 s_waitcnt lgkmcnt(4)
 v_mfma_f32_16x16x32_bf16 v[48:51], a[168:171], a[32:35], v[48:51]
 ds_read_b64_tr_b16 a[160:161], v9 offset:33984
 v_mfma_f32_16x16x32_bf16 v[48:51], a[172:175], a[48:51], v[48:51]
 ds_read_b64_tr_b16 a[162:163], v9 offset:34240
 v_mfma_f32_16x16x32_bf16 v[52:55], a[172:175], a[52:55], v[52:55]
 buffer_load_dwordx4 v7, s[12:15], s66 offen offset:3136 lds
 v_mfma_f32_16x16x32_bf16 v[52:55], a[168:171], a[36:39], v[52:55]
 v_mfma_f32_16x16x32_bf16 v[112:115], a[168:171], a[40:43], v[112:115]
 ds_read_b64_tr_b16 a[164:165], v9 offset:50880
 v_mfma_f32_16x16x32_bf16 v[112:115], a[172:175], a[56:59], v[112:115]
 ds_read_b64_tr_b16 a[166:167], v9 offset:51136
 v_mfma_f32_16x16x32_bf16 v[116:119], a[172:175], a[60:63], v[116:119]
 v_mfma_f32_16x16x32_bf16 v[116:119], a[168:171], a[44:47], v[116:119]
 s_waitcnt lgkmcnt(4)
 v_mfma_f32_16x16x32_bf16 v[124:127], a[176:179], a[44:47], v[124:127]
 ds_read_b64_tr_b16 a[168:169], v9 offset:34016
 v_mfma_f32_16x16x32_bf16 v[124:127], a[180:183], a[60:63], v[124:127]
 ds_read_b64_tr_b16 a[170:171], v9 offset:34272
 v_mfma_f32_16x16x32_bf16 v[120:123], a[180:183], a[56:59], v[120:123]
 v_mfma_f32_16x16x32_bf16 v[120:123], a[176:179], a[40:43], v[120:123]
 v_mfma_f32_16x16x32_bf16 v[60:63], a[176:179], a[36:39], v[60:63]
 ds_read_b64_tr_b16 a[172:173], v9 offset:50912
 v_mfma_f32_16x16x32_bf16 v[60:63], a[180:183], a[52:55], v[60:63]
 ds_read_b64_tr_b16 a[174:175], v9 offset:51168
 v_mfma_f32_16x16x32_bf16 v[56:59], a[180:183], a[48:51], v[56:59]
 v_mfma_f32_16x16x32_bf16 v[56:59], a[176:179], a[32:35], v[56:59]
 s_waitcnt lgkmcnt(4)
 v_mfma_f32_16x16x32_bf16 v[64:67], a[160:163], a[32:35], v[64:67]
 ds_read_b64_tr_b16 a[176:177], v9 offset:35872
 v_mfma_f32_16x16x32_bf16 v[64:67], a[164:167], a[48:51], v[64:67]
 ds_read_b64_tr_b16 a[178:179], v9 offset:36128
 v_mfma_f32_16x16x32_bf16 v[68:71], a[164:167], a[52:55], v[68:71]
 v_mfma_f32_16x16x32_bf16 v[68:71], a[160:163], a[36:39], v[68:71]
 v_mfma_f32_16x16x32_bf16 v[128:131], a[160:163], a[40:43], v[128:131]
 ds_read_b64_tr_b16 a[180:181], v9 offset:52768
 v_mfma_f32_16x16x32_bf16 v[128:131], a[164:167], a[56:59], v[128:131]
 ds_read_b64_tr_b16 a[182:183], v9 offset:53024
 v_mfma_f32_16x16x32_bf16 v[132:135], a[164:167], a[60:63], v[132:135]
 s_cmp_eq_u32 s69, s92
 s_cbranch_scc1 L_arr10d
L_arr10:
 v_mfma_f32_16x16x32_bf16 v[132:135], a[160:163], a[44:47], v[132:135]
 s_waitcnt lgkmcnt(4)
 v_mfma_f32_16x16x32_bf16 v[140:143], a[168:171], a[44:47], v[140:143]
 ds_read_b64_tr_b16 a[160:161], v9 offset:35904
 v_mfma_f32_16x16x32_bf16 v[140:143], a[172:175], a[60:63], v[140:143]
 ds_read_b64_tr_b16 a[162:163], v9 offset:36160
 v_mfma_f32_16x16x32_bf16 v[136:139], a[172:175], a[56:59], v[136:139]
 v_mfma_f32_16x16x32_bf16 v[136:139], a[168:171], a[40:43], v[136:139]
 v_mfma_f32_16x16x32_bf16 v[76:79], a[168:171], a[36:39], v[76:79]
 ds_read_b64_tr_b16 a[164:165], v9 offset:52800
 s_add_u32 s70, s69, s72
 v_mfma_f32_16x16x32_bf16 v[76:79], a[172:175], a[52:55], v[76:79]
 ds_read_b64_tr_b16 a[166:167], v9 offset:53056
 v_mfma_f32_16x16x32_bf16 v[72:75], a[172:175], a[48:51], v[72:75]
 v_mfma_f32_16x16x32_bf16 v[72:75], a[168:171], a[32:35], v[72:75]
 s_lshl_b32 s65, s70, 18
 s_lshl_b32 s64, s70, 12
 s_waitcnt lgkmcnt(4)
 v_mfma_f32_16x16x32_bf16 v[144:147], a[176:179], a[32:35], v[144:147]
 ds_read_b64_tr_b16 a[168:169], v9 offset:35936
 s_add_u32 s64, s64, s71
 v_mfma_f32_16x16x32_bf16 v[144:147], a[180:183], a[48:51], v[144:147]
 ds_read_b64_tr_b16 a[170:171], v9 offset:36192
 s_mul_i32 s66, s70, 229376
 v_mfma_f32_16x16x32_bf16 v[148:151], a[180:183], a[52:55], v[148:151]
 buffer_load_dwordx4 a[0:3], v8, s[16:19], s64 offen offset:0
 v_mfma_f32_16x16x32_bf16 v[148:151], a[176:179], a[36:39], v[148:151]
 s_add_u32 s69, s69, 1
 v_mfma_f32_16x16x32_bf16 v[152:155], a[176:179], a[40:43], v[152:155]
 ds_read_b64_tr_b16 a[172:173], v9 offset:52832
 s_add_u32 m0, s61, 0
 v_mfma_f32_16x16x32_bf16 v[152:155], a[180:183], a[56:59], v[152:155]
 ds_read_b64_tr_b16 a[174:175], v9 offset:53088
 v_mfma_f32_16x16x32_bf16 v[156:159], a[180:183], a[60:63], v[156:159]
 buffer_load_dwordx4 v4, s[8:11], s65 offen offset:0 lds
 v_mfma_f32_16x16x32_bf16 v[156:159], a[176:179], a[44:47], v[156:159]
 s_waitcnt lgkmcnt(4)
 v_mfma_f32_16x16x32_bf16 v[172:175], a[160:163], a[44:47], v[172:175]
 ds_read_b64_tr_b16 a[176:177], v9 offset:35968
 v_mfma_f32_16x16x32_bf16 v[172:175], a[164:167], a[60:63], v[172:175]
 ds_read_b64_tr_b16 a[178:179], v9 offset:36224
 v_mfma_f32_16x16x32_bf16 v[168:171], a[164:167], a[56:59], v[168:171]
 buffer_load_dwordx4 a[4:7], v8, s[16:19], s64 offen offset:1024
 v_mfma_f32_16x16x32_bf16 v[168:171], a[160:163], a[40:43], v[168:171]
 v_mfma_f32_16x16x32_bf16 v[164:167], a[160:163], a[36:39], v[164:167]
 ds_read_b64_tr_b16 a[180:181], v9 offset:52864
 v_mfma_f32_16x16x32_bf16 v[164:167], a[164:167], a[52:55], v[164:167]
 ds_read_b64_tr_b16 a[182:183], v9 offset:53120
 v_mfma_f32_16x16x32_bf16 v[160:163], a[164:167], a[48:51], v[160:163]
 buffer_load_dwordx4 v5, s[8:11], s65 offen offset:1056 lds
 v_mfma_f32_16x16x32_bf16 v[160:163], a[160:163], a[32:35], v[160:163]
 s_waitcnt lgkmcnt(4)
 v_mfma_f32_16x16x32_bf16 v[176:179], a[168:171], a[32:35], v[176:179]
 ds_read_b64_tr_b16 a[160:161], v9 offset:36000
 v_mfma_f32_16x16x32_bf16 v[176:179], a[172:175], a[48:51], v[176:179]
 ds_read_b64_tr_b16 a[162:163], v9 offset:36256
 v_mfma_f32_16x16x32_bf16 v[180:183], a[172:175], a[52:55], v[180:183]
 buffer_load_dwordx4 a[8:11], v8, s[16:19], s64 offen offset:2048
 v_mfma_f32_16x16x32_bf16 v[180:183], a[168:171], a[36:39], v[180:183]
 v_mfma_f32_16x16x32_bf16 v[184:187], a[168:171], a[40:43], v[184:187]
 ds_read_b64_tr_b16 a[164:165], v9 offset:52896
 v_mfma_f32_16x16x32_bf16 v[184:187], a[172:175], a[56:59], v[184:187]
 ds_read_b64_tr_b16 a[166:167], v9 offset:53152
 v_mfma_f32_16x16x32_bf16 v[188:191], a[172:175], a[60:63], v[188:191]
 buffer_load_dwordx4 v6, s[12:15], s66 offen offset:2080 lds
 v_mfma_f32_16x16x32_bf16 v[188:191], a[168:171], a[44:47], v[188:191]
 s_waitcnt lgkmcnt(4)
 v_mfma_f32_16x16x32_bf16 v[204:207], a[176:179], a[44:47], v[204:207]
 ds_read_b64_tr_b16 a[168:169], v9 offset:36032
 v_mfma_f32_16x16x32_bf16 v[204:207], a[180:183], a[60:63], v[204:207]
 ds_read_b64_tr_b16 a[170:171], v9 offset:36288
 v_mfma_f32_16x16x32_bf16 v[200:203], a[180:183], a[56:59], v[200:203]
 buffer_load_dwordx4 a[12:15], v8, s[16:19], s64 offen offset:3072
 v_mfma_f32_16x16x32_bf16 v[200:203], a[176:179], a[40:43], v[200:203]
 s_branch L_pg4k
L_pg4:
L_ic1w2:
 s_branch L_pg8
L_pg4k:
 v_mfma_f32_16x16x32_bf16 v[196:199], a[176:179], a[36:39], v[196:199]
 ds_read_b64_tr_b16 a[172:173], v9 offset:52928
 v_mfma_f32_16x16x32_bf16 v[196:199], a[180:183], a[52:55], v[196:199]
 ds_read_b64_tr_b16 a[174:175], v9 offset:53184
 v_mfma_f32_16x16x32_bf16 v[192:195], a[180:183], a[48:51], v[192:195]
 buffer_load_dwordx4 v7, s[12:15], s66 offen offset:3136 lds
 v_mfma_f32_16x16x32_bf16 v[192:195], a[176:179], a[32:35], v[192:195]
 s_waitcnt lgkmcnt(4)
 v_mfma_f32_16x16x32_bf16 v[208:211], a[160:163], a[32:35], v[208:211]
 ds_read_b64_tr_b16 a[176:177], v9 offset:36064
 v_mfma_f32_16x16x32_bf16 v[208:211], a[164:167], a[48:51], v[208:211]
 ds_read_b64_tr_b16 a[178:179], v9 offset:36320
 v_mfma_f32_16x16x32_bf16 v[212:215], a[164:167], a[52:55], v[212:215]
 ds_read_b64_tr_b16 a[180:181], v9 offset:52960
 v_mfma_f32_16x16x32_bf16 v[212:215], a[160:163], a[36:39], v[212:215]
 ds_read_b64_tr_b16 a[182:183], v9 offset:53216
 v_mfma_f32_16x16x32_bf16 v[216:219], a[160:163], a[40:43], v[216:219]
 v_mfma_f32_16x16x32_bf16 v[216:219], a[164:167], a[56:59], v[216:219]
 v_mfma_f32_16x16x32_bf16 v[220:223], a[164:167], a[60:63], v[220:223]
 v_mfma_f32_16x16x32_bf16 v[220:223], a[160:163], a[44:47], v[220:223]
 s_waitcnt lgkmcnt(4)
 v_mfma_f32_16x16x32_bf16 v[236:239], a[168:171], a[44:47], v[236:239]
 s_waitcnt vmcnt(24) lgkmcnt(0)
 v_mfma_f32_16x16x32_bf16 v[236:239], a[172:175], a[60:63], v[236:239]
 s_barrier
 v_mfma_f32_16x16x32_bf16 v[232:235], a[172:175], a[56:59], v[232:235]
 ds_read_b64_tr_b16 a[160:161], v10 offset:0
 v_mfma_f32_16x16x32_bf16 v[232:235], a[168:171], a[40:43], v[232:235]
 ds_read_b64_tr_b16 a[162:163], v10 offset:256
 v_mfma_f32_16x16x32_bf16 v[228:231], a[168:171], a[36:39], v[228:231]
 ds_read_b64_tr_b16 a[164:165], v10 offset:16896
 v_mfma_f32_16x16x32_bf16 v[228:231], a[172:175], a[52:55], v[228:231]
 ds_read_b64_tr_b16 a[166:167], v10 offset:17152
 v_mfma_f32_16x16x32_bf16 v[224:227], a[172:175], a[48:51], v[224:227]
 v_mfma_f32_16x16x32_bf16 v[224:227], a[168:171], a[32:35], v[224:227]
 s_waitcnt lgkmcnt(4)
 v_mfma_f32_16x16x32_bf16 v[240:243], a[176:179], a[32:35], v[240:243]
 ds_read_b64_tr_b16 a[168:169], v10 offset:32
 v_mfma_f32_16x16x32_bf16 v[240:243], a[180:183], a[48:51], v[240:243]
 ds_read_b64_tr_b16 a[170:171], v10 offset:288
 v_mfma_f32_16x16x32_bf16 v[244:247], a[180:183], a[52:55], v[244:247]
 s_cmp_eq_u32 s69, s92
 s_cbranch_scc1 L_arr11d
L_arr11:
 v_mfma_f32_16x16x32_bf16 v[244:247], a[176:179], a[36:39], v[244:247]
 v_mfma_f32_16x16x32_bf16 v[248:251], a[176:179], a[40:43], v[248:251]
 ds_read_b64_tr_b16 a[172:173], v10 offset:16928
 v_mfma_f32_16x16x32_bf16 v[248:251], a[180:183], a[56:59], v[248:251]
 ds_read_b64_tr_b16 a[174:175], v10 offset:17184
 v_mfma_f32_16x16x32_bf16 v[252:255], a[180:183], a[60:63], v[252:255]
 v_mfma_f32_16x16x32_bf16 v[252:255], a[176:179], a[44:47], v[252:255]
 s_waitcnt vmcnt(25) lgkmcnt(4)
 v_mfma_f32_16x16x32_bf16 v[16:19], a[160:163], a[64:67], v[16:19]
 ds_read_b64_tr_b16 a[176:177], v10 offset:64
 s_add_u32 s70, s69, s73
 v_mfma_f32_16x16x32_bf16 v[16:19], a[164:167], a[80:83], v[16:19]
 ds_read_b64_tr_b16 a[178:179], v10 offset:320
 v_mfma_f32_16x16x32_bf16 v[20:23], a[164:167], a[84:87], v[20:23]
 v_mfma_f32_16x16x32_bf16 v[20:23], a[160:163], a[68:71], v[20:23]
 s_lshl_b32 s65, s70, 18
 s_lshl_b32 s64, s70, 12
 v_mfma_f32_16x16x32_bf16 v[80:83], a[160:163], a[72:75], v[80:83]
 ds_read_b64_tr_b16 a[180:181], v10 offset:16960
 s_add_u32 s64, s64, s71
 v_mfma_f32_16x16x32_bf16 v[80:83], a[164:167], a[88:91], v[80:83]
 ds_read_b64_tr_b16 a[182:183], v10 offset:17216
 s_mul_i32 s66, s70, 229376
 v_mfma_f32_16x16x32_bf16 v[84:87], a[164:167], a[92:95], v[84:87]
 buffer_load_dwordx4 a[16:19], v8, s[16:19], s64 offen offset:0
 v_mfma_f32_16x16x32_bf16 v[84:87], a[160:163], a[76:79], v[84:87]
 s_add_u32 s69, s69, 1
 s_waitcnt lgkmcnt(4)
 v_mfma_f32_16x16x32_bf16 v[92:95], a[168:171], a[76:79], v[92:95]
 ds_read_b64_tr_b16 a[160:161], v10 offset:96
 s_add_u32 m0, s61, 16896
 v_mfma_f32_16x16x32_bf16 v[92:95], a[172:175], a[92:95], v[92:95]
 ds_read_b64_tr_b16 a[162:163], v10 offset:352
 v_mfma_f32_16x16x32_bf16 v[88:91], a[172:175], a[88:91], v[88:91]
 buffer_load_dwordx4 v4, s[8:11], s65 offen offset:0 lds
 v_mfma_f32_16x16x32_bf16 v[88:91], a[168:171], a[72:75], v[88:91]
 v_mfma_f32_16x16x32_bf16 v[28:31], a[168:171], a[68:71], v[28:31]
 ds_read_b64_tr_b16 a[164:165], v10 offset:16992
 v_mfma_f32_16x16x32_bf16 v[28:31], a[172:175], a[84:87], v[28:31]
 ds_read_b64_tr_b16 a[166:167], v10 offset:17248
 v_mfma_f32_16x16x32_bf16 v[24:27], a[172:175], a[80:83], v[24:27]
 buffer_load_dwordx4 a[20:23], v8, s[16:19], s64 offen offset:1024
 v_mfma_f32_16x16x32_bf16 v[24:27], a[168:171], a[64:67], v[24:27]
 s_waitcnt lgkmcnt(4)
 v_mfma_f32_16x16x32_bf16 v[32:35], a[176:179], a[64:67], v[32:35]
 ds_read_b64_tr_b16 a[168:169], v10 offset:128
 v_mfma_f32_16x16x32_bf16 v[32:35], a[180:183], a[80:83], v[32:35]
 ds_read_b64_tr_b16 a[170:171], v10 offset:384
 v_mfma_f32_16x16x32_bf16 v[36:39], a[180:183], a[84:87], v[36:39]
 buffer_load_dwordx4 v5, s[8:11], s65 offen offset:1056 lds
 v_mfma_f32_16x16x32_bf16 v[36:39], a[176:179], a[68:71], v[36:39]
 v_mfma_f32_16x16x32_bf16 v[96:99], a[176:179], a[72:75], v[96:99]
 ds_read_b64_tr_b16 a[172:173], v10 offset:17024
 v_mfma_f32_16x16x32_bf16 v[96:99], a[180:183], a[88:91], v[96:99]
 ds_read_b64_tr_b16 a[174:175], v10 offset:17280
 v_mfma_f32_16x16x32_bf16 v[100:103], a[180:183], a[92:95], v[100:103]
 buffer_load_dwordx4 a[24:27], v8, s[16:19], s64 offen offset:2048
 v_mfma_f32_16x16x32_bf16 v[100:103], a[176:179], a[76:79], v[100:103]
 s_waitcnt lgkmcnt(4)
 v_mfma_f32_16x16x32_bf16 v[108:111], a[160:163], a[76:79], v[108:111]
 ds_read_b64_tr_b16 a[176:177], v10 offset:160
 v_mfma_f32_16x16x32_bf16 v[108:111], a[164:167], a[92:95], v[108:111]
 ds_read_b64_tr_b16 a[178:179], v10 offset:416
 v_mfma_f32_16x16x32_bf16 v[104:107], a[164:167], a[88:91], v[104:107]
 buffer_load_dwordx4 v6, s[12:15], s66 offen offset:2080 lds
 v_mfma_f32_16x16x32_bf16 v[104:107], a[160:163], a[72:75], v[104:107]
 v_mfma_f32_16x16x32_bf16 v[44:47], a[160:163], a[68:71], v[44:47]
 ds_read_b64_tr_b16 a[180:181], v10 offset:17056
 v_mfma_f32_16x16x32_bf16 v[44:47], a[164:167], a[84:87], v[44:47]
 ds_read_b64_tr_b16 a[182:183], v10 offset:17312
 v_mfma_f32_16x16x32_bf16 v[40:43], a[164:167], a[80:83], v[40:43]
 buffer_load_dwordx4 a[28:31], v8, s[16:19], s64 offen offset:3072
 v_mfma_f32_16x16x32_bf16 v[40:43], a[160:163], a[64:67], v[40:43]
 s_waitcnt lgkmcnt(4)
 v_mfma_f32_16x16x32_bf16 v[48:51], a[168:171], a[64:67], v[48:51]
 ds_read_b64_tr_b16 a[160:161], v10 offset:192
 v_mfma_f32_16x16x32_bf16 v[48:51], a[172:175], a[80:83], v[48:51]
 ds_read_b64_tr_b16 a[162:163], v10 offset:448
 v_mfma_f32_16x16x32_bf16 v[52:55], a[172:175], a[84:87], v[52:55]
 buffer_load_dwordx4 v7, s[12:15], s66 offen offset:3136 lds
 v_mfma_f32_16x16x32_bf16 v[52:55], a[168:171], a[68:71], v[52:55]
 v_mfma_f32_16x16x32_bf16 v[112:115], a[168:171], a[72:75], v[112:115]
 ds_read_b64_tr_b16 a[164:165], v10 offset:17088
 v_mfma_f32_16x16x32_bf16 v[112:115], a[172:175], a[88:91], v[112:115]
 ds_read_b64_tr_b16 a[166:167], v10 offset:17344
 v_mfma_f32_16x16x32_bf16 v[116:119], a[172:175], a[92:95], v[116:119]
 v_mfma_f32_16x16x32_bf16 v[116:119], a[168:171], a[76:79], v[116:119]
 s_waitcnt lgkmcnt(4)
 v_mfma_f32_16x16x32_bf16 v[124:127], a[176:179], a[76:79], v[124:127]
 ds_read_b64_tr_b16 a[168:169], v10 offset:224
 v_mfma_f32_16x16x32_bf16 v[124:127], a[180:183], a[92:95], v[124:127]
 ds_read_b64_tr_b16 a[170:171], v10 offset:480
 v_mfma_f32_16x16x32_bf16 v[120:123], a[180:183], a[88:91], v[120:123]
 v_mfma_f32_16x16x32_bf16 v[120:123], a[176:179], a[72:75], v[120:123]
 v_mfma_f32_16x16x32_bf16 v[60:63], a[176:179], a[68:71], v[60:63]
 ds_read_b64_tr_b16 a[172:173], v10 offset:17120
 v_mfma_f32_16x16x32_bf16 v[60:63], a[180:183], a[84:87], v[60:63]
 ds_read_b64_tr_b16 a[174:175], v10 offset:17376
 v_mfma_f32_16x16x32_bf16 v[56:59], a[180:183], a[80:83], v[56:59]
 v_mfma_f32_16x16x32_bf16 v[56:59], a[176:179], a[64:67], v[56:59]
 s_waitcnt lgkmcnt(4)
 v_mfma_f32_16x16x32_bf16 v[64:67], a[160:163], a[64:67], v[64:67]
 ds_read_b64_tr_b16 a[176:177], v10 offset:2080
 v_mfma_f32_16x16x32_bf16 v[64:67], a[164:167], a[80:83], v[64:67]
 ds_read_b64_tr_b16 a[178:179], v10 offset:2336
 v_mfma_f32_16x16x32_bf16 v[68:71], a[164:167], a[84:87], v[68:71]
 v_mfma_f32_16x16x32_bf16 v[68:71], a[160:163], a[68:71], v[68:71]
 v_mfma_f32_16x16x32_bf16 v[128:131], a[160:163], a[72:75], v[128:131]
 ds_read_b64_tr_b16 a[180:181], v10 offset:18976
 v_mfma_f32_16x16x32_bf16 v[128:131], a[164:167], a[88:91], v[128:131]
 ds_read_b64_tr_b16 a[182:183], v10 offset:19232
 v_mfma_f32_16x16x32_bf16 v[132:135], a[164:167], a[92:95], v[132:135]
 v_mfma_f32_16x16x32_bf16 v[132:135], a[160:163], a[76:79], v[132:135]
 s_cmp_eq_u32 s69, s93
 s_cbranch_scc1 L_dochk
L_nochk:
 s_waitcnt lgkmcnt(4)
 v_mfma_f32_16x16x32_bf16 v[140:143], a[168:171], a[76:79], v[140:143]
 ds_read_b64_tr_b16 a[160:161], v10 offset:2112
 v_mfma_f32_16x16x32_bf16 v[140:143], a[172:175], a[92:95], v[140:143]
 ds_read_b64_tr_b16 a[162:163], v10 offset:2368
 v_mfma_f32_16x16x32_bf16 v[136:139], a[172:175], a[88:91], v[136:139]
 s_cmp_eq_u32 s69, s92
 s_cbranch_scc1 L_arr12d
L_arr12:
 v_mfma_f32_16x16x32_bf16 v[136:139], a[168:171], a[72:75], v[136:139]
 v_mfma_f32_16x16x32_bf16 v[76:79], a[168:171], a[68:71], v[76:79]
 ds_read_b64_tr_b16 a[164:165], v10 offset:19008
 s_add_u32 s70, s69, s74
 v_mfma_f32_16x16x32_bf16 v[76:79], a[172:175], a[84:87], v[76:79]
 ds_read_b64_tr_b16 a[166:167], v10 offset:19264
 v_mfma_f32_16x16x32_bf16 v[72:75], a[172:175], a[80:83], v[72:75]
 v_mfma_f32_16x16x32_bf16 v[72:75], a[168:171], a[64:67], v[72:75]
 s_lshl_b32 s65, s70, 18
 s_lshl_b32 s64, s70, 12
 s_waitcnt lgkmcnt(4)
 v_mfma_f32_16x16x32_bf16 v[144:147], a[176:179], a[64:67], v[144:147]
 ds_read_b64_tr_b16 a[168:169], v10 offset:2144
 s_add_u32 s64, s64, s71
 v_mfma_f32_16x16x32_bf16 v[144:147], a[180:183], a[80:83], v[144:147]
 ds_read_b64_tr_b16 a[170:171], v10 offset:2400
 s_mul_i32 s66, s70, 229376
 v_mfma_f32_16x16x32_bf16 v[148:151], a[180:183], a[84:87], v[148:151]
 buffer_load_dwordx4 a[32:35], v8, s[16:19], s64 offen offset:0
 v_mfma_f32_16x16x32_bf16 v[148:151], a[176:179], a[68:71], v[148:151]
 s_add_u32 s69, s69, 1
 v_mfma_f32_16x16x32_bf16 v[152:155], a[176:179], a[72:75], v[152:155]
 ds_read_b64_tr_b16 a[172:173], v10 offset:19040
 s_add_u32 m0, s61, 33792
 v_mfma_f32_16x16x32_bf16 v[152:155], a[180:183], a[88:91], v[152:155]
 ds_read_b64_tr_b16 a[174:175], v10 offset:19296
 v_mfma_f32_16x16x32_bf16 v[156:159], a[180:183], a[92:95], v[156:159]
 buffer_load_dwordx4 v4, s[8:11], s65 offen offset:0 lds
 v_mfma_f32_16x16x32_bf16 v[156:159], a[176:179], a[76:79], v[156:159]
 s_waitcnt lgkmcnt(4)
 v_mfma_f32_16x16x32_bf16 v[172:175], a[160:163], a[76:79], v[172:175]
 ds_read_b64_tr_b16 a[176:177], v10 offset:2176
 v_mfma_f32_16x16x32_bf16 v[172:175], a[164:167], a[92:95], v[172:175]
 ds_read_b64_tr_b16 a[178:179], v10 offset:2432
 v_mfma_f32_16x16x32_bf16 v[168:171], a[164:167], a[88:91], v[168:171]
 buffer_load_dwordx4 a[36:39], v8, s[16:19], s64 offen offset:1024
 v_mfma_f32_16x16x32_bf16 v[168:171], a[160:163], a[72:75], v[168:171]
 v_mfma_f32_16x16x32_bf16 v[164:167], a[160:163], a[68:71], v[164:167]
 ds_read_b64_tr_b16 a[180:181], v10 offset:19072
 v_mfma_f32_16x16x32_bf16 v[164:167], a[164:167], a[84:87], v[164:167]
 ds_read_b64_tr_b16 a[182:183], v10 offset:19328
 v_mfma_f32_16x16x32_bf16 v[160:163], a[164:167], a[80:83], v[160:163]
 buffer_load_dwordx4 v5, s[8:11], s65 offen offset:1056 lds
 v_mfma_f32_16x16x32_bf16 v[160:163], a[160:163], a[64:67], v[160:163]
 s_waitcnt lgkmcnt(4)
 v_mfma_f32_16x16x32_bf16 v[176:179], a[168:171], a[64:67], v[176:179]
 ds_read_b64_tr_b16 a[160:161], v10 offset:2208
 v_mfma_f32_16x16x32_bf16 v[176:179], a[172:175], a[80:83], v[176:179]
 ds_read_b64_tr_b16 a[162:163], v10 offset:2464
 v_mfma_f32_16x16x32_bf16 v[180:183], a[172:175], a[84:87], v[180:183]
 buffer_load_dwordx4 a[40:43], v8, s[16:19], s64 offen offset:2048
 v_mfma_f32_16x16x32_bf16 v[180:183], a[168:171], a[68:71], v[180:183]
 v_mfma_f32_16x16x32_bf16 v[184:187], a[168:171], a[72:75], v[184:187]
 ds_read_b64_tr_b16 a[164:165], v10 offset:19104
 v_mfma_f32_16x16x32_bf16 v[184:187], a[172:175], a[88:91], v[184:187]
 ds_read_b64_tr_b16 a[166:167], v10 offset:19360
 v_mfma_f32_16x16x32_bf16 v[188:191], a[172:175], a[92:95], v[188:191]
 buffer_load_dwordx4 v6, s[12:15], s66 offen offset:2080 lds
 v_mfma_f32_16x16x32_bf16 v[188:191], a[168:171], a[76:79], v[188:191]
 s_waitcnt lgkmcnt(4)
 v_mfma_f32_16x16x32_bf16 v[204:207], a[176:179], a[76:79], v[204:207]
 ds_read_b64_tr_b16 a[168:169], v10 offset:2240
 v_mfma_f32_16x16x32_bf16 v[204:207], a[180:183], a[92:95], v[204:207]
 ds_read_b64_tr_b16 a[170:171], v10 offset:2496
 v_mfma_f32_16x16x32_bf16 v[200:203], a[180:183], a[88:91], v[200:203]
 buffer_load_dwordx4 a[44:47], v8, s[16:19], s64 offen offset:3072
 v_mfma_f32_16x16x32_bf16 v[200:203], a[176:179], a[72:75], v[200:203]
 v_mfma_f32_16x16x32_bf16 v[196:199], a[176:179], a[68:71], v[196:199]
 ds_read_b64_tr_b16 a[172:173], v10 offset:19136
 v_mfma_f32_16x16x32_bf16 v[196:199], a[180:183], a[84:87], v[196:199]
 ds_read_b64_tr_b16 a[174:175], v10 offset:19392
 v_mfma_f32_16x16x32_bf16 v[192:195], a[180:183], a[80:83], v[192:195]
 buffer_load_dwordx4 v7, s[12:15], s66 offen offset:3136 lds
 v_mfma_f32_16x16x32_bf16 v[192:195], a[176:179], a[64:67], v[192:195]
 s_waitcnt lgkmcnt(4)
 v_mfma_f32_16x16x32_bf16 v[208:211], a[160:163], a[64:67], v[208:211]
 ds_read_b64_tr_b16 a[176:177], v10 offset:2272
 v_mfma_f32_16x16x32_bf16 v[208:211], a[164:167], a[80:83], v[208:211]
 ds_read_b64_tr_b16 a[178:179], v10 offset:2528
 v_mfma_f32_16x16x32_bf16 v[212:215], a[164:167], a[84:87], v[212:215]
 ds_read_b64_tr_b16 a[180:181], v10 offset:19168
 v_mfma_f32_16x16x32_bf16 v[212:215], a[160:163], a[68:71], v[212:215]
 ds_read_b64_tr_b16 a[182:183], v10 offset:19424
 v_mfma_f32_16x16x32_bf16 v[216:219], a[160:163], a[72:75], v[216:219]
 v_mfma_f32_16x16x32_bf16 v[216:219], a[164:167], a[88:91], v[216:219]
 v_mfma_f32_16x16x32_bf16 v[220:223], a[164:167], a[92:95], v[220:223]
 v_mfma_f32_16x16x32_bf16 v[220:223], a[160:163], a[76:79], v[220:223]
 s_waitcnt lgkmcnt(4)
 v_mfma_f32_16x16x32_bf16 v[236:239], a[168:171], a[76:79], v[236:239]
 s_waitcnt vmcnt(24) lgkmcnt(0)
 v_mfma_f32_16x16x32_bf16 v[236:239], a[172:175], a[92:95], v[236:239]
 s_barrier
 v_mfma_f32_16x16x32_bf16 v[232:235], a[172:175], a[88:91], v[232:235]
 ds_read_b64_tr_b16 a[160:161], v10 offset:33792
 v_mfma_f32_16x16x32_bf16 v[232:235], a[168:171], a[72:75], v[232:235]
 ds_read_b64_tr_b16 a[162:163], v10 offset:34048
 v_mfma_f32_16x16x32_bf16 v[228:231], a[168:171], a[68:71], v[228:231]
 ds_read_b64_tr_b16 a[164:165], v10 offset:50688
 v_mfma_f32_16x16x32_bf16 v[228:231], a[172:175], a[84:87], v[228:231]
 ds_read_b64_tr_b16 a[166:167], v10 offset:50944
 v_mfma_f32_16x16x32_bf16 v[224:227], a[172:175], a[80:83], v[224:227]
 v_mfma_f32_16x16x32_bf16 v[224:227], a[168:171], a[64:67], v[224:227]
 s_waitcnt lgkmcnt(4)
 v_mfma_f32_16x16x32_bf16 v[240:243], a[176:179], a[64:67], v[240:243]
 ds_read_b64_tr_b16 a[168:169], v10 offset:33824
 v_mfma_f32_16x16x32_bf16 v[240:243], a[180:183], a[80:83], v[240:243]
 ds_read_b64_tr_b16 a[170:171], v10 offset:34080
 v_mfma_f32_16x16x32_bf16 v[244:247], a[180:183], a[84:87], v[244:247]
 s_cmp_eq_u32 s69, s92
 s_cbranch_scc1 L_arr13d
L_arr13:
 v_mfma_f32_16x16x32_bf16 v[244:247], a[176:179], a[68:71], v[244:247]
 v_mfma_f32_16x16x32_bf16 v[248:251], a[176:179], a[72:75], v[248:251]
 ds_read_b64_tr_b16 a[172:173], v10 offset:50720
 v_mfma_f32_16x16x32_bf16 v[248:251], a[180:183], a[88:91], v[248:251]
 ds_read_b64_tr_b16 a[174:175], v10 offset:50976
 v_mfma_f32_16x16x32_bf16 v[252:255], a[180:183], a[92:95], v[252:255]
 v_mfma_f32_16x16x32_bf16 v[252:255], a[176:179], a[76:79], v[252:255]
 s_waitcnt vmcnt(25) lgkmcnt(4)
 v_mfma_f32_16x16x32_bf16 v[16:19], a[160:163], a[96:99], v[16:19]
 ds_read_b64_tr_b16 a[176:177], v10 offset:33856
 s_add_u32 s70, s69, s75
 v_mfma_f32_16x16x32_bf16 v[16:19], a[164:167], a[112:115], v[16:19]
 ds_read_b64_tr_b16 a[178:179], v10 offset:34112
 v_mfma_f32_16x16x32_bf16 v[20:23], a[164:167], a[116:119], v[20:23]
 v_mfma_f32_16x16x32_bf16 v[20:23], a[160:163], a[100:103], v[20:23]
 s_lshl_b32 s65, s70, 18
 s_lshl_b32 s64, s70, 12
 v_mfma_f32_16x16x32_bf16 v[80:83], a[160:163], a[104:107], v[80:83]
 ds_read_b64_tr_b16 a[180:181], v10 offset:50752
 s_add_u32 s64, s64, s71
 v_mfma_f32_16x16x32_bf16 v[80:83], a[164:167], a[120:123], v[80:83]
 ds_read_b64_tr_b16 a[182:183], v10 offset:51008
 s_mul_i32 s66, s70, 229376
 v_mfma_f32_16x16x32_bf16 v[84:87], a[164:167], a[124:127], v[84:87]
 buffer_load_dwordx4 a[48:51], v8, s[16:19], s64 offen offset:0
 v_mfma_f32_16x16x32_bf16 v[84:87], a[160:163], a[108:111], v[84:87]
 s_add_u32 s69, s69, 1
 s_waitcnt lgkmcnt(4)
 v_mfma_f32_16x16x32_bf16 v[92:95], a[168:171], a[108:111], v[92:95]
 ds_read_b64_tr_b16 a[160:161], v10 offset:33888
 s_add_u32 m0, s61, 50688
 v_mfma_f32_16x16x32_bf16 v[92:95], a[172:175], a[124:127], v[92:95]
 ds_read_b64_tr_b16 a[162:163], v10 offset:34144
 v_mfma_f32_16x16x32_bf16 v[88:91], a[172:175], a[120:123], v[88:91]
 buffer_load_dwordx4 v4, s[8:11], s65 offen offset:0 lds
 v_mfma_f32_16x16x32_bf16 v[88:91], a[168:171], a[104:107], v[88:91]
 v_mfma_f32_16x16x32_bf16 v[28:31], a[168:171], a[100:103], v[28:31]
 ds_read_b64_tr_b16 a[164:165], v10 offset:50784
 v_mfma_f32_16x16x32_bf16 v[28:31], a[172:175], a[116:119], v[28:31]
 ds_read_b64_tr_b16 a[166:167], v10 offset:51040
 v_mfma_f32_16x16x32_bf16 v[24:27], a[172:175], a[112:115], v[24:27]
 buffer_load_dwordx4 a[52:55], v8, s[16:19], s64 offen offset:1024
 v_mfma_f32_16x16x32_bf16 v[24:27], a[168:171], a[96:99], v[24:27]
 s_waitcnt lgkmcnt(4)
 v_mfma_f32_16x16x32_bf16 v[32:35], a[176:179], a[96:99], v[32:35]
 ds_read_b64_tr_b16 a[168:169], v10 offset:33920
 v_mfma_f32_16x16x32_bf16 v[32:35], a[180:183], a[112:115], v[32:35]
 ds_read_b64_tr_b16 a[170:171], v10 offset:34176
 v_mfma_f32_16x16x32_bf16 v[36:39], a[180:183], a[116:119], v[36:39]
 buffer_load_dwordx4 v5, s[8:11], s65 offen offset:1056 lds
 v_mfma_f32_16x16x32_bf16 v[36:39], a[176:179], a[100:103], v[36:39]
 v_mfma_f32_16x16x32_bf16 v[96:99], a[176:179], a[104:107], v[96:99]
 ds_read_b64_tr_b16 a[172:173], v10 offset:50816
 v_mfma_f32_16x16x32_bf16 v[96:99], a[180:183], a[120:123], v[96:99]
 ds_read_b64_tr_b16 a[174:175], v10 offset:51072
 v_mfma_f32_16x16x32_bf16 v[100:103], a[180:183], a[124:127], v[100:103]
 buffer_load_dwordx4 a[56:59], v8, s[16:19], s64 offen offset:2048
 v_mfma_f32_16x16x32_bf16 v[100:103], a[176:179], a[108:111], v[100:103]
 s_waitcnt lgkmcnt(4)
 v_mfma_f32_16x16x32_bf16 v[108:111], a[160:163], a[108:111], v[108:111]
 ds_read_b64_tr_b16 a[176:177], v10 offset:33952
 v_mfma_f32_16x16x32_bf16 v[108:111], a[164:167], a[124:127], v[108:111]
 ds_read_b64_tr_b16 a[178:179], v10 offset:34208
 v_mfma_f32_16x16x32_bf16 v[104:107], a[164:167], a[120:123], v[104:107]
 buffer_load_dwordx4 v6, s[12:15], s66 offen offset:2080 lds
 v_mfma_f32_16x16x32_bf16 v[104:107], a[160:163], a[104:107], v[104:107]
 v_mfma_f32_16x16x32_bf16 v[44:47], a[160:163], a[100:103], v[44:47]
 ds_read_b64_tr_b16 a[180:181], v10 offset:50848
 v_mfma_f32_16x16x32_bf16 v[44:47], a[164:167], a[116:119], v[44:47]
 ds_read_b64_tr_b16 a[182:183], v10 offset:51104
 v_mfma_f32_16x16x32_bf16 v[40:43], a[164:167], a[112:115], v[40:43]
 buffer_load_dwordx4 a[60:63], v8, s[16:19], s64 offen offset:3072
 v_mfma_f32_16x16x32_bf16 v[40:43], a[160:163], a[96:99], v[40:43]
 s_waitcnt lgkmcnt(4)
 v_mfma_f32_16x16x32_bf16 v[48:51], a[168:171], a[96:99], v[48:51]
 ds_read_b64_tr_b16 a[160:161], v10 offset:33984
 v_mfma_f32_16x16x32_bf16 v[48:51], a[172:175], a[112:115], v[48:51]
 ds_read_b64_tr_b16 a[162:163], v10 offset:34240
 v_mfma_f32_16x16x32_bf16 v[52:55], a[172:175], a[116:119], v[52:55]
 buffer_load_dwordx4 v7, s[12:15], s66 offen offset:3136 lds
 v_mfma_f32_16x16x32_bf16 v[52:55], a[168:171], a[100:103], v[52:55]
 v_mfma_f32_16x16x32_bf16 v[112:115], a[168:171], a[104:107], v[112:115]
 ds_read_b64_tr_b16 a[164:165], v10 offset:50880
 v_mfma_f32_16x16x32_bf16 v[112:115], a[172:175], a[120:123], v[112:115]
 ds_read_b64_tr_b16 a[166:167], v10 offset:51136
 v_mfma_f32_16x16x32_bf16 v[116:119], a[172:175], a[124:127], v[116:119]
 v_mfma_f32_16x16x32_bf16 v[116:119], a[168:171], a[108:111], v[116:119]
 s_waitcnt lgkmcnt(4)
 v_mfma_f32_16x16x32_bf16 v[124:127], a[176:179], a[108:111], v[124:127]
 ds_read_b64_tr_b16 a[168:169], v10 offset:34016
 v_mfma_f32_16x16x32_bf16 v[124:127], a[180:183], a[124:127], v[124:127]
 ds_read_b64_tr_b16 a[170:171], v10 offset:34272
 v_mfma_f32_16x16x32_bf16 v[120:123], a[180:183], a[120:123], v[120:123]
 v_mfma_f32_16x16x32_bf16 v[120:123], a[176:179], a[104:107], v[120:123]
 v_mfma_f32_16x16x32_bf16 v[60:63], a[176:179], a[100:103], v[60:63]
 ds_read_b64_tr_b16 a[172:173], v10 offset:50912
 v_mfma_f32_16x16x32_bf16 v[60:63], a[180:183], a[116:119], v[60:63]
 ds_read_b64_tr_b16 a[174:175], v10 offset:51168
 v_mfma_f32_16x16x32_bf16 v[56:59], a[180:183], a[112:115], v[56:59]
 v_mfma_f32_16x16x32_bf16 v[56:59], a[176:179], a[96:99], v[56:59]
 s_waitcnt lgkmcnt(4)
 v_mfma_f32_16x16x32_bf16 v[64:67], a[160:163], a[96:99], v[64:67]
 ds_read_b64_tr_b16 a[176:177], v10 offset:35872
 v_mfma_f32_16x16x32_bf16 v[64:67], a[164:167], a[112:115], v[64:67]
 ds_read_b64_tr_b16 a[178:179], v10 offset:36128
 v_mfma_f32_16x16x32_bf16 v[68:71], a[164:167], a[116:119], v[68:71]
 v_mfma_f32_16x16x32_bf16 v[68:71], a[160:163], a[100:103], v[68:71]
 v_mfma_f32_16x16x32_bf16 v[128:131], a[160:163], a[104:107], v[128:131]
 ds_read_b64_tr_b16 a[180:181], v10 offset:52768
 v_mfma_f32_16x16x32_bf16 v[128:131], a[164:167], a[120:123], v[128:131]
 ds_read_b64_tr_b16 a[182:183], v10 offset:53024
 v_mfma_f32_16x16x32_bf16 v[132:135], a[164:167], a[124:127], v[132:135]
 s_cmp_eq_u32 s69, s92
 s_cbranch_scc1 L_arr14d
L_arr14:
 v_mfma_f32_16x16x32_bf16 v[132:135], a[160:163], a[108:111], v[132:135]
 s_waitcnt lgkmcnt(4)
 v_mfma_f32_16x16x32_bf16 v[140:143], a[168:171], a[108:111], v[140:143]
 ds_read_b64_tr_b16 a[160:161], v10 offset:35904
 v_mfma_f32_16x16x32_bf16 v[140:143], a[172:175], a[124:127], v[140:143]
 ds_read_b64_tr_b16 a[162:163], v10 offset:36160
 v_mfma_f32_16x16x32_bf16 v[136:139], a[172:175], a[120:123], v[136:139]
 v_mfma_f32_16x16x32_bf16 v[136:139], a[168:171], a[104:107], v[136:139]
 v_mfma_f32_16x16x32_bf16 v[76:79], a[168:171], a[100:103], v[76:79]
 ds_read_b64_tr_b16 a[164:165], v10 offset:52800
 s_add_u32 s70, s69, s72
 v_mfma_f32_16x16x32_bf16 v[76:79], a[172:175], a[116:119], v[76:79]
 ds_read_b64_tr_b16 a[166:167], v10 offset:53056
 s_lshr_b32 s4, s70, 5
 v_mfma_f32_16x16x32_bf16 v[72:75], a[172:175], a[112:115], v[72:75]
 s_mul_i32 s4, s4, 24
 s_sub_u32 s70, s70, s4
 v_mfma_f32_16x16x32_bf16 v[72:75], a[168:171], a[96:99], v[72:75]
 s_lshl_b32 s65, s70, 18
 s_lshl_b32 s64, s70, 12
 s_waitcnt lgkmcnt(4)
 v_mfma_f32_16x16x32_bf16 v[144:147], a[176:179], a[96:99], v[144:147]
 ds_read_b64_tr_b16 a[168:169], v10 offset:35936
 s_add_u32 s64, s64, s71
 v_mfma_f32_16x16x32_bf16 v[144:147], a[180:183], a[112:115], v[144:147]
 ds_read_b64_tr_b16 a[170:171], v10 offset:36192
 s_mul_i32 s66, s70, 229376
 v_mfma_f32_16x16x32_bf16 v[148:151], a[180:183], a[116:119], v[148:151]
 buffer_load_dwordx4 a[64:67], v8, s[16:19], s64 offen offset:0
 v_mfma_f32_16x16x32_bf16 v[148:151], a[176:179], a[100:103], v[148:151]
 s_add_u32 s69, s69, 1
 v_mfma_f32_16x16x32_bf16 v[152:155], a[176:179], a[104:107], v[152:155]
 ds_read_b64_tr_b16 a[172:173], v10 offset:52832
 s_add_u32 m0, s61, 67584
 v_mfma_f32_16x16x32_bf16 v[152:155], a[180:183], a[120:123], v[152:155]
 ds_read_b64_tr_b16 a[174:175], v10 offset:53088
 v_mfma_f32_16x16x32_bf16 v[156:159], a[180:183], a[124:127], v[156:159]
 buffer_load_dwordx4 v4, s[8:11], s65 offen offset:0 lds
 v_mfma_f32_16x16x32_bf16 v[156:159], a[176:179], a[108:111], v[156:159]
 s_waitcnt lgkmcnt(4)
 v_mfma_f32_16x16x32_bf16 v[172:175], a[160:163], a[108:111], v[172:175]
 ds_read_b64_tr_b16 a[176:177], v10 offset:35968
 v_mfma_f32_16x16x32_bf16 v[172:175], a[164:167], a[124:127], v[172:175]
 ds_read_b64_tr_b16 a[178:179], v10 offset:36224
 v_mfma_f32_16x16x32_bf16 v[168:171], a[164:167], a[120:123], v[168:171]
 buffer_load_dwordx4 a[68:71], v8, s[16:19], s64 offen offset:1024
 v_mfma_f32_16x16x32_bf16 v[168:171], a[160:163], a[104:107], v[168:171]
 v_mfma_f32_16x16x32_bf16 v[164:167], a[160:163], a[100:103], v[164:167]
 ds_read_b64_tr_b16 a[180:181], v10 offset:52864
 v_mfma_f32_16x16x32_bf16 v[164:167], a[164:167], a[116:119], v[164:167]
 ds_read_b64_tr_b16 a[182:183], v10 offset:53120
 v_mfma_f32_16x16x32_bf16 v[160:163], a[164:167], a[112:115], v[160:163]
 buffer_load_dwordx4 v5, s[8:11], s65 offen offset:1056 lds
 v_mfma_f32_16x16x32_bf16 v[160:163], a[160:163], a[96:99], v[160:163]
 s_waitcnt lgkmcnt(4)
 v_mfma_f32_16x16x32_bf16 v[176:179], a[168:171], a[96:99], v[176:179]
 ds_read_b64_tr_b16 a[160:161], v10 offset:36000
 v_mfma_f32_16x16x32_bf16 v[176:179], a[172:175], a[112:115], v[176:179]
 ds_read_b64_tr_b16 a[162:163], v10 offset:36256
 v_mfma_f32_16x16x32_bf16 v[180:183], a[172:175], a[116:119], v[180:183]
 buffer_load_dwordx4 a[72:75], v8, s[16:19], s64 offen offset:2048
 v_mfma_f32_16x16x32_bf16 v[180:183], a[168:171], a[100:103], v[180:183]
 v_mfma_f32_16x16x32_bf16 v[184:187], a[168:171], a[104:107], v[184:187]
 ds_read_b64_tr_b16 a[164:165], v10 offset:52896
 v_mfma_f32_16x16x32_bf16 v[184:187], a[172:175], a[120:123], v[184:187]
 ds_read_b64_tr_b16 a[166:167], v10 offset:53152
 v_mfma_f32_16x16x32_bf16 v[188:191], a[172:175], a[124:127], v[188:191]
 buffer_load_dwordx4 v6, s[12:15], s66 offen offset:2080 lds
 v_mfma_f32_16x16x32_bf16 v[188:191], a[168:171], a[108:111], v[188:191]
 s_waitcnt lgkmcnt(4)
 v_mfma_f32_16x16x32_bf16 v[204:207], a[176:179], a[108:111], v[204:207]
 ds_read_b64_tr_b16 a[168:169], v10 offset:36032
 v_mfma_f32_16x16x32_bf16 v[204:207], a[180:183], a[124:127], v[204:207]
 ds_read_b64_tr_b16 a[170:171], v10 offset:36288
 v_mfma_f32_16x16x32_bf16 v[200:203], a[180:183], a[120:123], v[200:203]
 buffer_load_dwordx4 a[76:79], v8, s[16:19], s64 offen offset:3072
 v_mfma_f32_16x16x32_bf16 v[200:203], a[176:179], a[104:107], v[200:203]
 v_mfma_f32_16x16x32_bf16 v[196:199], a[176:179], a[100:103], v[196:199]
 ds_read_b64_tr_b16 a[172:173], v10 offset:52928
 v_mfma_f32_16x16x32_bf16 v[196:199], a[180:183], a[116:119], v[196:199]
 ds_read_b64_tr_b16 a[174:175], v10 offset:53184
 v_mfma_f32_16x16x32_bf16 v[192:195], a[180:183], a[112:115], v[192:195]
 buffer_load_dwordx4 v7, s[12:15], s66 offen offset:3136 lds
 v_mfma_f32_16x16x32_bf16 v[192:195], a[176:179], a[96:99], v[192:195]
 s_waitcnt lgkmcnt(4)
 v_mfma_f32_16x16x32_bf16 v[208:211], a[160:163], a[96:99], v[208:211]
 ds_read_b64_tr_b16 a[176:177], v10 offset:36064
 v_mfma_f32_16x16x32_bf16 v[208:211], a[164:167], a[112:115], v[208:211]
 ds_read_b64_tr_b16 a[178:179], v10 offset:36320
 v_mfma_f32_16x16x32_bf16 v[212:215], a[164:167], a[116:119], v[212:215]
 ds_read_b64_tr_b16 a[180:181], v10 offset:52960
 v_mfma_f32_16x16x32_bf16 v[212:215], a[160:163], a[100:103], v[212:215]
 ds_read_b64_tr_b16 a[182:183], v10 offset:53216
 v_mfma_f32_16x16x32_bf16 v[216:219], a[160:163], a[104:107], v[216:219]
 v_mfma_f32_16x16x32_bf16 v[216:219], a[164:167], a[120:123], v[216:219]
 v_mfma_f32_16x16x32_bf16 v[220:223], a[164:167], a[124:127], v[220:223]
 v_mfma_f32_16x16x32_bf16 v[220:223], a[160:163], a[108:111], v[220:223]
 s_waitcnt lgkmcnt(4)
 v_mfma_f32_16x16x32_bf16 v[236:239], a[168:171], a[108:111], v[236:239]
 s_waitcnt vmcnt(24) lgkmcnt(0)
 v_mfma_f32_16x16x32_bf16 v[236:239], a[172:175], a[124:127], v[236:239]
 s_barrier
 v_mfma_f32_16x16x32_bf16 v[232:235], a[172:175], a[120:123], v[232:235]
 ds_read_b64_tr_b16 a[160:161], v9 offset:0
 v_mfma_f32_16x16x32_bf16 v[232:235], a[168:171], a[104:107], v[232:235]
 ds_read_b64_tr_b16 a[162:163], v9 offset:256
 v_mfma_f32_16x16x32_bf16 v[228:231], a[168:171], a[100:103], v[228:231]
 ds_read_b64_tr_b16 a[164:165], v9 offset:16896
 v_mfma_f32_16x16x32_bf16 v[228:231], a[172:175], a[116:119], v[228:231]
 ds_read_b64_tr_b16 a[166:167], v9 offset:17152
 v_mfma_f32_16x16x32_bf16 v[224:227], a[172:175], a[112:115], v[224:227]
 v_mfma_f32_16x16x32_bf16 v[224:227], a[168:171], a[96:99], v[224:227]
 s_waitcnt lgkmcnt(4)
 v_mfma_f32_16x16x32_bf16 v[240:243], a[176:179], a[96:99], v[240:243]
 ds_read_b64_tr_b16 a[168:169], v9 offset:32
 v_mfma_f32_16x16x32_bf16 v[240:243], a[180:183], a[112:115], v[240:243]
 ds_read_b64_tr_b16 a[170:171], v9 offset:288
 v_mfma_f32_16x16x32_bf16 v[244:247], a[180:183], a[116:119], v[244:247]
 s_cmp_eq_u32 s69, s92
 s_cbranch_scc1 L_arr15d
L_arr15:
 v_mfma_f32_16x16x32_bf16 v[244:247], a[176:179], a[100:103], v[244:247]
 v_mfma_f32_16x16x32_bf16 v[248:251], a[176:179], a[104:107], v[248:251]
 ds_read_b64_tr_b16 a[172:173], v9 offset:16928
 v_mfma_f32_16x16x32_bf16 v[248:251], a[180:183], a[120:123], v[248:251]
 ds_read_b64_tr_b16 a[174:175], v9 offset:17184
 v_mfma_f32_16x16x32_bf16 v[252:255], a[180:183], a[124:127], v[252:255]
 v_mfma_f32_16x16x32_bf16 v[252:255], a[176:179], a[108:111], v[252:255]
 s_sub_u32 s68, s68, 1
 s_cmp_lg_u32 s68, 0
 s_cbranch_scc1 L_g1
 s_waitcnt vmcnt(25) lgkmcnt(4)
 v_mfma_f32_16x16x32_bf16 v[16:19], a[160:163], a[0:3], v[16:19]
 ds_read_b64_tr_b16 a[176:177], v9 offset:64
 s_add_u32 s70, s69, s73
 v_mfma_f32_16x16x32_bf16 v[16:19], a[164:167], a[16:19], v[16:19]
 ds_read_b64_tr_b16 a[178:179], v9 offset:320
 s_lshr_b32 s4, s70, 5
 v_mfma_f32_16x16x32_bf16 v[20:23], a[164:167], a[20:23], v[20:23]
 s_mul_i32 s4, s4, 24
 s_sub_u32 s70, s70, s4
 v_mfma_f32_16x16x32_bf16 v[20:23], a[160:163], a[4:7], v[20:23]
 s_lshl_b32 s65, s70, 18
 s_lshl_b32 s64, s70, 12
 v_mfma_f32_16x16x32_bf16 v[80:83], a[160:163], a[8:11], v[80:83]
 ds_read_b64_tr_b16 a[180:181], v9 offset:16960
 s_add_u32 s64, s64, s71
 v_mfma_f32_16x16x32_bf16 v[80:83], a[164:167], a[24:27], v[80:83]
 ds_read_b64_tr_b16 a[182:183], v9 offset:17216
 s_mul_i32 s66, s70, 229376
 v_mfma_f32_16x16x32_bf16 v[84:87], a[164:167], a[28:31], v[84:87]
 buffer_load_dwordx4 a[80:83], v8, s[16:19], s64 offen offset:0
 v_mfma_f32_16x16x32_bf16 v[84:87], a[160:163], a[12:15], v[84:87]
 s_add_u32 s69, s69, 1
 s_waitcnt lgkmcnt(4)
 v_mfma_f32_16x16x32_bf16 v[92:95], a[168:171], a[12:15], v[92:95]
 ds_read_b64_tr_b16 a[160:161], v9 offset:96
 s_add_u32 m0, s61, 84480
 v_mfma_f32_16x16x32_bf16 v[92:95], a[172:175], a[28:31], v[92:95]
 ds_read_b64_tr_b16 a[162:163], v9 offset:352
 s_lshl_b32 s4, s3, 10
 s_add_u32 s4, s4, 135168
 v_add_u32 v14, s4, v8
 v_mfma_f32_16x16x32_bf16 v[88:91], a[172:175], a[24:27], v[88:91]
 buffer_load_dwordx4 v4, s[8:11], s65 offen offset:0 lds
 v_accvgpr_read_b32 v11, a128
 v_mfma_f32_16x16x32_bf16 v[88:91], a[168:171], a[8:11], v[88:91]
 s_branch L_pg5k
L_pg5:
L_ic1w1:
 s_branch L_pg9
L_pg5k:
 v_cvt_pk_bf16_f32 v12, v11, v11
 v_and_b32 v15, 0xffff0000, v12
 v_mfma_f32_16x16x32_bf16 v[28:31], a[168:171], a[4:7], v[28:31]
 ds_read_b64_tr_b16 a[164:165], v9 offset:16992
 v_sub_f32 v11, v11, v15
 v_mfma_f32_16x16x32_bf16 v[28:31], a[172:175], a[20:23], v[28:31]
 ds_read_b64_tr_b16 a[166:167], v9 offset:17248
 v_cvt_pk_bf16_f32 v13, v11, v11
 v_mfma_f32_16x16x32_bf16 v[24:27], a[172:175], a[16:19], v[24:27]
 buffer_load_dwordx4 a[84:87], v8, s[16:19], s64 offen offset:1024
 v_and_b32 v15, 0xffff0000, v13
 v_mfma_f32_16x16x32_bf16 v[24:27], a[168:171], a[0:3], v[24:27]
 s_waitcnt lgkmcnt(4)
 v_sub_f32 v11, v11, v15
 v_alignbit_b32 v12, v13, v12, 16
 v_mfma_f32_16x16x32_bf16 v[32:35], a[176:179], a[0:3], v[32:35]
 ds_read_b64_tr_b16 a[168:169], v9 offset:128
 v_cvt_pk_bf16_f32 v13, v11, 0
 v_mfma_f32_16x16x32_bf16 v[32:35], a[180:183], a[16:19], v[32:35]
 ds_read_b64_tr_b16 a[170:171], v9 offset:384
 v_mfma_f32_16x16x32_bf16 v[36:39], a[180:183], a[20:23], v[36:39]
 buffer_load_dwordx4 v5, s[8:11], s65 offen offset:1056 lds
 v_mfma_f32_16x16x32_bf16 v[36:39], a[176:179], a[4:7], v[36:39]
 ds_write_b64 v14, v[12:13] offset:0
 v_accvgpr_read_b32 v11, a132
 v_mfma_f32_16x16x32_bf16 v[96:99], a[176:179], a[8:11], v[96:99]
 ds_read_b64_tr_b16 a[172:173], v9 offset:17024
 v_cvt_pk_bf16_f32 v12, v11, v11
 v_mfma_f32_16x16x32_bf16 v[96:99], a[180:183], a[24:27], v[96:99]
 ds_read_b64_tr_b16 a[174:175], v9 offset:17280
 v_and_b32 v15, 0xffff0000, v12
 v_mfma_f32_16x16x32_bf16 v[100:103], a[180:183], a[28:31], v[100:103]
 buffer_load_dwordx4 a[88:91], v8, s[16:19], s64 offen offset:2048
 v_sub_f32 v11, v11, v15
 v_mfma_f32_16x16x32_bf16 v[100:103], a[176:179], a[12:15], v[100:103]
 s_waitcnt lgkmcnt(5)
 v_cvt_pk_bf16_f32 v13, v11, v11
 v_and_b32 v15, 0xffff0000, v13
 v_mfma_f32_16x16x32_bf16 v[108:111], a[160:163], a[12:15], v[108:111]
 ds_read_b64_tr_b16 a[176:177], v9 offset:160
 v_sub_f32 v11, v11, v15
 v_mfma_f32_16x16x32_bf16 v[108:111], a[164:167], a[28:31], v[108:111]
 ds_read_b64_tr_b16 a[178:179], v9 offset:416
 v_alignbit_b32 v12, v13, v12, 16
 v_mfma_f32_16x16x32_bf16 v[104:107], a[164:167], a[24:27], v[104:107]
 buffer_load_dwordx4 v6, s[12:15], s66 offen offset:2080 lds
 v_cvt_pk_bf16_f32 v13, v11, 0
 v_mfma_f32_16x16x32_bf16 v[104:107], a[160:163], a[8:11], v[104:107]
 v_mfma_f32_16x16x32_bf16 v[44:47], a[160:163], a[4:7], v[44:47]
 s_add_u32 s70, s74, 30
 ds_read_b64_tr_b16 a[180:181], v9 offset:17056
 v_mfma_f32_16x16x32_bf16 v[44:47], a[164:167], a[20:23], v[44:47]
 s_lshr_b32 s4, s70, 5
 ds_read_b64_tr_b16 a[182:183], v9 offset:17312
 v_mfma_f32_16x16x32_bf16 v[40:43], a[164:167], a[16:19], v[40:43]
 s_mul_i32 s4, s4, 24
 buffer_load_dwordx4 a[92:95], v8, s[16:19], s64 offen offset:3072
 v_mfma_f32_16x16x32_bf16 v[40:43], a[160:163], a[0:3], v[40:43]
 ds_write_b64 v14, v[12:13] offset:4096
 s_sub_u32 s70, s70, s4
 s_waitcnt lgkmcnt(5)
 v_mfma_f32_16x16x32_bf16 v[48:51], a[168:171], a[0:3], v[48:51]
 ds_read_b64_tr_b16 a[160:161], v9 offset:192
 v_accvgpr_read_b32 v11, a136
 v_mfma_f32_16x16x32_bf16 v[48:51], a[172:175], a[16:19], v[48:51]
 ds_read_b64_tr_b16 a[162:163], v9 offset:448
 v_cvt_pk_bf16_f32 v12, v11, v11
 v_mfma_f32_16x16x32_bf16 v[52:55], a[172:175], a[20:23], v[52:55]
 buffer_load_dwordx4 v7, s[12:15], s66 offen offset:3136 lds
 v_and_b32 v15, 0xffff0000, v12
 v_mfma_f32_16x16x32_bf16 v[52:55], a[168:171], a[4:7], v[52:55]
 s_lshl_b32 s65, s70, 18
 v_sub_f32 v11, v11, v15
 v_mfma_f32_16x16x32_bf16 v[112:115], a[168:171], a[8:11], v[112:115]
 s_mul_i32 s66, s70, 229376
 ds_read_b64_tr_b16 a[164:165], v9 offset:17088
 v_cvt_pk_bf16_f32 v13, v11, v11
 v_mfma_f32_16x16x32_bf16 v[112:115], a[172:175], a[24:27], v[112:115]
 s_add_u32 m0, s61, 101376
 ds_read_b64_tr_b16 a[166:167], v9 offset:17344
 v_and_b32 v15, 0xffff0000, v13
 v_mfma_f32_16x16x32_bf16 v[116:119], a[172:175], a[28:31], v[116:119]
 buffer_load_dwordx4 v4, s[8:11], s65 offen offset:0 lds
 v_sub_f32 v11, v11, v15
 v_mfma_f32_16x16x32_bf16 v[116:119], a[168:171], a[12:15], v[116:119]
 s_waitcnt lgkmcnt(5)
 v_alignbit_b32 v12, v13, v12, 16
 v_cvt_pk_bf16_f32 v13, v11, 0
 v_mfma_f32_16x16x32_bf16 v[124:127], a[176:179], a[12:15], v[124:127]
 ds_read_b64_tr_b16 a[168:169], v9 offset:224
 v_accvgpr_read_b32 v15, a188
 v_mfma_f32_16x16x32_bf16 v[124:127], a[180:183], a[28:31], v[124:127]
 ds_read_b64_tr_b16 a[170:171], v9 offset:480
 v_lshl_or_b32 v13, v15, 16, v13
 v_mfma_f32_16x16x32_bf16 v[120:123], a[180:183], a[24:27], v[120:123]
 buffer_load_dwordx4 v5, s[8:11], s65 offen offset:1056 lds
 v_mfma_f32_16x16x32_bf16 v[120:123], a[176:179], a[8:11], v[120:123]
 ds_write_b64 v14, v[12:13] offset:8192
 v_accvgpr_read_b32 v11, a140
 v_mfma_f32_16x16x32_bf16 v[60:63], a[176:179], a[4:7], v[60:63]
 ds_read_b64_tr_b16 a[172:173], v9 offset:17120
 v_cvt_pk_bf16_f32 v12, v11, v11
 v_mfma_f32_16x16x32_bf16 v[60:63], a[180:183], a[20:23], v[60:63]
 ds_read_b64_tr_b16 a[174:175], v9 offset:17376
 v_and_b32 v15, 0xffff0000, v12
 v_mfma_f32_16x16x32_bf16 v[56:59], a[180:183], a[16:19], v[56:59]
 buffer_load_dwordx4 v6, s[12:15], s66 offen offset:2080 lds
 v_sub_f32 v11, v11, v15
 v_mfma_f32_16x16x32_bf16 v[56:59], a[176:179], a[0:3], v[56:59]
 s_waitcnt lgkmcnt(5)
 v_cvt_pk_bf16_f32 v13, v11, v11
 v_and_b32 v15, 0xffff0000, v13
 v_mfma_f32_16x16x32_bf16 v[64:67], a[160:163], a[0:3], v[64:67]
 ds_read_b64_tr_b16 a[176:177], v9 offset:2080
 v_sub_f32 v11, v11, v15
 v_mfma_f32_16x16x32_bf16 v[64:67], a[164:167], a[16:19], v[64:67]
 ds_read_b64_tr_b16 a[178:179], v9 offset:2336
 v_alignbit_b32 v12, v13, v12, 16
 v_mfma_f32_16x16x32_bf16 v[68:71], a[164:167], a[20:23], v[68:71]
 buffer_load_dwordx4 v7, s[12:15], s66 offen offset:3136 lds
 v_cvt_pk_bf16_f32 v13, v11, 0
 v_mfma_f32_16x16x32_bf16 v[68:71], a[160:163], a[4:7], v[68:71]
 v_accvgpr_read_b32 v15, a189
 v_lshl_or_b32 v13, v15, 16, v13
 v_mfma_f32_16x16x32_bf16 v[128:131], a[160:163], a[8:11], v[128:131]
 ds_read_b64_tr_b16 a[180:181], v9 offset:18976
 v_mfma_f32_16x16x32_bf16 v[128:131], a[164:167], a[24:27], v[128:131]
 ds_read_b64_tr_b16 a[182:183], v9 offset:19232
 v_mfma_f32_16x16x32_bf16 v[132:135], a[164:167], a[28:31], v[132:135]
 v_mfma_f32_16x16x32_bf16 v[132:135], a[160:163], a[12:15], v[132:135]
 ds_write_b64 v14, v[12:13] offset:12288
 s_waitcnt lgkmcnt(5)
 v_mfma_f32_16x16x32_bf16 v[140:143], a[168:171], a[12:15], v[140:143]
 ds_read_b64_tr_b16 a[160:161], v9 offset:2112
 v_mfma_f32_16x16x32_bf16 v[140:143], a[172:175], a[28:31], v[140:143]
 ds_read_b64_tr_b16 a[162:163], v9 offset:2368
 v_mfma_f32_16x16x32_bf16 v[136:139], a[172:175], a[24:27], v[136:139]
 v_mfma_f32_16x16x32_bf16 v[136:139], a[168:171], a[8:11], v[136:139]
 v_mfma_f32_16x16x32_bf16 v[76:79], a[168:171], a[4:7], v[76:79]
 ds_read_b64_tr_b16 a[164:165], v9 offset:19008
 s_add_u32 s70, s74, 30
 v_mfma_f32_16x16x32_bf16 v[76:79], a[172:175], a[20:23], v[76:79]
 ds_read_b64_tr_b16 a[166:167], v9 offset:19264
 s_lshr_b32 s4, s70, 5
 v_mfma_f32_16x16x32_bf16 v[72:75], a[172:175], a[16:19], v[72:75]
 s_mul_i32 s4, s4, 24
 s_sub_u32 s70, s70, s4
 v_cmp_ne_u32 vcc, s94, v2
 v_mfma_f32_16x16x32_bf16 v[72:75], a[168:171], a[0:3], v[72:75]
 s_lshl_b32 s64, s70, 12
 s_waitcnt lgkmcnt(5)
 v_mfma_f32_16x16x32_bf16 v[144:147], a[176:179], a[0:3], v[144:147]
 ds_read_b64_tr_b16 a[168:169], v9 offset:2144
 s_add_u32 s64, s64, s71
 v_mfma_f32_16x16x32_bf16 v[144:147], a[180:183], a[16:19], v[144:147]
 ds_read_b64_tr_b16 a[170:171], v9 offset:2400
 s_cbranch_vccnz L_chk_slow
L_chk_ret:
 v_mfma_f32_16x16x32_bf16 v[148:151], a[180:183], a[20:23], v[148:151]
 buffer_load_dwordx4 a[96:99], v8, s[16:19], s64 offen offset:0
 v_mfma_f32_16x16x32_bf16 v[148:151], a[176:179], a[4:7], v[148:151]
 v_add_u32 v11, 50688, v8
 v_add_u32 v12, 101376, v8
 v_mfma_f32_16x16x32_bf16 v[152:155], a[176:179], a[8:11], v[152:155]
 s_add_u32 s70, s75, 31
 ds_read_b64_tr_b16 a[172:173], v9 offset:19040
 v_mfma_f32_16x16x32_bf16 v[152:155], a[180:183], a[24:27], v[152:155]
 ds_read_b64_tr_b16 a[174:175], v9 offset:19296
 v_mfma_f32_16x16x32_bf16 v[156:159], a[180:183], a[28:31], v[156:159]
 s_lshr_b32 s4, s70, 5
 buffer_load_dwordx4 a[100:103], v8, s[16:19], s64 offen offset:1024
 v_mfma_f32_16x16x32_bf16 v[156:159], a[176:179], a[12:15], v[156:159]
 s_lshl_b32 s62, s3, 12
 s_mul_i32 s63, s3, 4224
 s_waitcnt lgkmcnt(4)
 v_mfma_f32_16x16x32_bf16 v[172:175], a[160:163], a[12:15], v[172:175]
 s_mul_i32 s4, s4, 24
 ds_read_b64_tr_b16 a[176:177], v9 offset:2176
 v_mfma_f32_16x16x32_bf16 v[172:175], a[164:167], a[28:31], v[172:175]
 ds_read_b64_tr_b16 a[178:179], v9 offset:2432
 v_mfma_f32_16x16x32_bf16 v[168:171], a[164:167], a[24:27], v[168:171]
 s_sub_u32 s70, s70, s4
 buffer_load_dwordx4 a[104:107], v8, s[16:19], s64 offen offset:2048
 v_mfma_f32_16x16x32_bf16 v[168:171], a[160:163], a[8:11], v[168:171]
 v_and_b32 v14, 15, v1
 v_lshlrev_b32 v14, 4, v14
 v_mfma_f32_16x16x32_bf16 v[164:167], a[160:163], a[4:7], v[164:167]
 s_lshl_b32 s65, s70, 18
 ds_read_b64_tr_b16 a[180:181], v9 offset:19072
 v_mfma_f32_16x16x32_bf16 v[164:167], a[164:167], a[20:23], v[164:167]
 ds_read_b64_tr_b16 a[182:183], v9 offset:19328
 v_mfma_f32_16x16x32_bf16 v[160:163], a[164:167], a[16:19], v[160:163]
 s_mul_i32 s66, s70, 229376
 buffer_load_dwordx4 a[108:111], v8, s[16:19], s64 offen offset:3072
 v_mfma_f32_16x16x32_bf16 v[160:163], a[160:163], a[0:3], v[160:163]
 s_waitcnt lgkmcnt(4)
 v_lshrrev_b32 v13, 4, v1
 v_min_u32 v13, 1, v13
 v_mfma_f32_16x16x32_bf16 v[176:179], a[168:171], a[0:3], v[176:179]
 s_add_u32 m0, s61, 118272
 ds_read_b64_tr_b16 a[160:161], v9 offset:2208
 v_mfma_f32_16x16x32_bf16 v[176:179], a[172:175], a[16:19], v[176:179]
 ds_read_b64_tr_b16 a[162:163], v9 offset:2464
 v_mfma_f32_16x16x32_bf16 v[180:183], a[172:175], a[20:23], v[180:183]
 buffer_load_dwordx4 v4, s[8:11], s65 offen offset:0 lds
 v_mfma_f32_16x16x32_bf16 v[180:183], a[168:171], a[4:7], v[180:183]
 v_lshlrev_b32 v13, 31, v13
 v_add_u32 v15, v13, v14
 v_mfma_f32_16x16x32_bf16 v[184:187], a[168:171], a[8:11], v[184:187]
 ds_read_b64_tr_b16 a[164:165], v9 offset:19104
 v_mfma_f32_16x16x32_bf16 v[184:187], a[172:175], a[24:27], v[184:187]
 ds_read_b64_tr_b16 a[166:167], v9 offset:19360
 v_mfma_f32_16x16x32_bf16 v[188:191], a[172:175], a[28:31], v[188:191]
 buffer_load_dwordx4 v5, s[8:11], s65 offen offset:1056 lds
 v_mfma_f32_16x16x32_bf16 v[188:191], a[168:171], a[12:15], v[188:191]
 s_waitcnt lgkmcnt(4)
 v_lshl_add_u32 v13, v1, 7, v13
 v_mfma_f32_16x16x32_bf16 v[204:207], a[176:179], a[12:15], v[204:207]
 ds_read_b64_tr_b16 a[168:169], v9 offset:2240
 v_mfma_f32_16x16x32_bf16 v[204:207], a[180:183], a[28:31], v[204:207]
 ds_read_b64_tr_b16 a[170:171], v9 offset:2496
 v_mfma_f32_16x16x32_bf16 v[200:203], a[180:183], a[24:27], v[200:203]
 buffer_load_dwordx4 v6, s[12:15], s66 offen offset:2080 lds
 v_mfma_f32_16x16x32_bf16 v[200:203], a[176:179], a[8:11], v[200:203]
 s_lshl_b32 s5, s58, 10
 s_add_u32 s5, s5, 6291456
 v_mfma_f32_16x16x32_bf16 v[196:199], a[176:179], a[4:7], v[196:199]
 ds_read_b64_tr_b16 a[172:173], v9 offset:19136
 v_mfma_f32_16x16x32_bf16 v[196:199], a[180:183], a[20:23], v[196:199]
 ds_read_b64_tr_b16 a[174:175], v9 offset:19392
 v_mfma_f32_16x16x32_bf16 v[192:195], a[180:183], a[16:19], v[192:195]
 buffer_load_dwordx4 v7, s[12:15], s66 offen offset:3136 lds
 v_mfma_f32_16x16x32_bf16 v[192:195], a[176:179], a[0:3], v[192:195]
 s_waitcnt lgkmcnt(4)
 v_mfma_f32_16x16x32_bf16 v[208:211], a[160:163], a[0:3], v[208:211]
 ds_read_b64_tr_b16 a[176:177], v9 offset:2272
 buffer_load_dwordx2 a[184:185], v15, s[16:19], s5 offen offset:0
 v_mfma_f32_16x16x32_bf16 v[208:211], a[164:167], a[16:19], v[208:211]
 ds_read_b64_tr_b16 a[178:179], v9 offset:2528
 buffer_load_dwordx2 a[186:187], v15, s[16:19], s5 offen offset:256
 v_mfma_f32_16x16x32_bf16 v[212:215], a[164:167], a[20:23], v[212:215]
 ds_read_b64_tr_b16 a[180:181], v9 offset:19168
 v_mfma_f32_16x16x32_bf16 v[212:215], a[160:163], a[4:7], v[212:215]
 ds_read_b64_tr_b16 a[182:183], v9 offset:19424
 buffer_load_dwordx2 a[188:189], v15, s[16:19], s5 offen offset:512
 v_mfma_f32_16x16x32_bf16 v[216:219], a[160:163], a[8:11], v[216:219]
 buffer_load_dwordx2 a[190:191], v15, s[16:19], s5 offen offset:768
 v_mfma_f32_16x16x32_bf16 v[216:219], a[164:167], a[24:27], v[216:219]
 v_mfma_f32_16x16x32_bf16 v[220:223], a[164:167], a[28:31], v[220:223]
 v_mfma_f32_16x16x32_bf16 v[220:223], a[160:163], a[12:15], v[220:223]
 s_and_b32 s68, s2, 3
 s_lshl_b32 s68, s68, 2
 s_add_u32 s68, s68, s3
 s_lshl_b32 s68, s68, 11
 s_waitcnt lgkmcnt(4)
 v_mfma_f32_16x16x32_bf16 v[236:239], a[168:171], a[12:15], v[236:239]
 s_waitcnt vmcnt(32) lgkmcnt(0)
 v_mfma_f32_16x16x32_bf16 v[236:239], a[172:175], a[28:31], v[236:239]
 s_barrier
 v_mfma_f32_16x16x32_bf16 v[232:235], a[172:175], a[24:27], v[232:235]
 ds_read_b64_tr_b16 a[160:161], v9 offset:33792
 v_mfma_f32_16x16x32_bf16 v[232:235], a[168:171], a[8:11], v[232:235]
 ds_read_b64_tr_b16 a[162:163], v9 offset:34048
 s_getpc_b64 s[100:101]
L_pc0:
 v_mfma_f32_16x16x32_bf16 v[228:231], a[168:171], a[4:7], v[228:231]
 ds_read_b64_tr_b16 a[164:165], v9 offset:50688
 s_add_u32 s100, s100, L_att-L_pc0+0
 v_mfma_f32_16x16x32_bf16 v[228:231], a[172:175], a[20:23], v[228:231]
 ds_read_b64_tr_b16 a[166:167], v9 offset:50944
 s_addc_u32 s101, s101, 0
 v_mfma_f32_16x16x32_bf16 v[224:227], a[172:175], a[16:19], v[224:227]
 v_min_u32 v2, 15, v1
 v_mfma_f32_16x16x32_bf16 v[224:227], a[168:171], a[0:3], v[224:227]
 s_waitcnt lgkmcnt(4)
 v_lshlrev_b32 v2, 7, v2
 v_mfma_f32_16x16x32_bf16 v[240:243], a[176:179], a[0:3], v[240:243]
 ds_read_b64_tr_b16 a[168:169], v9 offset:33824
 v_add_u32 v2, s68, v2
 v_mfma_f32_16x16x32_bf16 v[240:243], a[180:183], a[16:19], v[240:243]
 ds_read_b64_tr_b16 a[170:171], v9 offset:34080
 v_min_u32 v2, L_chk_slow-L_att-0-4, v2
 v_mfma_f32_16x16x32_bf16 v[244:247], a[180:183], a[20:23], v[244:247]
 v_mov_b32 v3, s101
 v_mfma_f32_16x16x32_bf16 v[244:247], a[176:179], a[4:7], v[244:247]
 v_add_co_u32 v2, vcc, s100, v2
 v_mfma_f32_16x16x32_bf16 v[248:251], a[176:179], a[8:11], v[248:251]
 ds_read_b64_tr_b16 a[172:173], v9 offset:50720
 v_addc_co_u32 v3, vcc, 0, v3, vcc
 v_mfma_f32_16x16x32_bf16 v[248:251], a[180:183], a[24:27], v[248:251]
 ds_read_b64_tr_b16 a[174:175], v9 offset:50976
 global_load_dword a128, v[2:3], off
 v_mfma_f32_16x16x32_bf16 v[252:255], a[180:183], a[28:31], v[252:255]
 v_mfma_f32_16x16x32_bf16 v[252:255], a[176:179], a[12:15], v[252:255]
 s_waitcnt vmcnt(34) lgkmcnt(4)
 v_mfma_f32_16x16x32_bf16 v[16:19], a[160:163], a[32:35], v[16:19]
 ds_read_b64_tr_b16 a[176:177], v9 offset:33856
 s_add_u32 s70, s75, 31
 v_mfma_f32_16x16x32_bf16 v[16:19], a[164:167], a[48:51], v[16:19]
 ds_read_b64_tr_b16 a[178:179], v9 offset:34112
 s_lshr_b32 s4, s70, 5
 v_mfma_f32_16x16x32_bf16 v[20:23], a[164:167], a[52:55], v[20:23]
 s_mul_i32 s4, s4, 24
 s_sub_u32 s70, s70, s4
 v_mfma_f32_16x16x32_bf16 v[20:23], a[160:163], a[36:39], v[20:23]
 s_lshl_b32 s64, s70, 12
 v_mfma_f32_16x16x32_bf16 v[80:83], a[160:163], a[40:43], v[80:83]
 ds_read_b64_tr_b16 a[180:181], v9 offset:50752
 s_add_u32 s64, s64, s71
 v_mfma_f32_16x16x32_bf16 v[80:83], a[164:167], a[56:59], v[80:83]
 ds_read_b64_tr_b16 a[182:183], v9 offset:51008
 v_mfma_f32_16x16x32_bf16 v[84:87], a[164:167], a[60:63], v[84:87]
 buffer_load_dwordx4 a[112:115], v8, s[16:19], s64 offen offset:0
 v_mfma_f32_16x16x32_bf16 v[84:87], a[160:163], a[44:47], v[84:87]
 s_waitcnt lgkmcnt(4)
 v_mfma_f32_16x16x32_bf16 v[92:95], a[168:171], a[44:47], v[92:95]
 ds_read_b64_tr_b16 a[160:161], v9 offset:33888
 v_mfma_f32_16x16x32_bf16 v[92:95], a[172:175], a[60:63], v[92:95]
 ds_read_b64_tr_b16 a[162:163], v9 offset:34144
 v_mfma_f32_16x16x32_bf16 v[88:91], a[172:175], a[56:59], v[88:91]
 buffer_load_dwordx4 a[116:119], v8, s[16:19], s64 offen offset:1024
 v_mfma_f32_16x16x32_bf16 v[88:91], a[168:171], a[40:43], v[88:91]
 v_mfma_f32_16x16x32_bf16 v[28:31], a[168:171], a[36:39], v[28:31]
 ds_read_b64_tr_b16 a[164:165], v9 offset:50784
 v_mfma_f32_16x16x32_bf16 v[28:31], a[172:175], a[52:55], v[28:31]
 ds_read_b64_tr_b16 a[166:167], v9 offset:51040
 v_mfma_f32_16x16x32_bf16 v[24:27], a[172:175], a[48:51], v[24:27]
 buffer_load_dwordx4 a[120:123], v8, s[16:19], s64 offen offset:2048
 v_mfma_f32_16x16x32_bf16 v[24:27], a[168:171], a[32:35], v[24:27]
 s_waitcnt lgkmcnt(4)
 v_mfma_f32_16x16x32_bf16 v[32:35], a[176:179], a[32:35], v[32:35]
 ds_read_b64_tr_b16 a[168:169], v9 offset:33920
 v_mfma_f32_16x16x32_bf16 v[32:35], a[180:183], a[48:51], v[32:35]
 ds_read_b64_tr_b16 a[170:171], v9 offset:34176
 v_mfma_f32_16x16x32_bf16 v[36:39], a[180:183], a[52:55], v[36:39]
 buffer_load_dwordx4 a[124:127], v8, s[16:19], s64 offen offset:3072
 v_mfma_f32_16x16x32_bf16 v[36:39], a[176:179], a[36:39], v[36:39]
 v_mfma_f32_16x16x32_bf16 v[96:99], a[176:179], a[40:43], v[96:99]
 ds_read_b64_tr_b16 a[172:173], v9 offset:50816
 v_mfma_f32_16x16x32_bf16 v[96:99], a[180:183], a[56:59], v[96:99]
 ds_read_b64_tr_b16 a[174:175], v9 offset:51072
 v_mfma_f32_16x16x32_bf16 v[100:103], a[180:183], a[60:63], v[100:103]
 buffer_load_dword v4, v14, s[16:19], s5 offen offset:8
 v_mfma_f32_16x16x32_bf16 v[100:103], a[176:179], a[44:47], v[100:103]
 s_waitcnt lgkmcnt(4)
 v_mfma_f32_16x16x32_bf16 v[108:111], a[160:163], a[44:47], v[108:111]
 ds_read_b64_tr_b16 a[176:177], v9 offset:33952
 v_mfma_f32_16x16x32_bf16 v[108:111], a[164:167], a[60:63], v[108:111]
 ds_read_b64_tr_b16 a[178:179], v9 offset:34208
 v_mfma_f32_16x16x32_bf16 v[104:107], a[164:167], a[56:59], v[104:107]
 buffer_load_dword v5, v14, s[16:19], s5 offen offset:264
 v_mfma_f32_16x16x32_bf16 v[104:107], a[160:163], a[40:43], v[104:107]
 v_mfma_f32_16x16x32_bf16 v[44:47], a[160:163], a[36:39], v[44:47]
 ds_read_b64_tr_b16 a[180:181], v9 offset:50848
 v_mfma_f32_16x16x32_bf16 v[44:47], a[164:167], a[52:55], v[44:47]
 ds_read_b64_tr_b16 a[182:183], v9 offset:51104
 v_mfma_f32_16x16x32_bf16 v[40:43], a[164:167], a[48:51], v[40:43]
 buffer_load_dword v6, v14, s[16:19], s5 offen offset:520
 v_mfma_f32_16x16x32_bf16 v[40:43], a[160:163], a[32:35], v[40:43]
 s_waitcnt lgkmcnt(4)
 v_mfma_f32_16x16x32_bf16 v[48:51], a[168:171], a[32:35], v[48:51]
 ds_read_b64_tr_b16 a[160:161], v9 offset:33984
 v_mfma_f32_16x16x32_bf16 v[48:51], a[172:175], a[48:51], v[48:51]
 ds_read_b64_tr_b16 a[162:163], v9 offset:34240
 v_mfma_f32_16x16x32_bf16 v[52:55], a[172:175], a[52:55], v[52:55]
 buffer_load_dword v7, v14, s[16:19], s5 offen offset:776
 v_mfma_f32_16x16x32_bf16 v[52:55], a[168:171], a[36:39], v[52:55]
 v_mfma_f32_16x16x32_bf16 v[112:115], a[168:171], a[40:43], v[112:115]
 ds_read_b64_tr_b16 a[164:165], v9 offset:50880
 v_mfma_f32_16x16x32_bf16 v[112:115], a[172:175], a[56:59], v[112:115]
 ds_read_b64_tr_b16 a[166:167], v9 offset:51136
 v_mfma_f32_16x16x32_bf16 v[116:119], a[172:175], a[60:63], v[116:119]
 v_mfma_f32_16x16x32_bf16 v[116:119], a[168:171], a[44:47], v[116:119]
 s_waitcnt lgkmcnt(4)
 v_mfma_f32_16x16x32_bf16 v[124:127], a[176:179], a[44:47], v[124:127]
 ds_read_b64_tr_b16 a[168:169], v9 offset:34016
 v_mfma_f32_16x16x32_bf16 v[124:127], a[180:183], a[60:63], v[124:127]
 ds_read_b64_tr_b16 a[170:171], v9 offset:34272
 v_mfma_f32_16x16x32_bf16 v[120:123], a[180:183], a[56:59], v[120:123]
 v_mfma_f32_16x16x32_bf16 v[120:123], a[176:179], a[40:43], v[120:123]
 v_mfma_f32_16x16x32_bf16 v[60:63], a[176:179], a[36:39], v[60:63]
 ds_read_b64_tr_b16 a[172:173], v9 offset:50912
 v_mfma_f32_16x16x32_bf16 v[60:63], a[180:183], a[52:55], v[60:63]
 ds_read_b64_tr_b16 a[174:175], v9 offset:51168
 v_mfma_f32_16x16x32_bf16 v[56:59], a[180:183], a[48:51], v[56:59]
 v_mfma_f32_16x16x32_bf16 v[56:59], a[176:179], a[32:35], v[56:59]
 s_waitcnt lgkmcnt(4)
 v_mfma_f32_16x16x32_bf16 v[64:67], a[160:163], a[32:35], v[64:67]
 ds_read_b64_tr_b16 a[176:177], v9 offset:35872
 v_mfma_f32_16x16x32_bf16 v[64:67], a[164:167], a[48:51], v[64:67]
 ds_read_b64_tr_b16 a[178:179], v9 offset:36128
 v_mfma_f32_16x16x32_bf16 v[68:71], a[164:167], a[52:55], v[68:71]
 v_mfma_f32_16x16x32_bf16 v[68:71], a[160:163], a[36:39], v[68:71]
 v_mfma_f32_16x16x32_bf16 v[128:131], a[160:163], a[40:43], v[128:131]
 ds_read_b64_tr_b16 a[180:181], v9 offset:52768
 v_mfma_f32_16x16x32_bf16 v[128:131], a[164:167], a[56:59], v[128:131]
 ds_read_b64_tr_b16 a[182:183], v9 offset:53024
 v_mfma_f32_16x16x32_bf16 v[132:135], a[164:167], a[60:63], v[132:135]
 v_mfma_f32_16x16x32_bf16 v[132:135], a[160:163], a[44:47], v[132:135]
 s_waitcnt lgkmcnt(4)
 v_mfma_f32_16x16x32_bf16 v[140:143], a[168:171], a[44:47], v[140:143]
 ds_read_b64_tr_b16 a[160:161], v9 offset:35904
 v_mfma_f32_16x16x32_bf16 v[140:143], a[172:175], a[60:63], v[140:143]
 ds_read_b64_tr_b16 a[162:163], v9 offset:36160
 v_mfma_f32_16x16x32_bf16 v[136:139], a[172:175], a[56:59], v[136:139]
 v_mfma_f32_16x16x32_bf16 v[136:139], a[168:171], a[40:43], v[136:139]
 v_mfma_f32_16x16x32_bf16 v[76:79], a[168:171], a[36:39], v[76:79]
 ds_read_b64_tr_b16 a[164:165], v9 offset:52800
 v_mfma_f32_16x16x32_bf16 v[76:79], a[172:175], a[52:55], v[76:79]
 ds_read_b64_tr_b16 a[166:167], v9 offset:53056
 v_mfma_f32_16x16x32_bf16 v[72:75], a[172:175], a[48:51], v[72:75]
 v_mfma_f32_16x16x32_bf16 v[72:75], a[168:171], a[32:35], v[72:75]
 s_waitcnt lgkmcnt(4)
 v_mfma_f32_16x16x32_bf16 v[144:147], a[176:179], a[32:35], v[144:147]
 ds_read_b64_tr_b16 a[168:169], v9 offset:35936
 s_add_u32 m0, s62, 0
 v_mfma_f32_16x16x32_bf16 v[144:147], a[180:183], a[48:51], v[144:147]
 ds_read_b64_tr_b16 a[170:171], v9 offset:36192
 v_mfma_f32_16x16x32_bf16 v[148:151], a[180:183], a[52:55], v[148:151]
 buffer_load_dwordx4 v8, s[40:43], s67 offen offset:0 lds
 v_mfma_f32_16x16x32_bf16 v[148:151], a[176:179], a[36:39], v[148:151]
 v_mfma_f32_16x16x32_bf16 v[152:155], a[176:179], a[40:43], v[152:155]
 ds_read_b64_tr_b16 a[172:173], v9 offset:52832
 v_mfma_f32_16x16x32_bf16 v[152:155], a[180:183], a[56:59], v[152:155]
 ds_read_b64_tr_b16 a[174:175], v9 offset:53088
 v_mfma_f32_16x16x32_bf16 v[156:159], a[180:183], a[60:63], v[156:159]
 buffer_load_dwordx4 v8, s[40:43], s67 offen offset:1024 lds
 v_mfma_f32_16x16x32_bf16 v[156:159], a[176:179], a[44:47], v[156:159]
 s_waitcnt lgkmcnt(4)
 v_mfma_f32_16x16x32_bf16 v[172:175], a[160:163], a[44:47], v[172:175]
 ds_read_b64_tr_b16 a[176:177], v9 offset:35968
 v_mfma_f32_16x16x32_bf16 v[172:175], a[164:167], a[60:63], v[172:175]
 ds_read_b64_tr_b16 a[178:179], v9 offset:36224
 v_mfma_f32_16x16x32_bf16 v[168:171], a[164:167], a[56:59], v[168:171]
 buffer_load_dwordx4 v8, s[40:43], s67 offen offset:2048 lds
 v_mfma_f32_16x16x32_bf16 v[168:171], a[160:163], a[40:43], v[168:171]
 v_mfma_f32_16x16x32_bf16 v[164:167], a[160:163], a[36:39], v[164:167]
 ds_read_b64_tr_b16 a[180:181], v9 offset:52864
 v_mfma_f32_16x16x32_bf16 v[164:167], a[164:167], a[52:55], v[164:167]
 ds_read_b64_tr_b16 a[182:183], v9 offset:53120
 v_mfma_f32_16x16x32_bf16 v[160:163], a[164:167], a[48:51], v[160:163]
 buffer_load_dwordx4 v8, s[40:43], s67 offen offset:3072 lds
 s_add_u32 s67, s67, 16384
 v_mfma_f32_16x16x32_bf16 v[160:163], a[160:163], a[32:35], v[160:163]
 s_waitcnt lgkmcnt(4)
 v_mfma_f32_16x16x32_bf16 v[176:179], a[168:171], a[32:35], v[176:179]
 ds_read_b64_tr_b16 a[160:161], v9 offset:36000
 v_mfma_f32_16x16x32_bf16 v[176:179], a[172:175], a[48:51], v[176:179]
 ds_read_b64_tr_b16 a[162:163], v9 offset:36256
 v_mfma_f32_16x16x32_bf16 v[180:183], a[172:175], a[52:55], v[180:183]
 buffer_load_dword v15, v13, s[48:51], s88 offen offset:0
 v_mfma_f32_16x16x32_bf16 v[180:183], a[168:171], a[36:39], v[180:183]
 v_mfma_f32_16x16x32_bf16 v[184:187], a[168:171], a[40:43], v[184:187]
 ds_read_b64_tr_b16 a[164:165], v9 offset:52896
 v_mfma_f32_16x16x32_bf16 v[184:187], a[172:175], a[56:59], v[184:187]
 ds_read_b64_tr_b16 a[166:167], v9 offset:53152
 v_mfma_f32_16x16x32_bf16 v[188:191], a[172:175], a[60:63], v[188:191]
 v_mfma_f32_16x16x32_bf16 v[188:191], a[168:171], a[44:47], v[188:191]
 s_waitcnt lgkmcnt(4)
 v_mfma_f32_16x16x32_bf16 v[204:207], a[176:179], a[44:47], v[204:207]
 ds_read_b64_tr_b16 a[168:169], v9 offset:36032
 v_mfma_f32_16x16x32_bf16 v[204:207], a[180:183], a[60:63], v[204:207]
 ds_read_b64_tr_b16 a[170:171], v9 offset:36288
 v_mfma_f32_16x16x32_bf16 v[200:203], a[180:183], a[56:59], v[200:203]
 v_mfma_f32_16x16x32_bf16 v[200:203], a[176:179], a[40:43], v[200:203]
 v_mfma_f32_16x16x32_bf16 v[196:199], a[176:179], a[36:39], v[196:199]
 ds_read_b64_tr_b16 a[172:173], v9 offset:52928
 v_mfma_f32_16x16x32_bf16 v[196:199], a[180:183], a[52:55], v[196:199]
 ds_read_b64_tr_b16 a[174:175], v9 offset:53184
 v_mfma_f32_16x16x32_bf16 v[192:195], a[180:183], a[48:51], v[192:195]
 v_mfma_f32_16x16x32_bf16 v[192:195], a[176:179], a[32:35], v[192:195]
 s_waitcnt lgkmcnt(4)
 v_mfma_f32_16x16x32_bf16 v[208:211], a[160:163], a[32:35], v[208:211]
 ds_read_b64_tr_b16 a[176:177], v9 offset:36064
 v_mfma_f32_16x16x32_bf16 v[208:211], a[164:167], a[48:51], v[208:211]
 ds_read_b64_tr_b16 a[178:179], v9 offset:36320
 v_mfma_f32_16x16x32_bf16 v[212:215], a[164:167], a[52:55], v[212:215]
 ds_read_b64_tr_b16 a[180:181], v9 offset:52960
 v_mfma_f32_16x16x32_bf16 v[212:215], a[160:163], a[36:39], v[212:215]
 ds_read_b64_tr_b16 a[182:183], v9 offset:53216
 v_mfma_f32_16x16x32_bf16 v[216:219], a[160:163], a[40:43], v[216:219]
 v_mfma_f32_16x16x32_bf16 v[216:219], a[164:167], a[56:59], v[216:219]
 v_mfma_f32_16x16x32_bf16 v[220:223], a[164:167], a[60:63], v[220:223]
 v_mfma_f32_16x16x32_bf16 v[220:223], a[160:163], a[44:47], v[220:223]
 s_waitcnt lgkmcnt(4)
 v_mfma_f32_16x16x32_bf16 v[236:239], a[168:171], a[44:47], v[236:239]
 s_waitcnt vmcnt(30) lgkmcnt(0)
 v_mfma_f32_16x16x32_bf16 v[236:239], a[172:175], a[60:63], v[236:239]
 s_barrier
 v_mfma_f32_16x16x32_bf16 v[232:235], a[172:175], a[56:59], v[232:235]
 ds_read_b64_tr_b16 a[160:161], v10 offset:0
 v_mfma_f32_16x16x32_bf16 v[232:235], a[168:171], a[40:43], v[232:235]
 ds_read_b64_tr_b16 a[162:163], v10 offset:256
 v_mfma_f32_16x16x32_bf16 v[228:231], a[168:171], a[36:39], v[228:231]
 ds_read_b64_tr_b16 a[164:165], v10 offset:16896
 v_mfma_f32_16x16x32_bf16 v[228:231], a[172:175], a[52:55], v[228:231]
 ds_read_b64_tr_b16 a[166:167], v10 offset:17152
 v_mfma_f32_16x16x32_bf16 v[224:227], a[172:175], a[48:51], v[224:227]
 v_mfma_f32_16x16x32_bf16 v[224:227], a[168:171], a[32:35], v[224:227]
 s_waitcnt lgkmcnt(4)
 v_mfma_f32_16x16x32_bf16 v[240:243], a[176:179], a[32:35], v[240:243]
 ds_read_b64_tr_b16 a[168:169], v10 offset:32
 v_mfma_f32_16x16x32_bf16 v[240:243], a[180:183], a[48:51], v[240:243]
 ds_read_b64_tr_b16 a[170:171], v10 offset:288
 v_mfma_f32_16x16x32_bf16 v[244:247], a[180:183], a[52:55], v[244:247]
 v_mfma_f32_16x16x32_bf16 v[244:247], a[176:179], a[36:39], v[244:247]
 v_mfma_f32_16x16x32_bf16 v[248:251], a[176:179], a[40:43], v[248:251]
 ds_read_b64_tr_b16 a[172:173], v10 offset:16928
 v_mfma_f32_16x16x32_bf16 v[248:251], a[180:183], a[56:59], v[248:251]
 ds_read_b64_tr_b16 a[174:175], v10 offset:17184
 v_mfma_f32_16x16x32_bf16 v[252:255], a[180:183], a[60:63], v[252:255]
 v_mfma_f32_16x16x32_bf16 v[252:255], a[176:179], a[44:47], v[252:255]
 s_waitcnt vmcnt(31) lgkmcnt(4)
 v_mfma_f32_16x16x32_bf16 v[16:19], a[160:163], a[64:67], v[16:19]
 s_mov_b32 s84, 0x4b800000
 ds_read_b64_tr_b16 a[176:177], v10 offset:64
 v_mfma_f32_16x16x32_bf16 v[16:19], a[164:167], a[80:83], v[16:19]
 s_mov_b32 s26, 0xbeeff558
 ds_read_b64_tr_b16 a[178:179], v10 offset:320
 v_mfma_f32_16x16x32_bf16 v[20:23], a[164:167], a[84:87], v[20:23]
 s_mov_b32 s27, 0xbeeff558
 s_add_u32 m0, s62, 16896
 v_mfma_f32_16x16x32_bf16 v[20:23], a[160:163], a[68:71], v[20:23]
 s_mov_b32 s86, 0xbfb8aa3b
 v_mfma_f32_16x16x32_bf16 v[80:83], a[160:163], a[72:75], v[80:83]
 s_bfe_u32 s76, s2, 0x20003
 ds_read_b64_tr_b16 a[180:181], v10 offset:16960
 v_mfma_f32_16x16x32_bf16 v[80:83], a[164:167], a[88:91], v[80:83]
 s_and_b32 s78, s2, 7
 ds_read_b64_tr_b16 a[182:183], v10 offset:17216
 v_mfma_f32_16x16x32_bf16 v[84:87], a[164:167], a[92:95], v[84:87]
 s_lshr_b32 s4, s3, 1
 buffer_load_dwordx4 v8, s[40:43], s67 offen offset:0 lds
 v_mfma_f32_16x16x32_bf16 v[84:87], a[160:163], a[76:79], v[84:87]
 s_lshl_b32 s4, s4, 16
 s_waitcnt lgkmcnt(4)
 v_mfma_f32_16x16x32_bf16 v[92:95], a[168:171], a[76:79], v[92:95]
 s_mul_i32 s82, s76, 1835008
 ds_read_b64_tr_b16 a[160:161], v10 offset:96
 v_accvgpr_write_b32 a0, -1
 v_mfma_f32_16x16x32_bf16 v[92:95], a[172:175], a[92:95], v[92:95]
 s_add_u32 s82, s82, s4
 ds_read_b64_tr_b16 a[162:163], v10 offset:352
 v_accvgpr_write_b32 a1, -1
 v_mfma_f32_16x16x32_bf16 v[88:91], a[172:175], a[88:91], v[88:91]
 s_lshl_b32 s66, s76, 21
 buffer_load_dwordx4 v8, s[40:43], s67 offen offset:1024 lds
 v_accvgpr_write_b32 a2, -1
 v_mfma_f32_16x16x32_bf16 v[88:91], a[168:171], a[72:75], v[88:91]
 s_add_u32 s66, s66, s4
 v_accvgpr_write_b32 a3, -1
 v_mfma_f32_16x16x32_bf16 v[28:31], a[168:171], a[68:71], v[28:31]
 s_lshl_b32 s4, s58, 2
 ds_read_b64_tr_b16 a[164:165], v10 offset:16992
 v_mfma_f32_16x16x32_bf16 v[28:31], a[172:175], a[84:87], v[28:31]
 s_add_u32 s4, s4, s76
 ds_read_b64_tr_b16 a[166:167], v10 offset:17248
 v_mfma_f32_16x16x32_bf16 v[24:27], a[172:175], a[80:83], v[24:27]
 s_mul_i32 s71, s4, 114688
 buffer_load_dwordx4 v8, s[40:43], s67 offen offset:2048 lds
 v_mfma_f32_16x16x32_bf16 v[24:27], a[168:171], a[64:67], v[24:27]
 s_branch L_pg6k
L_pg6:
L_ic1w0:
 s_branch L_pg10
L_pg6k:
 s_add_u32 s71, s71, 27262976
 s_waitcnt lgkmcnt(4)
 v_mfma_f32_16x16x32_bf16 v[32:35], a[176:179], a[64:67], v[32:35]
 s_mul_i32 s25, s58, 529408
 ds_read_b64_tr_b16 a[168:169], v10 offset:128
 v_mfma_f32_16x16x32_bf16 v[32:35], a[180:183], a[80:83], v[32:35]
 s_add_u32 s25, s25, 8388608
 ds_read_b64_tr_b16 a[170:171], v10 offset:384
 v_mfma_f32_16x16x32_bf16 v[36:39], a[180:183], a[84:87], v[36:39]
 s_lshl_b32 s4, s76, 17
 buffer_load_dwordx4 v8, s[40:43], s67 offen offset:3072 lds
 s_add_u32 s67, s67, 16384
 v_mfma_f32_16x16x32_bf16 v[36:39], a[176:179], a[68:71], v[36:39]
 s_add_u32 s81, s25, s4
 v_mfma_f32_16x16x32_bf16 v[96:99], a[176:179], a[72:75], v[96:99]
 s_lshl_b32 s4, s56, 14
 ds_read_b64_tr_b16 a[172:173], v10 offset:17024
 v_mfma_f32_16x16x32_bf16 v[96:99], a[180:183], a[88:91], v[96:99]
 s_add_u32 s25, s25, s4
 ds_read_b64_tr_b16 a[174:175], v10 offset:17280
 v_mfma_f32_16x16x32_bf16 v[100:103], a[180:183], a[92:95], v[100:103]
 s_lshl_b32 s6, s57, 3
 s_add_u32 m0, s62, 33792
 v_mfma_f32_16x16x32_bf16 v[100:103], a[176:179], a[76:79], v[100:103]
 s_add_u32 s6, s6, s78
 s_waitcnt lgkmcnt(4)
 v_mfma_f32_16x16x32_bf16 v[108:111], a[160:163], a[76:79], v[108:111]
 s_lshl_b32 s4, s6, 4
 ds_read_b64_tr_b16 a[176:177], v10 offset:160
 v_mfma_f32_16x16x32_bf16 v[108:111], a[164:167], a[92:95], v[108:111]
 s_add_u32 s4, s4, s3
 ds_read_b64_tr_b16 a[178:179], v10 offset:416
 v_mfma_f32_16x16x32_bf16 v[104:107], a[164:167], a[88:91], v[104:107]
 s_mul_i32 s4, s4, 13312
 buffer_load_dwordx4 v8, s[40:43], s67 offen offset:0 lds
 v_mfma_f32_16x16x32_bf16 v[104:107], a[160:163], a[72:75], v[104:107]
 s_add_u32 s4, s4, 67108864
 v_mfma_f32_16x16x32_bf16 v[44:47], a[160:163], a[68:71], v[44:47]
 s_mul_i32 s5, s76, 53248
 ds_read_b64_tr_b16 a[180:181], v10 offset:17056
 v_mfma_f32_16x16x32_bf16 v[44:47], a[164:167], a[84:87], v[44:47]
 s_add_u32 s39, s4, s5
 ds_read_b64_tr_b16 a[182:183], v10 offset:17312
 v_mfma_f32_16x16x32_bf16 v[40:43], a[164:167], a[80:83], v[40:43]
 s_xor_b32 s5, s76, 1
 buffer_load_dwordx4 v8, s[40:43], s67 offen offset:1024 lds
 v_mfma_f32_16x16x32_bf16 v[40:43], a[160:163], a[64:67], v[40:43]
 s_mul_i32 s5, s5, 53248
 s_waitcnt lgkmcnt(4)
 v_mfma_f32_16x16x32_bf16 v[48:51], a[168:171], a[64:67], v[48:51]
 s_add_u32 s5, s5, 0
 ds_read_b64_tr_b16 a[160:161], v10 offset:192
 v_mfma_f32_16x16x32_bf16 v[48:51], a[172:175], a[80:83], v[48:51]
 s_add_u32 s36, s4, s5
 ds_read_b64_tr_b16 a[162:163], v10 offset:448
 v_mfma_f32_16x16x32_bf16 v[52:55], a[172:175], a[84:87], v[52:55]
 s_xor_b32 s5, s76, 2
 buffer_load_dwordx4 v8, s[40:43], s67 offen offset:2048 lds
 v_mfma_f32_16x16x32_bf16 v[52:55], a[168:171], a[68:71], v[52:55]
 s_mul_i32 s5, s5, 53248
 v_mfma_f32_16x16x32_bf16 v[112:115], a[168:171], a[72:75], v[112:115]
 s_add_u32 s5, s5, 4096
 ds_read_b64_tr_b16 a[164:165], v10 offset:17088
 v_mfma_f32_16x16x32_bf16 v[112:115], a[172:175], a[88:91], v[112:115]
 s_add_u32 s37, s4, s5
 ds_read_b64_tr_b16 a[166:167], v10 offset:17344
 v_mfma_f32_16x16x32_bf16 v[116:119], a[172:175], a[92:95], v[116:119]
 s_xor_b32 s5, s76, 3
 buffer_load_dwordx4 v8, s[40:43], s67 offen offset:3072 lds
 s_add_u32 s67, s67, 16384
 v_mfma_f32_16x16x32_bf16 v[116:119], a[168:171], a[76:79], v[116:119]
 s_mul_i32 s5, s5, 53248
 s_waitcnt lgkmcnt(4)
 v_mfma_f32_16x16x32_bf16 v[124:127], a[176:179], a[76:79], v[124:127]
 s_add_u32 s5, s5, 8192
 ds_read_b64_tr_b16 a[168:169], v10 offset:224
 v_mfma_f32_16x16x32_bf16 v[124:127], a[180:183], a[92:95], v[124:127]
 s_add_u32 s38, s4, s5
 ds_read_b64_tr_b16 a[170:171], v10 offset:480
 v_mfma_f32_16x16x32_bf16 v[120:123], a[180:183], a[88:91], v[120:123]
 s_lshl_b32 s4, s6, 11
 v_mfma_f32_16x16x32_bf16 v[120:123], a[176:179], a[72:75], v[120:123]
 s_lshl_b32 s7, s3, 9
 v_mfma_f32_16x16x32_bf16 v[60:63], a[176:179], a[68:71], v[60:63]
 s_add_u32 s4, s4, s7
 ds_read_b64_tr_b16 a[172:173], v10 offset:17120
 v_mfma_f32_16x16x32_bf16 v[60:63], a[180:183], a[84:87], v[60:63]
 s_add_u32 s10, s4, 59113472
 ds_read_b64_tr_b16 a[174:175], v10 offset:17376
 v_mfma_f32_16x16x32_bf16 v[56:59], a[180:183], a[80:83], v[56:59]
 s_lshl_b32 s4, s76, 7
 v_mfma_f32_16x16x32_bf16 v[56:59], a[176:179], a[64:67], v[56:59]
 s_add_u32 s15, s10, s4
 s_waitcnt lgkmcnt(4)
 v_mfma_f32_16x16x32_bf16 v[64:67], a[160:163], a[64:67], v[64:67]
 s_mul_i32 s4, s58, 458752
 ds_read_b64 a[176:177], v12 offset:33792
 v_mfma_f32_16x16x32_bf16 v[64:67], a[164:167], a[80:83], v[64:67]
 s_add_u32 s4, s4, 27262976
 v_mfma_f32_16x16x32_bf16 v[68:71], a[164:167], a[84:87], v[68:71]
 s_mul_i32 s5, s59, 7
 v_mfma_f32_16x16x32_bf16 v[68:71], a[160:163], a[68:71], v[68:71]
 s_add_u32 s6, s5, 6
 v_mfma_f32_16x16x32_bf16 v[128:131], a[160:163], a[72:75], v[128:131]
 s_lshl_b32 s6, s6, 12
 ds_read_b64 a[180:181], v12 offset:34816
 v_mfma_f32_16x16x32_bf16 v[128:131], a[164:167], a[88:91], v[128:131]
 s_add_u32 s23, s6, s4
 v_mfma_f32_16x16x32_bf16 v[132:135], a[164:167], a[92:95], v[132:135]
 s_mul_i32 s7, s60, 3
 v_mfma_f32_16x16x32_bf16 v[132:135], a[160:163], a[76:79], v[132:135]
 s_add_u32 s5, s5, s7
 s_waitcnt lgkmcnt(2)
 v_mfma_f32_16x16x32_bf16 v[140:143], a[168:171], a[76:79], v[140:143]
 s_lshl_b32 s5, s5, 12
 ds_read_b64 a[160:161], v12 offset:35840
 v_mfma_f32_16x16x32_bf16 v[140:143], a[172:175], a[92:95], v[140:143]
 s_add_u32 s20, s5, s4
 v_mfma_f32_16x16x32_bf16 v[136:139], a[172:175], a[88:91], v[136:139]
 s_add_u32 s21, s20, 4096
 v_mfma_f32_16x16x32_bf16 v[136:139], a[168:171], a[72:75], v[136:139]
 s_add_u32 s22, s20, 8192
 v_mfma_f32_16x16x32_bf16 v[76:79], a[168:171], a[68:71], v[76:79]
 s_mul_i32 s9, s57, 4352
 ds_read_b64 a[164:165], v12 offset:36864
 v_mfma_f32_16x16x32_bf16 v[76:79], a[172:175], a[84:87], v[76:79]
 s_add_u32 s9, s9, 58720256
 v_mfma_f32_16x16x32_bf16 v[72:75], a[172:175], a[80:83], v[72:75]
 s_lshl_b32 s7, s56, 7
 s_waitcnt vmcnt(26)
 v_mfma_f32_16x16x32_bf16 v[72:75], a[168:171], a[64:67], v[72:75]
 s_add_u32 s8, s9, s7
 s_barrier
 s_waitcnt vmcnt(13) lgkmcnt(3)
 v_mfma_f32_16x16x16_bf16 v[16:19], a[176:177], a[184:185], v[16:19]
 s_lshl_b32 s85, s78, 8
 ds_read_b64 a[168:169], v12 offset:37888
 v_mfma_f32_16x16x16_bf16 v[20:23], a[176:177], a[186:187], v[20:23]
 s_lshl_b32 s4, s76, 6
 v_mfma_f32_16x16x16_bf16 v[80:83], a[176:177], a[188:189], v[80:83]
 s_add_u32 s87, s85, s4
 s_add_u32 m0, s62, 50688
 v_mfma_f32_16x16x16_bf16 v[84:87], a[176:177], a[190:191], v[84:87]
 s_lshl_b32 s11, s58, 17
 s_waitcnt lgkmcnt(3)
 v_mfma_f32_16x16x16_bf16 v[24:27], a[180:181], a[184:185], v[24:27]
 s_add_u32 s11, s11, s87
 ds_read_b64 a[172:173], v12 offset:38912
 v_mfma_f32_16x16x16_bf16 v[28:31], a[180:181], a[186:187], v[28:31]
 s_add_u32 s12, s11, 32768
 v_mfma_f32_16x16x16_bf16 v[88:91], a[180:181], a[188:189], v[88:91]
 s_add_u32 s13, s11, 65536
 buffer_load_dwordx4 v8, s[40:43], s67 offen offset:0 lds
 v_mfma_f32_16x16x16_bf16 v[92:95], a[180:181], a[190:191], v[92:95]
 s_add_u32 s14, s11, 98304
 s_waitcnt lgkmcnt(3)
 v_mfma_f32_16x16x16_bf16 v[32:35], a[160:161], a[184:185], v[32:35]
 s_add_u32 s4, s39, 16777216
 ds_read_b64 a[176:177], v12 offset:39936
 v_mfma_f32_16x16x16_bf16 v[36:39], a[160:161], a[186:187], v[36:39]
 s_add_u32 s5, s39, 16781312
 v_mfma_f32_16x16x16_bf16 v[96:99], a[160:161], a[188:189], v[96:99]
 s_add_u32 s6, s39, 16785408
 buffer_load_dwordx4 v8, s[40:43], s67 offen offset:1024 lds
 v_mfma_f32_16x16x16_bf16 v[100:103], a[160:161], a[190:191], v[100:103]
 s_waitcnt lgkmcnt(3)
 v_mfma_f32_16x16x16_bf16 v[40:43], a[164:165], a[184:185], v[40:43]
 ds_read_b64 a[180:181], v12 offset:40960
 v_mfma_f32_16x16x16_bf16 v[44:47], a[164:165], a[186:187], v[44:47]
 v_mfma_f32_16x16x16_bf16 v[104:107], a[164:165], a[188:189], v[104:107]
 buffer_load_dwordx4 v8, s[40:43], s67 offen offset:2048 lds
 v_mfma_f32_16x16x16_bf16 v[108:111], a[164:165], a[190:191], v[108:111]
 s_waitcnt lgkmcnt(3)
 v_mfma_f32_16x16x16_bf16 v[48:51], a[168:169], a[184:185], v[48:51]
 ds_read_b64_tr_b16 a[160:161], v10 offset:33792
 v_mfma_f32_16x16x16_bf16 v[52:55], a[168:169], a[186:187], v[52:55]
 ds_read_b64_tr_b16 a[162:163], v10 offset:34048
 v_mfma_f32_16x16x16_bf16 v[112:115], a[168:169], a[188:189], v[112:115]
 buffer_load_dwordx4 v8, s[40:43], s67 offen offset:3072 lds
 s_add_u32 s67, s67, 16384
 v_mfma_f32_16x16x16_bf16 v[116:119], a[168:169], a[190:191], v[116:119]
 s_waitcnt lgkmcnt(4)
 v_mfma_f32_16x16x16_bf16 v[56:59], a[172:173], a[184:185], v[56:59]
 ds_read_b64_tr_b16 a[164:165], v10 offset:50688
 v_mfma_f32_16x16x16_bf16 v[60:63], a[172:173], a[186:187], v[60:63]
 ds_read_b64_tr_b16 a[166:167], v10 offset:50944
 v_mfma_f32_16x16x16_bf16 v[120:123], a[172:173], a[188:189], v[120:123]
 v_mfma_f32_16x16x16_bf16 v[124:127], a[172:173], a[190:191], v[124:127]
 s_waitcnt lgkmcnt(5)
 v_mfma_f32_16x16x16_bf16 v[64:67], a[176:177], a[184:185], v[64:67]
 ds_read_b64_tr_b16 a[168:169], v10 offset:33824
 buffer_store_dwordx4 a[0:3], v8, s[16:19], s4 offen offset:0 sc0 sc1
 v_mfma_f32_16x16x16_bf16 v[68:71], a[176:177], a[186:187], v[68:71]
 ds_read_b64_tr_b16 a[170:171], v10 offset:34080
 v_mfma_f32_16x16x16_bf16 v[128:131], a[176:177], a[188:189], v[128:131]
 v_mfma_f32_16x16x16_bf16 v[132:135], a[176:177], a[190:191], v[132:135]
 s_waitcnt lgkmcnt(6)
 v_mfma_f32_16x16x16_bf16 v[72:75], a[180:181], a[184:185], v[72:75]
 ds_read_b64_tr_b16 a[172:173], v10 offset:50720
 v_mfma_f32_16x16x16_bf16 v[76:79], a[180:181], a[186:187], v[76:79]
 ds_read_b64_tr_b16 a[174:175], v10 offset:50976
 v_mfma_f32_16x16x16_bf16 v[136:139], a[180:181], a[188:189], v[136:139]
 v_mfma_f32_16x16x16_bf16 v[140:143], a[180:181], a[190:191], v[140:143]
 s_waitcnt vmcnt(22) lgkmcnt(4)
 v_mfma_f32_16x16x32_bf16 v[16:19], a[160:163], a[96:99], v[16:19]
 ds_read_b64_tr_b16 a[176:177], v10 offset:33856
 v_mfma_f32_16x16x32_bf16 v[16:19], a[164:167], a[112:115], v[16:19]
 ds_read_b64_tr_b16 a[178:179], v10 offset:34112
 v_mfma_f32_16x16x32_bf16 v[20:23], a[164:167], a[116:119], v[20:23]
 v_mfma_f32_16x16x32_bf16 v[20:23], a[160:163], a[100:103], v[20:23]
 v_mfma_f32_16x16x32_bf16 v[80:83], a[160:163], a[104:107], v[80:83]
 ds_read_b64_tr_b16 a[180:181], v10 offset:50752
 buffer_store_dwordx4 a[0:3], v8, s[16:19], s4 offen offset:1024 sc0 sc1
 v_mfma_f32_16x16x32_bf16 v[80:83], a[164:167], a[120:123], v[80:83]
 ds_read_b64_tr_b16 a[182:183], v10 offset:51008
 v_mfma_f32_16x16x32_bf16 v[84:87], a[164:167], a[124:127], v[84:87]
 v_mfma_f32_16x16x32_bf16 v[84:87], a[160:163], a[108:111], v[84:87]
 s_waitcnt lgkmcnt(4)
 v_mfma_f32_16x16x32_bf16 v[92:95], a[168:171], a[108:111], v[92:95]
 ds_read_b64_tr_b16 a[160:161], v10 offset:33888
 v_mfma_f32_16x16x32_bf16 v[92:95], a[172:175], a[124:127], v[92:95]
 ds_read_b64_tr_b16 a[162:163], v10 offset:34144
 v_mfma_f32_16x16x32_bf16 v[88:91], a[172:175], a[120:123], v[88:91]
 v_mfma_f32_16x16x32_bf16 v[88:91], a[168:171], a[104:107], v[88:91]
 v_mfma_f32_16x16x32_bf16 v[28:31], a[168:171], a[100:103], v[28:31]
 ds_read_b64_tr_b16 a[164:165], v10 offset:50784
 v_mfma_f32_16x16x32_bf16 v[28:31], a[172:175], a[116:119], v[28:31]
 ds_read_b64_tr_b16 a[166:167], v10 offset:51040
 v_mfma_f32_16x16x32_bf16 v[24:27], a[172:175], a[112:115], v[24:27]
 v_mfma_f32_16x16x32_bf16 v[24:27], a[168:171], a[96:99], v[24:27]
 s_waitcnt lgkmcnt(4)
 v_mfma_f32_16x16x32_bf16 v[32:35], a[176:179], a[96:99], v[32:35]
 ds_read_b64_tr_b16 a[168:169], v10 offset:33920
 buffer_store_dwordx4 a[0:3], v8, s[16:19], s4 offen offset:2048 sc0 sc1
 v_mfma_f32_16x16x32_bf16 v[32:35], a[180:183], a[112:115], v[32:35]
 ds_read_b64_tr_b16 a[170:171], v10 offset:34176
 v_mfma_f32_16x16x32_bf16 v[36:39], a[180:183], a[116:119], v[36:39]
 v_mfma_f32_16x16x32_bf16 v[36:39], a[176:179], a[100:103], v[36:39]
 v_mul_f32 v16, v4, v16
 v_mul_f32 v17, v4, v17
 v_mfma_f32_16x16x32_bf16 v[96:99], a[176:179], a[104:107], v[96:99]
 ds_read_b64_tr_b16 a[172:173], v10 offset:50816
 v_mul_f32 v18, v4, v18
 v_mfma_f32_16x16x32_bf16 v[96:99], a[180:183], a[120:123], v[96:99]
 ds_read_b64_tr_b16 a[174:175], v10 offset:51072
 v_mul_f32 v19, v4, v19
 v_mfma_f32_16x16x32_bf16 v[100:103], a[180:183], a[124:127], v[100:103]
 v_mul_f32 v24, v4, v24
 v_mul_f32 v25, v4, v25
 v_mfma_f32_16x16x32_bf16 v[100:103], a[176:179], a[108:111], v[100:103]
 s_waitcnt lgkmcnt(4)
 v_mul_f32 v26, v4, v26
 v_mul_f32 v27, v4, v27
 v_mfma_f32_16x16x32_bf16 v[108:111], a[160:163], a[108:111], v[108:111]
 ds_read_b64_tr_b16 a[176:177], v10 offset:33952
 v_cvt_pk_bf16_f32 v16, v16, v17
 v_mfma_f32_16x16x32_bf16 v[108:111], a[164:167], a[124:127], v[108:111]
 ds_read_b64_tr_b16 a[178:179], v10 offset:34208
 v_cvt_pk_bf16_f32 v17, v18, v19
 v_mfma_f32_16x16x32_bf16 v[104:107], a[164:167], a[120:123], v[104:107]
 v_cvt_pk_bf16_f32 v24, v24, v25
 v_cvt_pk_bf16_f32 v25, v26, v27
 v_mfma_f32_16x16x32_bf16 v[104:107], a[160:163], a[104:107], v[104:107]
 v_accvgpr_write_b32 a192, v16
 v_accvgpr_write_b32 a193, v17
 v_mfma_f32_16x16x32_bf16 v[44:47], a[160:163], a[100:103], v[44:47]
 ds_read_b64_tr_b16 a[180:181], v10 offset:50848
 v_accvgpr_write_b32 a194, v24
 v_mfma_f32_16x16x32_bf16 v[44:47], a[164:167], a[116:119], v[44:47]
 ds_read_b64_tr_b16 a[182:183], v10 offset:51104
 v_accvgpr_write_b32 a195, v25
 v_mfma_f32_16x16x32_bf16 v[40:43], a[164:167], a[112:115], v[40:43]
 v_mul_f32 v20, v5, v20
 v_mul_f32 v21, v5, v21
 v_mfma_f32_16x16x32_bf16 v[40:43], a[160:163], a[96:99], v[40:43]
 buffer_store_dwordx4 a[0:3], v8, s[16:19], s4 offen offset:3072 sc0 sc1
 v_mul_f32 v22, v5, v22
 v_mul_f32 v23, v5, v23
 s_waitcnt lgkmcnt(4)
 v_mfma_f32_16x16x32_bf16 v[48:51], a[168:171], a[96:99], v[48:51]
 ds_read_b64_tr_b16 a[160:161], v10 offset:33984
 v_mul_f32 v28, v5, v28
 v_mfma_f32_16x16x32_bf16 v[48:51], a[172:175], a[112:115], v[48:51]
 ds_read_b64_tr_b16 a[162:163], v10 offset:34240
 v_mul_f32 v29, v5, v29
 v_mfma_f32_16x16x32_bf16 v[52:55], a[172:175], a[116:119], v[52:55]
 v_mul_f32 v30, v5, v30
 v_mul_f32 v31, v5, v31
 v_mfma_f32_16x16x32_bf16 v[52:55], a[168:171], a[100:103], v[52:55]
 v_cvt_pk_bf16_f32 v20, v20, v21
 v_cvt_pk_bf16_f32 v21, v22, v23
 v_mfma_f32_16x16x32_bf16 v[112:115], a[168:171], a[104:107], v[112:115]
 ds_read_b64_tr_b16 a[164:165], v10 offset:50880
 v_cvt_pk_bf16_f32 v28, v28, v29
 v_mfma_f32_16x16x32_bf16 v[112:115], a[172:175], a[120:123], v[112:115]
 ds_read_b64_tr_b16 a[166:167], v10 offset:51136
 v_cvt_pk_bf16_f32 v29, v30, v31
 v_mfma_f32_16x16x32_bf16 v[116:119], a[172:175], a[124:127], v[116:119]
 v_accvgpr_write_b32 a208, v20
 v_accvgpr_write_b32 a209, v21
 v_mfma_f32_16x16x32_bf16 v[116:119], a[168:171], a[108:111], v[116:119]
 s_waitcnt lgkmcnt(4)
 v_accvgpr_write_b32 a210, v28
 v_accvgpr_write_b32 a211, v29
 v_mfma_f32_16x16x32_bf16 v[124:127], a[176:179], a[108:111], v[124:127]
 ds_read_b64_tr_b16 a[168:169], v10 offset:34016
 v_mul_f32 v32, v4, v32
 v_mfma_f32_16x16x32_bf16 v[124:127], a[180:183], a[124:127], v[124:127]
 ds_read_b64_tr_b16 a[170:171], v10 offset:34272
 v_mul_f32 v33, v4, v33
 v_mfma_f32_16x16x32_bf16 v[120:123], a[180:183], a[120:123], v[120:123]
 v_mul_f32 v34, v4, v34
 v_mul_f32 v35, v4, v35
 v_mfma_f32_16x16x32_bf16 v[120:123], a[176:179], a[104:107], v[120:123]
 buffer_store_dwordx4 a[0:3], v8, s[16:19], s5 offen offset:0 sc0 sc1
 v_mul_f32 v40, v4, v40
 v_mul_f32 v41, v4, v41
 v_mfma_f32_16x16x32_bf16 v[60:63], a[176:179], a[100:103], v[60:63]
 ds_read_b64_tr_b16 a[172:173], v10 offset:50912
 v_mul_f32 v42, v4, v42
 v_mfma_f32_16x16x32_bf16 v[60:63], a[180:183], a[116:119], v[60:63]
 ds_read_b64_tr_b16 a[174:175], v10 offset:51168
 v_mul_f32 v43, v4, v43
 v_mfma_f32_16x16x32_bf16 v[56:59], a[180:183], a[112:115], v[56:59]
 v_cvt_pk_bf16_f32 v32, v32, v33
 v_cvt_pk_bf16_f32 v33, v34, v35
 v_mfma_f32_16x16x32_bf16 v[56:59], a[176:179], a[96:99], v[56:59]
 s_waitcnt lgkmcnt(4)
 v_cvt_pk_bf16_f32 v40, v40, v41
 v_cvt_pk_bf16_f32 v41, v42, v43
 v_mfma_f32_16x16x32_bf16 v[64:67], a[160:163], a[96:99], v[64:67]
 ds_read_b64_tr_b16 a[176:177], v10 offset:2080
 v_accvgpr_write_b32 a196, v32
 v_mfma_f32_16x16x32_bf16 v[64:67], a[164:167], a[112:115], v[64:67]
 ds_read_b64_tr_b16 a[178:179], v10 offset:2336
 v_accvgpr_write_b32 a197, v33
 v_mfma_f32_16x16x32_bf16 v[68:71], a[164:167], a[116:119], v[68:71]
 v_accvgpr_write_b32 a198, v40
 v_accvgpr_write_b32 a199, v41
 v_mfma_f32_16x16x32_bf16 v[68:71], a[160:163], a[100:103], v[68:71]
 v_mul_f32 v36, v5, v36
 v_mul_f32 v37, v5, v37
 v_mfma_f32_16x16x32_bf16 v[128:131], a[160:163], a[104:107], v[128:131]
 ds_read_b64_tr_b16 a[180:181], v10 offset:18976
 v_mul_f32 v38, v5, v38
 v_mfma_f32_16x16x32_bf16 v[128:131], a[164:167], a[120:123], v[128:131]
 ds_read_b64_tr_b16 a[182:183], v10 offset:19232
 v_mul_f32 v39, v5, v39
 v_mfma_f32_16x16x32_bf16 v[132:135], a[164:167], a[124:127], v[132:135]
 v_mul_f32 v44, v5, v44
 v_mul_f32 v45, v5, v45
 v_mfma_f32_16x16x32_bf16 v[132:135], a[160:163], a[108:111], v[132:135]
 buffer_store_dwordx4 a[0:3], v8, s[16:19], s5 offen offset:1024 sc0 sc1
 v_mul_f32 v46, v5, v46
 v_mul_f32 v47, v5, v47
 s_waitcnt lgkmcnt(4)
 v_mfma_f32_16x16x32_bf16 v[140:143], a[168:171], a[108:111], v[140:143]
 ds_read_b64_tr_b16 a[160:161], v10 offset:2112
 v_cvt_pk_bf16_f32 v36, v36, v37
 v_mfma_f32_16x16x32_bf16 v[140:143], a[172:175], a[124:127], v[140:143]
 ds_read_b64_tr_b16 a[162:163], v10 offset:2368
 v_cvt_pk_bf16_f32 v37, v38, v39
 v_mfma_f32_16x16x32_bf16 v[136:139], a[172:175], a[120:123], v[136:139]
 v_cvt_pk_bf16_f32 v44, v44, v45
 v_cvt_pk_bf16_f32 v45, v46, v47
 v_mfma_f32_16x16x32_bf16 v[136:139], a[168:171], a[104:107], v[136:139]
 v_accvgpr_write_b32 a212, v36
 v_accvgpr_write_b32 a213, v37
 v_mfma_f32_16x16x32_bf16 v[76:79], a[168:171], a[100:103], v[76:79]
 ds_read_b64_tr_b16 a[164:165], v10 offset:19008
 v_accvgpr_write_b32 a214, v44
 v_mfma_f32_16x16x32_bf16 v[76:79], a[172:175], a[116:119], v[76:79]
 ds_read_b64_tr_b16 a[166:167], v10 offset:19264
 v_accvgpr_write_b32 a215, v45
 v_mfma_f32_16x16x32_bf16 v[72:75], a[172:175], a[112:115], v[72:75]
 v_mul_f32 v48, v4, v48
 v_mul_f32 v49, v4, v49
 v_mfma_f32_16x16x32_bf16 v[72:75], a[168:171], a[96:99], v[72:75]
 s_waitcnt lgkmcnt(4)
 v_mul_f32 v50, v4, v50
 v_mul_f32 v51, v4, v51
 v_mfma_f32_16x16x32_bf16 v[144:147], a[176:179], a[64:67], v[144:147]
 ds_read_b64_tr_b16 a[168:169], v10 offset:2144
 v_mul_f32 v56, v4, v56
 v_mfma_f32_16x16x32_bf16 v[144:147], a[180:183], a[80:83], v[144:147]
 ds_read_b64_tr_b16 a[170:171], v10 offset:2400
 v_mul_f32 v57, v4, v57
 v_mfma_f32_16x16x32_bf16 v[148:151], a[180:183], a[84:87], v[148:151]
 v_mul_f32 v58, v4, v58
 v_mul_f32 v59, v4, v59
 v_mfma_f32_16x16x32_bf16 v[148:151], a[176:179], a[68:71], v[148:151]
 buffer_store_dwordx4 a[0:3], v8, s[16:19], s5 offen offset:2048 sc0 sc1
 v_cvt_pk_bf16_f32 v48, v48, v49
 v_cvt_pk_bf16_f32 v49, v50, v51
 v_mfma_f32_16x16x32_bf16 v[152:155], a[176:179], a[72:75], v[152:155]
 ds_read_b64_tr_b16 a[172:173], v10 offset:19040
 v_cvt_pk_bf16_f32 v56, v56, v57
 v_mfma_f32_16x16x32_bf16 v[152:155], a[180:183], a[88:91], v[152:155]
 ds_read_b64_tr_b16 a[174:175], v10 offset:19296
 v_cvt_pk_bf16_f32 v57, v58, v59
 v_mfma_f32_16x16x32_bf16 v[156:159], a[180:183], a[92:95], v[156:159]
 v_accvgpr_write_b32 a200, v48
 v_accvgpr_write_b32 a201, v49
 v_mfma_f32_16x16x32_bf16 v[156:159], a[176:179], a[76:79], v[156:159]
 s_waitcnt lgkmcnt(4)
 v_accvgpr_write_b32 a202, v56
 v_accvgpr_write_b32 a203, v57
 v_mfma_f32_16x16x32_bf16 v[172:175], a[160:163], a[76:79], v[172:175]
 ds_read_b64_tr_b16 a[176:177], v10 offset:2176
 v_mul_f32 v52, v5, v52
 v_mfma_f32_16x16x32_bf16 v[172:175], a[164:167], a[92:95], v[172:175]
 ds_read_b64_tr_b16 a[178:179], v10 offset:2432
 v_mul_f32 v53, v5, v53
 v_mfma_f32_16x16x32_bf16 v[168:171], a[164:167], a[88:91], v[168:171]
 v_mul_f32 v54, v5, v54
 v_mul_f32 v55, v5, v55
 v_mfma_f32_16x16x32_bf16 v[168:171], a[160:163], a[72:75], v[168:171]
 v_mul_f32 v60, v5, v60
 v_mul_f32 v61, v5, v61
 v_mfma_f32_16x16x32_bf16 v[164:167], a[160:163], a[68:71], v[164:167]
 ds_read_b64_tr_b16 a[180:181], v10 offset:19072
 v_mul_f32 v62, v5, v62
 v_mfma_f32_16x16x32_bf16 v[164:167], a[164:167], a[84:87], v[164:167]
 ds_read_b64_tr_b16 a[182:183], v10 offset:19328
 v_mul_f32 v63, v5, v63
 v_mfma_f32_16x16x32_bf16 v[160:163], a[164:167], a[80:83], v[160:163]
 v_cvt_pk_bf16_f32 v52, v52, v53
 v_cvt_pk_bf16_f32 v53, v54, v55
 v_mfma_f32_16x16x32_bf16 v[160:163], a[160:163], a[64:67], v[160:163]
 buffer_store_dwordx4 a[0:3], v8, s[16:19], s5 offen offset:3072 sc0 sc1
 v_cvt_pk_bf16_f32 v60, v60, v61
 v_cvt_pk_bf16_f32 v61, v62, v63
 s_waitcnt lgkmcnt(4)
 v_mfma_f32_16x16x32_bf16 v[176:179], a[168:171], a[64:67], v[176:179]
 ds_read_b64_tr_b16 a[160:161], v10 offset:2208
 v_accvgpr_write_b32 a216, v52
 v_mfma_f32_16x16x32_bf16 v[176:179], a[172:175], a[80:83], v[176:179]
 ds_read_b64_tr_b16 a[162:163], v10 offset:2464
 v_accvgpr_write_b32 a217, v53
 v_mfma_f32_16x16x32_bf16 v[180:183], a[172:175], a[84:87], v[180:183]
 v_accvgpr_write_b32 a218, v60
 v_accvgpr_write_b32 a219, v61
 v_mfma_f32_16x16x32_bf16 v[180:183], a[168:171], a[68:71], v[180:183]
 v_mul_f32 v64, v4, v64
 v_mul_f32 v65, v4, v65
 v_mfma_f32_16x16x32_bf16 v[184:187], a[168:171], a[72:75], v[184:187]
 ds_read_b64_tr_b16 a[164:165], v10 offset:19104
 v_mul_f32 v66, v4, v66
 v_mfma_f32_16x16x32_bf16 v[184:187], a[172:175], a[88:91], v[184:187]
 ds_read_b64_tr_b16 a[166:167], v10 offset:19360
 v_mul_f32 v67, v4, v67
 v_mfma_f32_16x16x32_bf16 v[188:191], a[172:175], a[92:95], v[188:191]
 v_mul_f32 v72, v4, v72
 v_mul_f32 v73, v4, v73
 v_mfma_f32_16x16x32_bf16 v[188:191], a[168:171], a[76:79], v[188:191]
 s_waitcnt lgkmcnt(4)
 v_mul_f32 v74, v4, v74
 v_mul_f32 v75, v4, v75
 v_mfma_f32_16x16x32_bf16 v[204:207], a[176:179], a[76:79], v[204:207]
 ds_read_b64_tr_b16 a[168:169], v10 offset:2240
 v_cvt_pk_bf16_f32 v64, v64, v65
 v_mfma_f32_16x16x32_bf16 v[204:207], a[180:183], a[92:95], v[204:207]
 ds_read_b64_tr_b16 a[170:171], v10 offset:2496
 v_cvt_pk_bf16_f32 v65, v66, v67
 v_mfma_f32_16x16x32_bf16 v[200:203], a[180:183], a[88:91], v[200:203]
 v_cvt_pk_bf16_f32 v72, v72, v73
 v_cvt_pk_bf16_f32 v73, v74, v75
 v_mfma_f32_16x16x32_bf16 v[200:203], a[176:179], a[72:75], v[200:203]
 buffer_store_dwordx4 a[0:3], v8, s[16:19], s6 offen offset:0 sc0 sc1
 v_accvgpr_write_b32 a204, v64
 v_accvgpr_write_b32 a205, v65
 v_mfma_f32_16x16x32_bf16 v[196:199], a[176:179], a[68:71], v[196:199]
 ds_read_b64_tr_b16 a[172:173], v10 offset:19136
 v_accvgpr_write_b32 a206, v72
 v_mfma_f32_16x16x32_bf16 v[196:199], a[180:183], a[84:87], v[196:199]
 ds_read_b64_tr_b16 a[174:175], v10 offset:19392
 v_accvgpr_write_b32 a207, v73
 v_mfma_f32_16x16x32_bf16 v[192:195], a[180:183], a[80:83], v[192:195]
 v_mul_f32 v68, v5, v68
 v_mul_f32 v69, v5, v69
 v_mfma_f32_16x16x32_bf16 v[192:195], a[176:179], a[64:67], v[192:195]
 s_waitcnt lgkmcnt(4)
 v_mul_f32 v70, v5, v70
 v_mul_f32 v71, v5, v71
 v_mfma_f32_16x16x32_bf16 v[208:211], a[160:163], a[64:67], v[208:211]
 ds_read_b64_tr_b16 a[176:177], v10 offset:2272
 v_mul_f32 v76, v5, v76
 v_mfma_f32_16x16x32_bf16 v[208:211], a[164:167], a[80:83], v[208:211]
 ds_read_b64_tr_b16 a[178:179], v10 offset:2528
 v_mul_f32 v77, v5, v77
 v_mfma_f32_16x16x32_bf16 v[212:215], a[164:167], a[84:87], v[212:215]
 v_mul_f32 v78, v5, v78
 v_mul_f32 v79, v5, v79
 v_mfma_f32_16x16x32_bf16 v[212:215], a[160:163], a[68:71], v[212:215]
 v_cvt_pk_bf16_f32 v68, v68, v69
 v_cvt_pk_bf16_f32 v69, v70, v71
 v_mfma_f32_16x16x32_bf16 v[216:219], a[160:163], a[72:75], v[216:219]
 ds_read_b64_tr_b16 a[180:181], v10 offset:19168
 v_cvt_pk_bf16_f32 v76, v76, v77
 v_mfma_f32_16x16x32_bf16 v[216:219], a[164:167], a[88:91], v[216:219]
 ds_read_b64_tr_b16 a[182:183], v10 offset:19424
 v_cvt_pk_bf16_f32 v77, v78, v79
 v_mfma_f32_16x16x32_bf16 v[220:223], a[164:167], a[92:95], v[220:223]
 v_accvgpr_write_b32 a220, v68
 v_accvgpr_write_b32 a221, v69
 v_mfma_f32_16x16x32_bf16 v[220:223], a[160:163], a[76:79], v[220:223]
 buffer_store_dwordx4 a[0:3], v8, s[16:19], s6 offen offset:1024 sc0 sc1
 v_accvgpr_write_b32 a222, v76
 v_accvgpr_write_b32 a223, v77
 s_waitcnt lgkmcnt(4)
 v_mfma_f32_16x16x32_bf16 v[236:239], a[168:171], a[76:79], v[236:239]
 ds_read_b64_tr_b16 a[160:161], v10 offset:35872
 v_mul_f32 v80, v6, v80
 v_mfma_f32_16x16x32_bf16 v[236:239], a[172:175], a[92:95], v[236:239]
 ds_read_b64_tr_b16 a[162:163], v10 offset:36128
 v_mul_f32 v81, v6, v81
 v_mfma_f32_16x16x32_bf16 v[232:235], a[172:175], a[88:91], v[232:235]
 v_mul_f32 v82, v6, v82
 v_mul_f32 v83, v6, v83
 v_mfma_f32_16x16x32_bf16 v[232:235], a[168:171], a[72:75], v[232:235]
 v_mul_f32 v88, v6, v88
 v_mul_f32 v89, v6, v89
 v_mfma_f32_16x16x32_bf16 v[228:231], a[168:171], a[68:71], v[228:231]
 ds_read_b64_tr_b16 a[164:165], v10 offset:52768
 v_mul_f32 v90, v6, v90
 v_mfma_f32_16x16x32_bf16 v[228:231], a[172:175], a[84:87], v[228:231]
 ds_read_b64_tr_b16 a[166:167], v10 offset:53024
 v_mul_f32 v91, v6, v91
 v_mfma_f32_16x16x32_bf16 v[224:227], a[172:175], a[80:83], v[224:227]
 v_cvt_pk_bf16_f32 v80, v80, v81
 v_cvt_pk_bf16_f32 v81, v82, v83
 v_mfma_f32_16x16x32_bf16 v[224:227], a[168:171], a[64:67], v[224:227]
 s_waitcnt lgkmcnt(4)
 v_cvt_pk_bf16_f32 v88, v88, v89
 v_cvt_pk_bf16_f32 v89, v90, v91
 v_mfma_f32_16x16x32_bf16 v[240:243], a[176:179], a[64:67], v[240:243]
 ds_read_b64_tr_b16 a[168:169], v10 offset:35904
 v_accvgpr_write_b32 a224, v80
 v_mfma_f32_16x16x32_bf16 v[240:243], a[180:183], a[80:83], v[240:243]
 ds_read_b64_tr_b16 a[170:171], v10 offset:36160
 v_accvgpr_write_b32 a225, v81
 v_mfma_f32_16x16x32_bf16 v[244:247], a[180:183], a[84:87], v[244:247]
 v_accvgpr_write_b32 a226, v88
 v_accvgpr_write_b32 a227, v89
 v_mfma_f32_16x16x32_bf16 v[244:247], a[176:179], a[68:71], v[244:247]
 buffer_store_dwordx4 a[0:3], v8, s[16:19], s6 offen offset:2048 sc0 sc1
 v_mul_f32 v96, v6, v96
 v_mul_f32 v97, v6, v97
 v_mfma_f32_16x16x32_bf16 v[248:251], a[176:179], a[72:75], v[248:251]
 ds_read_b64_tr_b16 a[172:173], v10 offset:52800
 v_mul_f32 v98, v6, v98
 v_mfma_f32_16x16x32_bf16 v[248:251], a[180:183], a[88:91], v[248:251]
 ds_read_b64_tr_b16 a[174:175], v10 offset:53056
 v_mul_f32 v99, v6, v99
 v_mfma_f32_16x16x32_bf16 v[252:255], a[180:183], a[92:95], v[252:255]
 v_mul_f32 v104, v6, v104
 v_mul_f32 v105, v6, v105
 v_mfma_f32_16x16x32_bf16 v[252:255], a[176:179], a[76:79], v[252:255]
 s_waitcnt lgkmcnt(4)
 v_mul_f32 v106, v6, v106
 v_mul_f32 v107, v6, v107
 v_mfma_f32_16x16x32_bf16 v[144:147], a[160:163], a[96:99], v[144:147]
 ds_read_b64_tr_b16 a[176:177], v10 offset:35936
 v_cvt_pk_bf16_f32 v96, v96, v97
 v_mfma_f32_16x16x32_bf16 v[144:147], a[164:167], a[112:115], v[144:147]
 ds_read_b64_tr_b16 a[178:179], v10 offset:36192
 v_cvt_pk_bf16_f32 v97, v98, v99
 v_mfma_f32_16x16x32_bf16 v[148:151], a[164:167], a[116:119], v[148:151]
 v_cvt_pk_bf16_f32 v104, v104, v105
 v_cvt_pk_bf16_f32 v105, v106, v107
 v_mfma_f32_16x16x32_bf16 v[148:151], a[160:163], a[100:103], v[148:151]
 v_accvgpr_write_b32 a228, v96
 v_accvgpr_write_b32 a229, v97
 v_mfma_f32_16x16x32_bf16 v[152:155], a[160:163], a[104:107], v[152:155]
 ds_read_b64_tr_b16 a[180:181], v10 offset:52832
 v_accvgpr_write_b32 a230, v104
 v_mfma_f32_16x16x32_bf16 v[152:155], a[164:167], a[120:123], v[152:155]
 ds_read_b64_tr_b16 a[182:183], v10 offset:53088
 v_accvgpr_write_b32 a231, v105
 v_mfma_f32_16x16x32_bf16 v[156:159], a[164:167], a[124:127], v[156:159]
 v_mul_f32 v112, v6, v112
 v_mul_f32 v113, v6, v113
 v_mfma_f32_16x16x32_bf16 v[156:159], a[160:163], a[108:111], v[156:159]
 buffer_store_dwordx4 a[0:3], v8, s[16:19], s6 offen offset:3072 sc0 sc1
 v_mul_f32 v114, v6, v114
 v_mul_f32 v115, v6, v115
 s_waitcnt lgkmcnt(4)
 v_mfma_f32_16x16x32_bf16 v[172:175], a[168:171], a[108:111], v[172:175]
 s_branch L_pg7k
L_pg7:
 s_branch L_ic1r
L_pg7k:
 ds_read_b64_tr_b16 a[160:161], v10 offset:35968
 v_mul_f32 v120, v6, v120
 v_mfma_f32_16x16x32_bf16 v[172:175], a[172:175], a[124:127], v[172:175]
 ds_read_b64_tr_b16 a[162:163], v10 offset:36224
 v_mul_f32 v121, v6, v121
 v_mfma_f32_16x16x32_bf16 v[168:171], a[172:175], a[120:123], v[168:171]
 v_mul_f32 v122, v6, v122
 v_mul_f32 v123, v6, v123
 v_mfma_f32_16x16x32_bf16 v[168:171], a[168:171], a[104:107], v[168:171]
 v_cvt_pk_bf16_f32 v112, v112, v113
 v_cvt_pk_bf16_f32 v113, v114, v115
 v_mfma_f32_16x16x32_bf16 v[164:167], a[168:171], a[100:103], v[164:167]
 ds_read_b64_tr_b16 a[164:165], v10 offset:52864
 v_cvt_pk_bf16_f32 v120, v120, v121
 v_mfma_f32_16x16x32_bf16 v[164:167], a[172:175], a[116:119], v[164:167]
 ds_read_b64_tr_b16 a[166:167], v10 offset:53120
 v_cvt_pk_bf16_f32 v121, v122, v123
 v_mfma_f32_16x16x32_bf16 v[160:163], a[172:175], a[112:115], v[160:163]
 v_accvgpr_write_b32 a232, v112
 v_accvgpr_write_b32 a233, v113
 v_mfma_f32_16x16x32_bf16 v[160:163], a[168:171], a[96:99], v[160:163]
 s_waitcnt lgkmcnt(4)
 v_accvgpr_write_b32 a234, v120
 v_accvgpr_write_b32 a235, v121
 v_mfma_f32_16x16x32_bf16 v[176:179], a[176:179], a[96:99], v[176:179]
 ds_read_b64_tr_b16 a[168:169], v10 offset:36000
 v_mul_f32 v128, v6, v128
 v_mfma_f32_16x16x32_bf16 v[176:179], a[180:183], a[112:115], v[176:179]
 ds_read_b64_tr_b16 a[170:171], v10 offset:36256
 v_mul_f32 v129, v6, v129
 v_mfma_f32_16x16x32_bf16 v[180:183], a[180:183], a[116:119], v[180:183]
 v_mul_f32 v130, v6, v130
 v_mul_f32 v131, v6, v131
 v_mfma_f32_16x16x32_bf16 v[180:183], a[176:179], a[100:103], v[180:183]
 v_mul_f32 v136, v6, v136
 v_mul_f32 v137, v6, v137
 v_mfma_f32_16x16x32_bf16 v[184:187], a[176:179], a[104:107], v[184:187]
 ds_read_b64_tr_b16 a[172:173], v10 offset:52896
 v_mul_f32 v138, v6, v138
 v_mfma_f32_16x16x32_bf16 v[184:187], a[180:183], a[120:123], v[184:187]
 ds_read_b64_tr_b16 a[174:175], v10 offset:53152
 v_mul_f32 v139, v6, v139
 v_mfma_f32_16x16x32_bf16 v[188:191], a[180:183], a[124:127], v[188:191]
 v_cvt_pk_bf16_f32 v128, v128, v129
 v_cvt_pk_bf16_f32 v129, v130, v131
 v_mfma_f32_16x16x32_bf16 v[188:191], a[176:179], a[108:111], v[188:191]
 s_waitcnt lgkmcnt(4)
 v_cvt_pk_bf16_f32 v136, v136, v137
 v_cvt_pk_bf16_f32 v137, v138, v139
 v_mfma_f32_16x16x32_bf16 v[204:207], a[160:163], a[108:111], v[204:207]
 ds_read_b64_tr_b16 a[176:177], v10 offset:36032
 v_accvgpr_write_b32 a236, v128
 v_mfma_f32_16x16x32_bf16 v[204:207], a[164:167], a[124:127], v[204:207]
 ds_read_b64_tr_b16 a[178:179], v10 offset:36288
 v_accvgpr_write_b32 a237, v129
 v_mfma_f32_16x16x32_bf16 v[200:203], a[164:167], a[120:123], v[200:203]
 v_accvgpr_write_b32 a238, v136
 v_accvgpr_write_b32 a239, v137
 v_mfma_f32_16x16x32_bf16 v[200:203], a[160:163], a[104:107], v[200:203]
 v_mul_f32 v84, v7, v84
 v_mul_f32 v85, v7, v85
 v_mfma_f32_16x16x32_bf16 v[196:199], a[160:163], a[100:103], v[196:199]
 ds_read_b64_tr_b16 a[180:181], v10 offset:52928
 v_mul_f32 v86, v7, v86
 v_mfma_f32_16x16x32_bf16 v[196:199], a[164:167], a[116:119], v[196:199]
 ds_read_b64_tr_b16 a[182:183], v10 offset:53184
 v_mul_f32 v87, v7, v87
 v_mfma_f32_16x16x32_bf16 v[192:195], a[164:167], a[112:115], v[192:195]
 v_mul_f32 v92, v7, v92
 v_mul_f32 v93, v7, v93
 v_mfma_f32_16x16x32_bf16 v[192:195], a[160:163], a[96:99], v[192:195]
 s_waitcnt lgkmcnt(4)
 v_mul_f32 v94, v7, v94
 v_mul_f32 v95, v7, v95
 v_mfma_f32_16x16x32_bf16 v[208:211], a[168:171], a[96:99], v[208:211]
 ds_read_b64_tr_b16 a[160:161], v10 offset:36064
 v_cvt_pk_bf16_f32 v84, v84, v85
 v_mfma_f32_16x16x32_bf16 v[208:211], a[172:175], a[112:115], v[208:211]
 ds_read_b64_tr_b16 a[162:163], v10 offset:36320
 v_cvt_pk_bf16_f32 v85, v86, v87
 v_mfma_f32_16x16x32_bf16 v[212:215], a[172:175], a[116:119], v[212:215]
 v_cvt_pk_bf16_f32 v92, v92, v93
 v_cvt_pk_bf16_f32 v93, v94, v95
 v_mfma_f32_16x16x32_bf16 v[212:215], a[168:171], a[100:103], v[212:215]
 v_accvgpr_write_b32 a240, v84
 v_accvgpr_write_b32 a241, v85
 v_mfma_f32_16x16x32_bf16 v[216:219], a[168:171], a[104:107], v[216:219]
 ds_read_b64_tr_b16 a[164:165], v10 offset:52960
 v_accvgpr_write_b32 a242, v92
 v_mfma_f32_16x16x32_bf16 v[216:219], a[172:175], a[120:123], v[216:219]
 ds_read_b64_tr_b16 a[166:167], v10 offset:53216
 v_accvgpr_write_b32 a243, v93
 v_mfma_f32_16x16x32_bf16 v[220:223], a[172:175], a[124:127], v[220:223]
 s_waitcnt vmcnt(20) lgkmcnt(2)
 v_mul_f32 v100, v7, v100
 v_mul_f32 v101, v7, v101
 v_mfma_f32_16x16x32_bf16 v[220:223], a[168:171], a[108:111], v[220:223]
 s_barrier
 v_mul_f32 v102, v7, v102
 s_waitcnt lgkmcnt(4)
 v_mfma_f32_16x16x32_bf16 v[236:239], a[176:179], a[108:111], v[236:239]
 ds_read_b64 a[168:169], v12 offset:41984
 s_add_u32 m0, s62, 67584
 v_mfma_f32_16x16x32_bf16 v[236:239], a[180:183], a[124:127], v[236:239]
 buffer_load_dwordx4 v8, s[40:43], s67 offen offset:0 lds
 v_mul_f32 v103, v7, v103
 v_mfma_f32_16x16x32_bf16 v[232:235], a[180:183], a[120:123], v[232:235]
 v_mul_f32 v108, v7, v108
 v_mul_f32 v109, v7, v109
 v_mfma_f32_16x16x32_bf16 v[232:235], a[176:179], a[104:107], v[232:235]
 v_mul_f32 v110, v7, v110
 v_mul_f32 v111, v7, v111
 v_mfma_f32_16x16x32_bf16 v[228:231], a[176:179], a[100:103], v[228:231]
 ds_read_b64 a[172:173], v12 offset:43008
 buffer_load_dwordx4 v8, s[40:43], s67 offen offset:1024 lds
 v_mfma_f32_16x16x32_bf16 v[228:231], a[180:183], a[116:119], v[228:231]
 v_cvt_pk_bf16_f32 v100, v100, v101
 v_cvt_pk_bf16_f32 v101, v102, v103
 v_mfma_f32_16x16x32_bf16 v[224:227], a[180:183], a[112:115], v[224:227]
 v_cvt_pk_bf16_f32 v108, v108, v109
 v_cvt_pk_bf16_f32 v109, v110, v111
 v_mfma_f32_16x16x32_bf16 v[224:227], a[176:179], a[96:99], v[224:227]
 buffer_load_dwordx4 v8, s[40:43], s67 offen offset:2048 lds
L_ic2s:
 s_cmp_eq_u32 s3, 0
 s_cbranch_scc1 L_ic2w0
 s_cmp_eq_u32 s3, 1
 s_cbranch_scc1 L_ic2w1
 s_cmp_eq_u32 s3, 2
 s_cbranch_scc1 L_ic2w2
 s_branch L_ic2w3
L_ic2r:
 s_waitcnt lgkmcnt(2)
 v_mfma_f32_16x16x32_bf16 v[240:243], a[160:163], a[96:99], v[240:243]
 ds_read_b64 a[176:177], v12 offset:44032
 v_accvgpr_write_b32 a244, v100
 v_mfma_f32_16x16x32_bf16 v[240:243], a[164:167], a[112:115], v[240:243]
 v_accvgpr_write_b32 a245, v101
 v_accvgpr_write_b32 a246, v108
 v_mfma_f32_16x16x32_bf16 v[244:247], a[164:167], a[116:119], v[244:247]
 buffer_load_dwordx4 v8, s[40:43], s67 offen offset:3072 lds
 s_add_u32 s67, s67, 16384
 v_mfma_f32_16x16x32_bf16 v[244:247], a[160:163], a[100:103], v[244:247]
 v_accvgpr_write_b32 a247, v109
 v_mul_f32 v116, v7, v116
 v_mfma_f32_16x16x32_bf16 v[248:251], a[160:163], a[104:107], v[248:251]
 ds_read_b64 a[180:181], v12 offset:45056
 s_add_u32 m0, s62, 84480
 v_mfma_f32_16x16x32_bf16 v[248:251], a[164:167], a[120:123], v[248:251]
 buffer_load_dwordx4 v8, s[40:43], s67 offen offset:0 lds
 v_mul_f32 v117, v7, v117
 v_mfma_f32_16x16x32_bf16 v[252:255], a[164:167], a[124:127], v[252:255]
 v_mul_f32 v118, v7, v118
 v_mul_f32 v119, v7, v119
 v_mfma_f32_16x16x32_bf16 v[252:255], a[160:163], a[108:111], v[252:255]
 s_waitcnt lgkmcnt(3)
 v_mul_f32 v124, v7, v124
 v_mul_f32 v125, v7, v125
 v_mfma_f32_16x16x16_bf16 v[144:147], a[168:169], a[184:185], v[144:147]
 ds_read_b64 a[160:161], v12 offset:46080
 buffer_load_dwordx4 v8, s[40:43], s67 offen offset:1024 lds
 v_mfma_f32_16x16x16_bf16 v[148:151], a[168:169], a[186:187], v[148:151]
 v_mul_f32 v126, v7, v126
 v_mul_f32 v127, v7, v127
 v_mfma_f32_16x16x16_bf16 v[152:155], a[168:169], a[188:189], v[152:155]
 v_cvt_pk_bf16_f32 v116, v116, v117
 v_cvt_pk_bf16_f32 v117, v118, v119
 v_mfma_f32_16x16x16_bf16 v[156:159], a[168:169], a[190:191], v[156:159]
 buffer_load_dwordx4 v8, s[40:43], s67 offen offset:2048 lds
 s_waitcnt lgkmcnt(3)
 v_mfma_f32_16x16x16_bf16 v[160:163], a[172:173], a[184:185], v[160:163]
 ds_read_b64 a[164:165], v12 offset:47104
 v_cvt_pk_bf16_f32 v124, v124, v125
 v_mfma_f32_16x16x16_bf16 v[164:167], a[172:173], a[186:187], v[164:167]
 v_cvt_pk_bf16_f32 v125, v126, v127
 v_accvgpr_write_b32 a248, v116
 v_mfma_f32_16x16x16_bf16 v[168:171], a[172:173], a[188:189], v[168:171]
 buffer_load_dwordx4 v8, s[40:43], s67 offen offset:3072 lds
 s_add_u32 s67, s67, 16384
 v_mfma_f32_16x16x16_bf16 v[172:175], a[172:173], a[190:191], v[172:175]
 s_waitcnt lgkmcnt(3)
 v_accvgpr_write_b32 a249, v117
 v_accvgpr_write_b32 a250, v124
 v_mfma_f32_16x16x16_bf16 v[176:179], a[176:177], a[184:185], v[176:179]
 ds_read_b64 a[168:169], v12 offset:48128
 s_add_u32 m0, s62, 101376
 v_mfma_f32_16x16x16_bf16 v[180:183], a[176:177], a[186:187], v[180:183]
 buffer_load_dwordx4 v8, s[40:43], s67 offen offset:0 lds
 v_accvgpr_write_b32 a251, v125
 v_mfma_f32_16x16x16_bf16 v[184:187], a[176:177], a[188:189], v[184:187]
 v_mul_f32 v132, v7, v132
 v_mul_f32 v133, v7, v133
 v_mfma_f32_16x16x16_bf16 v[188:191], a[176:177], a[190:191], v[188:191]
 s_waitcnt lgkmcnt(3)
 v_mul_f32 v134, v7, v134
 v_mul_f32 v135, v7, v135
 v_mfma_f32_16x16x16_bf16 v[192:195], a[180:181], a[184:185], v[192:195]
 ds_read_b128 a[128:131], v8 offset:0
 buffer_load_dwordx4 v8, s[40:43], s67 offen offset:1024 lds
 v_mfma_f32_16x16x16_bf16 v[196:199], a[180:181], a[186:187], v[196:199]
 ds_read_b128 a[132:135], v8 offset:1024
 v_mul_f32 v140, v7, v140
 v_mfma_f32_16x16x16_bf16 v[200:203], a[180:181], a[188:189], v[200:203]
 ds_read_b128 a[136:139], v8 offset:2048
 v_mul_f32 v141, v7, v141
 v_mfma_f32_16x16x16_bf16 v[204:207], a[180:181], a[190:191], v[204:207]
 ds_read_b128 a[140:143], v8 offset:3072
 buffer_load_dwordx4 v8, s[40:43], s67 offen offset:2048 lds
 s_waitcnt lgkmcnt(6)
 v_mfma_f32_16x16x16_bf16 v[208:211], a[160:161], a[184:185], v[208:211]
 ds_read_b128 a[144:147], v8 offset:4096
 v_mul_f32 v142, v7, v142
 v_mfma_f32_16x16x16_bf16 v[212:215], a[160:161], a[186:187], v[212:215]
 ds_read_b128 a[148:151], v8 offset:5120
 v_mul_f32 v143, v7, v143
 v_mfma_f32_16x16x16_bf16 v[216:219], a[160:161], a[188:189], v[216:219]
 ds_read_b128 a[152:155], v8 offset:6144
 buffer_load_dwordx4 v8, s[40:43], s67 offen offset:3072 lds
 s_add_u32 s67, s67, 16384
 v_mfma_f32_16x16x16_bf16 v[220:223], a[160:161], a[190:191], v[220:223]
 ds_read_b128 a[156:159], v8 offset:7168
 s_waitcnt lgkmcnt(9)
 v_mfma_f32_16x16x16_bf16 v[224:227], a[164:165], a[184:185], v[224:227]
 v_cvt_pk_bf16_f32 v132, v132, v133
 v_cvt_pk_bf16_f32 v133, v134, v135
 v_mfma_f32_16x16x16_bf16 v[228:231], a[164:165], a[186:187], v[228:231]
 v_cvt_pk_bf16_f32 v140, v140, v141
 v_cvt_pk_bf16_f32 v141, v142, v143
 v_mfma_f32_16x16x16_bf16 v[232:235], a[164:165], a[188:189], v[232:235]
 v_accvgpr_write_b32 a252, v132
 v_accvgpr_write_b32 a253, v133
 v_mfma_f32_16x16x16_bf16 v[236:239], a[164:165], a[190:191], v[236:239]
 s_waitcnt lgkmcnt(8)
 v_accvgpr_write_b32 a254, v140
 v_accvgpr_write_b32 a255, v141
 v_mfma_f32_16x16x16_bf16 v[240:243], a[168:169], a[184:185], v[240:243]
 v_mfma_f32_16x16x16_bf16 v[244:247], a[168:169], a[186:187], v[244:247]
 v_mfma_f32_16x16x16_bf16 v[248:251], a[168:169], a[188:189], v[248:251]
 v_mfma_f32_16x16x16_bf16 v[252:255], a[168:169], a[190:191], v[252:255]
L_att:
 s_waitcnt lgkmcnt(0)
 v_mfma_f32_16x16x32_bf16 v[64:67], a[128:131], a[192:195], 0
 ds_read_b128 a[160:163], v8 offset:25088
 v_and_b32 v20, 3, v1
 v_mfma_f32_16x16x32_bf16 v[64:67], a[132:135], a[196:199], v[64:67]
 v_cmp_eq_u32 vcc, 0, v20
 v_mov_b32 v20, 0x3f803f80
 v_mfma_f32_16x16x32_bf16 v[64:67], a[136:139], a[200:203], v[64:67]
 ds_read_b128 a[164:167], v8 offset:26112
 v_mul_f32 v4, 0xc06b389d, v4
 v_mfma_f32_16x16x32_bf16 v[64:67], a[140:143], a[204:207], v[64:67]
 v_mul_f32 v5, 0xc06b389d, v5
 v_mul_f32 v6, 0xc06b389d, v6
 v_mfma_f32_16x16x32_bf16 v[68:71], a[156:159], a[204:207], 0
 ds_read_b128 a[168:171], v8 offset:27136
 v_mul_f32 v7, 0xc06b389d, v7
 v_mfma_f32_16x16x32_bf16 v[68:71], a[152:155], a[200:203], v[68:71]
 v_cndmask_b32 v124, 0, v20, vcc
 v_cndmask_b32 v125, 0, v20, vcc
 v_mfma_f32_16x16x32_bf16 v[68:71], a[148:151], a[196:199], v[68:71]
 ds_read_b128 a[172:175], v8 offset:28160
 v_cndmask_b32 v126, 0, v20, vcc
 v_mfma_f32_16x16x32_bf16 v[68:71], a[144:147], a[192:195], v[68:71]
 v_cndmask_b32 v127, 0, v20, vcc
 v_mov_b32 v116, 0x409d30fc
 v_mfma_f32_16x16x32_bf16 v[76:79], a[144:147], a[208:211], 0
 ds_read_b128 a[176:179], v8 offset:29184
 v_mov_b32 v117, 0x409d30fc
 v_mfma_f32_16x16x32_bf16 v[76:79], a[148:151], a[212:215], v[76:79]
 v_lshrrev_b32 v118, 5, v1
 v_add_u32 v118, s60, v118
 v_mfma_f32_16x16x32_bf16 v[76:79], a[152:155], a[216:219], v[76:79]
 ds_read_b128 a[180:183], v8 offset:30208
 v_lshl_add_u32 v118, v118, 9, v8
 v_mfma_f32_16x16x32_bf16 v[76:79], a[156:159], a[220:223], v[76:79]
 v_max3_f32 v16, v64, v65, v66
 v_mfma_f32_16x16x32_bf16 v[72:75], a[140:143], a[220:223], 0
 ds_read_b128 a[184:187], v8 offset:31232
 v_max3_f32 v16, v16, v67, v68
 v_mfma_f32_16x16x32_bf16 v[72:75], a[136:139], a[216:219], v[72:75]
 v_max3_f32 v16, v16, v69, v70
 v_max_f32 v16, v16, v71
 v_mfma_f32_16x16x32_bf16 v[72:75], a[132:135], a[212:215], v[72:75]
 ds_read_b128 a[188:191], v8 offset:32256
 v_mfma_f32_16x16x32_bf16 v[72:75], a[128:131], a[208:211], v[72:75]
 v_mfma_f32_16x16x32_bf16 v[32:35], a[128:131], a[224:227], 0
 v_max3_f32 v17, v76, v77, v78
 v_mfma_f32_16x16x32_bf16 v[32:35], a[132:135], a[228:231], v[32:35]
 v_mfma_f32_16x16x32_bf16 v[32:35], a[136:139], a[232:235], v[32:35]
 v_mfma_f32_16x16x32_bf16 v[32:35], a[140:143], a[236:239], v[32:35]
 v_mfma_f32_16x16x32_bf16 v[36:39], a[156:159], a[236:239], 0
 s_nop 1
 v_max3_f32 v17, v17, v79, v72
 v_max3_f32 v17, v17, v73, v74
 v_mfma_f32_16x16x32_bf16 v[36:39], a[152:155], a[232:235], v[36:39]
 v_max_f32 v17, v17, v75
 v_mfma_f32_16x16x32_bf16 v[36:39], a[148:151], a[228:231], v[36:39]
 s_nop 0
 v_permlane32_swap_b32 v16, v17
 v_mfma_f32_16x16x32_bf16 v[36:39], a[144:147], a[224:227], v[36:39]
 s_nop 0
 v_max_f32 v16, v16, v17
 v_mov_b32 v17, v16
 v_mfma_f32_16x16x32_bf16 v[44:47], a[144:147], a[240:243], 0
 s_nop 0
 v_permlane16_swap_b32 v16, v17
 v_mfma_f32_16x16x32_bf16 v[44:47], a[148:151], a[244:247], v[44:47]
 s_nop 0
 v_max_f32 v16, v16, v17
 v_mov_b32 v17, v16
 v_mfma_f32_16x16x32_bf16 v[44:47], a[152:155], a[248:251], v[44:47]
 s_nop 0
 v_permlane32_swap_b32 v16, v17
 v_mfma_f32_16x16x32_bf16 v[44:47], a[156:159], a[252:255], v[44:47]
 s_nop 0
 v_sub_f32 v48, 0, v16
 v_sub_f32 v49, 0, v16
 v_mfma_f32_16x16x32_bf16 v[40:43], a[140:143], a[252:255], 0
 v_sub_f32 v52, 0, v17
 v_sub_f32 v53, 0, v17
 v_mfma_f32_16x16x32_bf16 v[40:43], a[136:139], a[248:251], v[40:43]
 v_max3_f32 v18, v32, v33, v34
 v_max3_f32 v18, v18, v35, v36
 v_mfma_f32_16x16x32_bf16 v[40:43], a[132:135], a[244:247], v[40:43]
 v_max3_f32 v18, v18, v37, v38
 v_max_f32_e64 v18, v18, v39
 v_mfma_f32_16x16x32_bf16 v[40:43], a[128:131], a[240:243], v[40:43]
 ds_read_b128 a[144:147], v8 offset:20992
 ds_read_b128 a[148:151], v8 offset:22016
 ds_read_b128 a[152:155], v8 offset:23040
 ds_read_b128 a[156:159], v8 offset:24064
 ds_read_b128 a[140:143], v8 offset:19968
 ds_read_b128 a[136:139], v8 offset:18944
 ds_read_b128 a[132:135], v8 offset:17920
 ds_read_b128 a[128:131], v8 offset:16896
 v_max3_f32 v19, v44, v45, v46
 v_max3_f32 v19, v19, v47, v40
 v_max3_f32 v19, v19, v41, v42
 v_max_f32 v19, v19, v43
 v_pk_mov_b32 v[50:51], v[48:49], v[48:49]
 v_pk_mov_b32 v[54:55], v[52:53], v[52:53]
 v_permlane32_swap_b32 v18, v19
 v_pk_add_f32 v[64:65], v[64:65], v[48:49]
 v_pk_add_f32 v[66:67], v[66:67], v[48:49]
 v_max_f32 v18, v18, v19
 v_mov_b32 v19, v18
 v_pk_add_f32 v[68:69], v[68:69], v[48:49]
 v_pk_add_f32 v[70:71], v[70:71], v[48:49]
 v_permlane16_swap_b32 v18, v19
 v_pk_add_f32 v[72:73], v[72:73], v[52:53]
 v_pk_add_f32 v[74:75], v[74:75], v[52:53]
 v_max_f32 v18, v18, v19
 v_mov_b32 v19, v18
 v_pk_add_f32 v[76:77], v[76:77], v[52:53]
 v_pk_add_f32 v[78:79], v[78:79], v[52:53]
 v_permlane32_swap_b32 v18, v19
 s_nop 1
 v_sub_f32 v56, 0, v18
 v_sub_f32 v57, 0, v18
 v_sub_f32 v60, 0, v19
 v_sub_f32_e64 v61, 0, v19
 v_pk_mov_b32 v[58:59], v[56:57], v[56:57]
 v_pk_mov_b32 v[62:63], v[60:61], v[60:61]
 v_pk_add_f32 v[32:33], v[32:33], v[56:57]
 v_pk_add_f32 v[34:35], v[34:35], v[56:57]
 v_pk_add_f32 v[36:37], v[36:37], v[56:57]
 v_pk_add_f32 v[38:39], v[38:39], v[56:57]
 v_pk_add_f32 v[40:41], v[40:41], v[60:61]
 v_pk_add_f32 v[42:43], v[42:43], v[60:61]
 v_pk_add_f32 v[44:45], v[44:45], v[60:61]
 v_pk_add_f32 v[46:47], v[46:47], v[60:61]
 v_pk_mul_f32 v[144:145], v[144:145], v[4:5] op_sel:[0,0] op_sel_hi:[1,0]
 v_pk_mul_f32 v[146:147], v[146:147], v[4:5] op_sel:[0,0] op_sel_hi:[1,0]
 v_pk_mul_f32 v[160:161], v[160:161], v[4:5] op_sel:[0,0] op_sel_hi:[1,0]
 v_pk_mul_f32 v[162:163], v[162:163], v[4:5] op_sel:[0,0] op_sel_hi:[1,0]
 v_pk_fma_f32 v[16:17], v[144:145], v[144:145], v[116:117]
 v_pk_fma_f32 v[18:19], v[146:147], v[146:147], v[116:117]
 v_pk_fma_f32 v[20:21], v[160:161], v[160:161], v[116:117]
 v_pk_fma_f32 v[22:23], v[162:163], v[162:163], v[116:117]
 v_pk_mul_f32 v[16:17], v[16:17], v[144:145]
 v_pk_mul_f32 v[18:19], v[18:19], v[146:147]
 v_pk_mul_f32 v[20:21], v[20:21], v[160:161]
 v_pk_mul_f32 v[22:23], v[22:23], v[162:163]
 v_exp_f32 v16, v16
 v_exp_f32 v17, v17
 v_exp_f32 v18, v18
 v_exp_f32 v19, v19
 v_exp_f32 v20, v20
 v_exp_f32 v21, v21
 v_exp_f32 v22, v22
 v_exp_f32 v23, v23
 v_pk_fma_f32 v[16:17], v[16:17], s[26:27], s[26:27]
 v_pk_fma_f32 v[18:19], v[18:19], s[26:27], s[26:27]
 v_pk_fma_f32 v[20:21], v[20:21], s[26:27], s[26:27]
 v_pk_fma_f32 v[22:23], v[22:23], s[26:27], s[26:27]
 v_rcp_f32 v16, v16
 v_rcp_f32 v17, v17
 v_rcp_f32 v18, v18
 v_rcp_f32 v19, v19
 v_rcp_f32 v20, v20
 v_rcp_f32 v21, v21
 v_rcp_f32 v22, v22
 v_rcp_f32 v23, v23
 v_pk_mul_f32 v[16:17], v[16:17], v[144:145]
 v_pk_mul_f32 v[18:19], v[18:19], v[146:147]
 v_pk_mul_f32 v[20:21], v[20:21], v[160:161]
 v_pk_mul_f32 v[22:23], v[22:23], v[162:163]
 v_cvt_pk_bf16_f32 v144, v16, v17
 v_cvt_pk_bf16_f32 v145, v18, v19
 v_cvt_pk_bf16_f32 v146, v20, v21
 v_cvt_pk_bf16_f32 v147, v22, v23
 buffer_store_dwordx4 v[144:147], v8, s[16:19], s20 offen offset:0 sc0 sc1
 v_pk_mul_f32 v[148:149], v[148:149], v[4:5] op_sel:[0,1] op_sel_hi:[1,1]
 v_pk_mul_f32 v[150:151], v[150:151], v[4:5] op_sel:[0,1] op_sel_hi:[1,1]
 v_pk_mul_f32 v[164:165], v[164:165], v[4:5] op_sel:[0,1] op_sel_hi:[1,1]
 v_pk_mul_f32 v[166:167], v[166:167], v[4:5] op_sel:[0,1] op_sel_hi:[1,1]
 v_pk_fma_f32 v[16:17], v[148:149], v[148:149], v[116:117]
 v_pk_fma_f32 v[18:19], v[150:151], v[150:151], v[116:117]
 v_pk_fma_f32 v[20:21], v[164:165], v[164:165], v[116:117]
 v_pk_fma_f32 v[22:23], v[166:167], v[166:167], v[116:117]
 v_pk_mul_f32 v[16:17], v[16:17], v[148:149]
 v_pk_mul_f32 v[18:19], v[18:19], v[150:151]
 v_pk_mul_f32 v[20:21], v[20:21], v[164:165]
 v_pk_mul_f32 v[22:23], v[22:23], v[166:167]
 v_exp_f32 v16, v16
 v_exp_f32 v17, v17
 v_exp_f32 v18, v18
 v_exp_f32 v19, v19
 v_exp_f32 v20, v20
 v_exp_f32 v21, v21
 v_exp_f32 v22, v22
 v_exp_f32 v23, v23
 v_pk_fma_f32 v[16:17], v[16:17], s[26:27], s[26:27]
 v_pk_fma_f32 v[18:19], v[18:19], s[26:27], s[26:27]
 v_pk_fma_f32 v[20:21], v[20:21], s[26:27], s[26:27]
 v_pk_fma_f32 v[22:23], v[22:23], s[26:27], s[26:27]
 v_rcp_f32 v16, v16
 v_rcp_f32 v17, v17
 v_rcp_f32 v18, v18
 v_rcp_f32 v19, v19
 v_rcp_f32 v20, v20
 v_rcp_f32 v21, v21
 v_rcp_f32 v22, v22
 v_rcp_f32 v23, v23
 v_pk_mul_f32 v[16:17], v[16:17], v[148:149]
 v_pk_mul_f32 v[18:19], v[18:19], v[150:151]
 v_pk_mul_f32 v[20:21], v[20:21], v[164:165]
 v_pk_mul_f32 v[22:23], v[22:23], v[166:167]
 v_cvt_pk_bf16_f32 v148, v16, v17
 v_cvt_pk_bf16_f32 v149, v18, v19
 v_cvt_pk_bf16_f32 v150, v20, v21
 v_cvt_pk_bf16_f32 v151, v22, v23
 buffer_store_dwordx4 v[148:151], v8, s[16:19], s20 offen offset:1024 sc0 sc1
 v_pk_mul_f32 v[152:153], v[152:153], v[6:7] op_sel:[0,0] op_sel_hi:[1,0]
 v_pk_mul_f32 v[154:155], v[154:155], v[6:7] op_sel:[0,0] op_sel_hi:[1,0]
 v_pk_mul_f32 v[168:169], v[168:169], v[6:7] op_sel:[0,0] op_sel_hi:[1,0]
 v_pk_mul_f32 v[170:171], v[170:171], v[6:7] op_sel:[0,0] op_sel_hi:[1,0]
 v_pk_fma_f32 v[16:17], v[152:153], v[152:153], v[116:117]
 v_pk_fma_f32 v[18:19], v[154:155], v[154:155], v[116:117]
 v_pk_fma_f32 v[20:21], v[168:169], v[168:169], v[116:117]
 v_pk_fma_f32 v[22:23], v[170:171], v[170:171], v[116:117]
 v_pk_mul_f32 v[16:17], v[16:17], v[152:153]
 v_pk_mul_f32 v[18:19], v[18:19], v[154:155]
 v_pk_mul_f32 v[20:21], v[20:21], v[168:169]
 v_pk_mul_f32 v[22:23], v[22:23], v[170:171]
 v_exp_f32 v16, v16
 v_exp_f32 v17, v17
 v_exp_f32 v18, v18
 v_exp_f32 v19, v19
 v_exp_f32 v20, v20
 v_exp_f32 v21, v21
 v_exp_f32 v22, v22
 v_exp_f32 v23, v23
 v_pk_fma_f32 v[16:17], v[16:17], s[26:27], s[26:27]
 v_pk_fma_f32 v[18:19], v[18:19], s[26:27], s[26:27]
 v_pk_fma_f32 v[20:21], v[20:21], s[26:27], s[26:27]
 v_pk_fma_f32 v[22:23], v[22:23], s[26:27], s[26:27]
 v_rcp_f32 v16, v16
 v_rcp_f32 v17, v17
 v_rcp_f32 v18, v18
 v_rcp_f32 v19, v19
 v_rcp_f32 v20, v20
 v_rcp_f32 v21, v21
 v_rcp_f32 v22, v22
 v_rcp_f32 v23, v23
 v_pk_mul_f32 v[16:17], v[16:17], v[152:153]
 v_pk_mul_f32 v[18:19], v[18:19], v[154:155]
 v_pk_mul_f32 v[20:21], v[20:21], v[168:169]
 v_pk_mul_f32 v[22:23], v[22:23], v[170:171]
 v_cvt_pk_bf16_f32 v152, v16, v17
 v_cvt_pk_bf16_f32 v153, v18, v19
 v_cvt_pk_bf16_f32 v154, v20, v21
 v_cvt_pk_bf16_f32 v155, v22, v23
 buffer_store_dwordx4 v[152:155], v8, s[16:19], s20 offen offset:2048 sc0 sc1
 v_pk_mul_f32 v[156:157], v[156:157], v[6:7] op_sel:[0,1] op_sel_hi:[1,1]
 v_pk_mul_f32 v[158:159], v[158:159], v[6:7] op_sel:[0,1] op_sel_hi:[1,1]
 v_pk_mul_f32 v[172:173], v[172:173], v[6:7] op_sel:[0,1] op_sel_hi:[1,1]
 v_pk_mul_f32 v[174:175], v[174:175], v[6:7] op_sel:[0,1] op_sel_hi:[1,1]
 v_pk_fma_f32 v[16:17], v[156:157], v[156:157], v[116:117]
 v_pk_fma_f32 v[18:19], v[158:159], v[158:159], v[116:117]
 v_pk_fma_f32 v[20:21], v[172:173], v[172:173], v[116:117]
 v_pk_fma_f32 v[22:23], v[174:175], v[174:175], v[116:117]
 v_pk_mul_f32 v[16:17], v[16:17], v[156:157]
 v_pk_mul_f32 v[18:19], v[18:19], v[158:159]
 v_pk_mul_f32 v[20:21], v[20:21], v[172:173]
 v_pk_mul_f32 v[22:23], v[22:23], v[174:175]
 v_exp_f32 v16, v16
 v_exp_f32 v17, v17
 v_exp_f32 v18, v18
 v_exp_f32 v19, v19
 v_exp_f32 v20, v20
 v_exp_f32 v21, v21
 v_exp_f32 v22, v22
 v_exp_f32 v23, v23
 v_pk_fma_f32 v[16:17], v[16:17], s[26:27], s[26:27]
 v_pk_fma_f32 v[18:19], v[18:19], s[26:27], s[26:27]
 v_pk_fma_f32 v[20:21], v[20:21], s[26:27], s[26:27]
 v_pk_fma_f32 v[22:23], v[22:23], s[26:27], s[26:27]
 v_rcp_f32 v16, v16
 v_rcp_f32 v17, v17
 v_rcp_f32 v18, v18
 v_rcp_f32 v19, v19
 v_rcp_f32 v20, v20
 v_rcp_f32 v21, v21
 v_rcp_f32 v22, v22
 v_rcp_f32 v23, v23
 v_pk_mul_f32 v[16:17], v[16:17], v[156:157]
 v_pk_mul_f32 v[18:19], v[18:19], v[158:159]
 v_pk_mul_f32 v[20:21], v[20:21], v[172:173]
 v_pk_mul_f32 v[22:23], v[22:23], v[174:175]
 v_cvt_pk_bf16_f32 v156, v16, v17
 v_cvt_pk_bf16_f32 v157, v18, v19
 v_cvt_pk_bf16_f32 v158, v20, v21
 v_cvt_pk_bf16_f32 v159, v22, v23
 buffer_store_dwordx4 v[156:159], v8, s[16:19], s20 offen offset:3072 sc0 sc1
 v_pk_mul_f32 v[176:177], v[176:177], v[4:5] op_sel:[0,0] op_sel_hi:[1,0]
 v_pk_mul_f32 v[178:179], v[178:179], v[4:5] op_sel:[0,0] op_sel_hi:[1,0]
 v_pk_mul_f32 v[192:193], v[192:193], v[4:5] op_sel:[0,0] op_sel_hi:[1,0]
 v_pk_mul_f32 v[194:195], v[194:195], v[4:5] op_sel:[0,0] op_sel_hi:[1,0]
 v_pk_fma_f32 v[16:17], v[176:177], v[176:177], v[116:117]
 v_pk_fma_f32 v[18:19], v[178:179], v[178:179], v[116:117]
 v_pk_fma_f32 v[20:21], v[192:193], v[192:193], v[116:117]
 v_pk_fma_f32 v[22:23], v[194:195], v[194:195], v[116:117]
 v_pk_mul_f32 v[16:17], v[16:17], v[176:177]
 v_pk_mul_f32 v[18:19], v[18:19], v[178:179]
 v_pk_mul_f32 v[20:21], v[20:21], v[192:193]
 v_pk_mul_f32 v[22:23], v[22:23], v[194:195]
 v_exp_f32 v16, v16
 v_exp_f32 v17, v17
 v_exp_f32 v18, v18
 v_exp_f32 v19, v19
 v_exp_f32 v20, v20
 v_exp_f32 v21, v21
 v_exp_f32 v22, v22
 v_exp_f32 v23, v23
 v_pk_fma_f32 v[16:17], v[16:17], s[26:27], s[26:27]
 v_pk_fma_f32 v[18:19], v[18:19], s[26:27], s[26:27]
 v_pk_fma_f32 v[20:21], v[20:21], s[26:27], s[26:27]
 v_pk_fma_f32 v[22:23], v[22:23], s[26:27], s[26:27]
 v_rcp_f32 v16, v16
 v_rcp_f32 v17, v17
 v_rcp_f32 v18, v18
 v_rcp_f32 v19, v19
 v_rcp_f32 v20, v20
 v_rcp_f32 v21, v21
 v_rcp_f32 v22, v22
 v_rcp_f32 v23, v23
 v_pk_mul_f32 v[16:17], v[16:17], v[176:177]
 v_pk_mul_f32 v[18:19], v[18:19], v[178:179]
 v_pk_mul_f32 v[20:21], v[20:21], v[192:193]
 v_pk_mul_f32 v[22:23], v[22:23], v[194:195]
 v_cvt_pk_bf16_f32 v160, v16, v17
 v_cvt_pk_bf16_f32 v161, v18, v19
 v_cvt_pk_bf16_f32 v162, v20, v21
 v_cvt_pk_bf16_f32 v163, v22, v23
 buffer_store_dwordx4 v[160:163], v8, s[16:19], s21 offen offset:0 sc0 sc1
 v_pk_mul_f32 v[180:181], v[180:181], v[4:5] op_sel:[0,1] op_sel_hi:[1,1]
 v_pk_mul_f32 v[182:183], v[182:183], v[4:5] op_sel:[0,1] op_sel_hi:[1,1]
 v_pk_mul_f32 v[196:197], v[196:197], v[4:5] op_sel:[0,1] op_sel_hi:[1,1]
 v_pk_mul_f32 v[198:199], v[198:199], v[4:5] op_sel:[0,1] op_sel_hi:[1,1]
 v_pk_fma_f32 v[16:17], v[180:181], v[180:181], v[116:117]
 v_pk_fma_f32 v[18:19], v[182:183], v[182:183], v[116:117]
 v_pk_fma_f32 v[20:21], v[196:197], v[196:197], v[116:117]
 v_pk_fma_f32 v[22:23], v[198:199], v[198:199], v[116:117]
 v_pk_mul_f32 v[16:17], v[16:17], v[180:181]
 v_pk_mul_f32 v[18:19], v[18:19], v[182:183]
 v_pk_mul_f32 v[20:21], v[20:21], v[196:197]
 v_pk_mul_f32 v[22:23], v[22:23], v[198:199]
 v_exp_f32 v16, v16
 v_exp_f32 v17, v17
 v_exp_f32 v18, v18
 v_exp_f32 v19, v19
 v_exp_f32 v20, v20
 v_exp_f32 v21, v21
 v_exp_f32 v22, v22
 v_exp_f32 v23, v23
 v_pk_fma_f32 v[16:17], v[16:17], s[26:27], s[26:27]
 v_pk_fma_f32 v[18:19], v[18:19], s[26:27], s[26:27]
 v_pk_fma_f32 v[20:21], v[20:21], s[26:27], s[26:27]
 v_pk_fma_f32 v[22:23], v[22:23], s[26:27], s[26:27]
 v_rcp_f32 v16, v16
 v_rcp_f32 v17, v17
 v_rcp_f32 v18, v18
 v_rcp_f32 v19, v19
 v_rcp_f32 v20, v20
 v_rcp_f32 v21, v21
 v_rcp_f32 v22, v22
 v_rcp_f32 v23, v23
 v_pk_mul_f32 v[16:17], v[16:17], v[180:181]
 v_pk_mul_f32 v[18:19], v[18:19], v[182:183]
 v_pk_mul_f32 v[20:21], v[20:21], v[196:197]
 v_pk_mul_f32 v[22:23], v[22:23], v[198:199]
 v_cvt_pk_bf16_f32 v164, v16, v17
 s_branch L_pg8k
L_pg8:
 s_branch L_ic1r
L_pg8k:
 v_cvt_pk_bf16_f32 v165, v18, v19
 v_cvt_pk_bf16_f32 v166, v20, v21
 v_cvt_pk_bf16_f32 v167, v22, v23
 buffer_store_dwordx4 v[164:167], v8, s[16:19], s21 offen offset:1024 sc0 sc1
 v_pk_mul_f32 v[184:185], v[184:185], v[6:7] op_sel:[0,0] op_sel_hi:[1,0]
 v_pk_mul_f32 v[186:187], v[186:187], v[6:7] op_sel:[0,0] op_sel_hi:[1,0]
 v_pk_mul_f32 v[200:201], v[200:201], v[6:7] op_sel:[0,0] op_sel_hi:[1,0]
 v_pk_mul_f32 v[202:203], v[202:203], v[6:7] op_sel:[0,0] op_sel_hi:[1,0]
 v_pk_fma_f32 v[16:17], v[184:185], v[184:185], v[116:117]
 v_pk_fma_f32 v[18:19], v[186:187], v[186:187], v[116:117]
 v_pk_fma_f32 v[20:21], v[200:201], v[200:201], v[116:117]
 v_pk_fma_f32 v[22:23], v[202:203], v[202:203], v[116:117]
 v_pk_mul_f32 v[16:17], v[16:17], v[184:185]
 v_pk_mul_f32 v[18:19], v[18:19], v[186:187]
 v_pk_mul_f32 v[20:21], v[20:21], v[200:201]
 v_pk_mul_f32 v[22:23], v[22:23], v[202:203]
 v_exp_f32 v16, v16
 v_exp_f32 v17, v17
 v_exp_f32 v18, v18
 v_exp_f32 v19, v19
 v_exp_f32 v20, v20
 v_exp_f32 v21, v21
 v_exp_f32 v22, v22
 v_exp_f32 v23, v23
 v_pk_fma_f32 v[16:17], v[16:17], s[26:27], s[26:27]
 v_pk_fma_f32 v[18:19], v[18:19], s[26:27], s[26:27]
 v_pk_fma_f32 v[20:21], v[20:21], s[26:27], s[26:27]
 v_pk_fma_f32 v[22:23], v[22:23], s[26:27], s[26:27]
 v_rcp_f32 v16, v16
 v_rcp_f32 v17, v17
 v_rcp_f32 v18, v18
 v_rcp_f32 v19, v19
 v_rcp_f32 v20, v20
 v_rcp_f32 v21, v21
 v_rcp_f32 v22, v22
 v_rcp_f32 v23, v23
 v_pk_mul_f32 v[16:17], v[16:17], v[184:185]
 v_pk_mul_f32 v[18:19], v[18:19], v[186:187]
 v_pk_mul_f32 v[20:21], v[20:21], v[200:201]
 v_pk_mul_f32 v[22:23], v[22:23], v[202:203]
 v_cvt_pk_bf16_f32 v168, v16, v17
 v_cvt_pk_bf16_f32 v169, v18, v19
 v_cvt_pk_bf16_f32 v170, v20, v21
 v_cvt_pk_bf16_f32 v171, v22, v23
 buffer_store_dwordx4 v[168:171], v8, s[16:19], s21 offen offset:2048 sc0 sc1
 v_pk_mul_f32 v[188:189], v[188:189], v[6:7] op_sel:[0,1] op_sel_hi:[1,1]
 v_pk_mul_f32 v[190:191], v[190:191], v[6:7] op_sel:[0,1] op_sel_hi:[1,1]
 v_pk_mul_f32 v[204:205], v[204:205], v[6:7] op_sel:[0,1] op_sel_hi:[1,1]
 v_pk_mul_f32 v[206:207], v[206:207], v[6:7] op_sel:[0,1] op_sel_hi:[1,1]
 v_pk_fma_f32 v[16:17], v[188:189], v[188:189], v[116:117]
 v_pk_fma_f32 v[18:19], v[190:191], v[190:191], v[116:117]
 v_pk_fma_f32 v[20:21], v[204:205], v[204:205], v[116:117]
 v_pk_fma_f32 v[22:23], v[206:207], v[206:207], v[116:117]
 v_pk_mul_f32 v[16:17], v[16:17], v[188:189]
 v_pk_mul_f32 v[18:19], v[18:19], v[190:191]
 v_pk_mul_f32 v[20:21], v[20:21], v[204:205]
 v_pk_mul_f32 v[22:23], v[22:23], v[206:207]
 v_exp_f32 v16, v16
 v_exp_f32 v17, v17
 v_exp_f32 v18, v18
 v_exp_f32 v19, v19
 v_exp_f32 v20, v20
 v_exp_f32 v21, v21
 v_exp_f32 v22, v22
 v_exp_f32 v23, v23
 v_pk_fma_f32 v[16:17], v[16:17], s[26:27], s[26:27]
 v_pk_fma_f32 v[18:19], v[18:19], s[26:27], s[26:27]
 v_pk_fma_f32 v[20:21], v[20:21], s[26:27], s[26:27]
 v_pk_fma_f32 v[22:23], v[22:23], s[26:27], s[26:27]
 v_rcp_f32 v16, v16
 v_rcp_f32 v17, v17
 v_rcp_f32 v18, v18
 v_rcp_f32 v19, v19
 v_rcp_f32 v20, v20
 v_rcp_f32 v21, v21
 v_rcp_f32 v22, v22
 v_rcp_f32 v23, v23
 v_pk_mul_f32 v[16:17], v[16:17], v[188:189]
 v_pk_mul_f32 v[18:19], v[18:19], v[190:191]
 v_pk_mul_f32 v[20:21], v[20:21], v[204:205]
 v_pk_mul_f32 v[22:23], v[22:23], v[206:207]
 v_cvt_pk_bf16_f32 v172, v16, v17
 v_cvt_pk_bf16_f32 v173, v18, v19
 v_cvt_pk_bf16_f32 v174, v20, v21
 v_cvt_pk_bf16_f32 v175, v22, v23
 buffer_store_dwordx4 v[172:175], v8, s[16:19], s21 offen offset:3072 sc0 sc1
 v_pk_mul_f32 v[208:209], v[208:209], v[4:5] op_sel:[0,0] op_sel_hi:[1,0]
 v_pk_mul_f32 v[210:211], v[210:211], v[4:5] op_sel:[0,0] op_sel_hi:[1,0]
 v_pk_mul_f32 v[224:225], v[224:225], v[4:5] op_sel:[0,0] op_sel_hi:[1,0]
 v_pk_mul_f32 v[226:227], v[226:227], v[4:5] op_sel:[0,0] op_sel_hi:[1,0]
 v_pk_fma_f32 v[16:17], v[208:209], v[208:209], v[116:117]
 v_pk_fma_f32 v[18:19], v[210:211], v[210:211], v[116:117]
 v_pk_fma_f32 v[20:21], v[224:225], v[224:225], v[116:117]
 v_pk_fma_f32 v[22:23], v[226:227], v[226:227], v[116:117]
 v_pk_mul_f32 v[16:17], v[16:17], v[208:209]
 v_pk_mul_f32 v[18:19], v[18:19], v[210:211]
 v_pk_mul_f32 v[20:21], v[20:21], v[224:225]
 v_pk_mul_f32 v[22:23], v[22:23], v[226:227]
 v_exp_f32 v16, v16
 v_exp_f32 v17, v17
 v_exp_f32 v18, v18
 v_exp_f32 v19, v19
 v_exp_f32 v20, v20
 v_exp_f32 v21, v21
 v_exp_f32 v22, v22
 v_exp_f32 v23, v23
 v_pk_fma_f32 v[16:17], v[16:17], s[26:27], s[26:27]
 v_pk_fma_f32 v[18:19], v[18:19], s[26:27], s[26:27]
 v_pk_fma_f32 v[20:21], v[20:21], s[26:27], s[26:27]
 v_pk_fma_f32 v[22:23], v[22:23], s[26:27], s[26:27]
 v_rcp_f32 v16, v16
 v_rcp_f32 v17, v17
 v_rcp_f32 v18, v18
 v_rcp_f32 v19, v19
 v_rcp_f32 v20, v20
 v_rcp_f32 v21, v21
 v_rcp_f32 v22, v22
 v_rcp_f32 v23, v23
 v_pk_mul_f32 v[16:17], v[16:17], v[208:209]
 v_pk_mul_f32 v[18:19], v[18:19], v[210:211]
 v_pk_mul_f32 v[20:21], v[20:21], v[224:225]
 v_pk_mul_f32 v[22:23], v[22:23], v[226:227]
 v_cvt_pk_bf16_f32 v176, v16, v17
 v_cvt_pk_bf16_f32 v177, v18, v19
 v_cvt_pk_bf16_f32 v178, v20, v21
 v_cvt_pk_bf16_f32 v179, v22, v23
 buffer_store_dwordx4 v[176:179], v8, s[16:19], s22 offen offset:0 sc0 sc1
 v_pk_mul_f32 v[212:213], v[212:213], v[4:5] op_sel:[0,1] op_sel_hi:[1,1]
 v_pk_mul_f32 v[214:215], v[214:215], v[4:5] op_sel:[0,1] op_sel_hi:[1,1]
 v_pk_mul_f32 v[228:229], v[228:229], v[4:5] op_sel:[0,1] op_sel_hi:[1,1]
 v_pk_mul_f32 v[230:231], v[230:231], v[4:5] op_sel:[0,1] op_sel_hi:[1,1]
 v_pk_fma_f32 v[16:17], v[212:213], v[212:213], v[116:117]
 v_pk_fma_f32 v[18:19], v[214:215], v[214:215], v[116:117]
 v_pk_fma_f32 v[20:21], v[228:229], v[228:229], v[116:117]
 v_pk_fma_f32 v[22:23], v[230:231], v[230:231], v[116:117]
 v_pk_mul_f32 v[16:17], v[16:17], v[212:213]
 v_pk_mul_f32 v[18:19], v[18:19], v[214:215]
 v_pk_mul_f32 v[20:21], v[20:21], v[228:229]
 v_pk_mul_f32 v[22:23], v[22:23], v[230:231]
 v_exp_f32 v16, v16
 v_exp_f32 v17, v17
 v_exp_f32 v18, v18
 v_exp_f32 v19, v19
 v_exp_f32 v20, v20
 v_exp_f32 v21, v21
 v_exp_f32 v22, v22
 v_exp_f32 v23, v23
 v_pk_fma_f32 v[16:17], v[16:17], s[26:27], s[26:27]
 v_pk_fma_f32 v[18:19], v[18:19], s[26:27], s[26:27]
 v_pk_fma_f32 v[20:21], v[20:21], s[26:27], s[26:27]
 v_pk_fma_f32 v[22:23], v[22:23], s[26:27], s[26:27]
 v_rcp_f32 v16, v16
 v_rcp_f32 v17, v17
 v_rcp_f32 v18, v18
 v_rcp_f32 v19, v19
 v_rcp_f32 v20, v20
 v_rcp_f32 v21, v21
 v_rcp_f32 v22, v22
 v_rcp_f32 v23, v23
 v_pk_mul_f32 v[16:17], v[16:17], v[212:213]
 v_pk_mul_f32 v[18:19], v[18:19], v[214:215]
 v_pk_mul_f32 v[20:21], v[20:21], v[228:229]
 v_pk_mul_f32 v[22:23], v[22:23], v[230:231]
 v_cvt_pk_bf16_f32 v180, v16, v17
 v_cvt_pk_bf16_f32 v181, v18, v19
 v_cvt_pk_bf16_f32 v182, v20, v21
 v_cvt_pk_bf16_f32 v183, v22, v23
 buffer_store_dwordx4 v[180:183], v8, s[16:19], s22 offen offset:1024 sc0 sc1
 v_pk_mul_f32 v[216:217], v[216:217], v[6:7] op_sel:[0,0] op_sel_hi:[1,0]
 v_pk_mul_f32 v[218:219], v[218:219], v[6:7] op_sel:[0,0] op_sel_hi:[1,0]
 v_pk_mul_f32 v[232:233], v[232:233], v[6:7] op_sel:[0,0] op_sel_hi:[1,0]
 v_pk_mul_f32 v[234:235], v[234:235], v[6:7] op_sel:[0,0] op_sel_hi:[1,0]
 v_pk_fma_f32 v[16:17], v[216:217], v[216:217], v[116:117]
 v_pk_fma_f32 v[18:19], v[218:219], v[218:219], v[116:117]
 v_pk_fma_f32 v[20:21], v[232:233], v[232:233], v[116:117]
 v_pk_fma_f32 v[22:23], v[234:235], v[234:235], v[116:117]
 v_pk_mul_f32 v[16:17], v[16:17], v[216:217]
 v_pk_mul_f32 v[18:19], v[18:19], v[218:219]
 v_pk_mul_f32 v[20:21], v[20:21], v[232:233]
 v_pk_mul_f32 v[22:23], v[22:23], v[234:235]
 v_exp_f32 v16, v16
 v_exp_f32 v17, v17
 v_exp_f32 v18, v18
 v_exp_f32 v19, v19
 v_exp_f32 v20, v20
 v_exp_f32 v21, v21
 v_exp_f32 v22, v22
 v_exp_f32 v23, v23
 v_pk_fma_f32 v[16:17], v[16:17], s[26:27], s[26:27]
 v_pk_fma_f32 v[18:19], v[18:19], s[26:27], s[26:27]
 v_pk_fma_f32 v[20:21], v[20:21], s[26:27], s[26:27]
 v_pk_fma_f32 v[22:23], v[22:23], s[26:27], s[26:27]
 v_rcp_f32 v16, v16
 v_rcp_f32 v17, v17
 v_rcp_f32 v18, v18
 v_rcp_f32 v19, v19
 v_rcp_f32 v20, v20
 v_rcp_f32 v21, v21
 v_rcp_f32 v22, v22
 v_rcp_f32 v23, v23
 v_pk_mul_f32 v[16:17], v[16:17], v[216:217]
 v_pk_mul_f32 v[18:19], v[18:19], v[218:219]
 v_pk_mul_f32 v[20:21], v[20:21], v[232:233]
 v_pk_mul_f32 v[22:23], v[22:23], v[234:235]
 v_cvt_pk_bf16_f32 v184, v16, v17
 v_cvt_pk_bf16_f32 v185, v18, v19
 v_cvt_pk_bf16_f32 v186, v20, v21
 v_cvt_pk_bf16_f32 v187, v22, v23
 buffer_store_dwordx4 v[184:187], v8, s[16:19], s22 offen offset:2048 sc0 sc1
 v_pk_mul_f32 v[220:221], v[220:221], v[6:7] op_sel:[0,1] op_sel_hi:[1,1]
 v_pk_mul_f32 v[222:223], v[222:223], v[6:7] op_sel:[0,1] op_sel_hi:[1,1]
 v_pk_mul_f32 v[236:237], v[236:237], v[6:7] op_sel:[0,1] op_sel_hi:[1,1]
 v_pk_mul_f32 v[238:239], v[238:239], v[6:7] op_sel:[0,1] op_sel_hi:[1,1]
 v_pk_fma_f32 v[16:17], v[220:221], v[220:221], v[116:117]
 v_pk_fma_f32 v[18:19], v[222:223], v[222:223], v[116:117]
 v_pk_fma_f32 v[20:21], v[236:237], v[236:237], v[116:117]
 v_pk_fma_f32 v[22:23], v[238:239], v[238:239], v[116:117]
 v_pk_mul_f32 v[16:17], v[16:17], v[220:221]
 v_pk_mul_f32 v[18:19], v[18:19], v[222:223]
 v_pk_mul_f32 v[20:21], v[20:21], v[236:237]
 v_pk_mul_f32 v[22:23], v[22:23], v[238:239]
 v_exp_f32 v16, v16
 v_exp_f32 v17, v17
 v_exp_f32 v18, v18
 v_exp_f32 v19, v19
 v_exp_f32 v20, v20
 v_exp_f32 v21, v21
 v_exp_f32 v22, v22
 v_exp_f32 v23, v23
 v_pk_fma_f32 v[16:17], v[16:17], s[26:27], s[26:27]
 v_pk_fma_f32 v[18:19], v[18:19], s[26:27], s[26:27]
 v_pk_fma_f32 v[20:21], v[20:21], s[26:27], s[26:27]
 v_pk_fma_f32 v[22:23], v[22:23], s[26:27], s[26:27]
 v_rcp_f32 v16, v16
 v_rcp_f32 v17, v17
 v_rcp_f32 v18, v18
 v_rcp_f32 v19, v19
 v_rcp_f32 v20, v20
 v_rcp_f32 v21, v21
 v_rcp_f32 v22, v22
 v_rcp_f32 v23, v23
 v_pk_mul_f32 v[16:17], v[16:17], v[220:221]
 v_pk_mul_f32 v[18:19], v[18:19], v[222:223]
 v_pk_mul_f32 v[20:21], v[20:21], v[236:237]
 v_pk_mul_f32 v[22:23], v[22:23], v[238:239]
 v_cvt_pk_bf16_f32 v188, v16, v17
 v_cvt_pk_bf16_f32 v189, v18, v19
 v_cvt_pk_bf16_f32 v190, v20, v21
 v_cvt_pk_bf16_f32 v191, v22, v23
 buffer_store_dwordx4 v[188:191], v8, s[16:19], s22 offen offset:3072 sc0 sc1
 v_pk_mul_f32 v[240:241], v[240:241], v[4:5] op_sel:[0,0] op_sel_hi:[1,0]
 v_pk_mul_f32 v[242:243], v[242:243], v[4:5] op_sel:[0,0] op_sel_hi:[1,0]
 v_pk_mul_f32 v[244:245], v[244:245], v[4:5] op_sel:[0,1] op_sel_hi:[1,1]
 v_pk_mul_f32 v[246:247], v[246:247], v[4:5] op_sel:[0,1] op_sel_hi:[1,1]
 v_pk_fma_f32 v[16:17], v[240:241], v[240:241], v[116:117]
 v_pk_fma_f32 v[18:19], v[242:243], v[242:243], v[116:117]
 v_pk_fma_f32 v[20:21], v[244:245], v[244:245], v[116:117]
 v_pk_fma_f32 v[22:23], v[246:247], v[246:247], v[116:117]
 v_pk_mul_f32 v[16:17], v[16:17], v[240:241]
 v_pk_mul_f32 v[18:19], v[18:19], v[242:243]
 v_pk_mul_f32 v[20:21], v[20:21], v[244:245]
 v_pk_mul_f32 v[22:23], v[22:23], v[246:247]
 v_exp_f32 v16, v16
 v_exp_f32 v17, v17
 v_exp_f32 v18, v18
 v_exp_f32 v19, v19
 v_exp_f32 v20, v20
 v_exp_f32 v21, v21
 v_exp_f32 v22, v22
 v_exp_f32 v23, v23
 v_pk_fma_f32 v[16:17], v[16:17], s[26:27], s[26:27]
 v_pk_fma_f32 v[18:19], v[18:19], s[26:27], s[26:27]
 v_pk_fma_f32 v[20:21], v[20:21], s[26:27], s[26:27]
 v_pk_fma_f32 v[22:23], v[22:23], s[26:27], s[26:27]
 v_rcp_f32 v16, v16
 v_rcp_f32 v17, v17
 v_rcp_f32 v18, v18
 v_rcp_f32 v19, v19
 v_rcp_f32 v20, v20
 v_rcp_f32 v21, v21
 v_rcp_f32 v22, v22
 v_rcp_f32 v23, v23
 v_pk_mul_f32 v[16:17], v[16:17], v[240:241]
 v_pk_mul_f32 v[18:19], v[18:19], v[242:243]
 v_pk_mul_f32 v[20:21], v[20:21], v[244:245]
 v_pk_mul_f32 v[22:23], v[22:23], v[246:247]
 v_cvt_pk_bf16_f32 v192, v16, v17
 v_cvt_pk_bf16_f32 v193, v18, v19
 v_cvt_pk_bf16_f32 v194, v20, v21
 v_cvt_pk_bf16_f32 v195, v22, v23
 s_nop 0
 v_permlane32_swap_b32 v192, v194
 v_permlane32_swap_b32 v193, v195
 s_nop 1
 buffer_store_dwordx4 v[192:195], v118, s[16:19], s23 offen offset:0 sc0 sc1
 v_pk_mul_f32 v[248:249], v[248:249], v[6:7] op_sel:[0,0] op_sel_hi:[1,0]
 v_pk_mul_f32 v[250:251], v[250:251], v[6:7] op_sel:[0,0] op_sel_hi:[1,0]
 v_pk_mul_f32 v[252:253], v[252:253], v[6:7] op_sel:[0,1] op_sel_hi:[1,1]
 v_pk_mul_f32 v[254:255], v[254:255], v[6:7] op_sel:[0,1] op_sel_hi:[1,1]
 v_pk_fma_f32 v[16:17], v[248:249], v[248:249], v[116:117]
 v_pk_fma_f32 v[18:19], v[250:251], v[250:251], v[116:117]
 v_pk_fma_f32 v[20:21], v[252:253], v[252:253], v[116:117]
 v_pk_fma_f32 v[22:23], v[254:255], v[254:255], v[116:117]
 v_pk_mul_f32 v[16:17], v[16:17], v[248:249]
 v_pk_mul_f32 v[18:19], v[18:19], v[250:251]
 v_pk_mul_f32 v[20:21], v[20:21], v[252:253]
 v_pk_mul_f32 v[22:23], v[22:23], v[254:255]
 v_exp_f32 v16, v16
 v_exp_f32 v17, v17
 v_exp_f32 v18, v18
 v_exp_f32 v19, v19
 v_exp_f32 v20, v20
 v_exp_f32 v21, v21
 v_exp_f32 v22, v22
 v_exp_f32 v23, v23
 v_pk_fma_f32 v[16:17], v[16:17], s[26:27], s[26:27]
 v_pk_fma_f32 v[18:19], v[18:19], s[26:27], s[26:27]
 v_pk_fma_f32 v[20:21], v[20:21], s[26:27], s[26:27]
 v_pk_fma_f32 v[22:23], v[22:23], s[26:27], s[26:27]
 v_rcp_f32 v16, v16
 v_rcp_f32 v17, v17
 v_rcp_f32 v18, v18
 v_rcp_f32 v19, v19
 v_rcp_f32 v20, v20
 v_rcp_f32 v21, v21
 v_rcp_f32 v22, v22
 v_rcp_f32 v23, v23
 v_pk_mul_f32 v[16:17], v[16:17], v[248:249]
 v_pk_mul_f32 v[18:19], v[18:19], v[250:251]
 v_pk_mul_f32 v[20:21], v[20:21], v[252:253]
 v_pk_mul_f32 v[22:23], v[22:23], v[254:255]
 v_cvt_pk_bf16_f32 v196, v16, v17
 v_cvt_pk_bf16_f32 v197, v18, v19
 v_cvt_pk_bf16_f32 v198, v20, v21
 v_cvt_pk_bf16_f32 v199, v22, v23
 s_nop 0
 v_permlane32_swap_b32 v196, v198
 v_permlane32_swap_b32 v197, v199
 s_nop 1
 buffer_store_dwordx4 v[196:199], v118, s[16:19], s23 offen offset:2048 sc0 sc1
 s_waitcnt lgkmcnt(0)
 v_mfma_f32_16x16x32_bf16 v[16:19], a[128:131], a[192:195], v[48:51]
 v_exp_f32 v96, v64
 v_mfma_f32_16x16x32_bf16 v[16:19], a[132:135], a[196:199], v[16:19]
 v_exp_f32 v97, v65
 v_mfma_f32_16x16x32_bf16 v[16:19], a[136:139], a[200:203], v[16:19]
 v_exp_f32 v98, v66
 v_mfma_f32_16x16x32_bf16 v[16:19], a[140:143], a[204:207], v[16:19]
 v_exp_f32 v99, v67
 v_mfma_f32_16x16x32_bf16 v[20:23], a[156:159], a[204:207], v[48:51]
 v_cvt_pk_bf16_f32 v80, v96, v97
 v_cvt_pk_bf16_f32 v81, v98, v99
 v_mfma_f32_16x16x32_bf16 v[20:23], a[152:155], a[200:203], v[20:23]
 v_exp_f32 v96, v68
 v_mfma_f32_16x16x32_bf16 v[20:23], a[148:151], a[196:199], v[20:23]
 v_exp_f32 v97, v69
 v_mfma_f32_16x16x32_bf16 v[20:23], a[144:147], a[192:195], v[20:23]
 v_exp_f32 v98, v70
 v_mfma_f32_16x16x32_bf16 v[28:31], a[144:147], a[208:211], v[52:55]
 v_exp_f32 v99, v71
 v_mfma_f32_16x16x32_bf16 v[28:31], a[148:151], a[212:215], v[28:31]
 v_cvt_pk_bf16_f32 v82, v96, v97
 v_cvt_pk_bf16_f32 v83, v98, v99
 v_mfma_f32_16x16x32_bf16 v[28:31], a[152:155], a[216:219], v[28:31]
 v_exp_f32 v96, v76
 v_mfma_f32_16x16x32_bf16 v[28:31], a[156:159], a[220:223], v[28:31]
 v_exp_f32 v97, v77
 v_mfma_f32_16x16x32_bf16 v[24:27], a[140:143], a[220:223], v[52:55]
 v_exp_f32 v98, v78
 v_mfma_f32_16x16x32_bf16 v[24:27], a[136:139], a[216:219], v[24:27]
 v_exp_f32 v99, v79
 v_mfma_f32_16x16x32_bf16 v[24:27], a[132:135], a[212:215], v[24:27]
 v_cvt_pk_bf16_f32 v86, v96, v97
 v_cvt_pk_bf16_f32 v87, v98, v99
 v_exp_f32 v96, v72
 v_exp_f32 v97, v73
 v_exp_f32 v98, v74
 v_exp_f32 v99, v75
 v_cvt_pk_bf16_f32 v84, v96, v97
 v_cvt_pk_bf16_f32 v85, v98, v99
 v_mfma_f32_16x16x32_bf16 v[24:27], a[128:131], a[208:211], v[24:27]
 s_waitcnt lgkmcnt(8)
 v_exp_f32 v100, v32
 v_mfma_f32_16x16x32_bf16 a[0:3], a[160:163], v[80:83], 0
 v_exp_f32 v101, v33
 v_mfma_f32_16x16x32_bf16 a[32:35], a[160:163], v[84:87], 0
 v_exp_f32 v102, v34
 v_mfma_f32_16x16x32_bf16 a[4:7], a[164:167], v[80:83], 0
 v_exp_f32 v103, v35
 v_mfma_f32_16x16x32_bf16 a[36:39], a[164:167], v[84:87], 0
 v_cvt_pk_bf16_f32 v88, v100, v101
 v_cvt_pk_bf16_f32 v89, v102, v103
 v_mfma_f32_16x16x32_bf16 a[8:11], a[168:171], v[80:83], 0
 v_exp_f32 v100, v36
 v_mfma_f32_16x16x32_bf16 a[40:43], a[168:171], v[84:87], 0
 v_exp_f32 v101, v37
 v_mfma_f32_16x16x32_bf16 a[12:15], a[172:175], v[80:83], 0
 v_exp_f32 v102, v38
 v_mfma_f32_16x16x32_bf16 a[44:47], a[172:175], v[84:87], 0
 v_exp_f32 v103, v39
 v_mfma_f32_16x16x32_bf16 a[16:19], a[176:179], v[80:83], 0
 v_cvt_pk_bf16_f32 v90, v100, v101
 v_cvt_pk_bf16_f32 v91, v102, v103
 v_mfma_f32_16x16x32_bf16 a[48:51], a[176:179], v[84:87], 0
 v_exp_f32 v100, v44
 v_mfma_f32_16x16x32_bf16 a[20:23], a[180:183], v[80:83], 0
 v_exp_f32 v101, v45
 v_mfma_f32_16x16x32_bf16 a[52:55], a[180:183], v[84:87], 0
 v_exp_f32 v102, v46
 v_mfma_f32_16x16x32_bf16 a[24:27], a[184:187], v[80:83], 0
 v_exp_f32 v103, v47
 v_mfma_f32_16x16x32_bf16 a[56:59], a[184:187], v[84:87], 0
 v_cvt_pk_bf16_f32 v94, v100, v101
 v_cvt_pk_bf16_f32 v95, v102, v103
 v_mfma_f32_16x16x32_bf16 a[28:31], a[188:191], v[80:83], 0
 v_exp_f32 v100, v40
 v_mfma_f32_16x16x32_bf16 a[60:63], a[188:191], v[84:87], 0
 v_exp_f32 v101, v41
 v_mfma_f32_16x16x32_bf16 v[104:107], v[124:127], v[80:83], 0
 v_exp_f32 v102, v42
 v_exp_f32 v103, v43
 v_cvt_pk_bf16_f32 v92, v100, v101
 v_cvt_pk_bf16_f32 v93, v102, v103
 v_mfma_f32_16x16x32_bf16 v[108:111], v[124:127], v[84:87], 0
 s_waitcnt vmcnt(38)
 v_exp_f32 v96, v16
 v_mfma_f32_16x16x32_bf16 a[64:67], a[160:163], v[88:91], 0
 s_barrier
 v_exp_f32 v97, v17
 v_mfma_f32_16x16x32_bf16 a[96:99], a[160:163], v[92:95], 0
 ds_read_b128 a[160:163], v8 offset:41984
 v_mfma_f32_16x16x32_bf16 a[68:71], a[164:167], v[88:91], 0
 v_exp_f32 v98, v18
 v_mfma_f32_16x16x32_bf16 a[100:103], a[164:167], v[92:95], 0
 ds_read_b128 a[164:167], v8 offset:43008
 v_mfma_f32_16x16x32_bf16 a[72:75], a[168:171], v[88:91], 0
 v_mov_b32 v120, v104
 v_mov_b32 v121, v108
 v_mfma_f32_16x16x32_bf16 a[104:107], a[168:171], v[92:95], 0
 ds_read_b128 a[168:171], v8 offset:44032
 v_mfma_f32_16x16x32_bf16 a[76:79], a[172:175], v[88:91], 0
 v_exp_f32 v99, v19
 v_mfma_f32_16x16x32_bf16 a[108:111], a[172:175], v[92:95], 0
 ds_read_b128 a[172:175], v8 offset:45056
 v_cvt_pk_bf16_f32 v80, v96, v97
 v_mfma_f32_16x16x32_bf16 a[80:83], a[176:179], v[88:91], 0
 v_cvt_pk_bf16_f32 v81, v98, v99
 v_mfma_f32_16x16x32_bf16 a[112:115], a[176:179], v[92:95], 0
 ds_read_b128 a[176:179], v8 offset:46080
 v_mfma_f32_16x16x32_bf16 a[84:87], a[180:183], v[88:91], 0
 v_exp_f32 v96, v20
 v_mfma_f32_16x16x32_bf16 a[116:119], a[180:183], v[92:95], 0
 ds_read_b128 a[180:183], v8 offset:47104
 v_mfma_f32_16x16x32_bf16 a[88:91], a[184:187], v[88:91], 0
 v_exp_f32 v97, v21
 v_mfma_f32_16x16x32_bf16 a[120:123], a[184:187], v[92:95], 0
 ds_read_b128 a[184:187], v8 offset:48128
 v_mfma_f32_16x16x32_bf16 a[92:95], a[188:191], v[88:91], 0
 v_exp_f32 v98, v22
 v_mfma_f32_16x16x32_bf16 a[124:127], a[188:191], v[92:95], 0
 ds_read_b128 a[188:191], v8 offset:49152
 v_mfma_f32_16x16x32_bf16 v[104:107], v[124:127], v[88:91], 0
 v_exp_f32 v99, v23
 v_mfma_f32_16x16x32_bf16 v[108:111], v[124:127], v[92:95], 0
 v_cvt_pk_bf16_f32 v82, v96, v97
 v_cvt_pk_bf16_f32 v83, v98, v99
 v_mfma_f32_16x16x32_bf16 v[32:35], a[128:131], a[224:227], v[56:59]
 v_exp_f32 v96, v28
 v_mfma_f32_16x16x32_bf16 v[32:35], a[132:135], a[228:231], v[32:35]
 v_exp_f32 v97, v29
 v_mfma_f32_16x16x32_bf16 v[32:35], a[136:139], a[232:235], v[32:35]
 v_exp_f32 v98, v30
 v_mfma_f32_16x16x32_bf16 v[32:35], a[140:143], a[236:239], v[32:35]
 s_add_u32 m0, s62, 118272
 v_exp_f32 v99, v31
 v_mfma_f32_16x16x32_bf16 v[36:39], a[156:159], a[236:239], v[56:59]
 buffer_load_dwordx4 v8, s[40:43], s67 offen offset:0 lds
 v_mov_b32 v122, v104
 v_mfma_f32_16x16x32_bf16 v[36:39], a[152:155], a[232:235], v[36:39]
 v_mov_b32 v123, v108
 v_cvt_pk_bf16_f32 v86, v96, v97
 v_mfma_f32_16x16x32_bf16 v[36:39], a[148:151], a[228:231], v[36:39]
 buffer_load_dwordx4 v8, s[40:43], s67 offen offset:1024 lds
 v_cvt_pk_bf16_f32 v87, v98, v99
 v_exp_f32 v96, v24
 v_exp_f32 v97, v25
 v_exp_f32 v98, v26
 v_exp_f32 v99, v27
 v_cvt_pk_bf16_f32 v84, v96, v97
 v_cvt_pk_bf16_f32 v85, v98, v99
 v_mfma_f32_16x16x32_bf16 v[36:39], a[144:147], a[224:227], v[36:39]
 v_mfma_f32_16x16x32_bf16 v[104:107], v[124:127], v[80:83], 0
 v_exp_f32 v100, v32
 v_mfma_f32_16x16x32_bf16 v[108:111], v[124:127], v[84:87], 0
 v_exp_f32 v101, v33
 v_mfma_f32_16x16x32_bf16 v[44:47], a[144:147], a[240:243], v[60:63]
 ds_read_b128 a[144:147], v8 offset:37888
 v_cvt_pk_bf16_f32 v88, v100, v101
 v_mfma_f32_16x16x32_bf16 v[44:47], a[148:151], a[244:247], v[44:47]
 v_exp_f32 v102, v34
 v_mfma_f32_16x16x32_bf16 v[44:47], a[152:155], a[248:251], v[44:47]
 ds_read_b128 a[148:151], v8 offset:38912
 ds_read_b128 a[152:155], v8 offset:39936
 v_mfma_f32_16x16x32_bf16 v[44:47], a[156:159], a[252:255], v[44:47]
 v_exp_f32 v103, v35
 v_mfma_f32_16x16x32_bf16 v[40:43], a[140:143], a[252:255], v[60:63]
 v_add_f32 v105, v104, v108
 v_cmp_nge_f32 vcc, s84, v105
 v_mfma_f32_16x16x32_bf16 v[40:43], a[136:139], a[248:251], v[40:43]
 v_exp_f32 v100, v36
 v_mfma_f32_16x16x32_bf16 v[40:43], a[132:135], a[244:247], v[40:43]
 s_cbranch_vccnz L_tr0
L_ret0:
 buffer_load_dwordx4 v8, s[40:43], s67 offen offset:2048 lds
 buffer_load_dwordx4 v8, s[40:43], s67 offen offset:3072 lds
 v_cvt_pk_bf16_f32 v89, v102, v103
 v_mfma_f32_16x16x32_bf16 v[40:43], a[128:131], a[240:243], v[40:43]
 s_add_u32 s67, s67, 16384
 v_exp_f32 v101, v37
 s_waitcnt lgkmcnt(3)
 v_mfma_f32_16x16x32_bf16 a[0:3], a[160:163], v[80:83], a[0:3]
 ds_read_b128 a[156:159], v8 offset:40960
 v_cvt_pk_bf16_f32 v90, v100, v101
 v_mfma_f32_16x16x32_bf16 a[32:35], a[160:163], v[84:87], a[32:35]
 v_exp_f32 v102, v38
 v_mfma_f32_16x16x32_bf16 a[4:7], a[164:167], v[80:83], a[4:7]
 ds_read_b128 a[140:143], v8 offset:36864
 ds_read_b128 a[136:139], v8 offset:35840
 v_mfma_f32_16x16x32_bf16 a[36:39], a[164:167], v[84:87], a[36:39]
 v_exp_f32 v103, v39
 v_mfma_f32_16x16x32_bf16 a[8:11], a[168:171], v[80:83], a[8:11]
 ds_read_b128 a[132:135], v8 offset:34816
 v_cvt_pk_bf16_f32 v91, v102, v103
 v_mfma_f32_16x16x32_bf16 a[40:43], a[168:171], v[84:87], a[40:43]
 v_exp_f32 v100, v44
 v_mfma_f32_16x16x32_bf16 a[12:15], a[172:175], v[80:83], a[12:15]
 ds_read_b128 a[128:131], v8 offset:33792
 v_add_f32 v120, v120, v104
 v_mfma_f32_16x16x32_bf16 a[44:47], a[172:175], v[84:87], a[44:47]
 s_add_u32 m0, s62, 0
 v_exp_f32 v101, v45
 v_mfma_f32_16x16x32_bf16 a[16:19], a[176:179], v[80:83], a[16:19]
 v_cvt_pk_bf16_f32 v94, v100, v101
 v_add_f32 v121, v121, v108
 v_mfma_f32_16x16x32_bf16 a[48:51], a[176:179], v[84:87], a[48:51]
 v_exp_f32 v102, v46
 v_mfma_f32_16x16x32_bf16 a[20:23], a[180:183], v[80:83], a[20:23]
 buffer_load_dwordx4 v8, s[40:43], s67 offen offset:0 lds
 v_mfma_f32_16x16x32_bf16 a[52:55], a[180:183], v[84:87], a[52:55]
 v_exp_f32 v103, v47
 v_mfma_f32_16x16x32_bf16 a[24:27], a[184:187], v[80:83], a[24:27]
 buffer_load_dwordx4 v8, s[40:43], s67 offen offset:1024 lds
 v_cvt_pk_bf16_f32 v95, v102, v103
 v_mfma_f32_16x16x32_bf16 a[56:59], a[184:187], v[84:87], a[56:59]
 v_exp_f32 v100, v40
 v_mfma_f32_16x16x32_bf16 a[28:31], a[188:191], v[80:83], a[28:31]
 v_mfma_f32_16x16x32_bf16 a[60:63], a[188:191], v[84:87], a[60:63]
 s_waitcnt lgkmcnt(0)
 v_exp_f32 v101, v41
 v_mfma_f32_16x16x32_bf16 v[16:19], a[128:131], a[192:195], v[48:51]
 buffer_load_dwordx4 v8, s[40:43], s67 offen offset:2048 lds
 v_cvt_pk_bf16_f32 v92, v100, v101
 v_mfma_f32_16x16x32_bf16 v[16:19], a[132:135], a[196:199], v[16:19]
 v_exp_f32 v102, v42
 v_mfma_f32_16x16x32_bf16 v[16:19], a[136:139], a[200:203], v[16:19]
 v_lshrrev_b32 v2, 5, v1
 v_lshlrev_b32 v2, 31, v2
 v_mfma_f32_16x16x32_bf16 v[16:19], a[140:143], a[204:207], v[16:19]
 v_exp_f32 v103, v43
 v_mfma_f32_16x16x32_bf16 v[20:23], a[156:159], a[204:207], v[48:51]
 buffer_load_dwordx4 v8, s[40:43], s67 offen offset:3072 lds
 v_cvt_pk_bf16_f32 v93, v102, v103
 v_mfma_f32_16x16x32_bf16 v[20:23], a[152:155], a[200:203], v[20:23]
 s_add_u32 s67, s67, 16384
 v_lshl_add_u32 v2, v1, 2, v2
 v_mov_b32 v3, 1
 v_mfma_f32_16x16x32_bf16 v[20:23], a[148:151], a[196:199], v[20:23]
 v_bfe_u32 v4, v1, 4, 1
 v_lshlrev_b32 v4, 4, v4
 v_mfma_f32_16x16x32_bf16 v[20:23], a[144:147], a[192:195], v[20:23]
 v_lshrrev_b32 v5, 5, v1
 v_lshl_add_u32 v4, v5, 3, v4
 v_mfma_f32_16x16x32_bf16 v[104:107], v[124:127], v[88:91], 0
 v_exp_f32 v96, v16
 v_mfma_f32_16x16x32_bf16 v[108:111], v[124:127], v[92:95], 0
 v_exp_f32 v97, v17
 v_mfma_f32_16x16x32_bf16 v[28:31], a[144:147], a[208:211], v[52:55]
 v_cvt_pk_bf16_f32 v80, v96, v97
 v_mfma_f32_16x16x32_bf16 v[28:31], a[148:151], a[212:215], v[28:31]
 v_exp_f32 v98, v18
 v_mfma_f32_16x16x32_bf16 v[28:31], a[152:155], a[216:219], v[28:31]
 s_and_b32 s7, s3, 1
 v_lshl_add_u32 v4, s7, 2, v4
 v_lshlrev_b32 v4, 11, v4
 v_mfma_f32_16x16x32_bf16 v[28:31], a[156:159], a[220:223], v[28:31]
 v_exp_f32 v99, v19
 v_mfma_f32_16x16x32_bf16 v[24:27], a[140:143], a[220:223], v[52:55]
 v_add_f32 v105, v104, v108
 v_cmp_nge_f32 vcc, s84, v105
 v_mfma_f32_16x16x32_bf16 v[24:27], a[136:139], a[216:219], v[24:27]
 v_exp_f32 v96, v20
 v_mfma_f32_16x16x32_bf16 v[24:27], a[132:135], a[212:215], v[24:27]
 s_cbranch_vccnz L_tr1
L_ret1:
 v_cvt_pk_bf16_f32 v81, v98, v99
 v_mfma_f32_16x16x32_bf16 v[24:27], a[128:131], a[208:211], v[24:27]
 v_exp_f32 v97, v21
 v_mfma_f32_16x16x32_bf16 a[64:67], a[160:163], v[88:91], a[64:67]
 v_cvt_pk_bf16_f32 v82, v96, v97
 v_add_f32 v122, v122, v104
 v_mfma_f32_16x16x32_bf16 a[96:99], a[160:163], v[92:95], a[96:99]
 v_exp_f32 v98, v22
 v_mfma_f32_16x16x32_bf16 a[68:71], a[164:167], v[88:91], a[68:71]
 ds_read_b128 a[160:163], v11 offset:8192
 v_add_f32 v123, v123, v108
 v_mfma_f32_16x16x32_bf16 a[100:103], a[164:167], v[92:95], a[100:103]
 v_exp_f32 v99, v23
 v_mfma_f32_16x16x32_bf16 a[72:75], a[168:171], v[88:91], a[72:75]
 ds_read_b128 a[164:167], v11 offset:9216
 v_cvt_pk_bf16_f32 v83, v98, v99
 v_mfma_f32_16x16x32_bf16 a[104:107], a[168:171], v[92:95], a[104:107]
 v_exp_f32 v96, v28
 v_mfma_f32_16x16x32_bf16 a[76:79], a[172:175], v[88:91], a[76:79]
 ds_read_b128 a[168:171], v11 offset:10240
 v_and_b32 v5, 15, v1
 v_mfma_f32_16x16x32_bf16 a[108:111], a[172:175], v[92:95], a[108:111]
 v_exp_f32 v97, v29
 v_mfma_f32_16x16x32_bf16 a[80:83], a[176:179], v[88:91], a[80:83]
 ds_read_b128 a[172:175], v11 offset:11264
 v_cvt_pk_bf16_f32 v86, v96, v97
 v_mfma_f32_16x16x32_bf16 a[112:115], a[176:179], v[92:95], a[112:115]
 v_exp_f32 v98, v30
 v_mfma_f32_16x16x32_bf16 a[84:87], a[180:183], v[88:91], a[84:87]
 s_branch L_pg9k
L_pg9:
 s_branch L_ic1r
L_pg9k:
 ds_read_b128 a[176:179], v11 offset:12288
 v_mfma_f32_16x16x32_bf16 a[116:119], a[180:183], v[92:95], a[116:119]
 v_exp_f32 v99, v31
 v_mfma_f32_16x16x32_bf16 a[88:91], a[184:187], v[88:91], a[88:91]
 ds_read_b128 a[180:183], v11 offset:13312
 v_cvt_pk_bf16_f32 v87, v98, v99
 v_mfma_f32_16x16x32_bf16 a[120:123], a[184:187], v[92:95], a[120:123]
 v_exp_f32 v96, v24
 v_mfma_f32_16x16x32_bf16 a[92:95], a[188:191], v[88:91], a[92:95]
 ds_read_b128 a[184:187], v11 offset:14336
 v_mfma_f32_16x16x32_bf16 a[124:127], a[188:191], v[92:95], a[124:127]
 v_exp_f32 v97, v25
 v_mfma_f32_16x16x32_bf16 v[32:35], a[128:131], a[224:227], v[56:59]
 ds_read_b128 a[188:191], v11 offset:15360
 v_cvt_pk_bf16_f32 v84, v96, v97
 v_mfma_f32_16x16x32_bf16 v[32:35], a[132:135], a[228:231], v[32:35]
 v_exp_f32 v98, v26
 v_mfma_f32_16x16x32_bf16 v[32:35], a[136:139], a[232:235], v[32:35]
 buffer_load_dword v15, v13, s[48:51], s88 offen offset:2048
 s_add_u32 s88, s88, 4096
 v_mfma_f32_16x16x32_bf16 v[32:35], a[140:143], a[236:239], v[32:35]
 v_exp_f32 v99, v27
 v_mfma_f32_16x16x32_bf16 v[36:39], a[156:159], a[236:239], v[56:59]
 v_cvt_pk_bf16_f32 v85, v98, v99
 v_mfma_f32_16x16x32_bf16 v[36:39], a[152:155], a[232:235], v[36:39]
 s_lshl_b32 s7, s76, 2
 v_xor_b32 v5, s7, v5
 v_lshl_add_u32 v4, v5, 4, v4
 v_mfma_f32_16x16x32_bf16 v[36:39], a[148:151], a[228:231], v[36:39]
 v_add_u32 v4, s85, v4
 v_add_u32 v5, 992, v4
 v_mfma_f32_16x16x32_bf16 v[36:39], a[144:147], a[224:227], v[36:39]
 v_add_u32 v6, 1984, v4
 v_add_u32 v7, 2976, v4
 v_mfma_f32_16x16x32_bf16 v[104:107], v[124:127], v[80:83], 0
 v_exp_f32 v100, v32
 v_mfma_f32_16x16x32_bf16 v[108:111], v[124:127], v[84:87], 0
 v_exp_f32 v101, v33
 v_mfma_f32_16x16x32_bf16 v[44:47], a[144:147], a[240:243], v[60:63]
 ds_read_b128 a[144:147], v11 offset:4096
 v_cvt_pk_bf16_f32 v88, v100, v101
 v_mfma_f32_16x16x32_bf16 v[44:47], a[148:151], a[244:247], v[44:47]
 v_exp_f32 v102, v34
 v_mfma_f32_16x16x32_bf16 v[44:47], a[152:155], a[248:251], v[44:47]
 ds_read_b128 a[148:151], v11 offset:5120
 ds_read_b128 a[152:155], v11 offset:6144
 v_mfma_f32_16x16x32_bf16 v[44:47], a[156:159], a[252:255], v[44:47]
 v_exp_f32 v103, v35
 v_mfma_f32_16x16x32_bf16 v[40:43], a[140:143], a[252:255], v[60:63]
 v_add_f32 v105, v104, v108
 v_cmp_nge_f32 vcc, s84, v105
 v_mfma_f32_16x16x32_bf16 v[40:43], a[136:139], a[248:251], v[40:43]
 v_exp_f32 v100, v36
 v_mfma_f32_16x16x32_bf16 v[40:43], a[132:135], a[244:247], v[40:43]
 s_cbranch_vccnz L_tr2
L_ret2:
 v_cvt_pk_bf16_f32 v89, v102, v103
 v_mfma_f32_16x16x32_bf16 v[40:43], a[128:131], a[240:243], v[40:43]
 s_waitcnt lgkmcnt(3)
 v_exp_f32 v101, v37
 v_mfma_f32_16x16x32_bf16 a[0:3], a[160:163], v[80:83], a[0:3]
 ds_read_b128 a[156:159], v11 offset:7168
 v_cvt_pk_bf16_f32 v90, v100, v101
 v_mfma_f32_16x16x32_bf16 a[32:35], a[160:163], v[84:87], a[32:35]
 v_exp_f32 v102, v38
 v_mfma_f32_16x16x32_bf16 a[4:7], a[164:167], v[80:83], a[4:7]
 ds_read_b128 a[140:143], v11 offset:3072
 ds_read_b128 a[136:139], v11 offset:2048
 v_mfma_f32_16x16x32_bf16 a[36:39], a[164:167], v[84:87], a[36:39]
 v_exp_f32 v103, v39
 v_mfma_f32_16x16x32_bf16 a[8:11], a[168:171], v[80:83], a[8:11]
 ds_read_b128 a[132:135], v11 offset:1024
 v_cvt_pk_bf16_f32 v91, v102, v103
 v_mfma_f32_16x16x32_bf16 a[40:43], a[168:171], v[84:87], a[40:43]
 v_exp_f32 v100, v44
 v_mfma_f32_16x16x32_bf16 a[12:15], a[172:175], v[80:83], a[12:15]
 ds_read_b128 a[128:131], v11 offset:0
 v_add_f32 v120, v120, v104
 v_mfma_f32_16x16x32_bf16 a[44:47], a[172:175], v[84:87], a[44:47]
 s_add_u32 m0, s62, 16896
 v_exp_f32 v101, v45
 v_mfma_f32_16x16x32_bf16 a[16:19], a[176:179], v[80:83], a[16:19]
 v_cvt_pk_bf16_f32 v94, v100, v101
 v_add_f32 v121, v121, v108
 v_mfma_f32_16x16x32_bf16 a[48:51], a[176:179], v[84:87], a[48:51]
 v_exp_f32 v102, v46
 v_mfma_f32_16x16x32_bf16 a[20:23], a[180:183], v[80:83], a[20:23]
 buffer_load_dwordx4 v8, s[40:43], s67 offen offset:0 lds
 v_bfe_u32 v9, v1, 2, 3
 v_mfma_f32_16x16x32_bf16 a[52:55], a[180:183], v[84:87], a[52:55]
 v_exp_f32 v103, v47
 v_mfma_f32_16x16x32_bf16 a[24:27], a[184:187], v[80:83], a[24:27]
 buffer_load_dwordx4 v8, s[40:43], s67 offen offset:1024 lds
 v_cvt_pk_bf16_f32 v95, v102, v103
 v_mfma_f32_16x16x32_bf16 a[56:59], a[184:187], v[84:87], a[56:59]
 v_exp_f32 v100, v40
 v_mfma_f32_16x16x32_bf16 a[28:31], a[188:191], v[80:83], a[28:31]
 v_mul_u32_u24 v9, 1056, v9
 v_lshrrev_b32 v10, 5, v1
 v_mfma_f32_16x16x32_bf16 a[60:63], a[188:191], v[84:87], a[60:63]
 s_waitcnt lgkmcnt(0)
 v_exp_f32 v101, v41
 v_mfma_f32_16x16x32_bf16 v[16:19], a[128:131], a[192:195], v[48:51]
 buffer_load_dwordx4 v8, s[40:43], s67 offen offset:2048 lds
 v_cvt_pk_bf16_f32 v92, v100, v101
 v_mfma_f32_16x16x32_bf16 v[16:19], a[132:135], a[196:199], v[16:19]
 v_exp_f32 v102, v42
 v_mfma_f32_16x16x32_bf16 v[16:19], a[136:139], a[200:203], v[16:19]
 v_lshl_add_u32 v9, v10, 9, v9
 v_and_b32 v10, 3, v1
 v_mfma_f32_16x16x32_bf16 v[16:19], a[140:143], a[204:207], v[16:19]
 v_exp_f32 v103, v43
 v_mfma_f32_16x16x32_bf16 v[20:23], a[156:159], a[204:207], v[48:51]
 buffer_load_dwordx4 v8, s[40:43], s67 offen offset:3072 lds
 v_cvt_pk_bf16_f32 v93, v102, v103
 v_mfma_f32_16x16x32_bf16 v[20:23], a[152:155], a[200:203], v[20:23]
 s_add_u32 s67, s67, 16384
 v_lshl_add_u32 v9, v10, 3, v9
 v_add_u32 v10, 67584, v9
 v_mfma_f32_16x16x32_bf16 v[20:23], a[148:151], a[196:199], v[20:23]
 v_add_u32 v240, 4096, v8
 v_and_b32 v253, 15, v1
 v_mfma_f32_16x16x32_bf16 v[20:23], a[144:147], a[192:195], v[20:23]
 v_lshlrev_b32 v253, 11, v253
 v_bfe_u32 v254, v1, 4, 1
 v_mfma_f32_16x16x32_bf16 v[104:107], v[124:127], v[88:91], 0
 v_exp_f32 v96, v16
 v_mfma_f32_16x16x32_bf16 v[108:111], v[124:127], v[92:95], 0
 v_exp_f32 v97, v17
 v_mfma_f32_16x16x32_bf16 v[28:31], a[144:147], a[208:211], v[52:55]
 v_cvt_pk_bf16_f32 v80, v96, v97
 v_lshl_add_u32 v253, v254, 5, v253
 v_mfma_f32_16x16x32_bf16 v[28:31], a[148:151], a[212:215], v[28:31]
 v_exp_f32 v98, v18
 v_mfma_f32_16x16x32_bf16 v[28:31], a[152:155], a[216:219], v[28:31]
 v_lshrrev_b32 v254, 5, v1
 v_lshl_add_u32 v253, v254, 4, v253
 v_mfma_f32_16x16x32_bf16 v[28:31], a[156:159], a[220:223], v[28:31]
 v_exp_f32 v99, v19
 v_mfma_f32_16x16x32_bf16 v[24:27], a[140:143], a[220:223], v[52:55]
 v_add_f32 v105, v104, v108
 v_cmp_nge_f32 vcc, s84, v105
 v_mfma_f32_16x16x32_bf16 v[24:27], a[136:139], a[216:219], v[24:27]
 v_exp_f32 v96, v20
 v_mfma_f32_16x16x32_bf16 v[24:27], a[132:135], a[212:215], v[24:27]
 s_cbranch_vccnz L_tr3
L_ret3:
 v_cvt_pk_bf16_f32 v81, v98, v99
 v_mfma_f32_16x16x32_bf16 v[24:27], a[128:131], a[208:211], v[24:27]
 s_waitcnt vmcnt(31)
 v_exp_f32 v97, v21
 v_mfma_f32_16x16x32_bf16 a[64:67], a[160:163], v[88:91], a[64:67]
 s_barrier
 v_cvt_pk_bf16_f32 v82, v96, v97
 v_add_f32 v122, v122, v104
 v_mfma_f32_16x16x32_bf16 a[96:99], a[160:163], v[92:95], a[96:99]
 v_exp_f32 v98, v22
 v_mfma_f32_16x16x32_bf16 a[68:71], a[164:167], v[88:91], a[68:71]
 ds_read_b128 a[160:163], v11 offset:25088
 v_add_f32 v123, v123, v108
 v_mfma_f32_16x16x32_bf16 a[100:103], a[164:167], v[92:95], a[100:103]
 v_exp_f32 v99, v23
 v_mfma_f32_16x16x32_bf16 a[72:75], a[168:171], v[88:91], a[72:75]
 ds_read_b128 a[164:167], v11 offset:26112
 v_cvt_pk_bf16_f32 v83, v98, v99
 v_mfma_f32_16x16x32_bf16 a[104:107], a[168:171], v[92:95], a[104:107]
 v_exp_f32 v96, v28
 v_mfma_f32_16x16x32_bf16 a[76:79], a[172:175], v[88:91], a[76:79]
 ds_read_b128 a[168:171], v11 offset:27136
 buffer_load_dword v15, v13, s[48:51], s88 offen offset:0
 v_mfma_f32_16x16x32_bf16 a[108:111], a[172:175], v[92:95], a[108:111]
 v_exp_f32 v97, v29
 v_mfma_f32_16x16x32_bf16 a[80:83], a[176:179], v[88:91], a[80:83]
 ds_read_b128 a[172:175], v11 offset:28160
 v_cvt_pk_bf16_f32 v86, v96, v97
 v_mfma_f32_16x16x32_bf16 a[112:115], a[176:179], v[92:95], a[112:115]
 v_exp_f32 v98, v30
 v_mfma_f32_16x16x32_bf16 a[84:87], a[180:183], v[88:91], a[84:87]
 ds_read_b128 a[176:179], v11 offset:29184
 v_lshrrev_b32 v254, 4, v1
 v_mfma_f32_16x16x32_bf16 a[116:119], a[180:183], v[92:95], a[116:119]
 v_exp_f32 v99, v31
 v_mfma_f32_16x16x32_bf16 a[88:91], a[184:187], v[88:91], a[88:91]
 ds_read_b128 a[180:183], v11 offset:30208
 v_cvt_pk_bf16_f32 v87, v98, v99
 v_mfma_f32_16x16x32_bf16 a[120:123], a[184:187], v[92:95], a[120:123]
 v_exp_f32 v96, v24
 v_mfma_f32_16x16x32_bf16 a[92:95], a[188:191], v[88:91], a[92:95]
 ds_read_b128 a[184:187], v11 offset:31232
 v_lshl_add_u32 v254, v254, 3, s87
 v_mfma_f32_16x16x32_bf16 a[124:127], a[188:191], v[92:95], a[124:127]
 v_exp_f32 v97, v25
 v_mfma_f32_16x16x32_bf16 v[32:35], a[128:131], a[224:227], v[56:59]
 ds_read_b128 a[188:191], v11 offset:32256
 v_cvt_pk_bf16_f32 v84, v96, v97
 v_mfma_f32_16x16x32_bf16 v[32:35], a[132:135], a[228:231], v[32:35]
 v_exp_f32 v98, v26
 v_mfma_f32_16x16x32_bf16 v[32:35], a[136:139], a[232:235], v[32:35]
 v_and_b32 v255, 3, v1
 v_max_u32 v255, 1, v255
 v_mfma_f32_16x16x32_bf16 v[32:35], a[140:143], a[236:239], v[32:35]
 v_exp_f32 v99, v27
 v_mfma_f32_16x16x32_bf16 v[36:39], a[156:159], a[236:239], v[56:59]
 v_cvt_pk_bf16_f32 v85, v98, v99
 v_xor_b32 v255, s76, v255
 v_mfma_f32_16x16x32_bf16 v[36:39], a[152:155], a[232:235], v[36:39]
 v_lshlrev_b32 v255, 7, v255
 v_and_b32 v14, 7, v1
 v_mfma_f32_16x16x32_bf16 v[36:39], a[148:151], a[228:231], v[36:39]
 v_lshl_add_u32 v14, s76, 3, v14
 v_lshlrev_b32 v14, 7, v14
 v_mfma_f32_16x16x32_bf16 v[36:39], a[144:147], a[224:227], v[36:39]
 v_mfma_f32_16x16x32_bf16 v[104:107], v[124:127], v[80:83], 0
 v_exp_f32 v100, v32
 v_mfma_f32_16x16x32_bf16 v[108:111], v[124:127], v[84:87], 0
 v_exp_f32 v101, v33
 v_mfma_f32_16x16x32_bf16 v[44:47], a[144:147], a[240:243], v[60:63]
 ds_read_b128 a[144:147], v11 offset:20992
 v_cvt_pk_bf16_f32 v88, v100, v101
 v_mfma_f32_16x16x32_bf16 v[44:47], a[148:151], a[244:247], v[44:47]
 v_exp_f32 v102, v34
 v_mfma_f32_16x16x32_bf16 v[44:47], a[152:155], a[248:251], v[44:47]
 ds_read_b128 a[148:151], v11 offset:22016
 ds_read_b128 a[152:155], v11 offset:23040
 v_mfma_f32_16x16x32_bf16 v[44:47], a[156:159], a[252:255], v[44:47]
 v_exp_f32 v103, v35
 v_mfma_f32_16x16x32_bf16 v[40:43], a[140:143], a[252:255], v[60:63]
 v_add_f32 v105, v104, v108
 v_cmp_nge_f32 vcc, s84, v105
 v_mfma_f32_16x16x32_bf16 v[40:43], a[136:139], a[248:251], v[40:43]
 v_exp_f32 v100, v36
 v_mfma_f32_16x16x32_bf16 v[40:43], a[132:135], a[244:247], v[40:43]
 s_cbranch_vccnz L_tr4
L_ret4:
 v_cvt_pk_bf16_f32 v89, v102, v103
 v_mfma_f32_16x16x32_bf16 v[40:43], a[128:131], a[240:243], v[40:43]
 s_waitcnt lgkmcnt(3)
 v_exp_f32 v101, v37
 v_mfma_f32_16x16x32_bf16 a[0:3], a[160:163], v[80:83], a[0:3]
 ds_read_b128 a[156:159], v11 offset:24064
 v_cvt_pk_bf16_f32 v90, v100, v101
 v_mfma_f32_16x16x32_bf16 a[32:35], a[160:163], v[84:87], a[32:35]
 v_exp_f32 v102, v38
 v_mfma_f32_16x16x32_bf16 a[4:7], a[164:167], v[80:83], a[4:7]
 ds_read_b128 a[140:143], v11 offset:19968
 ds_read_b128 a[136:139], v11 offset:18944
 v_mfma_f32_16x16x32_bf16 a[36:39], a[164:167], v[84:87], a[36:39]
 v_exp_f32 v103, v39
 v_mfma_f32_16x16x32_bf16 a[8:11], a[168:171], v[80:83], a[8:11]
 ds_read_b128 a[132:135], v11 offset:17920
 v_cvt_pk_bf16_f32 v91, v102, v103
 v_mfma_f32_16x16x32_bf16 a[40:43], a[168:171], v[84:87], a[40:43]
 v_exp_f32 v100, v44
 v_mfma_f32_16x16x32_bf16 a[12:15], a[172:175], v[80:83], a[12:15]
 ds_read_b128 a[128:131], v11 offset:16896
 v_add_f32 v120, v120, v104
 v_mfma_f32_16x16x32_bf16 a[44:47], a[172:175], v[84:87], a[44:47]
 s_add_u32 m0, s62, 33792
 v_exp_f32 v101, v45
 v_mfma_f32_16x16x32_bf16 a[16:19], a[176:179], v[80:83], a[16:19]
 v_cvt_pk_bf16_f32 v94, v100, v101
 v_add_f32 v121, v121, v108
 v_mfma_f32_16x16x32_bf16 a[48:51], a[176:179], v[84:87], a[48:51]
 v_exp_f32 v102, v46
 v_mfma_f32_16x16x32_bf16 a[20:23], a[180:183], v[80:83], a[20:23]
 buffer_load_dwordx4 v8, s[40:43], s67 offen offset:0 lds
 v_mfma_f32_16x16x32_bf16 a[52:55], a[180:183], v[84:87], a[52:55]
 v_exp_f32 v103, v47
 v_mfma_f32_16x16x32_bf16 a[24:27], a[184:187], v[80:83], a[24:27]
 buffer_load_dwordx4 v8, s[40:43], s67 offen offset:1024 lds
 v_cvt_pk_bf16_f32 v95, v102, v103
 v_mfma_f32_16x16x32_bf16 a[56:59], a[184:187], v[84:87], a[56:59]
 v_exp_f32 v100, v40
 v_mfma_f32_16x16x32_bf16 a[28:31], a[188:191], v[80:83], a[28:31]
 v_mfma_f32_16x16x32_bf16 a[60:63], a[188:191], v[84:87], a[60:63]
 s_waitcnt lgkmcnt(0)
 v_exp_f32 v101, v41
 v_mfma_f32_16x16x32_bf16 v[16:19], a[128:131], a[192:195], v[48:51]
 buffer_load_dwordx4 v8, s[40:43], s67 offen offset:2048 lds
 v_cvt_pk_bf16_f32 v92, v100, v101
 v_mfma_f32_16x16x32_bf16 v[16:19], a[132:135], a[196:199], v[16:19]
 v_exp_f32 v102, v42
 v_mfma_f32_16x16x32_bf16 v[16:19], a[136:139], a[200:203], v[16:19]
 v_mfma_f32_16x16x32_bf16 v[16:19], a[140:143], a[204:207], v[16:19]
 v_exp_f32 v103, v43
 v_mfma_f32_16x16x32_bf16 v[20:23], a[156:159], a[204:207], v[48:51]
 buffer_load_dwordx4 v8, s[40:43], s67 offen offset:3072 lds
 v_cvt_pk_bf16_f32 v93, v102, v103
 v_mfma_f32_16x16x32_bf16 v[20:23], a[152:155], a[200:203], v[20:23]
 s_add_u32 s67, s67, 16384
 v_mfma_f32_16x16x32_bf16 v[20:23], a[148:151], a[196:199], v[20:23]
 v_mfma_f32_16x16x32_bf16 v[20:23], a[144:147], a[192:195], v[20:23]
 v_mfma_f32_16x16x32_bf16 v[104:107], v[124:127], v[88:91], 0
 v_exp_f32 v96, v16
 v_mfma_f32_16x16x32_bf16 v[108:111], v[124:127], v[92:95], 0
 v_exp_f32 v97, v17
 v_mfma_f32_16x16x32_bf16 v[28:31], a[144:147], a[208:211], v[52:55]
 v_cvt_pk_bf16_f32 v80, v96, v97
 v_mfma_f32_16x16x32_bf16 v[28:31], a[148:151], a[212:215], v[28:31]
 v_exp_f32 v98, v18
 v_mfma_f32_16x16x32_bf16 v[28:31], a[152:155], a[216:219], v[28:31]
 v_mfma_f32_16x16x32_bf16 v[28:31], a[156:159], a[220:223], v[28:31]
 v_exp_f32 v99, v19
 v_mfma_f32_16x16x32_bf16 v[24:27], a[140:143], a[220:223], v[52:55]
 v_add_f32 v105, v104, v108
 v_cmp_nge_f32 vcc, s84, v105
 v_mfma_f32_16x16x32_bf16 v[24:27], a[136:139], a[216:219], v[24:27]
 v_exp_f32 v96, v20
 v_mfma_f32_16x16x32_bf16 v[24:27], a[132:135], a[212:215], v[24:27]
 s_cbranch_vccnz L_tr5
L_ret5:
 v_cvt_pk_bf16_f32 v81, v98, v99
 v_mfma_f32_16x16x32_bf16 v[24:27], a[128:131], a[208:211], v[24:27]
 v_exp_f32 v97, v21
 v_mfma_f32_16x16x32_bf16 a[64:67], a[160:163], v[88:91], a[64:67]
 v_cvt_pk_bf16_f32 v82, v96, v97
 v_add_f32 v122, v122, v104
 v_mfma_f32_16x16x32_bf16 a[96:99], a[160:163], v[92:95], a[96:99]
 v_exp_f32 v98, v22
 v_mfma_f32_16x16x32_bf16 a[68:71], a[164:167], v[88:91], a[68:71]
 ds_read_b128 a[160:163], v11 offset:41984
 v_add_f32 v123, v123, v108
 v_mfma_f32_16x16x32_bf16 a[100:103], a[164:167], v[92:95], a[100:103]
 v_exp_f32 v99, v23
 v_mfma_f32_16x16x32_bf16 a[72:75], a[168:171], v[88:91], a[72:75]
 ds_read_b128 a[164:167], v11 offset:43008
 v_cvt_pk_bf16_f32 v83, v98, v99
 v_mfma_f32_16x16x32_bf16 a[104:107], a[168:171], v[92:95], a[104:107]
 v_exp_f32 v96, v28
 v_mfma_f32_16x16x32_bf16 a[76:79], a[172:175], v[88:91], a[76:79]
 ds_read_b128 a[168:171], v11 offset:44032
 v_mfma_f32_16x16x32_bf16 a[108:111], a[172:175], v[92:95], a[108:111]
 v_exp_f32 v97, v29
 v_mfma_f32_16x16x32_bf16 a[80:83], a[176:179], v[88:91], a[80:83]
 ds_read_b128 a[172:175], v11 offset:45056
 v_cvt_pk_bf16_f32 v86, v96, v97
 v_mfma_f32_16x16x32_bf16 a[112:115], a[176:179], v[92:95], a[112:115]
 v_exp_f32 v98, v30
 v_mfma_f32_16x16x32_bf16 a[84:87], a[180:183], v[88:91], a[84:87]
 ds_read_b128 a[176:179], v11 offset:46080
 v_mfma_f32_16x16x32_bf16 a[116:119], a[180:183], v[92:95], a[116:119]
 v_exp_f32 v99, v31
 v_mfma_f32_16x16x32_bf16 a[88:91], a[184:187], v[88:91], a[88:91]
 ds_read_b128 a[180:183], v11 offset:47104
 v_cvt_pk_bf16_f32 v87, v98, v99
 v_mfma_f32_16x16x32_bf16 a[120:123], a[184:187], v[92:95], a[120:123]
 v_exp_f32 v96, v24
 v_mfma_f32_16x16x32_bf16 a[92:95], a[188:191], v[88:91], a[92:95]
 ds_read_b128 a[184:187], v11 offset:48128
 v_mfma_f32_16x16x32_bf16 a[124:127], a[188:191], v[92:95], a[124:127]
 v_exp_f32 v97, v25
 v_mfma_f32_16x16x32_bf16 v[32:35], a[128:131], a[224:227], v[56:59]
 ds_read_b128 a[188:191], v11 offset:49152
 v_cvt_pk_bf16_f32 v84, v96, v97
 v_mfma_f32_16x16x32_bf16 v[32:35], a[132:135], a[228:231], v[32:35]
 v_exp_f32 v98, v26
 v_mfma_f32_16x16x32_bf16 v[32:35], a[136:139], a[232:235], v[32:35]
 buffer_load_dword v15, v13, s[48:51], s88 offen offset:2048
 s_add_u32 s88, s88, 4096
 v_mfma_f32_16x16x32_bf16 v[32:35], a[140:143], a[236:239], v[32:35]
 v_exp_f32 v99, v27
 v_mfma_f32_16x16x32_bf16 v[36:39], a[156:159], a[236:239], v[56:59]
 v_cvt_pk_bf16_f32 v85, v98, v99
 v_mfma_f32_16x16x32_bf16 v[36:39], a[152:155], a[232:235], v[36:39]
 v_mfma_f32_16x16x32_bf16 v[36:39], a[148:151], a[228:231], v[36:39]
 v_mfma_f32_16x16x32_bf16 v[36:39], a[144:147], a[224:227], v[36:39]
 v_mfma_f32_16x16x32_bf16 v[104:107], v[124:127], v[80:83], 0
 s_nop 0
 v_exp_f32 v100, v32
 v_mfma_f32_16x16x32_bf16 v[108:111], v[124:127], v[84:87], 0
 v_exp_f32 v101, v33
 v_mfma_f32_16x16x32_bf16 v[44:47], a[144:147], a[240:243], v[60:63]
 ds_read_b128 a[144:147], v11 offset:37888
 v_cvt_pk_bf16_f32 v88, v100, v101
 v_mfma_f32_16x16x32_bf16 v[44:47], a[148:151], a[244:247], v[44:47]
 v_exp_f32 v102, v34
 v_mfma_f32_16x16x32_bf16 v[44:47], a[152:155], a[248:251], v[44:47]
 ds_read_b128 a[148:151], v11 offset:38912
 ds_read_b128 a[152:155], v11 offset:39936
 v_mfma_f32_16x16x32_bf16 v[44:47], a[156:159], a[252:255], v[44:47]
 v_exp_f32 v103, v35
 v_mfma_f32_16x16x32_bf16 v[40:43], a[140:143], a[252:255], v[60:63]
 v_add_f32 v105, v104, v108
 v_cmp_nge_f32 vcc, s84, v105
 v_mfma_f32_16x16x32_bf16 v[40:43], a[136:139], a[248:251], v[40:43]
 v_exp_f32 v100, v36
 v_mfma_f32_16x16x32_bf16 v[40:43], a[132:135], a[244:247], v[40:43]
 s_cbranch_vccnz L_tr6
L_ret6:
 v_cvt_pk_bf16_f32 v89, v102, v103
 v_mfma_f32_16x16x32_bf16 v[40:43], a[128:131], a[240:243], v[40:43]
 s_waitcnt lgkmcnt(3)
 v_exp_f32 v101, v37
 v_mfma_f32_16x16x32_bf16 a[0:3], a[160:163], v[80:83], a[0:3]
 ds_read_b128 a[156:159], v11 offset:40960
 v_cvt_pk_bf16_f32 v90, v100, v101
 v_mfma_f32_16x16x32_bf16 a[32:35], a[160:163], v[84:87], a[32:35]
 v_exp_f32 v102, v38
 v_mfma_f32_16x16x32_bf16 a[4:7], a[164:167], v[80:83], a[4:7]
 ds_read_b128 a[140:143], v11 offset:36864
 ds_read_b128 a[136:139], v11 offset:35840
 v_mfma_f32_16x16x32_bf16 a[36:39], a[164:167], v[84:87], a[36:39]
 v_exp_f32 v103, v39
 v_mfma_f32_16x16x32_bf16 a[8:11], a[168:171], v[80:83], a[8:11]
 ds_read_b128 a[132:135], v11 offset:34816
 v_cvt_pk_bf16_f32 v91, v102, v103
 v_mfma_f32_16x16x32_bf16 a[40:43], a[168:171], v[84:87], a[40:43]
 v_exp_f32 v100, v44
 v_mfma_f32_16x16x32_bf16 a[12:15], a[172:175], v[80:83], a[12:15]
 ds_read_b128 a[128:131], v11 offset:33792
 v_add_f32 v120, v120, v104
 v_mfma_f32_16x16x32_bf16 a[44:47], a[172:175], v[84:87], a[44:47]
 s_add_u32 m0, s62, 50688
 v_exp_f32 v101, v45
 v_mfma_f32_16x16x32_bf16 a[16:19], a[176:179], v[80:83], a[16:19]
 v_cvt_pk_bf16_f32 v94, v100, v101
 v_add_f32 v121, v121, v108
 v_mfma_f32_16x16x32_bf16 a[48:51], a[176:179], v[84:87], a[48:51]
 v_exp_f32 v102, v46
 v_mfma_f32_16x16x32_bf16 a[20:23], a[180:183], v[80:83], a[20:23]
 buffer_load_dwordx4 v8, s[40:43], s67 offen offset:0 lds
 v_mfma_f32_16x16x32_bf16 a[52:55], a[180:183], v[84:87], a[52:55]
 v_exp_f32 v103, v47
 v_mfma_f32_16x16x32_bf16 a[24:27], a[184:187], v[80:83], a[24:27]
 buffer_load_dwordx4 v8, s[40:43], s67 offen offset:1024 lds
 v_cvt_pk_bf16_f32 v95, v102, v103
 v_mfma_f32_16x16x32_bf16 a[56:59], a[184:187], v[84:87], a[56:59]
 v_exp_f32 v100, v40
 v_mfma_f32_16x16x32_bf16 a[28:31], a[188:191], v[80:83], a[28:31]
 v_mfma_f32_16x16x32_bf16 a[60:63], a[188:191], v[84:87], a[60:63]
 s_waitcnt lgkmcnt(0)
 v_exp_f32 v101, v41
 v_mfma_f32_16x16x32_bf16 v[16:19], a[128:131], a[192:195], v[48:51]
 buffer_load_dwordx4 v8, s[40:43], s67 offen offset:2048 lds
 v_cvt_pk_bf16_f32 v92, v100, v101
 v_mfma_f32_16x16x32_bf16 v[16:19], a[132:135], a[196:199], v[16:19]
 v_exp_f32 v102, v42
 v_mfma_f32_16x16x32_bf16 v[16:19], a[136:139], a[200:203], v[16:19]
 v_mfma_f32_16x16x32_bf16 v[16:19], a[140:143], a[204:207], v[16:19]
 v_exp_f32 v103, v43
 v_mfma_f32_16x16x32_bf16 v[20:23], a[156:159], a[204:207], v[48:51]
 buffer_load_dwordx4 v8, s[40:43], s67 offen offset:3072 lds
 v_cvt_pk_bf16_f32 v93, v102, v103
 v_mfma_f32_16x16x32_bf16 v[20:23], a[152:155], a[200:203], v[20:23]
 s_add_u32 s67, s67, 16384
 v_mfma_f32_16x16x32_bf16 v[20:23], a[148:151], a[196:199], v[20:23]
 v_mfma_f32_16x16x32_bf16 v[20:23], a[144:147], a[192:195], v[20:23]
 v_mfma_f32_16x16x32_bf16 v[104:107], v[124:127], v[88:91], 0
 v_exp_f32 v96, v16
 v_mfma_f32_16x16x32_bf16 v[108:111], v[124:127], v[92:95], 0
 v_exp_f32 v97, v17
 v_mfma_f32_16x16x32_bf16 v[28:31], a[144:147], a[208:211], v[52:55]
 v_cvt_pk_bf16_f32 v80, v96, v97
 v_mfma_f32_16x16x32_bf16 v[28:31], a[148:151], a[212:215], v[28:31]
 v_exp_f32 v98, v18
 v_mfma_f32_16x16x32_bf16 v[28:31], a[152:155], a[216:219], v[28:31]
 v_mfma_f32_16x16x32_bf16 v[28:31], a[156:159], a[220:223], v[28:31]
 v_exp_f32 v99, v19
 v_mfma_f32_16x16x32_bf16 v[24:27], a[140:143], a[220:223], v[52:55]
 v_add_f32 v105, v104, v108
 v_cmp_nge_f32 vcc, s84, v105
 v_mfma_f32_16x16x32_bf16 v[24:27], a[136:139], a[216:219], v[24:27]
 v_exp_f32 v96, v20
 v_mfma_f32_16x16x32_bf16 v[24:27], a[132:135], a[212:215], v[24:27]
 s_cbranch_vccnz L_tr7
L_ret7:
 v_cvt_pk_bf16_f32 v81, v98, v99
 v_mfma_f32_16x16x32_bf16 v[24:27], a[128:131], a[208:211], v[24:27]
 s_waitcnt vmcnt(19)
 v_exp_f32 v97, v21
 v_mfma_f32_16x16x32_bf16 a[64:67], a[160:163], v[88:91], a[64:67]
 s_barrier
 v_cvt_pk_bf16_f32 v82, v96, v97
 v_add_f32 v122, v122, v104
 v_mfma_f32_16x16x32_bf16 a[96:99], a[160:163], v[92:95], a[96:99]
 s_cmp_lg_u32 s3, 0
 s_cbranch_scc1 L_pubh
 s_add_u32 s7, s8, 65536
 buffer_store_dword v3, v2, s[16:19], s7 offen sc0 sc1
L_pubh:
 v_exp_f32 v98, v22
 v_mfma_f32_16x16x32_bf16 a[68:71], a[164:167], v[88:91], a[68:71]
 ds_read_b128 a[160:163], v12 offset:8192
 v_add_f32 v123, v123, v108
 v_mfma_f32_16x16x32_bf16 a[100:103], a[164:167], v[92:95], a[100:103]
 v_exp_f32 v99, v23
 v_mfma_f32_16x16x32_bf16 a[72:75], a[168:171], v[88:91], a[72:75]
 ds_read_b128 a[164:167], v12 offset:9216
 v_cvt_pk_bf16_f32 v83, v98, v99
 v_mfma_f32_16x16x32_bf16 a[104:107], a[168:171], v[92:95], a[104:107]
 v_exp_f32 v96, v28
 v_mfma_f32_16x16x32_bf16 a[76:79], a[172:175], v[88:91], a[76:79]
 ds_read_b128 a[168:171], v12 offset:10240
 buffer_load_dword v15, v13, s[44:47], s89 offen offset:0
 v_mfma_f32_16x16x32_bf16 a[108:111], a[172:175], v[92:95], a[108:111]
 v_exp_f32 v97, v29
 v_mfma_f32_16x16x32_bf16 a[80:83], a[176:179], v[88:91], a[80:83]
 ds_read_b128 a[172:175], v12 offset:11264
 v_cvt_pk_bf16_f32 v86, v96, v97
 v_mfma_f32_16x16x32_bf16 a[112:115], a[176:179], v[92:95], a[112:115]
 v_exp_f32 v98, v30
 v_mfma_f32_16x16x32_bf16 a[84:87], a[180:183], v[88:91], a[84:87]
 ds_read_b128 a[176:179], v12 offset:12288
 v_mfma_f32_16x16x32_bf16 a[116:119], a[180:183], v[92:95], a[116:119]
 v_exp_f32 v99, v31
 v_mfma_f32_16x16x32_bf16 a[88:91], a[184:187], v[88:91], a[88:91]
 ds_read_b128 a[180:183], v12 offset:13312
 v_cvt_pk_bf16_f32 v87, v98, v99
 v_mfma_f32_16x16x32_bf16 a[120:123], a[184:187], v[92:95], a[120:123]
 v_exp_f32 v96, v24
 v_mfma_f32_16x16x32_bf16 a[92:95], a[188:191], v[88:91], a[92:95]
 ds_read_b128 a[184:187], v12 offset:14336
 v_mfma_f32_16x16x32_bf16 a[124:127], a[188:191], v[92:95], a[124:127]
 v_exp_f32 v97, v25
 v_mfma_f32_16x16x32_bf16 v[32:35], a[128:131], a[224:227], v[56:59]
 ds_read_b128 a[188:191], v12 offset:15360
 v_cvt_pk_bf16_f32 v84, v96, v97
 v_mfma_f32_16x16x32_bf16 v[32:35], a[132:135], a[228:231], v[32:35]
 v_exp_f32 v98, v26
 v_mfma_f32_16x16x32_bf16 v[32:35], a[136:139], a[232:235], v[32:35]
 v_mfma_f32_16x16x32_bf16 v[32:35], a[140:143], a[236:239], v[32:35]
 v_exp_f32 v99, v27
 v_mfma_f32_16x16x32_bf16 v[36:39], a[156:159], a[236:239], v[56:59]
 v_cvt_pk_bf16_f32 v85, v98, v99
 v_mfma_f32_16x16x32_bf16 v[36:39], a[152:155], a[232:235], v[36:39]
 v_mfma_f32_16x16x32_bf16 v[36:39], a[148:151], a[228:231], v[36:39]
 v_mfma_f32_16x16x32_bf16 v[36:39], a[144:147], a[224:227], v[36:39]
 v_mfma_f32_16x16x32_bf16 v[104:107], v[124:127], v[80:83], 0
 s_nop 0
 v_exp_f32 v100, v32
 v_mfma_f32_16x16x32_bf16 v[108:111], v[124:127], v[84:87], 0
 v_exp_f32 v101, v33
 v_mfma_f32_16x16x32_bf16 v[44:47], a[144:147], a[240:243], v[60:63]
 ds_read_b128 a[144:147], v12 offset:4096
 v_cvt_pk_bf16_f32 v88, v100, v101
 v_mfma_f32_16x16x32_bf16 v[44:47], a[148:151], a[244:247], v[44:47]
 v_exp_f32 v102, v34
 v_mfma_f32_16x16x32_bf16 v[44:47], a[152:155], a[248:251], v[44:47]
 ds_read_b128 a[148:151], v12 offset:5120
 ds_read_b128 a[152:155], v12 offset:6144
 v_mfma_f32_16x16x32_bf16 v[44:47], a[156:159], a[252:255], v[44:47]
 v_exp_f32 v103, v35
 v_mfma_f32_16x16x32_bf16 v[40:43], a[140:143], a[252:255], v[60:63]
 v_add_f32 v105, v104, v108
 v_cmp_nge_f32 vcc, s84, v105
 v_mfma_f32_16x16x32_bf16 v[40:43], a[136:139], a[248:251], v[40:43]
 v_exp_f32 v100, v36
 v_mfma_f32_16x16x32_bf16 v[40:43], a[132:135], a[244:247], v[40:43]
 s_cbranch_vccnz L_tr8
L_ret8:
 v_cvt_pk_bf16_f32 v89, v102, v103
 v_mfma_f32_16x16x32_bf16 v[40:43], a[128:131], a[240:243], v[40:43]
 s_waitcnt lgkmcnt(3)
 v_exp_f32 v101, v37
 v_mfma_f32_16x16x32_bf16 a[0:3], a[160:163], v[80:83], a[0:3]
 ds_read_b128 a[156:159], v12 offset:7168
 v_cvt_pk_bf16_f32 v90, v100, v101
 v_mfma_f32_16x16x32_bf16 a[32:35], a[160:163], v[84:87], a[32:35]
 v_exp_f32 v102, v38
 v_mfma_f32_16x16x32_bf16 a[4:7], a[164:167], v[80:83], a[4:7]
 ds_read_b128 a[140:143], v12 offset:3072
 ds_read_b128 a[136:139], v12 offset:2048
 v_mfma_f32_16x16x32_bf16 a[36:39], a[164:167], v[84:87], a[36:39]
 v_exp_f32 v103, v39
 v_mfma_f32_16x16x32_bf16 a[8:11], a[168:171], v[80:83], a[8:11]
 ds_read_b128 a[132:135], v12 offset:1024
 v_cvt_pk_bf16_f32 v91, v102, v103
 v_mfma_f32_16x16x32_bf16 a[40:43], a[168:171], v[84:87], a[40:43]
 v_exp_f32 v100, v44
 v_mfma_f32_16x16x32_bf16 a[12:15], a[172:175], v[80:83], a[12:15]
 ds_read_b128 a[128:131], v12 offset:0
 v_add_f32 v120, v120, v104
 v_mfma_f32_16x16x32_bf16 a[44:47], a[172:175], v[84:87], a[44:47]
 s_add_u32 m0, s62, 67584
 v_exp_f32 v101, v45
 v_mfma_f32_16x16x32_bf16 a[16:19], a[176:179], v[80:83], a[16:19]
 v_cvt_pk_bf16_f32 v94, v100, v101
 v_add_f32 v121, v121, v108
 v_mfma_f32_16x16x32_bf16 a[48:51], a[176:179], v[84:87], a[48:51]
 v_exp_f32 v102, v46
 v_mfma_f32_16x16x32_bf16 a[20:23], a[180:183], v[80:83], a[20:23]
 buffer_load_dwordx4 v8, s[40:43], s67 offen offset:0 lds
 v_mfma_f32_16x16x32_bf16 a[52:55], a[180:183], v[84:87], a[52:55]
 v_exp_f32 v103, v47
 v_mfma_f32_16x16x32_bf16 a[24:27], a[184:187], v[80:83], a[24:27]
 buffer_load_dwordx4 v8, s[40:43], s67 offen offset:1024 lds
 v_cvt_pk_bf16_f32 v95, v102, v103
 v_mfma_f32_16x16x32_bf16 a[56:59], a[184:187], v[84:87], a[56:59]
 v_exp_f32 v100, v40
 v_mfma_f32_16x16x32_bf16 a[28:31], a[188:191], v[80:83], a[28:31]
 v_mfma_f32_16x16x32_bf16 a[60:63], a[188:191], v[84:87], a[60:63]
 s_waitcnt lgkmcnt(0)
 v_exp_f32 v101, v41
 v_mfma_f32_16x16x32_bf16 v[16:19], a[128:131], a[192:195], v[48:51]
 buffer_load_dwordx4 v8, s[40:43], s67 offen offset:2048 lds
 v_cvt_pk_bf16_f32 v92, v100, v101
 v_mfma_f32_16x16x32_bf16 v[16:19], a[132:135], a[196:199], v[16:19]
 v_exp_f32 v102, v42
 v_mfma_f32_16x16x32_bf16 v[16:19], a[136:139], a[200:203], v[16:19]
 v_mfma_f32_16x16x32_bf16 v[16:19], a[140:143], a[204:207], v[16:19]
 v_exp_f32 v103, v43
 v_mfma_f32_16x16x32_bf16 v[20:23], a[156:159], a[204:207], v[48:51]
 buffer_load_dwordx4 v8, s[40:43], s67 offen offset:3072 lds
 v_cvt_pk_bf16_f32 v93, v102, v103
 v_mfma_f32_16x16x32_bf16 v[20:23], a[152:155], a[200:203], v[20:23]
 s_add_u32 s67, s67, 16384
 v_mfma_f32_16x16x32_bf16 v[20:23], a[148:151], a[196:199], v[20:23]
 v_mfma_f32_16x16x32_bf16 v[20:23], a[144:147], a[192:195], v[20:23]
 v_mfma_f32_16x16x32_bf16 v[104:107], v[124:127], v[88:91], 0
 v_exp_f32 v96, v16
 v_mfma_f32_16x16x32_bf16 v[108:111], v[124:127], v[92:95], 0
 s_branch L_pg10k
L_pg10:
 s_branch L_ic1r
L_pg10k:
 v_exp_f32 v97, v17
 v_mfma_f32_16x16x32_bf16 v[28:31], a[144:147], a[208:211], v[52:55]
 v_cvt_pk_bf16_f32 v80, v96, v97
 v_mfma_f32_16x16x32_bf16 v[28:31], a[148:151], a[212:215], v[28:31]
 v_exp_f32 v98, v18
 v_mfma_f32_16x16x32_bf16 v[28:31], a[152:155], a[216:219], v[28:31]
 v_mfma_f32_16x16x32_bf16 v[28:31], a[156:159], a[220:223], v[28:31]
 v_exp_f32 v99, v19
 v_mfma_f32_16x16x32_bf16 v[24:27], a[140:143], a[220:223], v[52:55]
 v_add_f32 v105, v104, v108
 v_cmp_nge_f32 vcc, s84, v105
 v_mfma_f32_16x16x32_bf16 v[24:27], a[136:139], a[216:219], v[24:27]
 v_exp_f32 v96, v20
 v_mfma_f32_16x16x32_bf16 v[24:27], a[132:135], a[212:215], v[24:27]
 s_cbranch_vccnz L_tr9
L_ret9:
 v_cvt_pk_bf16_f32 v81, v98, v99
 v_mfma_f32_16x16x32_bf16 v[24:27], a[128:131], a[208:211], v[24:27]
 v_exp_f32 v97, v21
 v_mfma_f32_16x16x32_bf16 a[64:67], a[160:163], v[88:91], a[64:67]
 v_cvt_pk_bf16_f32 v82, v96, v97
 v_add_f32 v122, v122, v104
 v_mfma_f32_16x16x32_bf16 a[96:99], a[160:163], v[92:95], a[96:99]
 v_exp_f32 v98, v22
 v_mfma_f32_16x16x32_bf16 a[68:71], a[164:167], v[88:91], a[68:71]
 ds_read_b128 a[160:163], v12 offset:25088
 v_add_f32 v123, v123, v108
 v_mfma_f32_16x16x32_bf16 a[100:103], a[164:167], v[92:95], a[100:103]
 v_exp_f32 v99, v23
 v_mfma_f32_16x16x32_bf16 a[72:75], a[168:171], v[88:91], a[72:75]
 ds_read_b128 a[164:167], v12 offset:26112
 v_cvt_pk_bf16_f32 v83, v98, v99
 v_mfma_f32_16x16x32_bf16 a[104:107], a[168:171], v[92:95], a[104:107]
 v_exp_f32 v96, v28
 v_mfma_f32_16x16x32_bf16 a[76:79], a[172:175], v[88:91], a[76:79]
 ds_read_b128 a[168:171], v12 offset:27136
 v_mfma_f32_16x16x32_bf16 a[108:111], a[172:175], v[92:95], a[108:111]
 v_exp_f32 v97, v29
 v_mfma_f32_16x16x32_bf16 a[80:83], a[176:179], v[88:91], a[80:83]
 ds_read_b128 a[172:175], v12 offset:28160
 v_cvt_pk_bf16_f32 v86, v96, v97
 v_mfma_f32_16x16x32_bf16 a[112:115], a[176:179], v[92:95], a[112:115]
 v_exp_f32 v98, v30
 v_mfma_f32_16x16x32_bf16 a[84:87], a[180:183], v[88:91], a[84:87]
 ds_read_b128 a[176:179], v12 offset:29184
 v_mfma_f32_16x16x32_bf16 a[116:119], a[180:183], v[92:95], a[116:119]
 v_exp_f32 v99, v31
 v_mfma_f32_16x16x32_bf16 a[88:91], a[184:187], v[88:91], a[88:91]
 ds_read_b128 a[180:183], v12 offset:30208
 v_cvt_pk_bf16_f32 v87, v98, v99
 v_mfma_f32_16x16x32_bf16 a[120:123], a[184:187], v[92:95], a[120:123]
 v_exp_f32 v96, v24
 v_mfma_f32_16x16x32_bf16 a[92:95], a[188:191], v[88:91], a[92:95]
 ds_read_b128 a[184:187], v12 offset:31232
 v_mfma_f32_16x16x32_bf16 a[124:127], a[188:191], v[92:95], a[124:127]
 v_exp_f32 v97, v25
 v_mfma_f32_16x16x32_bf16 v[32:35], a[128:131], a[224:227], v[56:59]
 ds_read_b128 a[188:191], v12 offset:32256
 v_cvt_pk_bf16_f32 v84, v96, v97
 v_mfma_f32_16x16x32_bf16 v[32:35], a[132:135], a[228:231], v[32:35]
 v_exp_f32 v98, v26
 v_mfma_f32_16x16x32_bf16 v[32:35], a[136:139], a[232:235], v[32:35]
 buffer_load_dword v15, v13, s[44:47], s89 offen offset:2048
 s_add_u32 s89, s89, 4096
 v_mfma_f32_16x16x32_bf16 v[32:35], a[140:143], a[236:239], v[32:35]
 v_exp_f32 v99, v27
 v_mfma_f32_16x16x32_bf16 v[36:39], a[156:159], a[236:239], v[56:59]
 v_cvt_pk_bf16_f32 v85, v98, v99
 v_mfma_f32_16x16x32_bf16 v[36:39], a[152:155], a[232:235], v[36:39]
 v_mfma_f32_16x16x32_bf16 v[36:39], a[148:151], a[228:231], v[36:39]
 v_mfma_f32_16x16x32_bf16 v[36:39], a[144:147], a[224:227], v[36:39]
 v_mfma_f32_16x16x32_bf16 v[104:107], v[124:127], v[80:83], 0
 s_nop 0
 v_exp_f32 v100, v32
 v_mfma_f32_16x16x32_bf16 v[108:111], v[124:127], v[84:87], 0
 v_exp_f32 v101, v33
 v_mfma_f32_16x16x32_bf16 v[44:47], a[144:147], a[240:243], v[60:63]
 ds_read_b128 a[144:147], v12 offset:20992
 v_cvt_pk_bf16_f32 v88, v100, v101
 v_mfma_f32_16x16x32_bf16 v[44:47], a[148:151], a[244:247], v[44:47]
 v_exp_f32 v102, v34
 v_mfma_f32_16x16x32_bf16 v[44:47], a[152:155], a[248:251], v[44:47]
 ds_read_b128 a[148:151], v12 offset:22016
 ds_read_b128 a[152:155], v12 offset:23040
 v_mfma_f32_16x16x32_bf16 v[44:47], a[156:159], a[252:255], v[44:47]
 v_exp_f32 v103, v35
 v_mfma_f32_16x16x32_bf16 v[40:43], a[140:143], a[252:255], v[60:63]
 v_add_f32 v105, v104, v108
 v_cmp_nge_f32 vcc, s84, v105
 v_mfma_f32_16x16x32_bf16 v[40:43], a[136:139], a[248:251], v[40:43]
 v_exp_f32 v100, v36
 v_mfma_f32_16x16x32_bf16 v[40:43], a[132:135], a[244:247], v[40:43]
 s_cbranch_vccnz L_tr10
L_ret10:
 v_cvt_pk_bf16_f32 v89, v102, v103
 v_mfma_f32_16x16x32_bf16 v[40:43], a[128:131], a[240:243], v[40:43]
 s_waitcnt lgkmcnt(3)
 v_exp_f32 v101, v37
 v_mfma_f32_16x16x32_bf16 a[0:3], a[160:163], v[80:83], a[0:3]
 ds_read_b128 a[156:159], v12 offset:24064
 v_cvt_pk_bf16_f32 v90, v100, v101
 v_mfma_f32_16x16x32_bf16 a[32:35], a[160:163], v[84:87], a[32:35]
 v_exp_f32 v102, v38
 v_mfma_f32_16x16x32_bf16 a[4:7], a[164:167], v[80:83], a[4:7]
 ds_read_b128 a[140:143], v12 offset:19968
 ds_read_b128 a[136:139], v12 offset:18944
 v_mfma_f32_16x16x32_bf16 a[36:39], a[164:167], v[84:87], a[36:39]
 v_exp_f32 v103, v39
 v_mfma_f32_16x16x32_bf16 a[8:11], a[168:171], v[80:83], a[8:11]
 ds_read_b128 a[132:135], v12 offset:17920
 v_cvt_pk_bf16_f32 v91, v102, v103
 v_mfma_f32_16x16x32_bf16 a[40:43], a[168:171], v[84:87], a[40:43]
 v_exp_f32 v100, v44
 v_mfma_f32_16x16x32_bf16 a[12:15], a[172:175], v[80:83], a[12:15]
 ds_read_b128 a[128:131], v12 offset:16896
 v_add_f32 v120, v120, v104
 v_mfma_f32_16x16x32_bf16 a[44:47], a[172:175], v[84:87], a[44:47]
 s_add_u32 m0, s62, 84480
 v_exp_f32 v101, v45
 v_mfma_f32_16x16x32_bf16 a[16:19], a[176:179], v[80:83], a[16:19]
 v_cvt_pk_bf16_f32 v94, v100, v101
 v_add_f32 v121, v121, v108
 v_mfma_f32_16x16x32_bf16 a[48:51], a[176:179], v[84:87], a[48:51]
 v_exp_f32 v102, v46
 v_mfma_f32_16x16x32_bf16 a[20:23], a[180:183], v[80:83], a[20:23]
 buffer_load_dwordx4 v8, s[40:43], s67 offen offset:0 lds
 v_mfma_f32_16x16x32_bf16 a[52:55], a[180:183], v[84:87], a[52:55]
 v_exp_f32 v103, v47
 v_mfma_f32_16x16x32_bf16 a[24:27], a[184:187], v[80:83], a[24:27]
 buffer_load_dwordx4 v8, s[40:43], s67 offen offset:1024 lds
 v_cvt_pk_bf16_f32 v95, v102, v103
 v_mfma_f32_16x16x32_bf16 a[56:59], a[184:187], v[84:87], a[56:59]
 v_exp_f32 v100, v40
 v_mfma_f32_16x16x32_bf16 a[28:31], a[188:191], v[80:83], a[28:31]
 v_mfma_f32_16x16x32_bf16 a[60:63], a[188:191], v[84:87], a[60:63]
 s_waitcnt lgkmcnt(0)
 v_exp_f32 v101, v41
 v_mfma_f32_16x16x32_bf16 v[16:19], a[128:131], a[192:195], v[48:51]
 buffer_load_dwordx4 v8, s[40:43], s67 offen offset:2048 lds
 v_cvt_pk_bf16_f32 v92, v100, v101
 v_mfma_f32_16x16x32_bf16 v[16:19], a[132:135], a[196:199], v[16:19]
 v_exp_f32 v102, v42
 v_mfma_f32_16x16x32_bf16 v[16:19], a[136:139], a[200:203], v[16:19]
 v_mfma_f32_16x16x32_bf16 v[16:19], a[140:143], a[204:207], v[16:19]
 v_exp_f32 v103, v43
 v_mfma_f32_16x16x32_bf16 v[20:23], a[156:159], a[204:207], v[48:51]
 buffer_load_dwordx4 v8, s[40:43], s67 offen offset:3072 lds
 v_cvt_pk_bf16_f32 v93, v102, v103
 v_mfma_f32_16x16x32_bf16 v[20:23], a[152:155], a[200:203], v[20:23]
 s_add_u32 s67, s67, 16384
 v_mfma_f32_16x16x32_bf16 v[20:23], a[148:151], a[196:199], v[20:23]
 v_mfma_f32_16x16x32_bf16 v[20:23], a[144:147], a[192:195], v[20:23]
 v_mfma_f32_16x16x32_bf16 v[104:107], v[124:127], v[88:91], 0
 v_exp_f32 v96, v16
 v_mfma_f32_16x16x32_bf16 v[108:111], v[124:127], v[92:95], 0
 v_exp_f32 v97, v17
 v_mfma_f32_16x16x32_bf16 v[28:31], a[144:147], a[208:211], v[52:55]
 v_cvt_pk_bf16_f32 v80, v96, v97
 v_mfma_f32_16x16x32_bf16 v[28:31], a[148:151], a[212:215], v[28:31]
 v_exp_f32 v98, v18
 v_mfma_f32_16x16x32_bf16 v[28:31], a[152:155], a[216:219], v[28:31]
 v_mfma_f32_16x16x32_bf16 v[28:31], a[156:159], a[220:223], v[28:31]
 v_exp_f32 v99, v19
 v_mfma_f32_16x16x32_bf16 v[24:27], a[140:143], a[220:223], v[52:55]
 v_add_f32 v105, v104, v108
 v_cmp_nge_f32 vcc, s84, v105
 v_mfma_f32_16x16x32_bf16 v[24:27], a[136:139], a[216:219], v[24:27]
 v_exp_f32 v96, v20
 v_mfma_f32_16x16x32_bf16 v[24:27], a[132:135], a[212:215], v[24:27]
 s_cbranch_vccnz L_tr11
L_ret11:
 v_cvt_pk_bf16_f32 v81, v98, v99
 v_mfma_f32_16x16x32_bf16 v[24:27], a[128:131], a[208:211], v[24:27]
 s_waitcnt vmcnt(20)
 v_exp_f32 v97, v21
 v_mfma_f32_16x16x32_bf16 a[64:67], a[160:163], v[88:91], a[64:67]
 s_barrier
 v_cvt_pk_bf16_f32 v82, v96, v97
 v_add_f32 v122, v122, v104
 v_mfma_f32_16x16x32_bf16 a[96:99], a[160:163], v[92:95], a[96:99]
 v_exp_f32 v98, v22
 v_mfma_f32_16x16x32_bf16 a[68:71], a[164:167], v[88:91], a[68:71]
 ds_read_b128 a[160:163], v8 offset:8192
 v_add_f32 v123, v123, v108
 v_mfma_f32_16x16x32_bf16 a[100:103], a[164:167], v[92:95], a[100:103]
 v_exp_f32 v99, v23
 v_mfma_f32_16x16x32_bf16 a[72:75], a[168:171], v[88:91], a[72:75]
 ds_read_b128 a[164:167], v8 offset:9216
 v_cvt_pk_bf16_f32 v83, v98, v99
 v_mfma_f32_16x16x32_bf16 a[104:107], a[168:171], v[92:95], a[104:107]
 v_exp_f32 v96, v28
 v_mfma_f32_16x16x32_bf16 a[76:79], a[172:175], v[88:91], a[76:79]
 ds_read_b128 a[168:171], v8 offset:10240
 buffer_load_dword v15, v13, s[44:47], s89 offen offset:0
 v_mfma_f32_16x16x32_bf16 a[108:111], a[172:175], v[92:95], a[108:111]
 v_exp_f32 v97, v29
 v_mfma_f32_16x16x32_bf16 a[80:83], a[176:179], v[88:91], a[80:83]
 ds_read_b128 a[172:175], v8 offset:11264
 v_cvt_pk_bf16_f32 v86, v96, v97
 v_mfma_f32_16x16x32_bf16 a[112:115], a[176:179], v[92:95], a[112:115]
 v_exp_f32 v98, v30
 v_mfma_f32_16x16x32_bf16 a[84:87], a[180:183], v[88:91], a[84:87]
 ds_read_b128 a[176:179], v8 offset:12288
 v_mfma_f32_16x16x32_bf16 a[116:119], a[180:183], v[92:95], a[116:119]
 v_exp_f32 v99, v31
 v_mfma_f32_16x16x32_bf16 a[88:91], a[184:187], v[88:91], a[88:91]
 ds_read_b128 a[180:183], v8 offset:13312
 v_cvt_pk_bf16_f32 v87, v98, v99
 v_mfma_f32_16x16x32_bf16 a[120:123], a[184:187], v[92:95], a[120:123]
 v_exp_f32 v96, v24
 v_mfma_f32_16x16x32_bf16 a[92:95], a[188:191], v[88:91], a[92:95]
 ds_read_b128 a[184:187], v8 offset:14336
 v_mfma_f32_16x16x32_bf16 a[124:127], a[188:191], v[92:95], a[124:127]
 v_exp_f32 v97, v25
 v_mfma_f32_16x16x32_bf16 v[32:35], a[128:131], a[224:227], v[56:59]
 ds_read_b128 a[188:191], v8 offset:15360
 v_cvt_pk_bf16_f32 v84, v96, v97
 v_mfma_f32_16x16x32_bf16 v[32:35], a[132:135], a[228:231], v[32:35]
 v_exp_f32 v98, v26
 v_mfma_f32_16x16x32_bf16 v[32:35], a[136:139], a[232:235], v[32:35]
 v_mfma_f32_16x16x32_bf16 v[32:35], a[140:143], a[236:239], v[32:35]
 v_exp_f32 v99, v27
 v_mfma_f32_16x16x32_bf16 v[36:39], a[156:159], a[236:239], v[56:59]
 v_cvt_pk_bf16_f32 v85, v98, v99
 v_mfma_f32_16x16x32_bf16 v[36:39], a[152:155], a[232:235], v[36:39]
 v_mfma_f32_16x16x32_bf16 v[36:39], a[148:151], a[228:231], v[36:39]
 v_mfma_f32_16x16x32_bf16 v[36:39], a[144:147], a[224:227], v[36:39]
 v_mfma_f32_16x16x32_bf16 v[104:107], v[124:127], v[80:83], 0
 s_nop 0
 v_exp_f32 v100, v32
 v_mfma_f32_16x16x32_bf16 v[108:111], v[124:127], v[84:87], 0
 v_exp_f32 v101, v33
 v_mfma_f32_16x16x32_bf16 v[44:47], a[144:147], a[240:243], v[60:63]
 ds_read_b128 a[144:147], v8 offset:4096
 v_cvt_pk_bf16_f32 v88, v100, v101
 v_mfma_f32_16x16x32_bf16 v[44:47], a[148:151], a[244:247], v[44:47]
 v_exp_f32 v102, v34
 v_mfma_f32_16x16x32_bf16 v[44:47], a[152:155], a[248:251], v[44:47]
 ds_read_b128 a[148:151], v8 offset:5120
 ds_read_b128 a[152:155], v8 offset:6144
 v_mfma_f32_16x16x32_bf16 v[44:47], a[156:159], a[252:255], v[44:47]
 v_exp_f32 v103, v35
 v_mfma_f32_16x16x32_bf16 v[40:43], a[140:143], a[252:255], v[60:63]
 v_add_f32 v105, v104, v108
 v_cmp_nge_f32 vcc, s84, v105
 v_mfma_f32_16x16x32_bf16 v[40:43], a[136:139], a[248:251], v[40:43]
 v_exp_f32 v100, v36
 v_mfma_f32_16x16x32_bf16 v[40:43], a[132:135], a[244:247], v[40:43]
 s_cbranch_vccnz L_tr12
L_ret12:
 v_cvt_pk_bf16_f32 v89, v102, v103
 v_mfma_f32_16x16x32_bf16 v[40:43], a[128:131], a[240:243], v[40:43]
 s_waitcnt lgkmcnt(3)
 v_exp_f32 v101, v37
 v_mfma_f32_16x16x32_bf16 a[0:3], a[160:163], v[80:83], a[0:3]
 ds_read_b128 a[156:159], v8 offset:7168
 v_cvt_pk_bf16_f32 v90, v100, v101
 v_mfma_f32_16x16x32_bf16 a[32:35], a[160:163], v[84:87], a[32:35]
 v_exp_f32 v102, v38
 v_mfma_f32_16x16x32_bf16 a[4:7], a[164:167], v[80:83], a[4:7]
 ds_read_b128 a[140:143], v8 offset:3072
 ds_read_b128 a[136:139], v8 offset:2048
 v_mfma_f32_16x16x32_bf16 a[36:39], a[164:167], v[84:87], a[36:39]
 v_exp_f32 v103, v39
 v_mfma_f32_16x16x32_bf16 a[8:11], a[168:171], v[80:83], a[8:11]
 ds_read_b128 a[132:135], v8 offset:1024
 v_cvt_pk_bf16_f32 v91, v102, v103
 v_mfma_f32_16x16x32_bf16 a[40:43], a[168:171], v[84:87], a[40:43]
 v_exp_f32 v100, v44
 v_mfma_f32_16x16x32_bf16 a[12:15], a[172:175], v[80:83], a[12:15]
 ds_read_b128 a[128:131], v8 offset:0
 v_add_f32 v120, v120, v104
 v_mfma_f32_16x16x32_bf16 a[44:47], a[172:175], v[84:87], a[44:47]
 s_add_u32 m0, s62, 101376
 v_exp_f32 v101, v45
 v_mfma_f32_16x16x32_bf16 a[16:19], a[176:179], v[80:83], a[16:19]
 v_cvt_pk_bf16_f32 v94, v100, v101
 v_add_f32 v121, v121, v108
 v_mfma_f32_16x16x32_bf16 a[48:51], a[176:179], v[84:87], a[48:51]
 v_exp_f32 v102, v46
 v_mfma_f32_16x16x32_bf16 a[20:23], a[180:183], v[80:83], a[20:23]
 buffer_load_dwordx4 v8, s[40:43], s67 offen offset:0 lds
 v_mfma_f32_16x16x32_bf16 a[52:55], a[180:183], v[84:87], a[52:55]
 v_exp_f32 v103, v47
 v_mfma_f32_16x16x32_bf16 a[24:27], a[184:187], v[80:83], a[24:27]
 buffer_load_dwordx4 v8, s[40:43], s67 offen offset:1024 lds
 v_cvt_pk_bf16_f32 v95, v102, v103
 v_mfma_f32_16x16x32_bf16 a[56:59], a[184:187], v[84:87], a[56:59]
 v_exp_f32 v100, v40
 v_mfma_f32_16x16x32_bf16 a[28:31], a[188:191], v[80:83], a[28:31]
 v_mfma_f32_16x16x32_bf16 a[60:63], a[188:191], v[84:87], a[60:63]
 s_waitcnt lgkmcnt(0)
 v_exp_f32 v101, v41
 v_mfma_f32_16x16x32_bf16 v[16:19], a[128:131], a[192:195], v[48:51]
 buffer_load_dwordx4 v8, s[40:43], s67 offen offset:2048 lds
 v_cvt_pk_bf16_f32 v92, v100, v101
 v_mfma_f32_16x16x32_bf16 v[16:19], a[132:135], a[196:199], v[16:19]
 v_exp_f32 v102, v42
 v_mfma_f32_16x16x32_bf16 v[16:19], a[136:139], a[200:203], v[16:19]
 v_mfma_f32_16x16x32_bf16 v[16:19], a[140:143], a[204:207], v[16:19]
 v_exp_f32 v103, v43
 v_mfma_f32_16x16x32_bf16 v[20:23], a[156:159], a[204:207], v[48:51]
 buffer_load_dwordx4 v8, s[40:43], s67 offen offset:3072 lds
 v_cvt_pk_bf16_f32 v93, v102, v103
 v_mfma_f32_16x16x32_bf16 v[20:23], a[152:155], a[200:203], v[20:23]
 s_add_u32 s67, s67, 16384
 v_mfma_f32_16x16x32_bf16 v[20:23], a[148:151], a[196:199], v[20:23]
 v_mfma_f32_16x16x32_bf16 v[20:23], a[144:147], a[192:195], v[20:23]
 v_mfma_f32_16x16x32_bf16 v[104:107], v[124:127], v[88:91], 0
 v_exp_f32 v96, v16
 v_mfma_f32_16x16x32_bf16 v[108:111], v[124:127], v[92:95], 0
 v_exp_f32 v97, v17
 v_mfma_f32_16x16x32_bf16 v[28:31], a[144:147], a[208:211], v[52:55]
 v_cvt_pk_bf16_f32 v80, v96, v97
 v_mfma_f32_16x16x32_bf16 v[28:31], a[148:151], a[212:215], v[28:31]
 v_exp_f32 v98, v18
 v_mfma_f32_16x16x32_bf16 v[28:31], a[152:155], a[216:219], v[28:31]
 v_mfma_f32_16x16x32_bf16 v[28:31], a[156:159], a[220:223], v[28:31]
 v_exp_f32 v99, v19
 v_mfma_f32_16x16x32_bf16 v[24:27], a[140:143], a[220:223], v[52:55]
 v_add_f32 v105, v104, v108
 v_cmp_nge_f32 vcc, s84, v105
 v_mfma_f32_16x16x32_bf16 v[24:27], a[136:139], a[216:219], v[24:27]
 v_exp_f32 v96, v20
 v_mfma_f32_16x16x32_bf16 v[24:27], a[132:135], a[212:215], v[24:27]
 s_cbranch_vccnz L_tr13
L_ret13:
 v_cvt_pk_bf16_f32 v81, v98, v99
 v_mfma_f32_16x16x32_bf16 v[24:27], a[128:131], a[208:211], v[24:27]
 v_exp_f32 v97, v21
 v_mfma_f32_16x16x32_bf16 a[64:67], a[160:163], v[88:91], a[64:67]
 v_cvt_pk_bf16_f32 v82, v96, v97
 v_add_f32 v122, v122, v104
 v_mfma_f32_16x16x32_bf16 a[96:99], a[160:163], v[92:95], a[96:99]
 v_exp_f32 v98, v22
 v_mfma_f32_16x16x32_bf16 a[68:71], a[164:167], v[88:91], a[68:71]
 ds_read_b128 a[160:163], v8 offset:25088
 v_add_f32 v123, v123, v108
 v_mfma_f32_16x16x32_bf16 a[100:103], a[164:167], v[92:95], a[100:103]
 v_exp_f32 v99, v23
 v_mfma_f32_16x16x32_bf16 a[72:75], a[168:171], v[88:91], a[72:75]
 ds_read_b128 a[164:167], v8 offset:26112
 v_cvt_pk_bf16_f32 v83, v98, v99
 v_mfma_f32_16x16x32_bf16 a[104:107], a[168:171], v[92:95], a[104:107]
 v_exp_f32 v96, v28
 v_mfma_f32_16x16x32_bf16 a[76:79], a[172:175], v[88:91], a[76:79]
 ds_read_b128 a[168:171], v8 offset:27136
 v_mfma_f32_16x16x32_bf16 a[108:111], a[172:175], v[92:95], a[108:111]
 v_exp_f32 v97, v29
 v_mfma_f32_16x16x32_bf16 a[80:83], a[176:179], v[88:91], a[80:83]
 ds_read_b128 a[172:175], v8 offset:28160
 v_cvt_pk_bf16_f32 v86, v96, v97
 v_mfma_f32_16x16x32_bf16 a[112:115], a[176:179], v[92:95], a[112:115]
 v_exp_f32 v98, v30
 v_mfma_f32_16x16x32_bf16 a[84:87], a[180:183], v[88:91], a[84:87]
 ds_read_b128 a[176:179], v8 offset:29184
 v_mfma_f32_16x16x32_bf16 a[116:119], a[180:183], v[92:95], a[116:119]
 v_exp_f32 v99, v31
 v_mfma_f32_16x16x32_bf16 a[88:91], a[184:187], v[88:91], a[88:91]
 ds_read_b128 a[180:183], v8 offset:30208
 v_cvt_pk_bf16_f32 v87, v98, v99
 v_mfma_f32_16x16x32_bf16 a[120:123], a[184:187], v[92:95], a[120:123]
 v_exp_f32 v96, v24
 v_mfma_f32_16x16x32_bf16 a[92:95], a[188:191], v[88:91], a[92:95]
 ds_read_b128 a[184:187], v8 offset:31232
 v_mfma_f32_16x16x32_bf16 a[124:127], a[188:191], v[92:95], a[124:127]
 v_exp_f32 v97, v25
 v_mfma_f32_16x16x32_bf16 v[32:35], a[128:131], a[224:227], v[56:59]
 ds_read_b128 a[188:191], v8 offset:32256
 v_cvt_pk_bf16_f32 v84, v96, v97
 v_mfma_f32_16x16x32_bf16 v[32:35], a[132:135], a[228:231], v[32:35]
 v_exp_f32 v98, v26
 v_mfma_f32_16x16x32_bf16 v[32:35], a[136:139], a[232:235], v[32:35]
 buffer_load_dword v15, v13, s[44:47], s89 offen offset:2048
 s_add_u32 s89, s89, 4096
 v_mfma_f32_16x16x32_bf16 v[32:35], a[140:143], a[236:239], v[32:35]
 v_exp_f32 v99, v27
 v_mfma_f32_16x16x32_bf16 v[36:39], a[156:159], a[236:239], v[56:59]
 v_cvt_pk_bf16_f32 v85, v98, v99
 v_mfma_f32_16x16x32_bf16 v[36:39], a[152:155], a[232:235], v[36:39]
 v_mfma_f32_16x16x32_bf16 v[36:39], a[148:151], a[228:231], v[36:39]
 v_mfma_f32_16x16x32_bf16 v[36:39], a[144:147], a[224:227], v[36:39]
 v_mfma_f32_16x16x32_bf16 v[104:107], v[124:127], v[80:83], 0
 s_nop 0
 v_exp_f32 v100, v32
 v_mfma_f32_16x16x32_bf16 v[108:111], v[124:127], v[84:87], 0
 v_exp_f32 v101, v33
 v_mfma_f32_16x16x32_bf16 v[44:47], a[144:147], a[240:243], v[60:63]
 ds_read_b128 a[144:147], v8 offset:20992
 v_cvt_pk_bf16_f32 v88, v100, v101
 v_mfma_f32_16x16x32_bf16 v[44:47], a[148:151], a[244:247], v[44:47]
 v_exp_f32 v102, v34
 v_mfma_f32_16x16x32_bf16 v[44:47], a[152:155], a[248:251], v[44:47]
 ds_read_b128 a[148:151], v8 offset:22016
 ds_read_b128 a[152:155], v8 offset:23040
 v_mfma_f32_16x16x32_bf16 v[44:47], a[156:159], a[252:255], v[44:47]
 v_exp_f32 v103, v35
 v_mfma_f32_16x16x32_bf16 v[40:43], a[140:143], a[252:255], v[60:63]
 v_add_f32 v105, v104, v108
 v_cmp_nge_f32 vcc, s84, v105
 v_mfma_f32_16x16x32_bf16 v[40:43], a[136:139], a[248:251], v[40:43]
 v_exp_f32 v100, v36
 v_mfma_f32_16x16x32_bf16 v[40:43], a[132:135], a[244:247], v[40:43]
 s_cbranch_vccnz L_tr14
L_ret14:
 v_cvt_pk_bf16_f32 v89, v102, v103
 v_mfma_f32_16x16x32_bf16 v[40:43], a[128:131], a[240:243], v[40:43]
 s_waitcnt lgkmcnt(3)
 v_exp_f32 v101, v37
 v_mfma_f32_16x16x32_bf16 a[0:3], a[160:163], v[80:83], a[0:3]
 ds_read_b128 a[156:159], v8 offset:24064
 v_cvt_pk_bf16_f32 v90, v100, v101
 v_mfma_f32_16x16x32_bf16 a[32:35], a[160:163], v[84:87], a[32:35]
 v_exp_f32 v102, v38
 v_mfma_f32_16x16x32_bf16 a[4:7], a[164:167], v[80:83], a[4:7]
 ds_read_b128 a[140:143], v8 offset:19968
 ds_read_b128 a[136:139], v8 offset:18944
 v_mfma_f32_16x16x32_bf16 a[36:39], a[164:167], v[84:87], a[36:39]
 v_exp_f32 v103, v39
 v_mfma_f32_16x16x32_bf16 a[8:11], a[168:171], v[80:83], a[8:11]
 ds_read_b128 a[132:135], v8 offset:17920
 v_cvt_pk_bf16_f32 v91, v102, v103
 v_mfma_f32_16x16x32_bf16 a[40:43], a[168:171], v[84:87], a[40:43]
 v_exp_f32 v100, v44
 v_mfma_f32_16x16x32_bf16 a[12:15], a[172:175], v[80:83], a[12:15]
 ds_read_b128 a[128:131], v8 offset:16896
 v_add_f32 v120, v120, v104
 v_mfma_f32_16x16x32_bf16 a[44:47], a[172:175], v[84:87], a[44:47]
 s_add_u32 m0, s62, 118272
 v_exp_f32 v101, v45
 v_mfma_f32_16x16x32_bf16 a[16:19], a[176:179], v[80:83], a[16:19]
 v_cvt_pk_bf16_f32 v94, v100, v101
 v_add_f32 v121, v121, v108
 v_mfma_f32_16x16x32_bf16 a[48:51], a[176:179], v[84:87], a[48:51]
 v_exp_f32 v102, v46
 v_mfma_f32_16x16x32_bf16 a[20:23], a[180:183], v[80:83], a[20:23]
 buffer_load_dwordx4 v8, s[40:43], s67 offen offset:0 lds
 v_mfma_f32_16x16x32_bf16 a[52:55], a[180:183], v[84:87], a[52:55]
 v_exp_f32 v103, v47
 v_mfma_f32_16x16x32_bf16 a[24:27], a[184:187], v[80:83], a[24:27]
 buffer_load_dwordx4 v8, s[40:43], s67 offen offset:1024 lds
 v_cvt_pk_bf16_f32 v95, v102, v103
 v_mfma_f32_16x16x32_bf16 a[56:59], a[184:187], v[84:87], a[56:59]
 v_exp_f32 v100, v40
 v_mfma_f32_16x16x32_bf16 a[28:31], a[188:191], v[80:83], a[28:31]
 v_mfma_f32_16x16x32_bf16 a[60:63], a[188:191], v[84:87], a[60:63]
 s_waitcnt lgkmcnt(0)
 v_exp_f32 v101, v41
 v_mfma_f32_16x16x32_bf16 v[16:19], a[128:131], a[192:195], v[48:51]
 buffer_load_dwordx4 v8, s[40:43], s67 offen offset:2048 lds
 v_cvt_pk_bf16_f32 v92, v100, v101
 v_mfma_f32_16x16x32_bf16 v[16:19], a[132:135], a[196:199], v[16:19]
 v_exp_f32 v102, v42
 v_mfma_f32_16x16x32_bf16 v[16:19], a[136:139], a[200:203], v[16:19]
 v_mfma_f32_16x16x32_bf16 v[16:19], a[140:143], a[204:207], v[16:19]
 v_exp_f32 v103, v43
 v_mfma_f32_16x16x32_bf16 v[20:23], a[156:159], a[204:207], v[48:51]
 buffer_load_dwordx4 v8, s[40:43], s67 offen offset:3072 lds
 v_cvt_pk_bf16_f32 v93, v102, v103
 v_mfma_f32_16x16x32_bf16 v[20:23], a[152:155], a[200:203], v[20:23]
 s_add_u32 s67, s67, 16384
 v_mfma_f32_16x16x32_bf16 v[20:23], a[148:151], a[196:199], v[20:23]
 v_mfma_f32_16x16x32_bf16 v[20:23], a[144:147], a[192:195], v[20:23]
 v_mfma_f32_16x16x32_bf16 v[104:107], v[124:127], v[88:91], 0
 v_exp_f32 v96, v16
 v_mfma_f32_16x16x32_bf16 v[108:111], v[124:127], v[92:95], 0
 v_exp_f32 v97, v17
 v_mfma_f32_16x16x32_bf16 v[28:31], a[144:147], a[208:211], v[52:55]
 v_cvt_pk_bf16_f32 v80, v96, v97
 v_mfma_f32_16x16x32_bf16 v[28:31], a[148:151], a[212:215], v[28:31]
 v_exp_f32 v98, v18
 v_mfma_f32_16x16x32_bf16 v[28:31], a[152:155], a[216:219], v[28:31]
 v_mfma_f32_16x16x32_bf16 v[28:31], a[156:159], a[220:223], v[28:31]
 v_exp_f32 v99, v19
 v_mfma_f32_16x16x32_bf16 v[24:27], a[140:143], a[220:223], v[52:55]
 v_add_f32 v105, v104, v108
 v_cmp_nge_f32 vcc, s84, v105
 v_mfma_f32_16x16x32_bf16 v[24:27], a[136:139], a[216:219], v[24:27]
 v_exp_f32 v96, v20
 v_mfma_f32_16x16x32_bf16 v[24:27], a[132:135], a[212:215], v[24:27]
 s_cbranch_vccnz L_tr15
L_ret15:
 v_cvt_pk_bf16_f32 v81, v98, v99
 v_mfma_f32_16x16x32_bf16 v[24:27], a[128:131], a[208:211], v[24:27]
 s_waitcnt vmcnt(20)
 v_exp_f32 v97, v21
 v_mfma_f32_16x16x32_bf16 a[64:67], a[160:163], v[88:91], a[64:67]
 s_barrier
 v_cvt_pk_bf16_f32 v82, v96, v97
 v_add_f32 v122, v122, v104
 v_mfma_f32_16x16x32_bf16 a[96:99], a[160:163], v[92:95], a[96:99]
 v_exp_f32 v98, v22
 v_mfma_f32_16x16x32_bf16 a[68:71], a[164:167], v[88:91], a[68:71]
 ds_read_b128 a[160:163], v8 offset:41984
 v_add_f32 v123, v123, v108
 v_mfma_f32_16x16x32_bf16 a[100:103], a[164:167], v[92:95], a[100:103]
 v_exp_f32 v99, v23
 v_mfma_f32_16x16x32_bf16 a[72:75], a[168:171], v[88:91], a[72:75]
 ds_read_b128 a[164:167], v8 offset:43008
 v_cvt_pk_bf16_f32 v83, v98, v99
 v_mfma_f32_16x16x32_bf16 a[104:107], a[168:171], v[92:95], a[104:107]
 v_exp_f32 v96, v28
 v_mfma_f32_16x16x32_bf16 a[76:79], a[172:175], v[88:91], a[76:79]
 ds_read_b128 a[168:171], v8 offset:44032
 v_mfma_f32_16x16x32_bf16 a[108:111], a[172:175], v[92:95], a[108:111]
 v_exp_f32 v97, v29
 v_mfma_f32_16x16x32_bf16 a[80:83], a[176:179], v[88:91], a[80:83]
 ds_read_b128 a[172:175], v8 offset:45056
 v_cvt_pk_bf16_f32 v86, v96, v97
 v_mfma_f32_16x16x32_bf16 a[112:115], a[176:179], v[92:95], a[112:115]
 v_exp_f32 v98, v30
 v_mfma_f32_16x16x32_bf16 a[84:87], a[180:183], v[88:91], a[84:87]
 ds_read_b128 a[176:179], v8 offset:46080
 v_mfma_f32_16x16x32_bf16 a[116:119], a[180:183], v[92:95], a[116:119]
 v_exp_f32 v99, v31
 v_mfma_f32_16x16x32_bf16 a[88:91], a[184:187], v[88:91], a[88:91]
 ds_read_b128 a[180:183], v8 offset:47104
 v_cvt_pk_bf16_f32 v87, v98, v99
 v_mfma_f32_16x16x32_bf16 a[120:123], a[184:187], v[92:95], a[120:123]
 v_exp_f32 v96, v24
 v_mfma_f32_16x16x32_bf16 a[92:95], a[188:191], v[88:91], a[92:95]
 ds_read_b128 a[184:187], v8 offset:48128
 v_mfma_f32_16x16x32_bf16 a[124:127], a[188:191], v[92:95], a[124:127]
 v_exp_f32 v97, v25
 v_mfma_f32_16x16x32_bf16 v[32:35], a[128:131], a[224:227], v[56:59]
 ds_read_b128 a[188:191], v8 offset:49152
 v_cvt_pk_bf16_f32 v84, v96, v97
 v_mfma_f32_16x16x32_bf16 v[32:35], a[132:135], a[228:231], v[32:35]
 v_exp_f32 v98, v26
 v_mfma_f32_16x16x32_bf16 v[32:35], a[136:139], a[232:235], v[32:35]
 s_getpc_b64 s[100:101]
L_pc1:
 s_add_u32 s100, s100, L_p2-L_pc1+0
 s_addc_u32 s101, s101, 0
 v_mfma_f32_16x16x32_bf16 v[32:35], a[140:143], a[236:239], v[32:35]
 v_exp_f32 v99, v27
 v_mfma_f32_16x16x32_bf16 v[36:39], a[156:159], a[236:239], v[56:59]
 v_cvt_pk_bf16_f32 v85, v98, v99
 v_min_u32 v250, 15, v1
 v_mfma_f32_16x16x32_bf16 v[36:39], a[152:155], a[232:235], v[36:39]
 v_lshlrev_b32 v250, 7, v250
 v_add_u32 v250, s68, v250
 v_mfma_f32_16x16x32_bf16 v[36:39], a[148:151], a[228:231], v[36:39]
 v_min_u32 v250, L_chk_slow-L_p2-0-4, v250
 v_mov_b32 v251, s101
 v_mfma_f32_16x16x32_bf16 v[36:39], a[144:147], a[224:227], v[36:39]
 v_add_co_u32 v250, vcc, s100, v250
 v_addc_co_u32 v251, vcc, 0, v251, vcc
 v_mfma_f32_16x16x32_bf16 v[104:107], v[124:127], v[80:83], 0
 v_exp_f32 v100, v32
 v_mfma_f32_16x16x32_bf16 v[108:111], v[124:127], v[84:87], 0
 v_exp_f32 v101, v33
 v_mfma_f32_16x16x32_bf16 v[44:47], a[144:147], a[240:243], v[60:63]
 ds_read_b128 a[144:147], v8 offset:37888
 v_cvt_pk_bf16_f32 v88, v100, v101
 v_mfma_f32_16x16x32_bf16 v[44:47], a[148:151], a[244:247], v[44:47]
 v_exp_f32 v102, v34
 v_mfma_f32_16x16x32_bf16 v[44:47], a[152:155], a[248:251], v[44:47]
 ds_read_b128 a[148:151], v8 offset:38912
 ds_read_b128 a[152:155], v8 offset:39936
 global_load_dword v249, v[250:251], off
 v_mfma_f32_16x16x32_bf16 v[44:47], a[156:159], a[252:255], v[44:47]
 v_exp_f32 v103, v35
 v_mfma_f32_16x16x32_bf16 v[40:43], a[140:143], a[252:255], v[60:63]
 v_add_f32 v105, v104, v108
 v_cmp_nge_f32 vcc, s84, v105
 v_mfma_f32_16x16x32_bf16 v[40:43], a[136:139], a[248:251], v[40:43]
 v_exp_f32 v100, v36
 v_mfma_f32_16x16x32_bf16 v[40:43], a[132:135], a[244:247], v[40:43]
 s_cbranch_vccnz L_tr16
L_ret16:
 v_cvt_pk_bf16_f32 v89, v102, v103
 v_mfma_f32_16x16x32_bf16 v[40:43], a[128:131], a[240:243], v[40:43]
 s_waitcnt lgkmcnt(3)
 v_exp_f32 v101, v37
 v_mfma_f32_16x16x32_bf16 a[0:3], a[160:163], v[80:83], a[0:3]
 ds_read_b128 a[156:159], v8 offset:40960
 v_cvt_pk_bf16_f32 v90, v100, v101
 v_mfma_f32_16x16x32_bf16 a[32:35], a[160:163], v[84:87], a[32:35]
 v_exp_f32 v102, v38
 v_mfma_f32_16x16x32_bf16 a[4:7], a[164:167], v[80:83], a[4:7]
 ds_read_b128 a[140:143], v8 offset:36864
 ds_read_b128 a[136:139], v8 offset:35840
 v_mfma_f32_16x16x32_bf16 a[36:39], a[164:167], v[84:87], a[36:39]
 v_exp_f32 v103, v39
 v_mfma_f32_16x16x32_bf16 a[8:11], a[168:171], v[80:83], a[8:11]
 ds_read_b128 a[132:135], v8 offset:34816
 v_cvt_pk_bf16_f32 v91, v102, v103
 v_mfma_f32_16x16x32_bf16 a[40:43], a[168:171], v[84:87], a[40:43]
 v_exp_f32 v100, v44
 v_mfma_f32_16x16x32_bf16 a[12:15], a[172:175], v[80:83], a[12:15]
 ds_read_b128 a[128:131], v8 offset:33792
 v_add_f32 v120, v120, v104
 v_mfma_f32_16x16x32_bf16 a[44:47], a[172:175], v[84:87], a[44:47]
 s_add_u32 m0, s62, 0
 v_exp_f32 v101, v45
 v_mfma_f32_16x16x32_bf16 a[16:19], a[176:179], v[80:83], a[16:19]
 v_cvt_pk_bf16_f32 v94, v100, v101
 v_add_f32 v121, v121, v108
 v_mfma_f32_16x16x32_bf16 a[48:51], a[176:179], v[84:87], a[48:51]
 v_exp_f32 v102, v46
 v_mfma_f32_16x16x32_bf16 a[20:23], a[180:183], v[80:83], a[20:23]
 buffer_load_dwordx4 v8, s[40:43], s67 offen offset:0 lds
 v_mfma_f32_16x16x32_bf16 a[52:55], a[180:183], v[84:87], a[52:55]
 v_exp_f32 v103, v47
 v_mfma_f32_16x16x32_bf16 a[24:27], a[184:187], v[80:83], a[24:27]
 buffer_load_dwordx4 v8, s[40:43], s67 offen offset:1024 lds
 v_cvt_pk_bf16_f32 v95, v102, v103
 v_mfma_f32_16x16x32_bf16 a[56:59], a[184:187], v[84:87], a[56:59]
 v_exp_f32 v100, v40
 v_mfma_f32_16x16x32_bf16 a[28:31], a[188:191], v[80:83], a[28:31]
 v_mfma_f32_16x16x32_bf16 a[60:63], a[188:191], v[84:87], a[60:63]
 s_waitcnt lgkmcnt(0)
 v_exp_f32 v101, v41
 v_mfma_f32_16x16x32_bf16 v[16:19], a[128:131], a[192:195], v[48:51]
 s_branch L_pg11k
L_pg11:
L_ic2w3:
 s_branch L_ic2r
L_pg11k:
 buffer_load_dwordx4 v8, s[40:43], s67 offen offset:2048 lds
 v_cvt_pk_bf16_f32 v92, v100, v101
 v_mfma_f32_16x16x32_bf16 v[16:19], a[132:135], a[196:199], v[16:19]
 v_exp_f32 v102, v42
 v_mfma_f32_16x16x32_bf16 v[16:19], a[136:139], a[200:203], v[16:19]
 s_add_u32 s7, s9, 65536
 buffer_load_dword v15, v14, s[16:19], s7 offen sc0 sc1
 v_mfma_f32_16x16x32_bf16 v[16:19], a[140:143], a[204:207], v[16:19]
 v_exp_f32 v103, v43
 v_mfma_f32_16x16x32_bf16 v[20:23], a[156:159], a[204:207], v[48:51]
 buffer_load_dwordx4 v8, s[40:43], s67 offen offset:3072 lds
 v_cvt_pk_bf16_f32 v93, v102, v103
 v_mfma_f32_16x16x32_bf16 v[20:23], a[152:155], a[200:203], v[20:23]
 s_add_u32 s67, s67, 16384
 v_mfma_f32_16x16x32_bf16 v[20:23], a[148:151], a[196:199], v[20:23]
 v_mfma_f32_16x16x32_bf16 v[20:23], a[144:147], a[192:195], v[20:23]
 v_mfma_f32_16x16x32_bf16 v[104:107], v[124:127], v[88:91], 0
 v_exp_f32 v96, v16
 v_mfma_f32_16x16x32_bf16 v[108:111], v[124:127], v[92:95], 0
 v_exp_f32 v97, v17
 v_mfma_f32_16x16x32_bf16 v[28:31], a[144:147], a[208:211], v[52:55]
 v_cvt_pk_bf16_f32 v80, v96, v97
 v_mfma_f32_16x16x32_bf16 v[28:31], a[148:151], a[212:215], v[28:31]
 v_exp_f32 v98, v18
 v_mfma_f32_16x16x32_bf16 v[28:31], a[152:155], a[216:219], v[28:31]
 v_mfma_f32_16x16x32_bf16 v[28:31], a[156:159], a[220:223], v[28:31]
 v_exp_f32 v99, v19
 v_mfma_f32_16x16x32_bf16 v[24:27], a[140:143], a[220:223], v[52:55]
 v_add_f32 v105, v104, v108
 v_cmp_nge_f32 vcc, s84, v105
 v_mfma_f32_16x16x32_bf16 v[24:27], a[136:139], a[216:219], v[24:27]
 v_exp_f32 v96, v20
 v_mfma_f32_16x16x32_bf16 v[24:27], a[132:135], a[212:215], v[24:27]
 s_cbranch_vccnz L_tr17
L_ret17:
 v_cvt_pk_bf16_f32 v81, v98, v99
 v_mfma_f32_16x16x32_bf16 v[24:27], a[128:131], a[208:211], v[24:27]
 v_exp_f32 v97, v21
 v_mfma_f32_16x16x32_bf16 a[64:67], a[160:163], v[88:91], a[64:67]
 v_cvt_pk_bf16_f32 v82, v96, v97
 v_add_f32 v122, v122, v104
 v_mfma_f32_16x16x32_bf16 a[96:99], a[160:163], v[92:95], a[96:99]
 v_exp_f32 v98, v22
 v_mfma_f32_16x16x32_bf16 a[68:71], a[164:167], v[88:91], a[68:71]
 ds_read_b128 a[160:163], v11 offset:8192
 v_add_f32 v123, v123, v108
 v_mfma_f32_16x16x32_bf16 a[100:103], a[164:167], v[92:95], a[100:103]
 v_exp_f32 v99, v23
 v_mfma_f32_16x16x32_bf16 a[72:75], a[168:171], v[88:91], a[72:75]
 ds_read_b128 a[164:167], v11 offset:9216
 v_cvt_pk_bf16_f32 v83, v98, v99
 v_mfma_f32_16x16x32_bf16 a[104:107], a[168:171], v[92:95], a[104:107]
 v_exp_f32 v96, v28
 v_mfma_f32_16x16x32_bf16 a[76:79], a[172:175], v[88:91], a[76:79]
 ds_read_b128 a[168:171], v11 offset:10240
 v_mfma_f32_16x16x32_bf16 a[108:111], a[172:175], v[92:95], a[108:111]
 v_exp_f32 v97, v29
 v_mfma_f32_16x16x32_bf16 a[80:83], a[176:179], v[88:91], a[80:83]
 ds_read_b128 a[172:175], v11 offset:11264
 v_cvt_pk_bf16_f32 v86, v96, v97
 v_mfma_f32_16x16x32_bf16 a[112:115], a[176:179], v[92:95], a[112:115]
 v_exp_f32 v98, v30
 v_mfma_f32_16x16x32_bf16 a[84:87], a[180:183], v[88:91], a[84:87]
 ds_read_b128 a[176:179], v11 offset:12288
 v_mfma_f32_16x16x32_bf16 a[116:119], a[180:183], v[92:95], a[116:119]
 v_exp_f32 v99, v31
 v_mfma_f32_16x16x32_bf16 a[88:91], a[184:187], v[88:91], a[88:91]
 ds_read_b128 a[180:183], v11 offset:13312
 v_cvt_pk_bf16_f32 v87, v98, v99
 v_mfma_f32_16x16x32_bf16 a[120:123], a[184:187], v[92:95], a[120:123]
 v_exp_f32 v96, v24
 v_mfma_f32_16x16x32_bf16 a[92:95], a[188:191], v[88:91], a[92:95]
 ds_read_b128 a[184:187], v11 offset:14336
 v_mfma_f32_16x16x32_bf16 a[124:127], a[188:191], v[92:95], a[124:127]
 v_exp_f32 v97, v25
 v_mfma_f32_16x16x32_bf16 v[32:35], a[128:131], a[224:227], v[56:59]
 ds_read_b128 a[188:191], v11 offset:15360
 v_cvt_pk_bf16_f32 v84, v96, v97
 v_mfma_f32_16x16x32_bf16 v[32:35], a[132:135], a[228:231], v[32:35]
 v_exp_f32 v98, v26
 v_mfma_f32_16x16x32_bf16 v[32:35], a[136:139], a[232:235], v[32:35]
 v_mfma_f32_16x16x32_bf16 v[32:35], a[140:143], a[236:239], v[32:35]
 v_exp_f32 v99, v27
 v_mfma_f32_16x16x32_bf16 v[36:39], a[156:159], a[236:239], v[56:59]
 v_cvt_pk_bf16_f32 v85, v98, v99
 v_mfma_f32_16x16x32_bf16 v[36:39], a[152:155], a[232:235], v[36:39]
 v_mfma_f32_16x16x32_bf16 v[36:39], a[148:151], a[228:231], v[36:39]
 v_mfma_f32_16x16x32_bf16 v[36:39], a[144:147], a[224:227], v[36:39]
 v_mfma_f32_16x16x32_bf16 v[104:107], v[124:127], v[80:83], 0
 s_nop 0
 v_exp_f32 v100, v32
 v_mfma_f32_16x16x32_bf16 v[108:111], v[124:127], v[84:87], 0
 v_exp_f32 v101, v33
 v_mfma_f32_16x16x32_bf16 v[44:47], a[144:147], a[240:243], v[60:63]
 ds_read_b128 a[144:147], v11 offset:4096
 v_cvt_pk_bf16_f32 v88, v100, v101
 v_mfma_f32_16x16x32_bf16 v[44:47], a[148:151], a[244:247], v[44:47]
 v_exp_f32 v102, v34
 v_mfma_f32_16x16x32_bf16 v[44:47], a[152:155], a[248:251], v[44:47]
 ds_read_b128 a[148:151], v11 offset:5120
 ds_read_b128 a[152:155], v11 offset:6144
 v_mfma_f32_16x16x32_bf16 v[44:47], a[156:159], a[252:255], v[44:47]
 v_exp_f32 v103, v35
 v_mfma_f32_16x16x32_bf16 v[40:43], a[140:143], a[252:255], v[60:63]
 v_add_f32 v105, v104, v108
 v_cmp_nge_f32 vcc, s84, v105
 v_mfma_f32_16x16x32_bf16 v[40:43], a[136:139], a[248:251], v[40:43]
 v_exp_f32 v100, v36
 v_mfma_f32_16x16x32_bf16 v[40:43], a[132:135], a[244:247], v[40:43]
 s_cbranch_vccnz L_tr18
L_ret18:
 v_cvt_pk_bf16_f32 v89, v102, v103
 v_mfma_f32_16x16x32_bf16 v[40:43], a[128:131], a[240:243], v[40:43]
 s_waitcnt lgkmcnt(3)
 v_exp_f32 v101, v37
 v_mfma_f32_16x16x32_bf16 a[0:3], a[160:163], v[80:83], a[0:3]
 ds_read_b128 a[156:159], v11 offset:7168
 v_cvt_pk_bf16_f32 v90, v100, v101
 v_mfma_f32_16x16x32_bf16 a[32:35], a[160:163], v[84:87], a[32:35]
 v_exp_f32 v102, v38
 v_mfma_f32_16x16x32_bf16 a[4:7], a[164:167], v[80:83], a[4:7]
 ds_read_b128 a[140:143], v11 offset:3072
 ds_read_b128 a[136:139], v11 offset:2048
 v_mfma_f32_16x16x32_bf16 a[36:39], a[164:167], v[84:87], a[36:39]
 v_exp_f32 v103, v39
 v_mfma_f32_16x16x32_bf16 a[8:11], a[168:171], v[80:83], a[8:11]
 ds_read_b128 a[132:135], v11 offset:1024
 v_cvt_pk_bf16_f32 v91, v102, v103
 v_mfma_f32_16x16x32_bf16 a[40:43], a[168:171], v[84:87], a[40:43]
 v_exp_f32 v100, v44
 v_mfma_f32_16x16x32_bf16 a[12:15], a[172:175], v[80:83], a[12:15]
 s_add_u32 s65, s82, 0
 ds_read_b128 a[128:131], v11 offset:0
 v_add_f32 v120, v120, v104
 v_mfma_f32_16x16x32_bf16 a[44:47], a[172:175], v[84:87], a[44:47]
 s_add_u32 m0, s63, 16896
 v_exp_f32 v101, v45
 v_mfma_f32_16x16x32_bf16 a[16:19], a[176:179], v[80:83], a[16:19]
 v_cvt_pk_bf16_f32 v94, v100, v101
 v_add_f32 v121, v121, v108
 v_mfma_f32_16x16x32_bf16 a[48:51], a[176:179], v[84:87], a[48:51]
 v_exp_f32 v102, v46
 v_mfma_f32_16x16x32_bf16 a[20:23], a[180:183], v[80:83], a[20:23]
 buffer_load_dwordx4 v4, s[48:51], s65 offen offset:0 lds
 v_mfma_f32_16x16x32_bf16 a[52:55], a[180:183], v[84:87], a[52:55]
 v_exp_f32 v103, v47
 v_mfma_f32_16x16x32_bf16 a[24:27], a[184:187], v[80:83], a[24:27]
 buffer_load_dwordx4 v5, s[48:51], s65 offen offset:1056 lds
 v_cvt_pk_bf16_f32 v95, v102, v103
 v_mfma_f32_16x16x32_bf16 a[56:59], a[184:187], v[84:87], a[56:59]
 v_exp_f32 v100, v40
 v_mfma_f32_16x16x32_bf16 a[28:31], a[188:191], v[80:83], a[28:31]
 v_mfma_f32_16x16x32_bf16 a[60:63], a[188:191], v[84:87], a[60:63]
 s_waitcnt lgkmcnt(0)
 v_exp_f32 v101, v41
 v_mfma_f32_16x16x32_bf16 v[16:19], a[128:131], a[192:195], v[48:51]
 buffer_load_dwordx4 v6, s[48:51], s65 offen offset:2112 lds
 v_cvt_pk_bf16_f32 v92, v100, v101
 v_mfma_f32_16x16x32_bf16 v[16:19], a[132:135], a[196:199], v[16:19]
 v_exp_f32 v102, v42
 v_mfma_f32_16x16x32_bf16 v[16:19], a[136:139], a[200:203], v[16:19]
 v_mfma_f32_16x16x32_bf16 v[16:19], a[140:143], a[204:207], v[16:19]
 v_exp_f32 v103, v43
 v_mfma_f32_16x16x32_bf16 v[20:23], a[156:159], a[204:207], v[48:51]
 buffer_load_dwordx4 v7, s[48:51], s65 offen offset:3168 lds
 v_cvt_pk_bf16_f32 v93, v102, v103
 v_mfma_f32_16x16x32_bf16 v[20:23], a[152:155], a[200:203], v[20:23]
 v_mfma_f32_16x16x32_bf16 v[20:23], a[148:151], a[196:199], v[20:23]
 v_mfma_f32_16x16x32_bf16 v[20:23], a[144:147], a[192:195], v[20:23]
 v_mfma_f32_16x16x32_bf16 v[104:107], v[124:127], v[88:91], 0
 v_exp_f32 v96, v16
 v_mfma_f32_16x16x32_bf16 v[108:111], v[124:127], v[92:95], 0
 v_exp_f32 v97, v17
 v_mfma_f32_16x16x32_bf16 v[28:31], a[144:147], a[208:211], v[52:55]
 v_cvt_pk_bf16_f32 v80, v96, v97
 v_mfma_f32_16x16x32_bf16 v[28:31], a[148:151], a[212:215], v[28:31]
 v_exp_f32 v98, v18
 v_mfma_f32_16x16x32_bf16 v[28:31], a[152:155], a[216:219], v[28:31]
 v_mfma_f32_16x16x32_bf16 v[28:31], a[156:159], a[220:223], v[28:31]
 v_exp_f32 v99, v19
 v_mfma_f32_16x16x32_bf16 v[24:27], a[140:143], a[220:223], v[52:55]
 v_add_f32 v105, v104, v108
 v_cmp_nge_f32 vcc, s84, v105
 v_mfma_f32_16x16x32_bf16 v[24:27], a[136:139], a[216:219], v[24:27]
 v_exp_f32 v96, v20
 v_mfma_f32_16x16x32_bf16 v[24:27], a[132:135], a[212:215], v[24:27]
 s_cbranch_vccnz L_tr19
L_ret19:
 v_cvt_pk_bf16_f32 v81, v98, v99
 v_mfma_f32_16x16x32_bf16 v[24:27], a[128:131], a[208:211], v[24:27]
 s_waitcnt vmcnt(5)
 v_exp_f32 v97, v21
 v_mfma_f32_16x16x32_bf16 a[64:67], a[160:163], v[88:91], a[64:67]
 s_barrier
 v_cvt_pk_bf16_f32 v82, v96, v97
 v_add_f32 v122, v122, v104
 v_mfma_f32_16x16x32_bf16 a[96:99], a[160:163], v[92:95], a[96:99]
 v_exp_f32 v98, v22
 v_mfma_f32_16x16x32_bf16 a[68:71], a[164:167], v[88:91], a[68:71]
 ds_read_b128 a[160:163], v11 offset:25088
 v_cmp_ne_u32 vcc, 1, v15
 v_mfma_f32_16x16x32_bf16 a[100:103], a[164:167], v[92:95], a[100:103]
 v_exp_f32 v99, v23
 v_mfma_f32_16x16x32_bf16 a[72:75], a[168:171], v[88:91], a[72:75]
 s_cbranch_vccnz L_hslow
L_hok:
 ds_read_b128 a[164:167], v11 offset:26112
 v_cvt_pk_bf16_f32 v83, v98, v99
 v_mfma_f32_16x16x32_bf16 a[104:107], a[168:171], v[92:95], a[104:107]
 v_exp_f32 v96, v28
 v_mfma_f32_16x16x32_bf16 a[76:79], a[172:175], v[88:91], a[76:79]
 ds_read_b128 a[168:171], v11 offset:27136
 v_add_f32 v123, v123, v108
 v_mfma_f32_16x16x32_bf16 a[108:111], a[172:175], v[92:95], a[108:111]
 v_exp_f32 v97, v29
 v_mfma_f32_16x16x32_bf16 a[80:83], a[176:179], v[88:91], a[80:83]
 ds_read_b128 a[172:175], v11 offset:28160
 v_cvt_pk_bf16_f32 v86, v96, v97
 v_mfma_f32_16x16x32_bf16 a[112:115], a[176:179], v[92:95], a[112:115]
 v_exp_f32 v98, v30
 v_mfma_f32_16x16x32_bf16 a[84:87], a[180:183], v[88:91], a[84:87]
 ds_read_b128 a[176:179], v11 offset:29184
 buffer_load_dwordx4 v[128:131], v253, s[28:31], s11 offen
 v_mfma_f32_16x16x32_bf16 a[116:119], a[180:183], v[92:95], a[116:119]
 v_exp_f32 v99, v31
 v_mfma_f32_16x16x32_bf16 a[88:91], a[184:187], v[88:91], a[88:91]
 ds_read_b128 a[180:183], v11 offset:30208
 v_cvt_pk_bf16_f32 v87, v98, v99
 v_mfma_f32_16x16x32_bf16 a[120:123], a[184:187], v[92:95], a[120:123]
 v_exp_f32 v96, v24
L_ic3s:
 s_cmp_eq_u32 s3, 0
 s_cbranch_scc1 L_ic3w0
 s_cmp_eq_u32 s3, 1
 s_cbranch_scc1 L_ic3w1
 s_cmp_eq_u32 s3, 2
 s_cbranch_scc1 L_ic3w2
 s_branch L_ic3w3
L_ic3r:
 v_mfma_f32_16x16x32_bf16 a[92:95], a[188:191], v[88:91], a[92:95]
 ds_read_b128 a[184:187], v11 offset:31232
 buffer_load_dwordx4 v[132:135], v253, s[28:31], s12 offen
 v_mfma_f32_16x16x32_bf16 a[124:127], a[188:191], v[92:95], a[124:127]
 v_exp_f32 v97, v25
 v_mfma_f32_16x16x32_bf16 v[32:35], a[128:131], a[224:227], v[56:59]
 ds_read_b128 a[188:191], v11 offset:32256
 v_cvt_pk_bf16_f32 v84, v96, v97
 v_mfma_f32_16x16x32_bf16 v[32:35], a[132:135], a[228:231], v[32:35]
 s_add_u32 s64, s71, 0
 buffer_load_dwordx4 v[144:147], v8, s[16:19], s64 offen offset:0
 v_exp_f32 v98, v26
 v_mfma_f32_16x16x32_bf16 v[32:35], a[136:139], a[232:235], v[32:35]
 buffer_load_dword v119, v13, s[52:55], 0 offen
 buffer_load_dwordx4 v[148:151], v8, s[16:19], s64 offen offset:1024
 v_mfma_f32_16x16x32_bf16 v[32:35], a[140:143], a[236:239], v[32:35]
 v_exp_f32 v99, v27
 v_mfma_f32_16x16x32_bf16 v[36:39], a[156:159], a[236:239], v[56:59]
 v_cvt_pk_bf16_f32 v85, v98, v99
 v_mfma_f32_16x16x32_bf16 v[36:39], a[152:155], a[232:235], v[36:39]
 v_mfma_f32_16x16x32_bf16 v[36:39], a[148:151], a[228:231], v[36:39]
 v_mfma_f32_16x16x32_bf16 v[36:39], a[144:147], a[224:227], v[36:39]
 v_mfma_f32_16x16x32_bf16 v[104:107], v[124:127], v[80:83], 0
 s_nop 0
 v_exp_f32 v100, v32
 v_mfma_f32_16x16x32_bf16 v[108:111], v[124:127], v[84:87], 0
 v_exp_f32 v101, v33
 v_mfma_f32_16x16x32_bf16 v[44:47], a[144:147], a[240:243], v[60:63]
 ds_read_b128 a[144:147], v11 offset:20992
 v_cvt_pk_bf16_f32 v88, v100, v101
 v_mfma_f32_16x16x32_bf16 v[44:47], a[148:151], a[244:247], v[44:47]
 v_exp_f32 v102, v34
 v_mfma_f32_16x16x32_bf16 v[44:47], a[152:155], a[248:251], v[44:47]
 ds_read_b128 a[148:151], v11 offset:22016
 ds_read_b128 a[152:155], v11 offset:23040
 v_mfma_f32_16x16x32_bf16 v[44:47], a[156:159], a[252:255], v[44:47]
 v_exp_f32 v103, v35
 v_mfma_f32_16x16x32_bf16 v[40:43], a[140:143], a[252:255], v[60:63]
 v_add_f32 v105, v104, v108
 v_cmp_nge_f32 vcc, s84, v105
 v_mfma_f32_16x16x32_bf16 v[40:43], a[136:139], a[248:251], v[40:43]
 v_exp_f32 v100, v36
 v_mfma_f32_16x16x32_bf16 v[40:43], a[132:135], a[244:247], v[40:43]
 s_cbranch_vccnz L_tr20
L_ret20:
 v_cvt_pk_bf16_f32 v89, v102, v103
 v_mfma_f32_16x16x32_bf16 v[40:43], a[128:131], a[240:243], v[40:43]
 s_waitcnt lgkmcnt(3)
 v_exp_f32 v101, v37
 v_mfma_f32_16x16x32_bf16 a[0:3], a[160:163], v[80:83], a[0:3]
 ds_read_b128 a[156:159], v11 offset:24064
 v_cvt_pk_bf16_f32 v90, v100, v101
 v_mfma_f32_16x16x32_bf16 a[32:35], a[160:163], v[84:87], a[32:35]
 v_exp_f32 v102, v38
 v_mfma_f32_16x16x32_bf16 a[4:7], a[164:167], v[80:83], a[4:7]
 ds_read_b128 a[140:143], v11 offset:19968
 ds_read_b128 a[136:139], v11 offset:18944
 v_mfma_f32_16x16x32_bf16 a[36:39], a[164:167], v[84:87], a[36:39]
 v_exp_f32 v103, v39
 v_mfma_f32_16x16x32_bf16 a[8:11], a[168:171], v[80:83], a[8:11]
 ds_read_b128 a[132:135], v11 offset:17920
 buffer_load_dwordx4 v[152:155], v8, s[16:19], s64 offen offset:2048
 v_cvt_pk_bf16_f32 v91, v102, v103
 v_mfma_f32_16x16x32_bf16 a[40:43], a[168:171], v[84:87], a[40:43]
 v_exp_f32 v100, v44
 v_mfma_f32_16x16x32_bf16 a[12:15], a[172:175], v[80:83], a[12:15]
 s_add_u32 s65, s82, 131072
 ds_read_b128 a[128:131], v11 offset:16896
 v_add_f32 v120, v120, v104
 v_mfma_f32_16x16x32_bf16 a[44:47], a[172:175], v[84:87], a[44:47]
 s_add_u32 m0, s63, 33792
 v_exp_f32 v101, v45
 v_mfma_f32_16x16x32_bf16 a[16:19], a[176:179], v[80:83], a[16:19]
 v_cvt_pk_bf16_f32 v94, v100, v101
 v_add_f32 v121, v121, v108
 v_mfma_f32_16x16x32_bf16 a[48:51], a[176:179], v[84:87], a[48:51]
 v_exp_f32 v102, v46
 v_mfma_f32_16x16x32_bf16 a[20:23], a[180:183], v[80:83], a[20:23]
 buffer_load_dwordx4 v4, s[48:51], s65 offen offset:0 lds
 buffer_load_dwordx4 v[156:159], v8, s[16:19], s64 offen offset:3072
 v_mfma_f32_16x16x32_bf16 a[52:55], a[180:183], v[84:87], a[52:55]
 v_exp_f32 v103, v47
 v_mfma_f32_16x16x32_bf16 a[24:27], a[184:187], v[80:83], a[24:27]
 buffer_load_dwordx4 v5, s[48:51], s65 offen offset:1056 lds
 v_cvt_pk_bf16_f32 v95, v102, v103
 v_mfma_f32_16x16x32_bf16 a[56:59], a[184:187], v[84:87], a[56:59]
 v_exp_f32 v100, v40
 v_mfma_f32_16x16x32_bf16 a[28:31], a[188:191], v[80:83], a[28:31]
 buffer_load_dwordx4 v[160:163], v240, s[16:19], s64 offen offset:0
 v_mfma_f32_16x16x32_bf16 a[60:63], a[188:191], v[84:87], a[60:63]
 s_waitcnt lgkmcnt(0)
 v_exp_f32 v101, v41
 v_mfma_f32_16x16x32_bf16 v[16:19], a[128:131], a[192:195], v[48:51]
 buffer_load_dwordx4 v6, s[48:51], s65 offen offset:2112 lds
 v_cvt_pk_bf16_f32 v92, v100, v101
 v_mfma_f32_16x16x32_bf16 v[16:19], a[132:135], a[196:199], v[16:19]
 v_exp_f32 v102, v42
 v_mfma_f32_16x16x32_bf16 v[16:19], a[136:139], a[200:203], v[16:19]
 v_mfma_f32_16x16x32_bf16 v[16:19], a[140:143], a[204:207], v[16:19]
 v_exp_f32 v103, v43
 v_mfma_f32_16x16x32_bf16 v[20:23], a[156:159], a[204:207], v[48:51]
 buffer_load_dwordx4 v7, s[48:51], s65 offen offset:3168 lds
 v_cvt_pk_bf16_f32 v93, v102, v103
 v_mfma_f32_16x16x32_bf16 v[20:23], a[152:155], a[200:203], v[20:23]
 v_mfma_f32_16x16x32_bf16 v[20:23], a[148:151], a[196:199], v[20:23]
 v_mfma_f32_16x16x32_bf16 v[20:23], a[144:147], a[192:195], v[20:23]
 v_mfma_f32_16x16x32_bf16 v[104:107], v[124:127], v[88:91], 0
 v_exp_f32 v96, v16
 v_mfma_f32_16x16x32_bf16 v[108:111], v[124:127], v[92:95], 0
 v_exp_f32 v97, v17
 v_mfma_f32_16x16x32_bf16 v[28:31], a[144:147], a[208:211], v[52:55]
 buffer_load_dwordx4 v[164:167], v240, s[16:19], s64 offen offset:1024
 v_cvt_pk_bf16_f32 v80, v96, v97
 v_mfma_f32_16x16x32_bf16 v[28:31], a[148:151], a[212:215], v[28:31]
 v_exp_f32 v98, v18
 v_mfma_f32_16x16x32_bf16 v[28:31], a[152:155], a[216:219], v[28:31]
 v_mfma_f32_16x16x32_bf16 v[28:31], a[156:159], a[220:223], v[28:31]
 v_exp_f32 v99, v19
 v_mfma_f32_16x16x32_bf16 v[24:27], a[140:143], a[220:223], v[52:55]
 v_add_f32 v105, v104, v108
 v_cmp_nge_f32 vcc, s84, v105
 v_mfma_f32_16x16x32_bf16 v[24:27], a[136:139], a[216:219], v[24:27]
 v_exp_f32 v96, v20
 v_mfma_f32_16x16x32_bf16 v[24:27], a[132:135], a[212:215], v[24:27]
 s_cbranch_vccnz L_tr21
L_ret21:
 v_cvt_pk_bf16_f32 v81, v98, v99
 v_mfma_f32_16x16x32_bf16 v[24:27], a[128:131], a[208:211], v[24:27]
 v_exp_f32 v97, v21
 v_mfma_f32_16x16x32_bf16 a[64:67], a[160:163], v[88:91], a[64:67]
 v_cvt_pk_bf16_f32 v82, v96, v97
 v_add_f32 v122, v122, v104
 v_mfma_f32_16x16x32_bf16 a[96:99], a[160:163], v[92:95], a[96:99]
 v_exp_f32 v98, v22
 v_mfma_f32_16x16x32_bf16 a[68:71], a[164:167], v[88:91], a[68:71]
 ds_read_b128 a[160:163], v11 offset:41984
 v_add_f32 v123, v123, v108
 v_mfma_f32_16x16x32_bf16 a[100:103], a[164:167], v[92:95], a[100:103]
 v_exp_f32 v99, v23
 v_mfma_f32_16x16x32_bf16 a[72:75], a[168:171], v[88:91], a[72:75]
 ds_read_b128 a[164:167], v11 offset:43008
 v_cvt_pk_bf16_f32 v83, v98, v99
 v_mfma_f32_16x16x32_bf16 a[104:107], a[168:171], v[92:95], a[104:107]
 v_exp_f32 v96, v28
 v_mfma_f32_16x16x32_bf16 a[76:79], a[172:175], v[88:91], a[76:79]
 ds_read_b128 a[168:171], v11 offset:44032
 buffer_load_dwordx4 v[136:139], v253, s[28:31], s13 offen
 v_mfma_f32_16x16x32_bf16 a[108:111], a[172:175], v[92:95], a[108:111]
 v_exp_f32 v97, v29
 v_mfma_f32_16x16x32_bf16 a[80:83], a[176:179], v[88:91], a[80:83]
 ds_read_b128 a[172:175], v11 offset:45056
 v_cvt_pk_bf16_f32 v86, v96, v97
 v_mfma_f32_16x16x32_bf16 a[112:115], a[176:179], v[92:95], a[112:115]
 v_exp_f32 v98, v30
 v_mfma_f32_16x16x32_bf16 a[84:87], a[180:183], v[88:91], a[84:87]
 ds_read_b128 a[176:179], v11 offset:46080
 buffer_load_dwordx4 v[168:171], v240, s[16:19], s64 offen offset:2048
 v_mfma_f32_16x16x32_bf16 a[116:119], a[180:183], v[92:95], a[116:119]
 v_exp_f32 v99, v31
 v_mfma_f32_16x16x32_bf16 a[88:91], a[184:187], v[88:91], a[88:91]
 ds_read_b128 a[180:183], v11 offset:47104
 v_cvt_pk_bf16_f32 v87, v98, v99
 v_mfma_f32_16x16x32_bf16 a[120:123], a[184:187], v[92:95], a[120:123]
 v_exp_f32 v96, v24
 v_mfma_f32_16x16x32_bf16 a[92:95], a[188:191], v[88:91], a[92:95]
 ds_read_b128 a[184:187], v11 offset:48128
 buffer_load_dwordx4 v[140:143], v253, s[28:31], s14 offen
 v_mfma_f32_16x16x32_bf16 a[124:127], a[188:191], v[92:95], a[124:127]
 v_exp_f32 v97, v25
 v_mfma_f32_16x16x32_bf16 v[32:35], a[128:131], a[224:227], v[56:59]
 ds_read_b128 a[188:191], v11 offset:49152
 v_cvt_pk_bf16_f32 v84, v96, v97
 v_mfma_f32_16x16x32_bf16 v[32:35], a[132:135], a[228:231], v[32:35]
 v_exp_f32 v98, v26
 v_mfma_f32_16x16x32_bf16 v[32:35], a[136:139], a[232:235], v[32:35]
 buffer_load_dwordx4 v[172:175], v240, s[16:19], s64 offen offset:3072
 v_mfma_f32_16x16x32_bf16 v[32:35], a[140:143], a[236:239], v[32:35]
 v_exp_f32 v99, v27
 v_mfma_f32_16x16x32_bf16 v[36:39], a[156:159], a[236:239], v[56:59]
 v_cvt_pk_bf16_f32 v85, v98, v99
 v_mfma_f32_16x16x32_bf16 v[36:39], a[152:155], a[232:235], v[36:39]
 v_mfma_f32_16x16x32_bf16 v[36:39], a[148:151], a[228:231], v[36:39]
 v_mfma_f32_16x16x32_bf16 v[36:39], a[144:147], a[224:227], v[36:39]
 v_mfma_f32_16x16x32_bf16 v[104:107], v[124:127], v[80:83], 0
 s_nop 0
 v_exp_f32 v100, v32
 v_mfma_f32_16x16x32_bf16 v[108:111], v[124:127], v[84:87], 0
 v_exp_f32 v101, v33
 v_mfma_f32_16x16x32_bf16 v[44:47], a[144:147], a[240:243], v[60:63]
 ds_read_b128 a[144:147], v11 offset:37888
 v_cvt_pk_bf16_f32 v88, v100, v101
 v_mfma_f32_16x16x32_bf16 v[44:47], a[148:151], a[244:247], v[44:47]
 v_exp_f32 v102, v34
 v_mfma_f32_16x16x32_bf16 v[44:47], a[152:155], a[248:251], v[44:47]
 ds_read_b128 a[148:151], v11 offset:38912
 ds_read_b128 a[152:155], v11 offset:39936
 v_mfma_f32_16x16x32_bf16 v[44:47], a[156:159], a[252:255], v[44:47]
 v_exp_f32 v103, v35
 v_mfma_f32_16x16x32_bf16 v[40:43], a[140:143], a[252:255], v[60:63]
 v_add_f32 v105, v104, v108
 v_cmp_nge_f32 vcc, s84, v105
 v_mfma_f32_16x16x32_bf16 v[40:43], a[136:139], a[248:251], v[40:43]
 v_exp_f32 v100, v36
 v_mfma_f32_16x16x32_bf16 v[40:43], a[132:135], a[244:247], v[40:43]
 s_cbranch_vccnz L_tr22
L_ret22:
 v_cvt_pk_bf16_f32 v89, v102, v103
 v_mfma_f32_16x16x32_bf16 v[40:43], a[128:131], a[240:243], v[40:43]
 s_waitcnt lgkmcnt(3)
 v_exp_f32 v101, v37
 v_mfma_f32_16x16x32_bf16 a[0:3], a[160:163], v[80:83], a[0:3]
 ds_read_b128 a[156:159], v11 offset:40960
 v_cvt_pk_bf16_f32 v90, v100, v101
 v_mfma_f32_16x16x32_bf16 a[32:35], a[160:163], v[84:87], a[32:35]
 v_exp_f32 v102, v38
 v_mfma_f32_16x16x32_bf16 a[4:7], a[164:167], v[80:83], a[4:7]
 ds_read_b128 a[140:143], v11 offset:36864
 ds_read_b128 a[136:139], v11 offset:35840
 s_add_u32 s64, s71, 8192
 buffer_load_dwordx4 v[176:179], v8, s[16:19], s64 offen offset:0
 v_mfma_f32_16x16x32_bf16 a[36:39], a[164:167], v[84:87], a[36:39]
 v_exp_f32 v103, v39
 v_mfma_f32_16x16x32_bf16 a[8:11], a[168:171], v[80:83], a[8:11]
 ds_read_b128 a[132:135], v11 offset:34816
 v_cvt_pk_bf16_f32 v91, v102, v103
 v_mfma_f32_16x16x32_bf16 a[40:43], a[168:171], v[84:87], a[40:43]
 v_exp_f32 v100, v44
 v_mfma_f32_16x16x32_bf16 a[12:15], a[172:175], v[80:83], a[12:15]
 s_add_u32 s65, s82, 262144
 ds_read_b128 a[128:131], v11 offset:33792
 v_add_f32 v120, v120, v104
 v_mfma_f32_16x16x32_bf16 a[44:47], a[172:175], v[84:87], a[44:47]
 s_add_u32 m0, s63, 50688
 v_exp_f32 v101, v45
 v_mfma_f32_16x16x32_bf16 a[16:19], a[176:179], v[80:83], a[16:19]
 v_cvt_pk_bf16_f32 v94, v100, v101
 v_add_f32 v121, v121, v108
 v_mfma_f32_16x16x32_bf16 a[48:51], a[176:179], v[84:87], a[48:51]
 v_exp_f32 v102, v46
 v_mfma_f32_16x16x32_bf16 a[20:23], a[180:183], v[80:83], a[20:23]
 buffer_load_dwordx4 v4, s[48:51], s65 offen offset:0 lds
 buffer_load_dwordx4 v[180:183], v8, s[16:19], s64 offen offset:1024
 v_mfma_f32_16x16x32_bf16 a[52:55], a[180:183], v[84:87], a[52:55]
 v_exp_f32 v103, v47
 v_mfma_f32_16x16x32_bf16 a[24:27], a[184:187], v[80:83], a[24:27]
 buffer_load_dwordx4 v5, s[48:51], s65 offen offset:1056 lds
 v_cvt_pk_bf16_f32 v95, v102, v103
 v_mfma_f32_16x16x32_bf16 a[56:59], a[184:187], v[84:87], a[56:59]
 v_exp_f32 v100, v40
 v_mfma_f32_16x16x32_bf16 a[28:31], a[188:191], v[80:83], a[28:31]
 buffer_load_dwordx4 v[184:187], v8, s[16:19], s64 offen offset:2048
 v_mfma_f32_16x16x32_bf16 a[60:63], a[188:191], v[84:87], a[60:63]
 s_waitcnt lgkmcnt(0)
 v_exp_f32 v101, v41
 v_mfma_f32_16x16x32_bf16 v[16:19], a[128:131], a[192:195], v[48:51]
 buffer_load_dwordx4 v6, s[48:51], s65 offen offset:2112 lds
 v_cvt_pk_bf16_f32 v92, v100, v101
 v_mfma_f32_16x16x32_bf16 v[16:19], a[132:135], a[196:199], v[16:19]
 v_exp_f32 v102, v42
 v_mfma_f32_16x16x32_bf16 v[16:19], a[136:139], a[200:203], v[16:19]
 v_mfma_f32_16x16x32_bf16 v[16:19], a[140:143], a[204:207], v[16:19]
 v_exp_f32 v103, v43
 v_mfma_f32_16x16x32_bf16 v[20:23], a[156:159], a[204:207], v[48:51]
 buffer_load_dwordx4 v7, s[48:51], s65 offen offset:3168 lds
 v_cvt_pk_bf16_f32 v93, v102, v103
 v_mfma_f32_16x16x32_bf16 v[20:23], a[152:155], a[200:203], v[20:23]
 v_mfma_f32_16x16x32_bf16 v[20:23], a[148:151], a[196:199], v[20:23]
 buffer_load_dwordx4 v[188:191], v8, s[16:19], s64 offen offset:3072
 v_mfma_f32_16x16x32_bf16 v[20:23], a[144:147], a[192:195], v[20:23]
 v_mfma_f32_16x16x32_bf16 v[104:107], v[124:127], v[88:91], 0
 v_exp_f32 v96, v16
 v_mfma_f32_16x16x32_bf16 v[108:111], v[124:127], v[92:95], 0
 v_exp_f32 v97, v17
 v_mfma_f32_16x16x32_bf16 v[28:31], a[144:147], a[208:211], v[52:55]
 v_cvt_pk_bf16_f32 v80, v96, v97
 v_mfma_f32_16x16x32_bf16 v[28:31], a[148:151], a[212:215], v[28:31]
 v_exp_f32 v98, v18
 v_mfma_f32_16x16x32_bf16 v[28:31], a[152:155], a[216:219], v[28:31]
 v_mfma_f32_16x16x32_bf16 v[28:31], a[156:159], a[220:223], v[28:31]
 v_exp_f32 v99, v19
 v_mfma_f32_16x16x32_bf16 v[24:27], a[140:143], a[220:223], v[52:55]
 v_add_f32 v105, v104, v108
 v_cmp_nge_f32 vcc, s84, v105
 v_mfma_f32_16x16x32_bf16 v[24:27], a[136:139], a[216:219], v[24:27]
 v_exp_f32 v96, v20
 v_mfma_f32_16x16x32_bf16 v[24:27], a[132:135], a[212:215], v[24:27]
 s_cbranch_vccnz L_tr23
L_ret23:
 v_cvt_pk_bf16_f32 v81, v98, v99
 v_mfma_f32_16x16x32_bf16 v[24:27], a[128:131], a[208:211], v[24:27]
 s_waitcnt vmcnt(35)
 v_exp_f32 v97, v21
 v_mfma_f32_16x16x32_bf16 a[64:67], a[160:163], v[88:91], a[64:67]
 s_barrier
 v_cvt_pk_bf16_f32 v82, v96, v97
 v_add_f32 v122, v122, v104
 v_mfma_f32_16x16x32_bf16 a[96:99], a[160:163], v[92:95], a[96:99]
 v_exp_f32 v98, v22
 v_mfma_f32_16x16x32_bf16 a[68:71], a[164:167], v[88:91], a[68:71]
 ds_read_b128 a[160:163], v12 offset:8192
 v_add_f32 v123, v123, v108
 v_mfma_f32_16x16x32_bf16 a[100:103], a[164:167], v[92:95], a[100:103]
 v_exp_f32 v99, v23
 v_mfma_f32_16x16x32_bf16 a[72:75], a[168:171], v[88:91], a[72:75]
 ds_read_b128 a[164:167], v12 offset:9216
 v_cvt_pk_bf16_f32 v83, v98, v99
 v_mfma_f32_16x16x32_bf16 a[104:107], a[168:171], v[92:95], a[104:107]
 v_exp_f32 v96, v28
 v_mfma_f32_16x16x32_bf16 a[76:79], a[172:175], v[88:91], a[76:79]
 ds_read_b128 a[168:171], v12 offset:10240
 buffer_load_dwordx4 v[192:195], v240, s[16:19], s64 offen offset:0
 v_mfma_f32_16x16x32_bf16 a[108:111], a[172:175], v[92:95], a[108:111]
 v_exp_f32 v97, v29
 v_mfma_f32_16x16x32_bf16 a[80:83], a[176:179], v[88:91], a[80:83]
 ds_read_b128 a[172:175], v12 offset:11264
 v_cvt_pk_bf16_f32 v86, v96, v97
 v_mfma_f32_16x16x32_bf16 a[112:115], a[176:179], v[92:95], a[112:115]
 v_exp_f32 v98, v30
 v_mfma_f32_16x16x32_bf16 a[84:87], a[180:183], v[88:91], a[84:87]
 ds_read_b128 a[176:179], v12 offset:12288
 buffer_load_dwordx4 v[196:199], v240, s[16:19], s64 offen offset:1024
 v_mfma_f32_16x16x32_bf16 a[116:119], a[180:183], v[92:95], a[116:119]
 v_exp_f32 v99, v31
 v_mfma_f32_16x16x32_bf16 a[88:91], a[184:187], v[88:91], a[88:91]
 ds_read_b128 a[180:183], v12 offset:13312
 v_cvt_pk_bf16_f32 v87, v98, v99
 v_mfma_f32_16x16x32_bf16 a[120:123], a[184:187], v[92:95], a[120:123]
 v_exp_f32 v96, v24
 v_mfma_f32_16x16x32_bf16 a[92:95], a[188:191], v[88:91], a[92:95]
 ds_read_b128 a[184:187], v12 offset:14336
 v_mfma_f32_16x16x32_bf16 a[124:127], a[188:191], v[92:95], a[124:127]
 v_exp_f32 v97, v25
 v_mfma_f32_16x16x32_bf16 v[32:35], a[128:131], a[224:227], v[56:59]
 ds_read_b128 a[188:191], v12 offset:15360
 v_cvt_pk_bf16_f32 v84, v96, v97
 v_mfma_f32_16x16x32_bf16 v[32:35], a[132:135], a[228:231], v[32:35]
 v_exp_f32 v98, v26
 v_mfma_f32_16x16x32_bf16 v[32:35], a[136:139], a[232:235], v[32:35]
 v_mfma_f32_16x16x32_bf16 v[32:35], a[140:143], a[236:239], v[32:35]
 v_exp_f32 v99, v27
 v_mfma_f32_16x16x32_bf16 v[36:39], a[156:159], a[236:239], v[56:59]
 v_cvt_pk_bf16_f32 v85, v98, v99
 v_mfma_f32_16x16x32_bf16 v[36:39], a[152:155], a[232:235], v[36:39]
 buffer_load_dwordx4 v[200:203], v240, s[16:19], s64 offen offset:2048
 v_mfma_f32_16x16x32_bf16 v[36:39], a[148:151], a[228:231], v[36:39]
 v_mfma_f32_16x16x32_bf16 v[36:39], a[144:147], a[224:227], v[36:39]
 v_mfma_f32_16x16x32_bf16 v[104:107], v[124:127], v[80:83], 0
 v_exp_f32 v100, v32
 v_mfma_f32_16x16x32_bf16 v[108:111], v[124:127], v[84:87], 0
 v_exp_f32 v101, v33
 v_mfma_f32_16x16x32_bf16 v[44:47], a[144:147], a[240:243], v[60:63]
 ds_read_b128 a[144:147], v12 offset:4096
 v_cvt_pk_bf16_f32 v88, v100, v101
 v_mfma_f32_16x16x32_bf16 v[44:47], a[148:151], a[244:247], v[44:47]
 v_exp_f32 v102, v34
 v_mfma_f32_16x16x32_bf16 v[44:47], a[152:155], a[248:251], v[44:47]
 ds_read_b128 a[148:151], v12 offset:5120
 ds_read_b128 a[152:155], v12 offset:6144
 v_mfma_f32_16x16x32_bf16 v[44:47], a[156:159], a[252:255], v[44:47]
 v_exp_f32 v103, v35
 v_mfma_f32_16x16x32_bf16 v[40:43], a[140:143], a[252:255], v[60:63]
 v_add_f32 v105, v104, v108
 v_cmp_nge_f32 vcc, s84, v105
 v_mfma_f32_16x16x32_bf16 v[40:43], a[136:139], a[248:251], v[40:43]
 v_exp_f32 v100, v36
 v_mfma_f32_16x16x32_bf16 v[40:43], a[132:135], a[244:247], v[40:43]
 s_cbranch_vccnz L_tr24
L_ret24:
 v_cvt_pk_bf16_f32 v89, v102, v103
 v_mfma_f32_16x16x32_bf16 v[40:43], a[128:131], a[240:243], v[40:43]
 s_waitcnt lgkmcnt(3)
 v_exp_f32 v101, v37
 v_mfma_f32_16x16x32_bf16 a[0:3], a[160:163], v[80:83], a[0:3]
 ds_read_b128 a[156:159], v12 offset:7168
 v_cvt_pk_bf16_f32 v90, v100, v101
 v_mfma_f32_16x16x32_bf16 a[32:35], a[160:163], v[84:87], a[32:35]
 s_branch L_pg12k
L_pg12:
L_ic2w2:
 s_branch L_ic2r
L_pg12k:
 v_exp_f32 v102, v38
 v_mfma_f32_16x16x32_bf16 a[4:7], a[164:167], v[80:83], a[4:7]
 ds_read_b128 a[140:143], v12 offset:3072
 ds_read_b128 a[136:139], v12 offset:2048
 v_mfma_f32_16x16x32_bf16 a[36:39], a[164:167], v[84:87], a[36:39]
 v_exp_f32 v103, v39
 v_mfma_f32_16x16x32_bf16 a[8:11], a[168:171], v[80:83], a[8:11]
 ds_read_b128 a[132:135], v12 offset:1024
 v_cvt_pk_bf16_f32 v91, v102, v103
 v_mfma_f32_16x16x32_bf16 a[40:43], a[168:171], v[84:87], a[40:43]
 v_exp_f32 v100, v44
 v_mfma_f32_16x16x32_bf16 a[12:15], a[172:175], v[80:83], a[12:15]
 s_add_u32 s65, s82, 393216
 ds_read_b128 a[128:131], v12 offset:0
 v_add_f32 v120, v120, v104
 v_mfma_f32_16x16x32_bf16 a[44:47], a[172:175], v[84:87], a[44:47]
 s_add_u32 m0, s63, 67584
 v_exp_f32 v101, v45
 v_mfma_f32_16x16x32_bf16 a[16:19], a[176:179], v[80:83], a[16:19]
 v_cvt_pk_bf16_f32 v94, v100, v101
 v_add_f32 v121, v121, v108
 v_mfma_f32_16x16x32_bf16 a[48:51], a[176:179], v[84:87], a[48:51]
 v_exp_f32 v102, v46
 v_mfma_f32_16x16x32_bf16 a[20:23], a[180:183], v[80:83], a[20:23]
 buffer_load_dwordx4 v4, s[48:51], s65 offen offset:0 lds
 buffer_load_dwordx4 v[204:207], v240, s[16:19], s64 offen offset:3072
 v_mfma_f32_16x16x32_bf16 a[52:55], a[180:183], v[84:87], a[52:55]
 v_exp_f32 v103, v47
 v_mfma_f32_16x16x32_bf16 a[24:27], a[184:187], v[80:83], a[24:27]
 buffer_load_dwordx4 v5, s[48:51], s65 offen offset:1056 lds
 v_cvt_pk_bf16_f32 v95, v102, v103
 v_mfma_f32_16x16x32_bf16 a[56:59], a[184:187], v[84:87], a[56:59]
 v_exp_f32 v100, v40
 v_mfma_f32_16x16x32_bf16 a[28:31], a[188:191], v[80:83], a[28:31]
 s_add_u32 s64, s71, 16384
 buffer_load_dwordx4 v[208:211], v8, s[16:19], s64 offen offset:0
 v_mfma_f32_16x16x32_bf16 a[60:63], a[188:191], v[84:87], a[60:63]
 s_waitcnt lgkmcnt(0)
 v_exp_f32 v101, v41
 v_mfma_f32_16x16x32_bf16 v[16:19], a[128:131], a[192:195], v[48:51]
 buffer_load_dwordx4 v6, s[48:51], s65 offen offset:2112 lds
 v_cvt_pk_bf16_f32 v92, v100, v101
 v_mfma_f32_16x16x32_bf16 v[16:19], a[132:135], a[196:199], v[16:19]
 v_exp_f32 v102, v42
 v_mfma_f32_16x16x32_bf16 v[16:19], a[136:139], a[200:203], v[16:19]
 v_mfma_f32_16x16x32_bf16 v[16:19], a[140:143], a[204:207], v[16:19]
 v_exp_f32 v103, v43
 v_mfma_f32_16x16x32_bf16 v[20:23], a[156:159], a[204:207], v[48:51]
 buffer_load_dwordx4 v7, s[48:51], s65 offen offset:3168 lds
 v_cvt_pk_bf16_f32 v93, v102, v103
 v_mfma_f32_16x16x32_bf16 v[20:23], a[152:155], a[200:203], v[20:23]
 buffer_load_dwordx4 v[212:215], v8, s[16:19], s64 offen offset:1024
 v_mfma_f32_16x16x32_bf16 v[20:23], a[148:151], a[196:199], v[20:23]
 v_mfma_f32_16x16x32_bf16 v[20:23], a[144:147], a[192:195], v[20:23]
 v_mfma_f32_16x16x32_bf16 v[104:107], v[124:127], v[88:91], 0
 v_exp_f32 v96, v16
 v_mfma_f32_16x16x32_bf16 v[108:111], v[124:127], v[92:95], 0
 v_exp_f32 v97, v17
 v_mfma_f32_16x16x32_bf16 v[28:31], a[144:147], a[208:211], v[52:55]
 v_cvt_pk_bf16_f32 v80, v96, v97
 v_mfma_f32_16x16x32_bf16 v[28:31], a[148:151], a[212:215], v[28:31]
 v_exp_f32 v98, v18
 v_mfma_f32_16x16x32_bf16 v[28:31], a[152:155], a[216:219], v[28:31]
 v_mfma_f32_16x16x32_bf16 v[28:31], a[156:159], a[220:223], v[28:31]
 v_exp_f32 v99, v19
 v_mfma_f32_16x16x32_bf16 v[24:27], a[140:143], a[220:223], v[52:55]
 v_add_f32 v105, v104, v108
 v_cmp_nge_f32 vcc, s84, v105
 v_mfma_f32_16x16x32_bf16 v[24:27], a[136:139], a[216:219], v[24:27]
 v_exp_f32 v96, v20
 v_mfma_f32_16x16x32_bf16 v[24:27], a[132:135], a[212:215], v[24:27]
 s_cbranch_vccnz L_tr25
L_ret25:
 v_cvt_pk_bf16_f32 v81, v98, v99
 v_mfma_f32_16x16x32_bf16 v[24:27], a[128:131], a[208:211], v[24:27]
 v_exp_f32 v97, v21
 v_mfma_f32_16x16x32_bf16 a[64:67], a[160:163], v[88:91], a[64:67]
 v_cvt_pk_bf16_f32 v82, v96, v97
 v_add_f32 v122, v122, v104
 v_mfma_f32_16x16x32_bf16 a[96:99], a[160:163], v[92:95], a[96:99]
 v_exp_f32 v98, v22
 v_mfma_f32_16x16x32_bf16 a[68:71], a[164:167], v[88:91], a[68:71]
 ds_read_b128 a[160:163], v12 offset:25088
 v_add_f32 v123, v123, v108
 v_mfma_f32_16x16x32_bf16 a[100:103], a[164:167], v[92:95], a[100:103]
 v_exp_f32 v99, v23
 v_mfma_f32_16x16x32_bf16 a[72:75], a[168:171], v[88:91], a[72:75]
 ds_read_b128 a[164:167], v12 offset:26112
 v_cvt_pk_bf16_f32 v83, v98, v99
 v_mfma_f32_16x16x32_bf16 a[104:107], a[168:171], v[92:95], a[104:107]
 v_exp_f32 v96, v28
 v_mfma_f32_16x16x32_bf16 a[76:79], a[172:175], v[88:91], a[76:79]
 ds_read_b128 a[168:171], v12 offset:27136
 buffer_load_dwordx4 v[216:219], v8, s[16:19], s64 offen offset:2048
 v_mfma_f32_16x16x32_bf16 a[108:111], a[172:175], v[92:95], a[108:111]
 v_exp_f32 v97, v29
 v_mfma_f32_16x16x32_bf16 a[80:83], a[176:179], v[88:91], a[80:83]
 ds_read_b128 a[172:175], v12 offset:28160
 v_cvt_pk_bf16_f32 v86, v96, v97
 v_mfma_f32_16x16x32_bf16 a[112:115], a[176:179], v[92:95], a[112:115]
 v_exp_f32 v98, v30
 v_mfma_f32_16x16x32_bf16 a[84:87], a[180:183], v[88:91], a[84:87]
 ds_read_b128 a[176:179], v12 offset:29184
 buffer_load_dwordx4 v[220:223], v8, s[16:19], s64 offen offset:3072
 v_mfma_f32_16x16x32_bf16 a[116:119], a[180:183], v[92:95], a[116:119]
 v_exp_f32 v99, v31
 v_mfma_f32_16x16x32_bf16 a[88:91], a[184:187], v[88:91], a[88:91]
 ds_read_b128 a[180:183], v12 offset:30208
 v_cvt_pk_bf16_f32 v87, v98, v99
 v_mfma_f32_16x16x32_bf16 a[120:123], a[184:187], v[92:95], a[120:123]
 v_exp_f32 v96, v24
 v_mfma_f32_16x16x32_bf16 a[92:95], a[188:191], v[88:91], a[92:95]
 ds_read_b128 a[184:187], v12 offset:31232
 v_mfma_f32_16x16x32_bf16 a[124:127], a[188:191], v[92:95], a[124:127]
 v_exp_f32 v97, v25
 v_mfma_f32_16x16x32_bf16 v[32:35], a[128:131], a[224:227], v[56:59]
 ds_read_b128 a[188:191], v12 offset:32256
 v_cvt_pk_bf16_f32 v84, v96, v97
 v_mfma_f32_16x16x32_bf16 v[32:35], a[132:135], a[228:231], v[32:35]
 v_exp_f32 v98, v26
 v_mfma_f32_16x16x32_bf16 v[32:35], a[136:139], a[232:235], v[32:35]
 buffer_load_dwordx4 v[224:227], v240, s[16:19], s64 offen offset:0
 v_mfma_f32_16x16x32_bf16 v[32:35], a[140:143], a[236:239], v[32:35]
 v_exp_f32 v99, v27
 v_mfma_f32_16x16x32_bf16 v[36:39], a[156:159], a[236:239], v[56:59]
 v_cvt_pk_bf16_f32 v85, v98, v99
 v_mfma_f32_16x16x32_bf16 v[36:39], a[152:155], a[232:235], v[36:39]
 v_mfma_f32_16x16x32_bf16 v[36:39], a[148:151], a[228:231], v[36:39]
 v_mfma_f32_16x16x32_bf16 v[36:39], a[144:147], a[224:227], v[36:39]
 v_mfma_f32_16x16x32_bf16 v[104:107], v[124:127], v[80:83], 0
 s_nop 0
 v_exp_f32 v100, v32
 v_mfma_f32_16x16x32_bf16 v[108:111], v[124:127], v[84:87], 0
 v_exp_f32 v101, v33
 v_mfma_f32_16x16x32_bf16 v[44:47], a[144:147], a[240:243], v[60:63]
 ds_read_b128 a[144:147], v12 offset:20992
 v_cvt_pk_bf16_f32 v88, v100, v101
 v_mfma_f32_16x16x32_bf16 v[44:47], a[148:151], a[244:247], v[44:47]
 v_exp_f32 v102, v34
 v_mfma_f32_16x16x32_bf16 v[44:47], a[152:155], a[248:251], v[44:47]
 ds_read_b128 a[148:151], v12 offset:22016
 ds_read_b128 a[152:155], v12 offset:23040
 v_mfma_f32_16x16x32_bf16 v[44:47], a[156:159], a[252:255], v[44:47]
 v_exp_f32 v103, v35
 v_mfma_f32_16x16x32_bf16 v[40:43], a[140:143], a[252:255], v[60:63]
 v_add_f32 v105, v104, v108
 v_cmp_nge_f32 vcc, s84, v105
 v_mfma_f32_16x16x32_bf16 v[40:43], a[136:139], a[248:251], v[40:43]
 v_exp_f32 v100, v36
 v_mfma_f32_16x16x32_bf16 v[40:43], a[132:135], a[244:247], v[40:43]
 s_cbranch_vccnz L_tr26
L_ret26:
 v_cvt_pk_bf16_f32 v89, v102, v103
 v_mfma_f32_16x16x32_bf16 v[40:43], a[128:131], a[240:243], v[40:43]
 s_waitcnt lgkmcnt(3)
 v_exp_f32 v101, v37
 v_mfma_f32_16x16x32_bf16 a[0:3], a[160:163], v[80:83], a[0:3]
 ds_read_b128 a[156:159], v12 offset:24064
 v_cvt_pk_bf16_f32 v90, v100, v101
 v_mfma_f32_16x16x32_bf16 a[32:35], a[160:163], v[84:87], a[32:35]
 v_exp_f32 v102, v38
 v_mfma_f32_16x16x32_bf16 a[4:7], a[164:167], v[80:83], a[4:7]
 ds_read_b128 a[140:143], v12 offset:19968
 ds_read_b128 a[136:139], v12 offset:18944
 v_mfma_f32_16x16x32_bf16 a[36:39], a[164:167], v[84:87], a[36:39]
 v_exp_f32 v103, v39
 v_mfma_f32_16x16x32_bf16 a[8:11], a[168:171], v[80:83], a[8:11]
 ds_read_b128 a[132:135], v12 offset:17920
 v_cvt_pk_bf16_f32 v91, v102, v103
 v_mfma_f32_16x16x32_bf16 a[40:43], a[168:171], v[84:87], a[40:43]
 v_exp_f32 v100, v44
 v_mfma_f32_16x16x32_bf16 a[12:15], a[172:175], v[80:83], a[12:15]
 s_add_u32 s65, s82, 524288
 ds_read_b128 a[128:131], v12 offset:16896
 v_add_f32 v120, v120, v104
 v_mfma_f32_16x16x32_bf16 a[44:47], a[172:175], v[84:87], a[44:47]
 s_add_u32 m0, s63, 84480
 buffer_load_dwordx4 v[228:231], v240, s[16:19], s64 offen offset:1024
 v_exp_f32 v101, v45
 v_mfma_f32_16x16x32_bf16 a[16:19], a[176:179], v[80:83], a[16:19]
 v_cvt_pk_bf16_f32 v94, v100, v101
 v_add_f32 v121, v121, v108
 v_mfma_f32_16x16x32_bf16 a[48:51], a[176:179], v[84:87], a[48:51]
 v_exp_f32 v102, v46
 v_mfma_f32_16x16x32_bf16 a[20:23], a[180:183], v[80:83], a[20:23]
 buffer_load_dwordx4 v4, s[48:51], s65 offen offset:0 lds
 buffer_load_dwordx4 v[232:235], v240, s[16:19], s64 offen offset:2048
 v_mfma_f32_16x16x32_bf16 a[52:55], a[180:183], v[84:87], a[52:55]
 v_exp_f32 v103, v47
 v_mfma_f32_16x16x32_bf16 a[24:27], a[184:187], v[80:83], a[24:27]
 buffer_load_dwordx4 v5, s[48:51], s65 offen offset:1056 lds
 v_cvt_pk_bf16_f32 v95, v102, v103
 v_mfma_f32_16x16x32_bf16 a[56:59], a[184:187], v[84:87], a[56:59]
 v_exp_f32 v100, v40
 v_mfma_f32_16x16x32_bf16 a[28:31], a[188:191], v[80:83], a[28:31]
 v_mfma_f32_16x16x32_bf16 a[60:63], a[188:191], v[84:87], a[60:63]
 s_waitcnt lgkmcnt(0)
 v_exp_f32 v101, v41
 v_mfma_f32_16x16x32_bf16 v[16:19], a[128:131], a[192:195], v[48:51]
 buffer_load_dwordx4 v6, s[48:51], s65 offen offset:2112 lds
 v_cvt_pk_bf16_f32 v92, v100, v101
 v_mfma_f32_16x16x32_bf16 v[16:19], a[132:135], a[196:199], v[16:19]
 v_exp_f32 v102, v42
 v_mfma_f32_16x16x32_bf16 v[16:19], a[136:139], a[200:203], v[16:19]
 buffer_load_dwordx4 v[236:239], v240, s[16:19], s64 offen offset:3072
 v_mfma_f32_16x16x32_bf16 v[16:19], a[140:143], a[204:207], v[16:19]
 v_exp_f32 v103, v43
 v_mfma_f32_16x16x32_bf16 v[20:23], a[156:159], a[204:207], v[48:51]
 buffer_load_dwordx4 v7, s[48:51], s65 offen offset:3168 lds
 v_cvt_pk_bf16_f32 v93, v102, v103
 v_mfma_f32_16x16x32_bf16 v[20:23], a[152:155], a[200:203], v[20:23]
 v_mfma_f32_16x16x32_bf16 v[20:23], a[148:151], a[196:199], v[20:23]
 v_mfma_f32_16x16x32_bf16 v[20:23], a[144:147], a[192:195], v[20:23]
 v_mfma_f32_16x16x32_bf16 v[104:107], v[124:127], v[88:91], 0
 v_exp_f32 v96, v16
 v_mfma_f32_16x16x32_bf16 v[108:111], v[124:127], v[92:95], 0
 v_exp_f32 v97, v17
 v_mfma_f32_16x16x32_bf16 v[28:31], a[144:147], a[208:211], v[52:55]
 v_cvt_pk_bf16_f32 v80, v96, v97
 v_mfma_f32_16x16x32_bf16 v[28:31], a[148:151], a[212:215], v[28:31]
 v_exp_f32 v98, v18
 v_mfma_f32_16x16x32_bf16 v[28:31], a[152:155], a[216:219], v[28:31]
 v_mfma_f32_16x16x32_bf16 v[28:31], a[156:159], a[220:223], v[28:31]
 v_exp_f32 v99, v19
 v_mfma_f32_16x16x32_bf16 v[24:27], a[140:143], a[220:223], v[52:55]
 v_add_f32 v105, v104, v108
 v_cmp_nge_f32 vcc, s84, v105
 v_mfma_f32_16x16x32_bf16 v[24:27], a[136:139], a[216:219], v[24:27]
 v_exp_f32 v96, v20
 v_mfma_f32_16x16x32_bf16 v[24:27], a[132:135], a[212:215], v[24:27]
 s_cbranch_vccnz L_tr27
L_ret27:
 v_cvt_pk_bf16_f32 v81, v98, v99
 v_mfma_f32_16x16x32_bf16 v[24:27], a[128:131], a[208:211], v[24:27]
 s_waitcnt vmcnt(29)
 v_exp_f32 v97, v21
 v_mfma_f32_16x16x32_bf16 a[64:67], a[160:163], v[88:91], a[64:67]
 s_barrier
 v_cvt_pk_bf16_f32 v82, v96, v97
 v_add_f32 v122, v122, v104
 v_mfma_f32_16x16x32_bf16 a[96:99], a[160:163], v[92:95], a[96:99]
 s_add_u32 s65, s82, 655360
 v_exp_f32 v98, v22
 v_mfma_f32_16x16x32_bf16 a[68:71], a[164:167], v[88:91], a[68:71]
 s_add_u32 m0, s63, 101376
 ds_read_b128 a[160:163], v8 offset:8192
 v_add_f32 v123, v123, v108
 v_mfma_f32_16x16x32_bf16 a[100:103], a[164:167], v[92:95], a[100:103]
 v_exp_f32 v99, v23
 v_mfma_f32_16x16x32_bf16 a[72:75], a[168:171], v[88:91], a[72:75]
 ds_read_b128 a[164:167], v8 offset:9216
 v_cvt_pk_bf16_f32 v83, v98, v99
 v_mfma_f32_16x16x32_bf16 a[104:107], a[168:171], v[92:95], a[104:107]
 v_exp_f32 v96, v28
 v_mfma_f32_16x16x32_bf16 a[76:79], a[172:175], v[88:91], a[76:79]
 ds_read_b128 a[168:171], v8 offset:10240
 buffer_load_dwordx4 v4, s[48:51], s65 offen offset:0 lds
 v_mfma_f32_16x16x32_bf16 a[108:111], a[172:175], v[92:95], a[108:111]
 v_exp_f32 v97, v29
 v_mfma_f32_16x16x32_bf16 a[80:83], a[176:179], v[88:91], a[80:83]
 ds_read_b128 a[172:175], v8 offset:11264
 v_cvt_pk_bf16_f32 v86, v96, v97
 v_mfma_f32_16x16x32_bf16 a[112:115], a[176:179], v[92:95], a[112:115]
 v_exp_f32 v98, v30
 v_mfma_f32_16x16x32_bf16 a[84:87], a[180:183], v[88:91], a[84:87]
 ds_read_b128 a[176:179], v8 offset:12288
 buffer_load_dwordx4 v5, s[48:51], s65 offen offset:1056 lds
 v_mfma_f32_16x16x32_bf16 a[116:119], a[180:183], v[92:95], a[116:119]
 v_exp_f32 v99, v31
 v_mfma_f32_16x16x32_bf16 a[88:91], a[184:187], v[88:91], a[88:91]
 ds_read_b128 a[180:183], v8 offset:13312
 v_cvt_pk_bf16_f32 v87, v98, v99
 v_mfma_f32_16x16x32_bf16 a[120:123], a[184:187], v[92:95], a[120:123]
 v_exp_f32 v96, v24
 v_mfma_f32_16x16x32_bf16 a[92:95], a[188:191], v[88:91], a[92:95]
 ds_read_b128 a[184:187], v8 offset:14336
 buffer_load_dwordx4 v6, s[48:51], s65 offen offset:2112 lds
 s_add_u32 s64, s71, 24576
 buffer_load_dwordx4 a[192:195], v8, s[16:19], s64 offen offset:0
 v_mfma_f32_16x16x32_bf16 a[124:127], a[188:191], v[92:95], a[124:127]
 buffer_load_dwordx4 v7, s[48:51], s65 offen offset:3168 lds
 v_exp_f32 v97, v25
 v_mfma_f32_16x16x32_bf16 v[32:35], a[128:131], a[224:227], v[56:59]
 s_add_u32 s65, s82, 786432
 ds_read_b128 a[188:191], v8 offset:15360
 v_cvt_pk_bf16_f32 v84, v96, v97
 v_mfma_f32_16x16x32_bf16 v[32:35], a[132:135], a[228:231], v[32:35]
 s_add_u32 m0, s63, 118272
 v_exp_f32 v98, v26
 v_mfma_f32_16x16x32_bf16 v[32:35], a[136:139], a[232:235], v[32:35]
 buffer_load_dwordx4 v4, s[48:51], s65 offen offset:0 lds
 buffer_load_dwordx4 a[196:199], v8, s[16:19], s64 offen offset:1024
 v_mfma_f32_16x16x32_bf16 v[32:35], a[140:143], a[236:239], v[32:35]
 v_exp_f32 v99, v27
 v_mfma_f32_16x16x32_bf16 v[36:39], a[156:159], a[236:239], v[56:59]
 buffer_load_dwordx4 v5, s[48:51], s65 offen offset:1056 lds
 v_cvt_pk_bf16_f32 v85, v98, v99
 v_mfma_f32_16x16x32_bf16 v[36:39], a[152:155], a[232:235], v[36:39]
 buffer_load_dwordx4 a[200:203], v8, s[16:19], s64 offen offset:2048
 buffer_load_dwordx4 a[204:207], v8, s[16:19], s64 offen offset:3072
 v_mfma_f32_16x16x32_bf16 v[36:39], a[148:151], a[228:231], v[36:39]
 buffer_load_dwordx4 v6, s[48:51], s65 offen offset:2112 lds
 buffer_load_dwordx4 a[208:211], v240, s[16:19], s64 offen offset:0
 v_mfma_f32_16x16x32_bf16 v[36:39], a[144:147], a[224:227], v[36:39]
 v_exp_f32 v100, v32
 v_mfma_f32_16x16x32_bf16 v[104:107], v[124:127], v[80:83], 0
 buffer_load_dwordx4 v7, s[48:51], s65 offen offset:3168 lds
 buffer_load_dwordx4 a[212:215], v240, s[16:19], s64 offen offset:1024
 v_mfma_f32_16x16x32_bf16 v[108:111], v[124:127], v[84:87], 0
 v_exp_f32 v101, v33
 v_mfma_f32_16x16x32_bf16 v[44:47], a[144:147], a[240:243], v[60:63]
 v_exp_f32 v102, v34
 v_mfma_f32_16x16x32_bf16 v[44:47], a[148:151], a[244:247], v[44:47]
 v_exp_f32 v103, v35
 v_mfma_f32_16x16x32_bf16 v[44:47], a[152:155], a[248:251], v[44:47]
 v_cvt_pk_bf16_f32 v88, v100, v101
 v_cvt_pk_bf16_f32 v89, v102, v103
 v_mfma_f32_16x16x32_bf16 v[44:47], a[156:159], a[252:255], v[44:47]
 v_exp_f32 v100, v36
 v_mfma_f32_16x16x32_bf16 v[40:43], a[140:143], a[252:255], v[60:63]
 v_add_f32 v105, v104, v108
 v_cmp_nge_f32 vcc, s84, v105
 v_mfma_f32_16x16x32_bf16 v[40:43], a[136:139], a[248:251], v[40:43]
 v_exp_f32 v101, v37
 v_mfma_f32_16x16x32_bf16 v[40:43], a[132:135], a[244:247], v[40:43]
 s_cbranch_vccnz L_tr28
L_ret28:
 v_add_f32 v120, v120, v104
 v_mfma_f32_16x16x32_bf16 v[40:43], a[128:131], a[240:243], v[40:43]
 s_waitcnt lgkmcnt(0)
 v_add_f32 v121, v121, v108
 v_mfma_f32_16x16x32_bf16 a[0:3], a[160:163], v[80:83], a[0:3]
 v_exp_f32 v102, v38
 v_mfma_f32_16x16x32_bf16 a[32:35], a[160:163], v[84:87], a[32:35]
 v_exp_f32 v103, v39
 v_mfma_f32_16x16x32_bf16 a[4:7], a[164:167], v[80:83], a[4:7]
 buffer_load_dwordx4 a[216:219], v240, s[16:19], s64 offen offset:2048
 v_cvt_pk_bf16_f32 v90, v100, v101
 v_cvt_pk_bf16_f32 v91, v102, v103
 v_mfma_f32_16x16x32_bf16 a[36:39], a[164:167], v[84:87], a[36:39]
 v_exp_f32 v100, v44
 v_mfma_f32_16x16x32_bf16 a[8:11], a[168:171], v[80:83], a[8:11]
 v_exp_f32 v101, v45
 v_mfma_f32_16x16x32_bf16 a[40:43], a[168:171], v[84:87], a[40:43]
 v_exp_f32 v102, v46
 v_mfma_f32_16x16x32_bf16 a[12:15], a[172:175], v[80:83], a[12:15]
 v_exp_f32 v103, v47
 v_mfma_f32_16x16x32_bf16 a[44:47], a[172:175], v[84:87], a[44:47]
 v_cvt_pk_bf16_f32 v94, v100, v101
 v_cvt_pk_bf16_f32 v95, v102, v103
 v_mfma_f32_16x16x32_bf16 a[16:19], a[176:179], v[80:83], a[16:19]
 v_exp_f32 v100, v40
 v_exp_f32 v101, v41
 v_exp_f32 v102, v42
 v_exp_f32 v103, v43
 v_cvt_pk_bf16_f32 v92, v100, v101
 v_cvt_pk_bf16_f32 v93, v102, v103
 v_mfma_f32_16x16x32_bf16 a[48:51], a[176:179], v[84:87], a[48:51]
 buffer_load_dwordx4 a[220:223], v240, s[16:19], s64 offen offset:3072
 v_mfma_f32_16x16x32_bf16 v[104:107], v[124:127], v[88:91], 0
 s_add_u32 s64, s71, 32768
 buffer_load_dwordx4 a[224:227], v8, s[16:19], s64 offen offset:0
 buffer_load_dwordx4 a[228:231], v8, s[16:19], s64 offen offset:1024
 v_mfma_f32_16x16x32_bf16 v[108:111], v[124:127], v[92:95], 0
 v_permlane16_swap_b32 v128, v130
 v_mfma_f32_16x16x32_bf16 a[20:23], a[180:183], v[80:83], a[20:23]
 buffer_load_dwordx4 a[232:235], v8, s[16:19], s64 offen offset:2048
 v_mfma_f32_16x16x32_bf16 a[52:55], a[180:183], v[84:87], a[52:55]
 v_permlane16_swap_b32 v129, v131
 v_mfma_f32_16x16x32_bf16 a[24:27], a[184:187], v[80:83], a[24:27]
 buffer_load_dwordx4 a[236:239], v8, s[16:19], s64 offen offset:3072
 v_mfma_f32_16x16x32_bf16 a[56:59], a[184:187], v[84:87], a[56:59]
 v_add_f32 v105, v104, v108
 v_cmp_nge_f32 vcc, s84, v105
 v_mfma_f32_16x16x32_bf16 a[28:31], a[188:191], v[80:83], a[28:31]
 buffer_load_dwordx4 a[240:243], v240, s[16:19], s64 offen offset:0
 v_mfma_f32_16x16x32_bf16 a[60:63], a[188:191], v[84:87], a[60:63]
 s_cbranch_vccnz L_tr29
L_ret29:
 v_add_f32 v122, v122, v104
 v_mfma_f32_16x16x32_bf16 a[64:67], a[160:163], v[88:91], a[64:67]
 buffer_load_dwordx4 a[244:247], v240, s[16:19], s64 offen offset:1024
 v_add_f32 v123, v123, v108
 v_permlane16_swap_b32 v132, v134
 v_permlane16_swap_b32 v133, v135
 v_permlane16_swap_b32 v136, v138
 v_permlane16_swap_b32 v137, v139
 v_permlane16_swap_b32 v140, v142
 v_permlane16_swap_b32 v141, v143
 v_mfma_f32_16x16x32_bf16 a[96:99], a[160:163], v[92:95], a[96:99]
 ds_read_b64_tr_b16 a[160:161], v9 offset:16896
 v_mfma_f32_16x16x32_bf16 a[68:71], a[164:167], v[88:91], a[68:71]
 ds_read_b64_tr_b16 a[162:163], v9 offset:17152
 buffer_load_dwordx4 a[248:251], v240, s[16:19], s64 offen offset:2048
 v_mfma_f32_16x16x32_bf16 a[100:103], a[164:167], v[92:95], a[100:103]
 ds_read_b64_tr_b16 a[164:165], v9 offset:25344
 v_mfma_f32_16x16x32_bf16 a[72:75], a[168:171], v[88:91], a[72:75]
 ds_read_b64_tr_b16 a[166:167], v9 offset:25600
 buffer_load_dwordx4 a[252:255], v240, s[16:19], s64 offen offset:3072
 v_mfma_f32_16x16x32_bf16 a[104:107], a[168:171], v[92:95], a[104:107]
 ds_read_b64_tr_b16 a[168:169], v9 offset:16928
 v_mfma_f32_16x16x32_bf16 a[76:79], a[172:175], v[88:91], a[76:79]
 ds_read_b64_tr_b16 a[170:171], v9 offset:17184
 v_mfma_f32_16x16x32_bf16 a[108:111], a[172:175], v[92:95], a[108:111]
 ds_read_b64_tr_b16 a[172:173], v9 offset:25376
 v_mfma_f32_16x16x32_bf16 a[80:83], a[176:179], v[88:91], a[80:83]
 ds_read_b64_tr_b16 a[174:175], v9 offset:25632
 v_mfma_f32_16x16x32_bf16 a[112:115], a[176:179], v[92:95], a[112:115]
 s_add_u32 s64, s71, 40960
 buffer_load_dwordx4 a[128:131], v8, s[16:19], s64 offen offset:0
 buffer_load_dwordx4 a[132:135], v8, s[16:19], s64 offen offset:1024
 v_mfma_f32_16x16x32_bf16 a[84:87], a[180:183], v[88:91], a[84:87]
 buffer_load_dwordx4 a[136:139], v8, s[16:19], s64 offen offset:2048
 v_mfma_f32_16x16x32_bf16 a[116:119], a[180:183], v[92:95], a[116:119]
 v_rcp_f32 v11, v120
 v_mfma_f32_16x16x32_bf16 a[88:91], a[184:187], v[88:91], a[88:91]
 buffer_load_dwordx4 a[140:143], v8, s[16:19], s64 offen offset:3072
 v_mfma_f32_16x16x32_bf16 a[120:123], a[184:187], v[92:95], a[120:123]
 v_rcp_f32 v12, v121
 v_mfma_f32_16x16x32_bf16 a[92:95], a[188:191], v[88:91], a[92:95]
 buffer_load_dwordx4 a[144:147], v240, s[16:19], s64 offen offset:0
 v_accvgpr_read_b32 v241, a0
 v_mfma_f32_16x16x32_bf16 a[124:127], a[188:191], v[92:95], a[124:127]
 v_accvgpr_read_b32 v242, a1
L_p2:
 s_waitcnt vmcnt(57) lgkmcnt(4)
 v_mfma_f32_16x16x32_bf16 v[16:19], a[160:163], v[144:147], 0
 ds_read_b64_tr_b16 a[176:177], v9 offset:16960
 buffer_load_dwordx4 a[148:151], v240, s[16:19], s64 offen offset:1024
 v_mfma_f32_16x16x32_bf16 v[16:19], a[164:167], v[160:163], v[16:19]
 ds_read_b64_tr_b16 a[178:179], v9 offset:17216
 v_accvgpr_read_b32 v243, a2
 v_mfma_f32_16x16x32_bf16 v[20:23], a[164:167], v[164:167], 0
 buffer_load_dwordx4 a[152:155], v240, s[16:19], s64 offen offset:2048
 v_accvgpr_read_b32 v249, a3
 v_mfma_f32_16x16x32_bf16 v[20:23], a[160:163], v[148:151], v[20:23]
 v_mul_f32 v241, v11, v241
 v_mul_f32 v242, v11, v242
 v_mfma_f32_16x16x32_bf16 v[24:27], a[160:163], v[152:155], 0
 ds_read_b64_tr_b16 a[180:181], v9 offset:25408
 buffer_load_dwordx4 a[156:159], v240, s[16:19], s64 offen offset:3072
 v_mfma_f32_16x16x32_bf16 v[24:27], a[164:167], v[168:171], v[24:27]
 ds_read_b64_tr_b16 a[182:183], v9 offset:25664
 v_cvt_pk_bf16_f32 v244, v241, v242
 v_mfma_f32_16x16x32_bf16 v[28:31], a[164:167], v[172:175], 0
 v_accvgpr_read_b32 v241, a4
 v_accvgpr_read_b32 v242, a5
 v_mfma_f32_16x16x32_bf16 v[28:31], a[160:163], v[156:159], v[28:31]
 s_waitcnt lgkmcnt(4)
 v_mul_f32 v243, v11, v243
 v_mul_f32 v249, v11, v249
 v_mfma_f32_16x16x32_bf16 v[44:47], a[168:171], v[156:159], 0
 ds_read_b64_tr_b16 a[184:185], v9 offset:16992
 v_cvt_pk_bf16_f32 v245, v243, v249
 v_mfma_f32_16x16x32_bf16 v[44:47], a[172:175], v[172:175], v[44:47]
 ds_read_b64_tr_b16 a[186:187], v9 offset:17248
 v_accvgpr_read_b32 v243, a6
 v_mfma_f32_16x16x32_bf16 v[40:43], a[172:175], v[168:171], 0
 v_accvgpr_read_b32 v249, a7
 v_mul_f32 v241, v11, v241
 v_mfma_f32_16x16x32_bf16 v[40:43], a[168:171], v[152:155], v[40:43]
 v_mul_f32 v242, v11, v242
 v_cvt_pk_bf16_f32 v246, v241, v242
 v_mfma_f32_16x16x32_bf16 v[36:39], a[168:171], v[148:151], 0
 ds_read_b64_tr_b16 a[188:189], v9 offset:25440
 v_accvgpr_read_b32 v241, a8
 v_mfma_f32_16x16x32_bf16 v[36:39], a[172:175], v[164:167], v[36:39]
 ds_read_b64_tr_b16 a[190:191], v9 offset:25696
 v_accvgpr_read_b32 v242, a9
 v_mfma_f32_16x16x32_bf16 v[32:35], a[172:175], v[160:163], 0
 v_mul_f32 v243, v11, v243
 v_mul_f32 v249, v11, v249
 v_mfma_f32_16x16x32_bf16 v[32:35], a[168:171], v[144:147], v[32:35]
 s_waitcnt lgkmcnt(4)
 v_cvt_pk_bf16_f32 v247, v243, v249
 v_mfma_f32_16x16x32_bf16 v[48:51], a[176:179], v[144:147], 0
 s_add_u32 s89, s25, 0
 buffer_store_dwordx4 v[244:247], v8, s[16:19], s89 offen offset:0 sc0 sc1
 ds_read_b64_tr_b16 a[160:161], v9 offset:17024
 v_mfma_f32_16x16x32_bf16 v[48:51], a[180:183], v[160:163], v[48:51]
 ds_read_b64_tr_b16 a[162:163], v9 offset:17280
 v_accvgpr_read_b32 v243, a10
 v_mfma_f32_16x16x32_bf16 v[52:55], a[180:183], v[164:167], 0
 v_accvgpr_read_b32 v249, a11
 v_mul_f32 v241, v11, v241
 v_mfma_f32_16x16x32_bf16 v[52:55], a[176:179], v[148:151], v[52:55]
 v_mul_f32 v242, v11, v242
 v_cvt_pk_bf16_f32 v244, v241, v242
 v_mfma_f32_16x16x32_bf16 v[56:59], a[176:179], v[152:155], 0
 ds_read_b64_tr_b16 a[164:165], v9 offset:25472
 v_accvgpr_read_b32 v241, a12
 v_mfma_f32_16x16x32_bf16 v[56:59], a[180:183], v[168:171], v[56:59]
 ds_read_b64_tr_b16 a[166:167], v9 offset:25728
 v_accvgpr_read_b32 v242, a13
 v_mfma_f32_16x16x32_bf16 v[60:63], a[180:183], v[172:175], 0
 v_mul_f32 v243, v11, v243
 v_mul_f32 v249, v11, v249
 v_mfma_f32_16x16x32_bf16 v[60:63], a[176:179], v[156:159], v[60:63]
 s_waitcnt lgkmcnt(4)
 v_cvt_pk_bf16_f32 v245, v243, v249
 v_accvgpr_read_b32 v243, a14
 v_mfma_f32_16x16x32_bf16 v[76:79], a[184:187], v[156:159], 0
 ds_read_b64_tr_b16 a[168:169], v9 offset:17056
 v_accvgpr_read_b32 v249, a15
 v_mfma_f32_16x16x32_bf16 v[76:79], a[188:191], v[172:175], v[76:79]
 ds_read_b64_tr_b16 a[170:171], v9 offset:17312
 v_mul_f32 v241, v11, v241
 v_mfma_f32_16x16x32_bf16 v[72:75], a[188:191], v[168:171], 0
 v_mul_f32 v242, v11, v242
 v_cvt_pk_bf16_f32 v246, v241, v242
 v_mfma_f32_16x16x32_bf16 v[72:75], a[184:187], v[152:155], v[72:75]
 v_mul_f32 v243, v11, v243
 v_mul_f32 v249, v11, v249
 v_mfma_f32_16x16x32_bf16 v[68:71], a[184:187], v[148:151], 0
 ds_read_b64_tr_b16 a[172:173], v9 offset:25504
 v_cvt_pk_bf16_f32 v247, v243, v249
 v_mfma_f32_16x16x32_bf16 v[68:71], a[188:191], v[164:167], v[68:71]
 s_add_u32 s89, s25, 4096
 buffer_store_dwordx4 v[244:247], v8, s[16:19], s89 offen offset:0 sc0 sc1
 ds_read_b64_tr_b16 a[174:175], v9 offset:25760
 v_mfma_f32_16x16x32_bf16 v[64:67], a[188:191], v[160:163], 0
 v_rcp_f32 v13, v122
 v_mfma_f32_16x16x32_bf16 v[64:67], a[184:187], v[144:147], v[64:67]
 s_waitcnt lgkmcnt(4)
 v_rcp_f32 v248, v123
 v_mfma_f32_16x16x32_bf16 v[80:83], a[160:163], v[144:147], 0
 ds_read_b64_tr_b16 a[176:177], v9 offset:17088
 v_accvgpr_write_b32 a0, v128
 v_mfma_f32_16x16x32_bf16 v[80:83], a[164:167], v[160:163], v[80:83]
 ds_read_b64_tr_b16 a[178:179], v9 offset:17344
 v_accvgpr_write_b32 a1, v129
 v_mfma_f32_16x16x32_bf16 v[84:87], a[164:167], v[164:167], 0
 v_accvgpr_write_b32 a2, v130
 v_accvgpr_write_b32 a3, v131
 v_mfma_f32_16x16x32_bf16 v[84:87], a[160:163], v[148:151], v[84:87]
 v_accvgpr_write_b32 a4, v132
 v_accvgpr_write_b32 a5, v133
 v_mfma_f32_16x16x32_bf16 v[88:91], a[160:163], v[152:155], 0
 ds_read_b64_tr_b16 a[180:181], v9 offset:25536
 v_accvgpr_write_b32 a6, v134
 v_mfma_f32_16x16x32_bf16 v[88:91], a[164:167], v[168:171], v[88:91]
 ds_read_b64_tr_b16 a[182:183], v9 offset:25792
 v_accvgpr_write_b32 a7, v135
 v_mfma_f32_16x16x32_bf16 v[92:95], a[164:167], v[172:175], 0
 v_accvgpr_write_b32 a8, v136
 v_accvgpr_write_b32 a9, v137
 v_mfma_f32_16x16x32_bf16 v[92:95], a[160:163], v[156:159], v[92:95]
 s_waitcnt lgkmcnt(4)
 v_accvgpr_write_b32 a10, v138
 v_accvgpr_write_b32 a11, v139
 v_mfma_f32_16x16x32_bf16 v[108:111], a[168:171], v[156:159], 0
 ds_read_b64_tr_b16 a[184:185], v9 offset:17120
 v_accvgpr_write_b32 a12, v140
 v_mfma_f32_16x16x32_bf16 v[108:111], a[172:175], v[172:175], v[108:111]
 ds_read_b64_tr_b16 a[186:187], v9 offset:17376
 v_accvgpr_write_b32 a13, v141
 v_mfma_f32_16x16x32_bf16 v[104:107], a[172:175], v[168:171], 0
 v_accvgpr_write_b32 a14, v142
 v_accvgpr_write_b32 a15, v143
 v_mfma_f32_16x16x32_bf16 v[104:107], a[168:171], v[152:155], v[104:107]
 v_accvgpr_read_b32 v241, a16
 v_accvgpr_read_b32 v242, a17
 v_mfma_f32_16x16x32_bf16 v[100:103], a[168:171], v[148:151], 0
 ds_read_b64_tr_b16 a[188:189], v9 offset:25568
 v_accvgpr_read_b32 v243, a18
 v_mfma_f32_16x16x32_bf16 v[100:103], a[172:175], v[164:167], v[100:103]
 ds_read_b64_tr_b16 a[190:191], v9 offset:25824
 v_accvgpr_read_b32 v249, a19
 v_mfma_f32_16x16x32_bf16 v[96:99], a[172:175], v[160:163], 0
 v_mul_f32 v241, v11, v241
 v_mul_f32 v242, v11, v242
 v_mfma_f32_16x16x32_bf16 v[96:99], a[168:171], v[144:147], v[96:99]
 s_waitcnt lgkmcnt(4)
 v_cvt_pk_bf16_f32 v244, v241, v242
 v_accvgpr_read_b32 v241, a20
 v_mfma_f32_16x16x32_bf16 v[112:115], a[176:179], v[144:147], 0
 ds_read_b64_tr_b16 a[160:161], v9 offset:33792
 v_accvgpr_read_b32 v242, a21
 v_mfma_f32_16x16x32_bf16 v[112:115], a[180:183], v[160:163], v[112:115]
 ds_read_b64_tr_b16 a[162:163], v9 offset:34048
 v_mul_f32 v243, v11, v243
 v_mfma_f32_16x16x32_bf16 v[116:119], a[180:183], v[164:167], 0
 v_mul_f32 v249, v11, v249
 v_cvt_pk_bf16_f32 v245, v243, v249
 v_mfma_f32_16x16x32_bf16 v[116:119], a[176:179], v[148:151], v[116:119]
 v_accvgpr_read_b32 v243, a22
 v_accvgpr_read_b32 v249, a23
 v_mfma_f32_16x16x32_bf16 v[120:123], a[176:179], v[152:155], 0
 ds_read_b64_tr_b16 a[164:165], v9 offset:42240
 v_mul_f32 v241, v11, v241
 v_mfma_f32_16x16x32_bf16 v[120:123], a[180:183], v[168:171], v[120:123]
 s_branch L_pg13k
L_pg13:
L_ic2w1:
 s_branch L_ic2r
L_pg13k:
 ds_read_b64_tr_b16 a[166:167], v9 offset:42496
 v_mul_f32 v242, v11, v242
 v_mfma_f32_16x16x32_bf16 v[124:127], a[180:183], v[172:175], 0
 v_cvt_pk_bf16_f32 v246, v241, v242
 v_accvgpr_read_b32 v241, a24
 v_mfma_f32_16x16x32_bf16 v[124:127], a[176:179], v[156:159], v[124:127]
 s_add_u32 s65, s82, 917504
 v_accvgpr_read_b32 v242, a25
 s_waitcnt lgkmcnt(4)
 v_mfma_f32_16x16x32_bf16 v[140:143], a[184:187], v[156:159], 0
 ds_read_b64_tr_b16 a[168:169], v9 offset:33824
 v_mul_f32 v243, v11, v243
 v_mfma_f32_16x16x32_bf16 v[140:143], a[188:191], v[172:175], v[140:143]
 ds_read_b64_tr_b16 a[170:171], v9 offset:34080
 v_mul_f32 v249, v11, v249
 v_mfma_f32_16x16x32_bf16 v[136:139], a[188:191], v[168:171], 0
 v_cvt_pk_bf16_f32 v247, v243, v249
 v_mfma_f32_16x16x32_bf16 v[136:139], a[184:187], v[152:155], v[136:139]
 s_add_u32 s89, s25, 8192
 buffer_store_dwordx4 v[244:247], v8, s[16:19], s89 offen offset:0 sc0 sc1
 v_accvgpr_read_b32 v243, a26
 v_mfma_f32_16x16x32_bf16 v[132:135], a[184:187], v[148:151], 0
 ds_read_b64_tr_b16 a[172:173], v9 offset:42272
 v_accvgpr_read_b32 v249, a27
 v_mfma_f32_16x16x32_bf16 v[132:135], a[188:191], v[164:167], v[132:135]
 ds_read_b64_tr_b16 a[174:175], v9 offset:42528
 v_mul_f32 v241, v11, v241
 v_mfma_f32_16x16x32_bf16 v[128:131], a[188:191], v[160:163], 0
 v_mul_f32 v242, v11, v242
 v_cvt_pk_bf16_f32 v244, v241, v242
 v_mfma_f32_16x16x32_bf16 v[128:131], a[184:187], v[144:147], v[128:131]
 s_waitcnt vmcnt(50) lgkmcnt(4)
 v_accvgpr_read_b32 v241, a28
 v_accvgpr_read_b32 v242, a29
 v_mfma_f32_16x16x32_bf16 v[16:19], a[160:163], v[176:179], v[16:19]
 ds_read_b64_tr_b16 a[176:177], v9 offset:33856
 v_mul_f32 v243, v11, v243
 v_mfma_f32_16x16x32_bf16 v[16:19], a[164:167], v[192:195], v[16:19]
 ds_read_b64_tr_b16 a[178:179], v9 offset:34112
 v_mul_f32 v249, v11, v249
 v_mfma_f32_16x16x32_bf16 v[20:23], a[164:167], v[196:199], v[20:23]
 v_cvt_pk_bf16_f32 v245, v243, v249
 v_accvgpr_read_b32 v243, a30
 v_mfma_f32_16x16x32_bf16 v[20:23], a[160:163], v[180:183], v[20:23]
 s_add_u32 m0, s63, 0
 v_accvgpr_read_b32 v249, a31
 v_mul_f32 v241, v11, v241
 v_mfma_f32_16x16x32_bf16 v[24:27], a[160:163], v[184:187], v[24:27]
 ds_read_b64_tr_b16 a[180:181], v9 offset:42304
 v_mul_f32 v242, v11, v242
 v_mfma_f32_16x16x32_bf16 v[24:27], a[164:167], v[200:203], v[24:27]
 ds_read_b64_tr_b16 a[182:183], v9 offset:42560
 v_cvt_pk_bf16_f32 v246, v241, v242
 v_mfma_f32_16x16x32_bf16 v[28:31], a[164:167], v[204:207], v[28:31]
 v_mul_f32 v243, v11, v243
 v_mul_f32 v249, v11, v249
 v_mfma_f32_16x16x32_bf16 v[28:31], a[160:163], v[188:191], v[28:31]
 s_waitcnt lgkmcnt(4)
 v_cvt_pk_bf16_f32 v247, v243, v249
 v_mfma_f32_16x16x32_bf16 v[44:47], a[168:171], v[188:191], v[44:47]
 s_add_u32 s89, s25, 12288
 buffer_store_dwordx4 v[244:247], v8, s[16:19], s89 offen offset:0 sc0 sc1
 ds_read_b64_tr_b16 a[184:185], v9 offset:33888
 v_mfma_f32_16x16x32_bf16 v[44:47], a[172:175], v[204:207], v[44:47]
 ds_read_b64_tr_b16 a[186:187], v9 offset:34144
 v_accvgpr_read_b32 v241, a32
 v_mfma_f32_16x16x32_bf16 v[40:43], a[172:175], v[200:203], v[40:43]
 v_accvgpr_read_b32 v242, a33
 v_accvgpr_read_b32 v243, a34
 v_mfma_f32_16x16x32_bf16 v[40:43], a[168:171], v[184:187], v[40:43]
 v_accvgpr_read_b32 v249, a35
 v_mul_f32 v241, v12, v241
 v_mfma_f32_16x16x32_bf16 v[36:39], a[168:171], v[180:183], v[36:39]
 ds_read_b64_tr_b16 a[188:189], v9 offset:42336
 v_mul_f32 v242, v12, v242
 v_mfma_f32_16x16x32_bf16 v[36:39], a[172:175], v[196:199], v[36:39]
 ds_read_b64_tr_b16 a[190:191], v9 offset:42592
 v_cvt_pk_bf16_f32 v244, v241, v242
 v_mfma_f32_16x16x32_bf16 v[32:35], a[172:175], v[192:195], v[32:35]
 v_accvgpr_read_b32 v241, a36
 v_accvgpr_read_b32 v242, a37
 v_mfma_f32_16x16x32_bf16 v[32:35], a[168:171], v[176:179], v[32:35]
 s_waitcnt lgkmcnt(4)
 v_mul_f32 v243, v12, v243
 v_mul_f32 v249, v12, v249
 v_mfma_f32_16x16x32_bf16 v[48:51], a[176:179], v[176:179], v[48:51]
 ds_read_b64_tr_b16 a[160:161], v9 offset:33920
 v_cvt_pk_bf16_f32 v245, v243, v249
 v_mfma_f32_16x16x32_bf16 v[48:51], a[180:183], v[192:195], v[48:51]
 ds_read_b64_tr_b16 a[162:163], v9 offset:34176
 v_accvgpr_read_b32 v243, a38
 v_mfma_f32_16x16x32_bf16 v[52:55], a[180:183], v[196:199], v[52:55]
 v_accvgpr_read_b32 v249, a39
 v_mul_f32 v241, v12, v241
 v_mfma_f32_16x16x32_bf16 v[52:55], a[176:179], v[180:183], v[52:55]
 v_mul_f32 v242, v12, v242
 v_cvt_pk_bf16_f32 v246, v241, v242
 v_mfma_f32_16x16x32_bf16 v[56:59], a[176:179], v[184:187], v[56:59]
 ds_read_b64_tr_b16 a[164:165], v9 offset:42368
 v_accvgpr_read_b32 v241, a40
 v_mfma_f32_16x16x32_bf16 v[56:59], a[180:183], v[200:203], v[56:59]
 ds_read_b64_tr_b16 a[166:167], v9 offset:42624
 v_accvgpr_read_b32 v242, a41
 v_mfma_f32_16x16x32_bf16 v[60:63], a[180:183], v[204:207], v[60:63]
 v_mul_f32 v243, v12, v243
 v_mul_f32 v249, v12, v249
 v_mfma_f32_16x16x32_bf16 v[60:63], a[176:179], v[188:191], v[60:63]
 s_waitcnt lgkmcnt(4)
 v_cvt_pk_bf16_f32 v247, v243, v249
 v_mfma_f32_16x16x32_bf16 v[76:79], a[184:187], v[188:191], v[76:79]
 s_add_u32 s89, s25, 0
 buffer_store_dwordx4 v[244:247], v8, s[16:19], s89 offen offset:1024 sc0 sc1
 ds_read_b64_tr_b16 a[168:169], v9 offset:33952
 v_mfma_f32_16x16x32_bf16 v[76:79], a[188:191], v[204:207], v[76:79]
 ds_read_b64_tr_b16 a[170:171], v9 offset:34208
 v_accvgpr_read_b32 v243, a42
 v_mfma_f32_16x16x32_bf16 v[72:75], a[188:191], v[200:203], v[72:75]
 v_accvgpr_read_b32 v249, a43
 v_mul_f32 v241, v12, v241
 v_mfma_f32_16x16x32_bf16 v[72:75], a[184:187], v[184:187], v[72:75]
 v_mul_f32 v242, v12, v242
 v_cvt_pk_bf16_f32 v244, v241, v242
 v_mfma_f32_16x16x32_bf16 v[68:71], a[184:187], v[180:183], v[68:71]
 ds_read_b64_tr_b16 a[172:173], v9 offset:42400
 v_accvgpr_read_b32 v241, a44
 v_mfma_f32_16x16x32_bf16 v[68:71], a[188:191], v[196:199], v[68:71]
 ds_read_b64_tr_b16 a[174:175], v9 offset:42656
 v_accvgpr_read_b32 v242, a45
 v_mfma_f32_16x16x32_bf16 v[64:67], a[188:191], v[192:195], v[64:67]
 v_mul_f32 v243, v12, v243
 v_mul_f32 v249, v12, v249
 v_mfma_f32_16x16x32_bf16 v[64:67], a[184:187], v[176:179], v[64:67]
 s_waitcnt lgkmcnt(4)
 v_cvt_pk_bf16_f32 v245, v243, v249
 v_accvgpr_read_b32 v243, a46
 v_mfma_f32_16x16x32_bf16 v[80:83], a[160:163], v[176:179], v[80:83]
 ds_read_b64_tr_b16 a[176:177], v9 offset:33984
 v_accvgpr_read_b32 v249, a47
 v_mfma_f32_16x16x32_bf16 v[80:83], a[164:167], v[192:195], v[80:83]
 ds_read_b64_tr_b16 a[178:179], v9 offset:34240
 v_mul_f32 v241, v12, v241
 v_mfma_f32_16x16x32_bf16 v[84:87], a[164:167], v[196:199], v[84:87]
 v_mul_f32 v242, v12, v242
 v_cvt_pk_bf16_f32 v246, v241, v242
 v_mfma_f32_16x16x32_bf16 v[84:87], a[160:163], v[180:183], v[84:87]
 v_mul_f32 v243, v12, v243
 v_mul_f32 v249, v12, v249
 v_mfma_f32_16x16x32_bf16 v[88:91], a[160:163], v[184:187], v[88:91]
 ds_read_b64_tr_b16 a[180:181], v9 offset:42432
 v_cvt_pk_bf16_f32 v247, v243, v249
 v_mfma_f32_16x16x32_bf16 v[88:91], a[164:167], v[200:203], v[88:91]
 s_add_u32 s89, s25, 4096
 buffer_store_dwordx4 v[244:247], v8, s[16:19], s89 offen offset:1024 sc0 sc1
 ds_read_b64_tr_b16 a[182:183], v9 offset:42688
 v_mfma_f32_16x16x32_bf16 v[92:95], a[164:167], v[204:207], v[92:95]
 v_accvgpr_read_b32 v241, a48
 v_accvgpr_read_b32 v242, a49
 v_mfma_f32_16x16x32_bf16 v[92:95], a[160:163], v[188:191], v[92:95]
 s_waitcnt lgkmcnt(4)
 v_accvgpr_read_b32 v243, a50
 v_accvgpr_read_b32 v249, a51
 v_mfma_f32_16x16x32_bf16 v[108:111], a[168:171], v[188:191], v[108:111]
 ds_read_b64_tr_b16 a[184:185], v9 offset:34016
 v_mul_f32 v241, v12, v241
 v_mfma_f32_16x16x32_bf16 v[108:111], a[172:175], v[204:207], v[108:111]
 ds_read_b64_tr_b16 a[186:187], v9 offset:34272
 v_mul_f32 v242, v12, v242
 v_mfma_f32_16x16x32_bf16 v[104:107], a[172:175], v[200:203], v[104:107]
 v_cvt_pk_bf16_f32 v244, v241, v242
 v_accvgpr_read_b32 v241, a52
 v_mfma_f32_16x16x32_bf16 v[104:107], a[168:171], v[184:187], v[104:107]
 v_accvgpr_read_b32 v242, a53
 v_mul_f32 v243, v12, v243
 v_mfma_f32_16x16x32_bf16 v[100:103], a[168:171], v[180:183], v[100:103]
 ds_read_b64_tr_b16 a[188:189], v9 offset:42464
 v_mul_f32 v249, v12, v249
 v_mfma_f32_16x16x32_bf16 v[100:103], a[172:175], v[196:199], v[100:103]
 ds_read_b64_tr_b16 a[190:191], v9 offset:42720
 v_cvt_pk_bf16_f32 v245, v243, v249
 v_mfma_f32_16x16x32_bf16 v[96:99], a[172:175], v[192:195], v[96:99]
 v_accvgpr_read_b32 v243, a54
 v_accvgpr_read_b32 v249, a55
 v_mfma_f32_16x16x32_bf16 v[96:99], a[168:171], v[176:179], v[96:99]
 s_waitcnt vmcnt(49)
 s_barrier
 s_waitcnt lgkmcnt(4)
 v_mfma_f32_16x16x32_bf16 v[112:115], a[176:179], v[176:179], v[112:115]
 ds_read_b64_tr_b16 a[160:161], v9 offset:50688
 buffer_load_dwordx4 v4, s[48:51], s65 offen offset:0 lds
 v_mfma_f32_16x16x32_bf16 v[112:115], a[180:183], v[192:195], v[112:115]
 ds_read_b64_tr_b16 a[162:163], v9 offset:50944
 v_mul_f32 v241, v12, v241
 v_mfma_f32_16x16x32_bf16 v[116:119], a[180:183], v[196:199], v[116:119]
 buffer_load_dwordx4 v5, s[48:51], s65 offen offset:1056 lds
 v_mul_f32 v242, v12, v242
 v_mfma_f32_16x16x32_bf16 v[116:119], a[176:179], v[180:183], v[116:119]
 v_cvt_pk_bf16_f32 v246, v241, v242
 v_accvgpr_read_b32 v241, a56
 v_mfma_f32_16x16x32_bf16 v[120:123], a[176:179], v[184:187], v[120:123]
 ds_read_b64_tr_b16 a[164:165], v9 offset:59136
 buffer_load_dwordx4 v6, s[48:51], s65 offen offset:2112 lds
 v_mfma_f32_16x16x32_bf16 v[120:123], a[180:183], v[200:203], v[120:123]
 ds_read_b64_tr_b16 a[166:167], v9 offset:59392
 v_accvgpr_read_b32 v242, a57
 v_mfma_f32_16x16x32_bf16 v[124:127], a[180:183], v[204:207], v[124:127]
 buffer_load_dwordx4 v7, s[48:51], s65 offen offset:3168 lds
 v_mul_f32 v243, v12, v243
 v_mfma_f32_16x16x32_bf16 v[124:127], a[176:179], v[188:191], v[124:127]
 s_add_u32 s65, s82, 1048576
 v_mul_f32 v249, v12, v249
 s_waitcnt lgkmcnt(4)
 v_mfma_f32_16x16x32_bf16 v[140:143], a[184:187], v[188:191], v[140:143]
 ds_read_b64_tr_b16 a[168:169], v9 offset:50720
 v_cvt_pk_bf16_f32 v247, v243, v249
 v_mfma_f32_16x16x32_bf16 v[140:143], a[188:191], v[204:207], v[140:143]
 s_add_u32 s89, s25, 8192
 buffer_store_dwordx4 v[244:247], v8, s[16:19], s89 offen offset:1024 sc0 sc1
 ds_read_b64_tr_b16 a[170:171], v9 offset:50976
 v_mfma_f32_16x16x32_bf16 v[136:139], a[188:191], v[200:203], v[136:139]
 v_accvgpr_read_b32 v243, a58
 v_accvgpr_read_b32 v249, a59
 v_mfma_f32_16x16x32_bf16 v[136:139], a[184:187], v[184:187], v[136:139]
 v_mul_f32 v241, v12, v241
 v_mul_f32 v242, v12, v242
 v_mfma_f32_16x16x32_bf16 v[132:135], a[184:187], v[180:183], v[132:135]
 ds_read_b64_tr_b16 a[172:173], v9 offset:59168
 v_cvt_pk_bf16_f32 v244, v241, v242
 v_mfma_f32_16x16x32_bf16 v[132:135], a[188:191], v[196:199], v[132:135]
 ds_read_b64_tr_b16 a[174:175], v9 offset:59424
 v_accvgpr_read_b32 v241, a60
 v_mfma_f32_16x16x32_bf16 v[128:131], a[188:191], v[192:195], v[128:131]
 v_accvgpr_read_b32 v242, a61
 v_mul_f32 v243, v12, v243
 v_mfma_f32_16x16x32_bf16 v[128:131], a[184:187], v[176:179], v[128:131]
 s_waitcnt vmcnt(44) lgkmcnt(4)
 v_mul_f32 v249, v12, v249
 v_cvt_pk_bf16_f32 v245, v243, v249
 v_mfma_f32_16x16x32_bf16 v[16:19], a[160:163], v[208:211], v[16:19]
 ds_read_b64_tr_b16 a[176:177], v9 offset:50752
 v_accvgpr_read_b32 v243, a62
 v_mfma_f32_16x16x32_bf16 v[16:19], a[164:167], v[224:227], v[16:19]
 ds_read_b64_tr_b16 a[178:179], v9 offset:51008
 v_accvgpr_read_b32 v249, a63
 v_mfma_f32_16x16x32_bf16 v[20:23], a[164:167], v[228:231], v[20:23]
 v_mul_f32 v241, v12, v241
 v_mul_f32 v242, v12, v242
 v_mfma_f32_16x16x32_bf16 v[20:23], a[160:163], v[212:215], v[20:23]
 s_add_u32 m0, s63, 16896
 v_cvt_pk_bf16_f32 v246, v241, v242
 v_mul_f32 v243, v12, v243
 v_mfma_f32_16x16x32_bf16 v[24:27], a[160:163], v[216:219], v[24:27]
 ds_read_b64_tr_b16 a[180:181], v9 offset:59200
 v_mul_f32 v249, v12, v249
 v_mfma_f32_16x16x32_bf16 v[24:27], a[164:167], v[232:235], v[24:27]
 ds_read_b64_tr_b16 a[182:183], v9 offset:59456
 v_cvt_pk_bf16_f32 v247, v243, v249
 v_mfma_f32_16x16x32_bf16 v[28:31], a[164:167], v[236:239], v[28:31]
 s_add_u32 s89, s25, 12288
 buffer_store_dwordx4 v[244:247], v8, s[16:19], s89 offen offset:1024 sc0 sc1
 v_accvgpr_read_b32 v241, a64
 v_mfma_f32_16x16x32_bf16 v[28:31], a[160:163], v[220:223], v[28:31]
 s_waitcnt lgkmcnt(4)
 v_accvgpr_read_b32 v242, a65
 v_accvgpr_read_b32 v243, a66
 v_mfma_f32_16x16x32_bf16 v[44:47], a[168:171], v[220:223], v[44:47]
 ds_read_b64_tr_b16 a[184:185], v9 offset:50784
 v_accvgpr_read_b32 v249, a67
 v_mfma_f32_16x16x32_bf16 v[44:47], a[172:175], v[236:239], v[44:47]
 ds_read_b64_tr_b16 a[186:187], v9 offset:51040
 v_mul_f32 v241, v13, v241
 v_mfma_f32_16x16x32_bf16 v[40:43], a[172:175], v[232:235], v[40:43]
 buffer_load_dwordx4 v4, s[48:51], s65 offen offset:0 lds
 v_mul_f32 v242, v13, v242
 v_mfma_f32_16x16x32_bf16 v[40:43], a[168:171], v[216:219], v[40:43]
 v_cvt_pk_bf16_f32 v244, v241, v242
 v_accvgpr_read_b32 v241, a68
 v_mfma_f32_16x16x32_bf16 v[36:39], a[168:171], v[212:215], v[36:39]
 ds_read_b64_tr_b16 a[188:189], v9 offset:59232
 v_accvgpr_read_b32 v242, a69
 v_mfma_f32_16x16x32_bf16 v[36:39], a[172:175], v[228:231], v[36:39]
 ds_read_b64_tr_b16 a[190:191], v9 offset:59488
 v_mul_f32 v243, v13, v243
 v_mfma_f32_16x16x32_bf16 v[32:35], a[172:175], v[224:227], v[32:35]
 v_mul_f32 v249, v13, v249
 v_cvt_pk_bf16_f32 v245, v243, v249
 v_mfma_f32_16x16x32_bf16 v[32:35], a[168:171], v[208:211], v[32:35]
 s_waitcnt lgkmcnt(4)
 v_accvgpr_read_b32 v243, a70
 v_accvgpr_read_b32 v249, a71
 v_mfma_f32_16x16x32_bf16 v[48:51], a[176:179], v[208:211], v[48:51]
 ds_read_b64_tr_b16 a[160:161], v9 offset:50816
 v_mul_f32 v241, v13, v241
 v_mfma_f32_16x16x32_bf16 v[48:51], a[180:183], v[224:227], v[48:51]
 ds_read_b64_tr_b16 a[162:163], v9 offset:51072
 v_mul_f32 v242, v13, v242
 v_mfma_f32_16x16x32_bf16 v[52:55], a[180:183], v[228:231], v[52:55]
 v_cvt_pk_bf16_f32 v246, v241, v242
 v_accvgpr_read_b32 v241, a72
 v_mfma_f32_16x16x32_bf16 v[52:55], a[176:179], v[212:215], v[52:55]
 v_accvgpr_read_b32 v242, a73
 v_mul_f32 v243, v13, v243
 v_mfma_f32_16x16x32_bf16 v[56:59], a[176:179], v[216:219], v[56:59]
 ds_read_b64_tr_b16 a[164:165], v9 offset:59264
 v_mul_f32 v249, v13, v249
 v_mfma_f32_16x16x32_bf16 v[56:59], a[180:183], v[232:235], v[56:59]
 ds_read_b64_tr_b16 a[166:167], v9 offset:59520
 v_cvt_pk_bf16_f32 v247, v243, v249
 v_mfma_f32_16x16x32_bf16 v[60:63], a[180:183], v[236:239], v[60:63]
 s_add_u32 s89, s25, 0
 buffer_store_dwordx4 v[244:247], v8, s[16:19], s89 offen offset:2048 sc0 sc1
 buffer_load_dwordx4 v5, s[48:51], s65 offen offset:1056 lds
 v_mfma_f32_16x16x32_bf16 v[60:63], a[176:179], v[220:223], v[60:63]
 s_waitcnt lgkmcnt(4)
 v_accvgpr_read_b32 v243, a74
 v_accvgpr_read_b32 v249, a75
 v_mfma_f32_16x16x32_bf16 v[76:79], a[184:187], v[220:223], v[76:79]
 ds_read_b64_tr_b16 a[168:169], v9 offset:50848
 v_mul_f32 v241, v13, v241
 v_mfma_f32_16x16x32_bf16 v[76:79], a[188:191], v[236:239], v[76:79]
 ds_read_b64_tr_b16 a[170:171], v9 offset:51104
 v_mul_f32 v242, v13, v242
 v_mfma_f32_16x16x32_bf16 v[72:75], a[188:191], v[232:235], v[72:75]
 v_cvt_pk_bf16_f32 v244, v241, v242
 v_accvgpr_read_b32 v241, a76
 v_mfma_f32_16x16x32_bf16 v[72:75], a[184:187], v[216:219], v[72:75]
 v_accvgpr_read_b32 v242, a77
 v_mul_f32 v243, v13, v243
 v_mfma_f32_16x16x32_bf16 v[68:71], a[184:187], v[212:215], v[68:71]
 ds_read_b64_tr_b16 a[172:173], v9 offset:59296
 v_mul_f32 v249, v13, v249
 v_mfma_f32_16x16x32_bf16 v[68:71], a[188:191], v[228:231], v[68:71]
 ds_read_b64_tr_b16 a[174:175], v9 offset:59552
 v_cvt_pk_bf16_f32 v245, v243, v249
 v_mfma_f32_16x16x32_bf16 v[64:67], a[188:191], v[224:227], v[64:67]
 v_accvgpr_read_b32 v243, a78
 v_accvgpr_read_b32 v249, a79
 v_mfma_f32_16x16x32_bf16 v[64:67], a[184:187], v[208:211], v[64:67]
 s_waitcnt lgkmcnt(4)
 v_mul_f32 v241, v13, v241
 v_mul_f32 v242, v13, v242
 v_mfma_f32_16x16x32_bf16 v[80:83], a[160:163], v[208:211], v[80:83]
 ds_read_b64_tr_b16 a[176:177], v9 offset:50880
 v_cvt_pk_bf16_f32 v246, v241, v242
 v_mfma_f32_16x16x32_bf16 v[80:83], a[164:167], v[224:227], v[80:83]
 ds_read_b64_tr_b16 a[178:179], v9 offset:51136
 v_mul_f32 v243, v13, v243
 v_mfma_f32_16x16x32_bf16 v[84:87], a[164:167], v[228:231], v[84:87]
 buffer_load_dwordx4 v6, s[48:51], s65 offen offset:2112 lds
 v_mul_f32 v249, v13, v249
 v_mfma_f32_16x16x32_bf16 v[84:87], a[160:163], v[212:215], v[84:87]
 v_cvt_pk_bf16_f32 v247, v243, v249
 v_mfma_f32_16x16x32_bf16 v[88:91], a[160:163], v[216:219], v[88:91]
 s_add_u32 s89, s25, 4096
 buffer_store_dwordx4 v[244:247], v8, s[16:19], s89 offen offset:2048 sc0 sc1
 ds_read_b64_tr_b16 a[180:181], v9 offset:59328
 v_mfma_f32_16x16x32_bf16 v[88:91], a[164:167], v[232:235], v[88:91]
 ds_read_b64_tr_b16 a[182:183], v9 offset:59584
 v_accvgpr_read_b32 v241, a80
 v_mfma_f32_16x16x32_bf16 v[92:95], a[164:167], v[236:239], v[92:95]
 v_accvgpr_read_b32 v242, a81
 v_accvgpr_read_b32 v243, a82
 v_mfma_f32_16x16x32_bf16 v[92:95], a[160:163], v[220:223], v[92:95]
 s_waitcnt lgkmcnt(4)
 v_accvgpr_read_b32 v249, a83
 v_mul_f32 v241, v13, v241
 v_mfma_f32_16x16x32_bf16 v[108:111], a[168:171], v[220:223], v[108:111]
 ds_read_b64_tr_b16 a[184:185], v9 offset:50912
 v_mul_f32 v242, v13, v242
 v_mfma_f32_16x16x32_bf16 v[108:111], a[172:175], v[236:239], v[108:111]
 ds_read_b64_tr_b16 a[186:187], v9 offset:51168
 v_cvt_pk_bf16_f32 v244, v241, v242
 v_mfma_f32_16x16x32_bf16 v[104:107], a[172:175], v[232:235], v[104:107]
 v_accvgpr_read_b32 v241, a84
 v_accvgpr_read_b32 v242, a85
 v_mfma_f32_16x16x32_bf16 v[104:107], a[168:171], v[216:219], v[104:107]
 v_mul_f32 v243, v13, v243
 v_mul_f32 v249, v13, v249
 v_mfma_f32_16x16x32_bf16 v[100:103], a[168:171], v[212:215], v[100:103]
 ds_read_b64_tr_b16 a[188:189], v9 offset:59360
 v_cvt_pk_bf16_f32 v245, v243, v249
 v_mfma_f32_16x16x32_bf16 v[100:103], a[172:175], v[228:231], v[100:103]
 ds_read_b64_tr_b16 a[190:191], v9 offset:59616
 v_accvgpr_read_b32 v243, a86
 v_mfma_f32_16x16x32_bf16 v[96:99], a[172:175], v[224:227], v[96:99]
 buffer_load_dwordx4 v7, s[48:51], s65 offen offset:3168 lds
 v_accvgpr_read_b32 v249, a87
 v_mfma_f32_16x16x32_bf16 v[96:99], a[168:171], v[208:211], v[96:99]
 s_waitcnt lgkmcnt(4)
 v_mul_f32 v241, v13, v241
 v_mul_f32 v242, v13, v242
 v_mfma_f32_16x16x32_bf16 v[112:115], a[176:179], v[208:211], v[112:115]
 ds_read_b64_tr_b16 a[160:161], v10 offset:0
 v_cvt_pk_bf16_f32 v246, v241, v242
 v_mfma_f32_16x16x32_bf16 v[112:115], a[180:183], v[224:227], v[112:115]
 ds_read_b64_tr_b16 a[162:163], v10 offset:256
 v_accvgpr_read_b32 v241, a88
 v_mfma_f32_16x16x32_bf16 v[116:119], a[180:183], v[228:231], v[116:119]
 v_accvgpr_read_b32 v242, a89
 v_mul_f32 v243, v13, v243
 v_mfma_f32_16x16x32_bf16 v[116:119], a[176:179], v[212:215], v[116:119]
 v_mul_f32 v249, v13, v249
 v_cvt_pk_bf16_f32 v247, v243, v249
 v_mfma_f32_16x16x32_bf16 v[120:123], a[176:179], v[216:219], v[120:123]
 s_add_u32 s89, s25, 8192
 buffer_store_dwordx4 v[244:247], v8, s[16:19], s89 offen offset:2048 sc0 sc1
 ds_read_b64_tr_b16 a[164:165], v10 offset:8448
 v_mfma_f32_16x16x32_bf16 v[120:123], a[180:183], v[232:235], v[120:123]
 ds_read_b64_tr_b16 a[166:167], v10 offset:8704
 v_accvgpr_read_b32 v243, a90
 v_mfma_f32_16x16x32_bf16 v[124:127], a[180:183], v[236:239], v[124:127]
 v_accvgpr_read_b32 v249, a91
 v_mul_f32 v241, v13, v241
 v_mfma_f32_16x16x32_bf16 v[124:127], a[176:179], v[220:223], v[124:127]
 s_add_u32 s65, s82, 1179648
 v_mul_f32 v242, v13, v242
 s_waitcnt lgkmcnt(4)
 v_mfma_f32_16x16x32_bf16 v[140:143], a[184:187], v[220:223], v[140:143]
 ds_read_b64_tr_b16 a[168:169], v10 offset:32
 v_cvt_pk_bf16_f32 v244, v241, v242
 v_mfma_f32_16x16x32_bf16 v[140:143], a[188:191], v[236:239], v[140:143]
 ds_read_b64_tr_b16 a[170:171], v10 offset:288
 v_accvgpr_read_b32 v241, a92
 v_mfma_f32_16x16x32_bf16 v[136:139], a[188:191], v[232:235], v[136:139]
 v_accvgpr_read_b32 v242, a93
 v_mul_f32 v243, v13, v243
 v_mfma_f32_16x16x32_bf16 v[136:139], a[184:187], v[216:219], v[136:139]
 v_mul_f32 v249, v13, v249
 v_cvt_pk_bf16_f32 v245, v243, v249
 v_mfma_f32_16x16x32_bf16 v[132:135], a[184:187], v[212:215], v[132:135]
 ds_read_b64_tr_b16 a[172:173], v10 offset:8480
 v_accvgpr_read_b32 v243, a94
 v_mfma_f32_16x16x32_bf16 v[132:135], a[188:191], v[228:231], v[132:135]
 ds_read_b64_tr_b16 a[174:175], v10 offset:8736
 v_accvgpr_read_b32 v249, a95
 v_mfma_f32_16x16x32_bf16 v[128:131], a[188:191], v[224:227], v[128:131]
 v_mul_f32 v241, v13, v241
 v_mul_f32 v242, v13, v242
 v_mfma_f32_16x16x32_bf16 v[128:131], a[184:187], v[208:211], v[128:131]
 s_waitcnt vmcnt(35) lgkmcnt(4)
 v_cvt_pk_bf16_f32 v246, v241, v242
 v_mul_f32 v243, v13, v243
 v_mfma_f32_16x16x32_bf16 v[16:19], a[160:163], a[192:195], v[16:19]
 ds_read_b64_tr_b16 a[176:177], v10 offset:64
 v_mul_f32 v249, v13, v249
 v_mfma_f32_16x16x32_bf16 v[16:19], a[164:167], a[208:211], v[16:19]
 ds_read_b64_tr_b16 a[178:179], v10 offset:320
 v_cvt_pk_bf16_f32 v247, v243, v249
 v_mfma_f32_16x16x32_bf16 v[20:23], a[164:167], a[212:215], v[20:23]
 s_add_u32 s89, s25, 12288
 buffer_store_dwordx4 v[244:247], v8, s[16:19], s89 offen offset:2048 sc0 sc1
 v_accvgpr_read_b32 v241, a96
 v_mfma_f32_16x16x32_bf16 v[20:23], a[160:163], a[196:199], v[20:23]
 s_add_u32 m0, s63, 33792
 v_accvgpr_read_b32 v242, a97
 v_accvgpr_read_b32 v243, a98
 v_mfma_f32_16x16x32_bf16 v[24:27], a[160:163], a[200:203], v[24:27]
 ds_read_b64_tr_b16 a[180:181], v10 offset:8512
 v_accvgpr_read_b32 v249, a99
 v_mfma_f32_16x16x32_bf16 v[24:27], a[164:167], a[216:219], v[24:27]
 ds_read_b64_tr_b16 a[182:183], v10 offset:8768
 v_mul_f32 v241, v248, v241
 v_mfma_f32_16x16x32_bf16 v[28:31], a[164:167], a[220:223], v[28:31]
 v_mul_f32 v242, v248, v242
 v_cvt_pk_bf16_f32 v244, v241, v242
 v_mfma_f32_16x16x32_bf16 v[28:31], a[160:163], a[204:207], v[28:31]
 s_waitcnt lgkmcnt(4)
 v_accvgpr_read_b32 v241, a100
 v_accvgpr_read_b32 v242, a101
 v_mfma_f32_16x16x32_bf16 v[44:47], a[168:171], a[204:207], v[44:47]
 ds_read_b64_tr_b16 a[184:185], v10 offset:96
 v_mul_f32 v243, v248, v243
 v_mfma_f32_16x16x32_bf16 v[44:47], a[172:175], a[220:223], v[44:47]
 ds_read_b64_tr_b16 a[186:187], v10 offset:352
 v_mul_f32 v249, v248, v249
 v_mfma_f32_16x16x32_bf16 v[40:43], a[172:175], a[216:219], v[40:43]
 buffer_load_dwordx4 v4, s[48:51], s65 offen offset:0 lds
 v_cvt_pk_bf16_f32 v245, v243, v249
 v_mfma_f32_16x16x32_bf16 v[40:43], a[168:171], a[200:203], v[40:43]
 v_accvgpr_read_b32 v243, a102
 v_accvgpr_read_b32 v249, a103
 v_mfma_f32_16x16x32_bf16 v[36:39], a[168:171], a[196:199], v[36:39]
 ds_read_b64_tr_b16 a[188:189], v10 offset:8544
 v_mul_f32 v241, v248, v241
 v_mfma_f32_16x16x32_bf16 v[36:39], a[172:175], a[212:215], v[36:39]
 ds_read_b64_tr_b16 a[190:191], v10 offset:8800
 v_mul_f32 v242, v248, v242
 v_mfma_f32_16x16x32_bf16 v[32:35], a[172:175], a[208:211], v[32:35]
 v_cvt_pk_bf16_f32 v246, v241, v242
 v_accvgpr_read_b32 v241, a104
 v_mfma_f32_16x16x32_bf16 v[32:35], a[168:171], a[192:195], v[32:35]
 s_waitcnt lgkmcnt(4)
 v_accvgpr_read_b32 v242, a105
 v_mul_f32 v243, v248, v243
 v_mfma_f32_16x16x32_bf16 v[48:51], a[176:179], a[192:195], v[48:51]
 ds_read_b64_tr_b16 a[160:161], v10 offset:128
 v_mul_f32 v249, v248, v249
 v_mfma_f32_16x16x32_bf16 v[48:51], a[180:183], a[208:211], v[48:51]
 ds_read_b64_tr_b16 a[162:163], v10 offset:384
 v_cvt_pk_bf16_f32 v247, v243, v249
 v_mfma_f32_16x16x32_bf16 v[52:55], a[180:183], a[212:215], v[52:55]
 s_add_u32 s89, s25, 0
 buffer_store_dwordx4 v[244:247], v8, s[16:19], s89 offen offset:3072 sc0 sc1
 v_accvgpr_read_b32 v243, a106
 v_mfma_f32_16x16x32_bf16 v[52:55], a[176:179], a[196:199], v[52:55]
 v_accvgpr_read_b32 v249, a107
 v_mul_f32 v241, v248, v241
 v_mfma_f32_16x16x32_bf16 v[56:59], a[176:179], a[200:203], v[56:59]
 ds_read_b64_tr_b16 a[164:165], v10 offset:8576
 v_mul_f32 v242, v248, v242
 v_mfma_f32_16x16x32_bf16 v[56:59], a[180:183], a[216:219], v[56:59]
 ds_read_b64_tr_b16 a[166:167], v10 offset:8832
 v_cvt_pk_bf16_f32 v244, v241, v242
 v_mfma_f32_16x16x32_bf16 v[60:63], a[180:183], a[220:223], v[60:63]
 buffer_load_dwordx4 v5, s[48:51], s65 offen offset:1056 lds
 v_accvgpr_read_b32 v241, a108
 v_mfma_f32_16x16x32_bf16 v[60:63], a[176:179], a[204:207], v[60:63]
 s_waitcnt lgkmcnt(4)
 v_accvgpr_read_b32 v242, a109
 v_mul_f32 v243, v248, v243
 v_mfma_f32_16x16x32_bf16 v[76:79], a[184:187], a[204:207], v[76:79]
 ds_read_b64_tr_b16 a[168:169], v10 offset:160
 v_mul_f32 v249, v248, v249
 v_mfma_f32_16x16x32_bf16 v[76:79], a[188:191], a[220:223], v[76:79]
 ds_read_b64_tr_b16 a[170:171], v10 offset:416
 v_cvt_pk_bf16_f32 v245, v243, v249
 v_mfma_f32_16x16x32_bf16 v[72:75], a[188:191], a[216:219], v[72:75]
 v_accvgpr_read_b32 v243, a110
 v_accvgpr_read_b32 v249, a111
 v_mfma_f32_16x16x32_bf16 v[72:75], a[184:187], a[200:203], v[72:75]
 v_mul_f32 v241, v248, v241
 v_mul_f32 v242, v248, v242
 v_mfma_f32_16x16x32_bf16 v[68:71], a[184:187], a[196:199], v[68:71]
 ds_read_b64_tr_b16 a[172:173], v10 offset:8608
 v_cvt_pk_bf16_f32 v246, v241, v242
 v_mfma_f32_16x16x32_bf16 v[68:71], a[188:191], a[212:215], v[68:71]
 ds_read_b64_tr_b16 a[174:175], v10 offset:8864
 v_mul_f32 v243, v248, v243
 v_mfma_f32_16x16x32_bf16 v[64:67], a[188:191], a[208:211], v[64:67]
 v_mul_f32 v249, v248, v249
 v_cvt_pk_bf16_f32 v247, v243, v249
 v_mfma_f32_16x16x32_bf16 v[64:67], a[184:187], a[192:195], v[64:67]
 s_add_u32 s89, s25, 4096
 buffer_store_dwordx4 v[244:247], v8, s[16:19], s89 offen offset:3072 sc0 sc1
 s_waitcnt lgkmcnt(4)
 v_mfma_f32_16x16x32_bf16 v[80:83], a[160:163], a[192:195], v[80:83]
 ds_read_b64_tr_b16 a[176:177], v10 offset:192
 v_accvgpr_read_b32 v241, a112
 v_mfma_f32_16x16x32_bf16 v[80:83], a[164:167], a[208:211], v[80:83]
 ds_read_b64_tr_b16 a[178:179], v10 offset:448
 v_accvgpr_read_b32 v242, a113
 v_mfma_f32_16x16x32_bf16 v[84:87], a[164:167], a[212:215], v[84:87]
 buffer_load_dwordx4 v6, s[48:51], s65 offen offset:2112 lds
 v_accvgpr_read_b32 v243, a114
 v_mfma_f32_16x16x32_bf16 v[84:87], a[160:163], a[196:199], v[84:87]
 v_accvgpr_read_b32 v249, a115
 v_mul_f32 v241, v248, v241
 v_mfma_f32_16x16x32_bf16 v[88:91], a[160:163], a[200:203], v[88:91]
 ds_read_b64_tr_b16 a[180:181], v10 offset:8640
 v_mul_f32 v242, v248, v242
 v_mfma_f32_16x16x32_bf16 v[88:91], a[164:167], a[216:219], v[88:91]
 ds_read_b64_tr_b16 a[182:183], v10 offset:8896
 v_cvt_pk_bf16_f32 v244, v241, v242
 v_mfma_f32_16x16x32_bf16 v[92:95], a[164:167], a[220:223], v[92:95]
 v_accvgpr_read_b32 v241, a116
 v_accvgpr_read_b32 v242, a117
 v_mfma_f32_16x16x32_bf16 v[92:95], a[160:163], a[204:207], v[92:95]
 s_waitcnt lgkmcnt(4)
 v_mul_f32 v243, v248, v243
 v_mul_f32 v249, v248, v249
 v_mfma_f32_16x16x32_bf16 v[108:111], a[168:171], a[204:207], v[108:111]
 ds_read_b64_tr_b16 a[184:185], v10 offset:224
 v_cvt_pk_bf16_f32 v245, v243, v249
 v_mfma_f32_16x16x32_bf16 v[108:111], a[172:175], a[220:223], v[108:111]
 s_branch L_pg14k
L_pg14:
L_ic2w0:
 s_branch L_ic2r
L_pg14k:
 ds_read_b64_tr_b16 a[186:187], v10 offset:480
 v_accvgpr_read_b32 v243, a118
 v_mfma_f32_16x16x32_bf16 v[104:107], a[172:175], a[216:219], v[104:107]
 v_accvgpr_read_b32 v249, a119
 v_mul_f32 v241, v248, v241
 v_mfma_f32_16x16x32_bf16 v[104:107], a[168:171], a[200:203], v[104:107]
 v_mul_f32 v242, v248, v242
 v_cvt_pk_bf16_f32 v246, v241, v242
 v_mfma_f32_16x16x32_bf16 v[100:103], a[168:171], a[196:199], v[100:103]
 ds_read_b64_tr_b16 a[188:189], v10 offset:8672
 v_accvgpr_read_b32 v241, a120
 v_mfma_f32_16x16x32_bf16 v[100:103], a[172:175], a[212:215], v[100:103]
 ds_read_b64_tr_b16 a[190:191], v10 offset:8928
 v_accvgpr_read_b32 v242, a121
 v_mfma_f32_16x16x32_bf16 v[96:99], a[172:175], a[208:211], v[96:99]
 buffer_load_dwordx4 v7, s[48:51], s65 offen offset:3168 lds
 v_mul_f32 v243, v248, v243
 v_mfma_f32_16x16x32_bf16 v[96:99], a[168:171], a[192:195], v[96:99]
 s_waitcnt vmcnt(53)
 s_barrier
 s_waitcnt lgkmcnt(4)
 v_mfma_f32_16x16x32_bf16 v[112:115], a[176:179], a[192:195], v[112:115]
 ds_read_b64_tr_b16 a[160:161], v10 offset:16896
 v_mul_f32 v249, v248, v249
 v_mfma_f32_16x16x32_bf16 v[112:115], a[180:183], a[208:211], v[112:115]
 ds_read_b64_tr_b16 a[162:163], v10 offset:17152
 v_cvt_pk_bf16_f32 v247, v243, v249
 v_mfma_f32_16x16x32_bf16 v[116:119], a[180:183], a[212:215], v[116:119]
 s_add_u32 s89, s25, 8192
 buffer_store_dwordx4 v[244:247], v8, s[16:19], s89 offen offset:3072 sc0 sc1
 v_accvgpr_read_b32 v243, a122
 v_mfma_f32_16x16x32_bf16 v[116:119], a[176:179], a[196:199], v[116:119]
 v_accvgpr_read_b32 v249, a123
 v_mul_f32 v241, v248, v241
 v_mfma_f32_16x16x32_bf16 v[120:123], a[176:179], a[200:203], v[120:123]
 ds_read_b64_tr_b16 a[164:165], v10 offset:25344
 v_mul_f32 v242, v248, v242
 v_mfma_f32_16x16x32_bf16 v[120:123], a[180:183], a[216:219], v[120:123]
 ds_read_b64_tr_b16 a[166:167], v10 offset:25600
 v_cvt_pk_bf16_f32 v244, v241, v242
 v_mfma_f32_16x16x32_bf16 v[124:127], a[180:183], a[220:223], v[124:127]
 v_accvgpr_read_b32 v241, a124
 v_accvgpr_read_b32 v242, a125
 v_mfma_f32_16x16x32_bf16 v[124:127], a[176:179], a[204:207], v[124:127]
 s_add_u32 s65, s82, 1310720
 v_mul_f32 v243, v248, v243
 s_waitcnt lgkmcnt(4)
 v_mfma_f32_16x16x32_bf16 v[140:143], a[184:187], a[204:207], v[140:143]
 ds_read_b64_tr_b16 a[168:169], v10 offset:16928
 v_mul_f32 v249, v248, v249
 v_mfma_f32_16x16x32_bf16 v[140:143], a[188:191], a[220:223], v[140:143]
 ds_read_b64_tr_b16 a[170:171], v10 offset:17184
 v_cvt_pk_bf16_f32 v245, v243, v249
 v_mfma_f32_16x16x32_bf16 v[136:139], a[188:191], a[216:219], v[136:139]
 v_accvgpr_read_b32 v243, a126
 v_accvgpr_read_b32 v249, a127
 v_mfma_f32_16x16x32_bf16 v[136:139], a[184:187], a[200:203], v[136:139]
 v_mul_f32 v241, v248, v241
 v_mul_f32 v242, v248, v242
 v_mfma_f32_16x16x32_bf16 v[132:135], a[184:187], a[196:199], v[132:135]
 ds_read_b64_tr_b16 a[172:173], v10 offset:25376
 v_cvt_pk_bf16_f32 v246, v241, v242
 v_mfma_f32_16x16x32_bf16 v[132:135], a[188:191], a[212:215], v[132:135]
 ds_read_b64_tr_b16 a[174:175], v10 offset:25632
 v_mul_f32 v243, v248, v243
 v_mfma_f32_16x16x32_bf16 v[128:131], a[188:191], a[208:211], v[128:131]
 v_mul_f32 v249, v248, v249
 v_cvt_pk_bf16_f32 v247, v243, v249
 v_mfma_f32_16x16x32_bf16 v[128:131], a[184:187], a[192:195], v[128:131]
 s_add_u32 s89, s25, 12288
 buffer_store_dwordx4 v[244:247], v8, s[16:19], s89 offen offset:3072 sc0 sc1
 s_waitcnt vmcnt(36) lgkmcnt(4)
 v_mfma_f32_16x16x32_bf16 v[16:19], a[160:163], a[224:227], v[16:19]
 ds_read_b64_tr_b16 a[176:177], v10 offset:16960
 v_lshrrev_b32 v230, 4, v1
 v_mfma_f32_16x16x32_bf16 v[16:19], a[164:167], a[240:243], v[16:19]
 ds_read_b64_tr_b16 a[178:179], v10 offset:17216
 s_add_u32 s64, s71, 49152
 v_mfma_f32_16x16x32_bf16 v[20:23], a[164:167], a[244:247], v[20:23]
 buffer_load_dwordx4 a[16:19], v8, s[16:19], s64 offen offset:0
 v_lshlrev_b32 v230, 2, v230
 v_mfma_f32_16x16x32_bf16 v[20:23], a[160:163], a[228:231], v[20:23]
 s_add_u32 m0, s63, 50688
 v_and_b32 v231, 15, v1
 v_sub_u32 v230, v231, v230
 v_mfma_f32_16x16x32_bf16 v[24:27], a[160:163], a[232:235], v[24:27]
 ds_read_b64_tr_b16 a[180:181], v10 offset:25408
 v_mov_b32 v232, 0x3f80
 v_mfma_f32_16x16x32_bf16 v[24:27], a[164:167], a[248:251], v[24:27]
 ds_read_b64_tr_b16 a[182:183], v10 offset:25664
 v_mov_b32 v233, 0x3f800000
 v_mfma_f32_16x16x32_bf16 v[28:31], a[164:167], a[252:255], v[28:31]
 v_mov_b32 v224, 0
 v_mov_b32 v225, 0
 v_mfma_f32_16x16x32_bf16 v[28:31], a[160:163], a[236:239], v[28:31]
 s_waitcnt lgkmcnt(4)
 v_mov_b32 v228, 0
 v_mov_b32 v229, 0
 v_mfma_f32_16x16x32_bf16 v[44:47], a[168:171], a[236:239], v[44:47]
 ds_read_b64_tr_b16 a[184:185], v10 offset:16992
 v_cmp_eq_u32 vcc, 0, v230
 v_mfma_f32_16x16x32_bf16 v[44:47], a[172:175], a[252:255], v[44:47]
 ds_read_b64_tr_b16 a[186:187], v10 offset:17248
 v_mfma_f32_16x16x32_bf16 v[40:43], a[172:175], a[248:251], v[40:43]
 buffer_load_dwordx4 v4, s[48:51], s65 offen offset:0 lds
 v_cndmask_b32 v226, v224, v232, vcc
 v_mfma_f32_16x16x32_bf16 v[40:43], a[168:171], a[232:235], v[40:43]
 v_cmp_eq_u32 vcc, 1, v230
 v_mfma_f32_16x16x32_bf16 v[36:39], a[168:171], a[228:231], v[36:39]
 ds_read_b64_tr_b16 a[188:189], v10 offset:25440
 v_mfma_f32_16x16x32_bf16 v[36:39], a[172:175], a[244:247], v[36:39]
 ds_read_b64_tr_b16 a[190:191], v10 offset:25696
 v_cndmask_b32 v226, v226, v233, vcc
 v_mfma_f32_16x16x32_bf16 v[32:35], a[172:175], a[240:243], v[32:35]
 buffer_load_dwordx4 a[20:23], v8, s[16:19], s64 offen offset:1024
 v_cmp_eq_u32 vcc, 2, v230
 v_mfma_f32_16x16x32_bf16 v[32:35], a[168:171], a[224:227], v[32:35]
 s_waitcnt lgkmcnt(4)
 v_mfma_f32_16x16x32_bf16 v[48:51], a[176:179], a[224:227], v[48:51]
 ds_read_b64_tr_b16 a[160:161], v10 offset:17024
 v_cndmask_b32 v227, v224, v232, vcc
 v_mfma_f32_16x16x32_bf16 v[48:51], a[180:183], a[240:243], v[48:51]
 ds_read_b64_tr_b16 a[162:163], v10 offset:17280
 v_cmp_eq_u32 vcc, 3, v230
 v_mfma_f32_16x16x32_bf16 v[52:55], a[180:183], a[244:247], v[52:55]
 buffer_load_dwordx4 a[24:27], v8, s[16:19], s64 offen offset:2048
 v_mfma_f32_16x16x32_bf16 v[52:55], a[176:179], a[228:231], v[52:55]
 v_cndmask_b32 v227, v227, v233, vcc
 v_mfma_f32_16x16x32_bf16 v[56:59], a[176:179], a[232:235], v[56:59]
 ds_read_b64_tr_b16 a[164:165], v10 offset:25472
 v_mfma_f32_16x16x32_bf16 v[56:59], a[180:183], a[248:251], v[56:59]
 ds_read_b64_tr_b16 a[166:167], v10 offset:25728
 v_mfma_f32_16x16x32_bf16 v[60:63], a[180:183], a[252:255], v[60:63]
 buffer_load_dwordx4 v5, s[48:51], s65 offen offset:1056 lds
 v_mfma_f32_16x16x32_bf16 v[60:63], a[176:179], a[236:239], v[60:63]
 s_waitcnt lgkmcnt(4)
 v_mfma_f32_16x16x32_bf16 v[76:79], a[184:187], a[236:239], v[76:79]
 ds_read_b64_tr_b16 a[168:169], v10 offset:17056
 v_mfma_f32_16x16x32_bf16 v[76:79], a[188:191], a[252:255], v[76:79]
 ds_read_b64_tr_b16 a[170:171], v10 offset:17312
 v_mfma_f32_16x16x32_bf16 v[72:75], a[188:191], a[248:251], v[72:75]
 buffer_load_dwordx4 a[28:31], v8, s[16:19], s64 offen offset:3072
 v_mfma_f32_16x16x32_bf16 v[72:75], a[184:187], a[232:235], v[72:75]
 v_mfma_f32_16x16x32_bf16 v[68:71], a[184:187], a[228:231], v[68:71]
 ds_read_b64_tr_b16 a[172:173], v10 offset:25504
 v_mfma_f32_16x16x32_bf16 v[68:71], a[188:191], a[244:247], v[68:71]
 ds_read_b64_tr_b16 a[174:175], v10 offset:25760
 v_mfma_f32_16x16x32_bf16 v[64:67], a[188:191], a[240:243], v[64:67]
 v_mfma_f32_16x16x32_bf16 v[64:67], a[184:187], a[224:227], v[64:67]
 s_waitcnt lgkmcnt(4)
 v_mfma_f32_16x16x32_bf16 v[80:83], a[160:163], a[224:227], v[80:83]
 ds_read_b64_tr_b16 a[176:177], v10 offset:17088
 v_mfma_f32_16x16x32_bf16 v[80:83], a[164:167], a[240:243], v[80:83]
 ds_read_b64_tr_b16 a[178:179], v10 offset:17344
 v_mfma_f32_16x16x32_bf16 v[84:87], a[164:167], a[244:247], v[84:87]
 buffer_load_dwordx4 v6, s[48:51], s65 offen offset:2112 lds
 v_mfma_f32_16x16x32_bf16 v[84:87], a[160:163], a[228:231], v[84:87]
 v_mfma_f32_16x16x32_bf16 v[88:91], a[160:163], a[232:235], v[88:91]
 ds_read_b64_tr_b16 a[180:181], v10 offset:25536
 v_mfma_f32_16x16x32_bf16 v[88:91], a[164:167], a[248:251], v[88:91]
 ds_read_b64_tr_b16 a[182:183], v10 offset:25792
 v_mfma_f32_16x16x32_bf16 v[92:95], a[164:167], a[252:255], v[92:95]
 buffer_load_dwordx4 a[32:35], v240, s[16:19], s64 offen offset:0
 v_mfma_f32_16x16x32_bf16 v[92:95], a[160:163], a[236:239], v[92:95]
 s_waitcnt lgkmcnt(4)
 v_mfma_f32_16x16x32_bf16 v[108:111], a[168:171], a[236:239], v[108:111]
 ds_read_b64_tr_b16 a[184:185], v10 offset:17120
 v_mfma_f32_16x16x32_bf16 v[108:111], a[172:175], a[252:255], v[108:111]
 ds_read_b64_tr_b16 a[186:187], v10 offset:17376
 v_mfma_f32_16x16x32_bf16 v[104:107], a[172:175], a[248:251], v[104:107]
 buffer_load_dwordx4 a[36:39], v240, s[16:19], s64 offen offset:1024
 v_mfma_f32_16x16x32_bf16 v[104:107], a[168:171], a[232:235], v[104:107]
 v_mfma_f32_16x16x32_bf16 v[100:103], a[168:171], a[228:231], v[100:103]
 ds_read_b64_tr_b16 a[188:189], v10 offset:25568
 v_mfma_f32_16x16x32_bf16 v[100:103], a[172:175], a[244:247], v[100:103]
 ds_read_b64_tr_b16 a[190:191], v10 offset:25824
 v_mfma_f32_16x16x32_bf16 v[96:99], a[172:175], a[240:243], v[96:99]
 buffer_load_dwordx4 v7, s[48:51], s65 offen offset:3168 lds
 v_mfma_f32_16x16x32_bf16 v[96:99], a[168:171], a[224:227], v[96:99]
 s_waitcnt lgkmcnt(4)
 v_mfma_f32_16x16x32_bf16 v[112:115], a[176:179], a[224:227], v[112:115]
 ds_read_b64_tr_b16 a[160:161], v10 offset:33792
 v_mfma_f32_16x16x32_bf16 v[112:115], a[180:183], a[240:243], v[112:115]
 ds_read_b64_tr_b16 a[162:163], v10 offset:34048
 v_mfma_f32_16x16x32_bf16 v[116:119], a[180:183], a[244:247], v[116:119]
 buffer_load_dwordx4 a[40:43], v240, s[16:19], s64 offen offset:2048
 v_mfma_f32_16x16x32_bf16 v[116:119], a[176:179], a[228:231], v[116:119]
 v_mfma_f32_16x16x32_bf16 v[120:123], a[176:179], a[232:235], v[120:123]
 ds_read_b64_tr_b16 a[164:165], v10 offset:42240
 v_mfma_f32_16x16x32_bf16 v[120:123], a[180:183], a[248:251], v[120:123]
 ds_read_b64_tr_b16 a[166:167], v10 offset:42496
 v_mfma_f32_16x16x32_bf16 v[124:127], a[180:183], a[252:255], v[124:127]
 v_mfma_f32_16x16x32_bf16 v[124:127], a[176:179], a[236:239], v[124:127]
 s_add_u32 s65, s82, 1441792
 s_waitcnt lgkmcnt(4)
 v_mfma_f32_16x16x32_bf16 v[140:143], a[184:187], a[236:239], v[140:143]
 ds_read_b64_tr_b16 a[168:169], v10 offset:33824
 v_mfma_f32_16x16x32_bf16 v[140:143], a[188:191], a[252:255], v[140:143]
 ds_read_b64_tr_b16 a[170:171], v10 offset:34080
 v_mfma_f32_16x16x32_bf16 v[136:139], a[188:191], a[248:251], v[136:139]
 buffer_load_dwordx4 a[44:47], v240, s[16:19], s64 offen offset:3072
 v_mfma_f32_16x16x32_bf16 v[136:139], a[184:187], a[232:235], v[136:139]
 v_mfma_f32_16x16x32_bf16 v[132:135], a[184:187], a[228:231], v[132:135]
 ds_read_b64_tr_b16 a[172:173], v10 offset:42272
 v_mfma_f32_16x16x32_bf16 v[132:135], a[188:191], a[244:247], v[132:135]
 ds_read_b64_tr_b16 a[174:175], v10 offset:42528
 s_add_u32 s64, s71, 57344
 v_mfma_f32_16x16x32_bf16 v[128:131], a[188:191], a[240:243], v[128:131]
 buffer_load_dwordx4 a[48:51], v8, s[16:19], s64 offen offset:0
 v_mfma_f32_16x16x32_bf16 v[128:131], a[184:187], a[224:227], v[128:131]
 s_waitcnt vmcnt(41) lgkmcnt(4)
 v_mfma_f32_16x16x32_bf16 v[16:19], a[160:163], a[128:131], v[16:19]
 ds_read_b64_tr_b16 a[176:177], v10 offset:33856
 v_mfma_f32_16x16x32_bf16 v[16:19], a[164:167], a[144:147], v[16:19]
 ds_read_b64_tr_b16 a[178:179], v10 offset:34112
 v_mfma_f32_16x16x32_bf16 v[20:23], a[164:167], a[148:151], v[20:23]
 buffer_load_dwordx4 a[52:55], v8, s[16:19], s64 offen offset:1024
 v_mfma_f32_16x16x32_bf16 v[20:23], a[160:163], a[132:135], v[20:23]
 s_add_u32 m0, s63, 67584
 v_mfma_f32_16x16x32_bf16 v[24:27], a[160:163], a[136:139], v[24:27]
 ds_read_b64_tr_b16 a[180:181], v10 offset:42304
 v_mfma_f32_16x16x32_bf16 v[24:27], a[164:167], a[152:155], v[24:27]
 ds_read_b64_tr_b16 a[182:183], v10 offset:42560
 v_mfma_f32_16x16x32_bf16 v[28:31], a[164:167], a[156:159], v[28:31]
 v_mfma_f32_16x16x32_bf16 v[28:31], a[160:163], a[140:143], v[28:31]
 s_waitcnt lgkmcnt(4)
 v_mfma_f32_16x16x32_bf16 v[44:47], a[168:171], a[140:143], v[44:47]
 ds_read_b64_tr_b16 a[184:185], v10 offset:33888
 v_mfma_f32_16x16x32_bf16 v[44:47], a[172:175], a[156:159], v[44:47]
 ds_read_b64_tr_b16 a[186:187], v10 offset:34144
 v_mfma_f32_16x16x32_bf16 v[40:43], a[172:175], a[152:155], v[40:43]
 buffer_load_dwordx4 v4, s[48:51], s65 offen offset:0 lds
 v_mfma_f32_16x16x32_bf16 v[40:43], a[168:171], a[136:139], v[40:43]
 v_mfma_f32_16x16x32_bf16 v[36:39], a[168:171], a[132:135], v[36:39]
 ds_read_b64_tr_b16 a[188:189], v10 offset:42336
 v_mfma_f32_16x16x32_bf16 v[36:39], a[172:175], a[148:151], v[36:39]
 ds_read_b64_tr_b16 a[190:191], v10 offset:42592
 v_mfma_f32_16x16x32_bf16 v[32:35], a[172:175], a[144:147], v[32:35]
 buffer_load_dwordx4 a[56:59], v8, s[16:19], s64 offen offset:2048
 v_mfma_f32_16x16x32_bf16 v[32:35], a[168:171], a[128:131], v[32:35]
 s_waitcnt lgkmcnt(4)
 v_mfma_f32_16x16x32_bf16 v[48:51], a[176:179], a[128:131], v[48:51]
 ds_read_b64_tr_b16 a[160:161], v10 offset:33920
 v_mfma_f32_16x16x32_bf16 v[48:51], a[180:183], a[144:147], v[48:51]
 ds_read_b64_tr_b16 a[162:163], v10 offset:34176
 v_mfma_f32_16x16x32_bf16 v[52:55], a[180:183], a[148:151], v[52:55]
 buffer_load_dwordx4 a[60:63], v8, s[16:19], s64 offen offset:3072
 v_mfma_f32_16x16x32_bf16 v[52:55], a[176:179], a[132:135], v[52:55]
 v_mfma_f32_16x16x32_bf16 v[56:59], a[176:179], a[136:139], v[56:59]
 ds_read_b64_tr_b16 a[164:165], v10 offset:42368
 v_mfma_f32_16x16x32_bf16 v[56:59], a[180:183], a[152:155], v[56:59]
 ds_read_b64_tr_b16 a[166:167], v10 offset:42624
 v_mfma_f32_16x16x32_bf16 v[60:63], a[180:183], a[156:159], v[60:63]
 buffer_load_dwordx4 v5, s[48:51], s65 offen offset:1056 lds
 v_mfma_f32_16x16x32_bf16 v[60:63], a[176:179], a[140:143], v[60:63]
 s_waitcnt lgkmcnt(4)
 v_mfma_f32_16x16x32_bf16 v[76:79], a[184:187], a[140:143], v[76:79]
 ds_read_b64_tr_b16 a[168:169], v10 offset:33952
 v_mfma_f32_16x16x32_bf16 v[76:79], a[188:191], a[156:159], v[76:79]
 ds_read_b64_tr_b16 a[170:171], v10 offset:34208
 v_mfma_f32_16x16x32_bf16 v[72:75], a[188:191], a[152:155], v[72:75]
 buffer_load_dwordx4 a[64:67], v240, s[16:19], s64 offen offset:0
 v_mfma_f32_16x16x32_bf16 v[72:75], a[184:187], a[136:139], v[72:75]
 v_mfma_f32_16x16x32_bf16 v[68:71], a[184:187], a[132:135], v[68:71]
 ds_read_b64_tr_b16 a[172:173], v10 offset:42400
 v_mfma_f32_16x16x32_bf16 v[68:71], a[188:191], a[148:151], v[68:71]
 ds_read_b64_tr_b16 a[174:175], v10 offset:42656
 v_mfma_f32_16x16x32_bf16 v[64:67], a[188:191], a[144:147], v[64:67]
 v_mfma_f32_16x16x32_bf16 v[64:67], a[184:187], a[128:131], v[64:67]
 s_waitcnt lgkmcnt(4)
 v_mfma_f32_16x16x32_bf16 v[80:83], a[160:163], a[128:131], v[80:83]
 ds_read_b64_tr_b16 a[176:177], v10 offset:33984
 v_mfma_f32_16x16x32_bf16 v[80:83], a[164:167], a[144:147], v[80:83]
 ds_read_b64_tr_b16 a[178:179], v10 offset:34240
 v_mfma_f32_16x16x32_bf16 v[84:87], a[164:167], a[148:151], v[84:87]
 buffer_load_dwordx4 v6, s[48:51], s65 offen offset:2112 lds
 v_mfma_f32_16x16x32_bf16 v[84:87], a[160:163], a[132:135], v[84:87]
 v_mfma_f32_16x16x32_bf16 v[88:91], a[160:163], a[136:139], v[88:91]
 ds_read_b64_tr_b16 a[180:181], v10 offset:42432
 v_mfma_f32_16x16x32_bf16 v[88:91], a[164:167], a[152:155], v[88:91]
 ds_read_b64_tr_b16 a[182:183], v10 offset:42688
 v_mfma_f32_16x16x32_bf16 v[92:95], a[164:167], a[156:159], v[92:95]
 buffer_load_dwordx4 a[68:71], v240, s[16:19], s64 offen offset:1024
 v_mfma_f32_16x16x32_bf16 v[92:95], a[160:163], a[140:143], v[92:95]
 s_waitcnt lgkmcnt(4)
 v_mfma_f32_16x16x32_bf16 v[108:111], a[168:171], a[140:143], v[108:111]
 ds_read_b64_tr_b16 a[184:185], v10 offset:34016
 v_mfma_f32_16x16x32_bf16 v[108:111], a[172:175], a[156:159], v[108:111]
 ds_read_b64_tr_b16 a[186:187], v10 offset:34272
 v_mfma_f32_16x16x32_bf16 v[104:107], a[172:175], a[152:155], v[104:107]
 buffer_load_dwordx4 a[72:75], v240, s[16:19], s64 offen offset:2048
 v_mfma_f32_16x16x32_bf16 v[104:107], a[168:171], a[136:139], v[104:107]
 v_mfma_f32_16x16x32_bf16 v[100:103], a[168:171], a[132:135], v[100:103]
 ds_read_b64_tr_b16 a[188:189], v10 offset:42464
 v_mfma_f32_16x16x32_bf16 v[100:103], a[172:175], a[148:151], v[100:103]
 ds_read_b64_tr_b16 a[190:191], v10 offset:42720
 v_mfma_f32_16x16x32_bf16 v[96:99], a[172:175], a[144:147], v[96:99]
 buffer_load_dwordx4 v7, s[48:51], s65 offen offset:3168 lds
 v_mfma_f32_16x16x32_bf16 v[96:99], a[168:171], a[128:131], v[96:99]
 s_waitcnt vmcnt(23)
 s_barrier
 s_cmp_lg_u32 s3, 0
 s_cbranch_scc1 L_pubo
 buffer_store_dword v3, v2, s[16:19], s8 offen sc0 sc1
L_pubo:
 s_waitcnt lgkmcnt(4)
 v_mfma_f32_16x16x32_bf16 v[112:115], a[176:179], a[128:131], v[112:115]
 ds_read_b64_tr_b16 a[160:161], v10 offset:50688
 v_mfma_f32_16x16x32_bf16 v[112:115], a[180:183], a[144:147], v[112:115]
 ds_read_b64_tr_b16 a[162:163], v10 offset:50944
 v_mfma_f32_16x16x32_bf16 v[116:119], a[180:183], a[148:151], v[116:119]
 buffer_load_dwordx4 a[76:79], v240, s[16:19], s64 offen offset:3072
 v_mfma_f32_16x16x32_bf16 v[116:119], a[176:179], a[132:135], v[116:119]
 v_mfma_f32_16x16x32_bf16 v[120:123], a[176:179], a[136:139], v[120:123]
 ds_read_b64_tr_b16 a[164:165], v10 offset:59136
 v_mfma_f32_16x16x32_bf16 v[120:123], a[180:183], a[152:155], v[120:123]
 ds_read_b64_tr_b16 a[166:167], v10 offset:59392
 v_mfma_f32_16x16x32_bf16 v[124:127], a[180:183], a[156:159], v[124:127]
 v_mfma_f32_16x16x32_bf16 v[124:127], a[176:179], a[140:143], v[124:127]
 s_add_u32 s65, s82, 1572864
 s_waitcnt lgkmcnt(4)
 v_mfma_f32_16x16x32_bf16 v[140:143], a[184:187], a[140:143], v[140:143]
 ds_read_b64_tr_b16 a[168:169], v10 offset:50720
 v_mfma_f32_16x16x32_bf16 v[140:143], a[188:191], a[156:159], v[140:143]
 ds_read_b64_tr_b16 a[170:171], v10 offset:50976
 s_add_u32 s64, s71, 65536
 v_mfma_f32_16x16x32_bf16 v[136:139], a[188:191], a[152:155], v[136:139]
 buffer_load_dwordx4 a[80:83], v8, s[16:19], s64 offen offset:0
 v_mfma_f32_16x16x32_bf16 v[136:139], a[184:187], a[136:139], v[136:139]
 v_mfma_f32_16x16x32_bf16 v[132:135], a[184:187], a[132:135], v[132:135]
 ds_read_b64_tr_b16 a[172:173], v10 offset:59168
 v_mfma_f32_16x16x32_bf16 v[132:135], a[188:191], a[148:151], v[132:135]
 ds_read_b64_tr_b16 a[174:175], v10 offset:59424
 v_mfma_f32_16x16x32_bf16 v[128:131], a[188:191], a[144:147], v[128:131]
 buffer_load_dwordx4 a[84:87], v8, s[16:19], s64 offen offset:1024
 v_mfma_f32_16x16x32_bf16 v[128:131], a[184:187], a[128:131], v[128:131]
 s_waitcnt vmcnt(14) lgkmcnt(4)
 v_mfma_f32_16x16x32_bf16 v[16:19], a[160:163], a[16:19], v[16:19]
 ds_read_b64_tr_b16 a[176:177], v10 offset:50752
 v_mfma_f32_16x16x32_bf16 v[16:19], a[164:167], a[32:35], v[16:19]
 ds_read_b64_tr_b16 a[178:179], v10 offset:51008
 v_mfma_f32_16x16x32_bf16 v[20:23], a[164:167], a[36:39], v[20:23]
 buffer_load_dwordx4 a[88:91], v8, s[16:19], s64 offen offset:2048
 v_mfma_f32_16x16x32_bf16 v[20:23], a[160:163], a[20:23], v[20:23]
 s_add_u32 m0, s63, 84480
 v_mfma_f32_16x16x32_bf16 v[24:27], a[160:163], a[24:27], v[24:27]
 ds_read_b64_tr_b16 a[180:181], v10 offset:59200
 v_mfma_f32_16x16x32_bf16 v[24:27], a[164:167], a[40:43], v[24:27]
 ds_read_b64_tr_b16 a[182:183], v10 offset:59456
 v_mfma_f32_16x16x32_bf16 v[28:31], a[164:167], a[44:47], v[28:31]
 v_mfma_f32_16x16x32_bf16 v[28:31], a[160:163], a[28:31], v[28:31]
 s_waitcnt lgkmcnt(4)
 v_mfma_f32_16x16x32_bf16 v[44:47], a[168:171], a[28:31], v[44:47]
 ds_read_b64_tr_b16 a[184:185], v10 offset:50784
 v_mfma_f32_16x16x32_bf16 v[44:47], a[172:175], a[44:47], v[44:47]
 ds_read_b64_tr_b16 a[186:187], v10 offset:51040
 v_mfma_f32_16x16x32_bf16 v[40:43], a[172:175], a[40:43], v[40:43]
 buffer_load_dwordx4 v4, s[48:51], s65 offen offset:0 lds
 v_mfma_f32_16x16x32_bf16 v[40:43], a[168:171], a[24:27], v[40:43]
 v_mfma_f32_16x16x32_bf16 v[36:39], a[168:171], a[20:23], v[36:39]
 ds_read_b64_tr_b16 a[188:189], v10 offset:59232
 v_mfma_f32_16x16x32_bf16 v[36:39], a[172:175], a[36:39], v[36:39]
 ds_read_b64_tr_b16 a[190:191], v10 offset:59488
 v_mfma_f32_16x16x32_bf16 v[32:35], a[172:175], a[32:35], v[32:35]
 buffer_load_dwordx4 a[92:95], v8, s[16:19], s64 offen offset:3072
 v_mfma_f32_16x16x32_bf16 v[32:35], a[168:171], a[16:19], v[32:35]
 s_waitcnt lgkmcnt(4)
 v_mfma_f32_16x16x32_bf16 v[48:51], a[176:179], a[16:19], v[48:51]
 ds_read_b64_tr_b16 a[160:161], v10 offset:50816
 v_mfma_f32_16x16x32_bf16 v[48:51], a[180:183], a[32:35], v[48:51]
 ds_read_b64_tr_b16 a[162:163], v10 offset:51072
 v_mfma_f32_16x16x32_bf16 v[52:55], a[180:183], a[36:39], v[52:55]
 buffer_load_dwordx4 a[96:99], v240, s[16:19], s64 offen offset:0
 v_mfma_f32_16x16x32_bf16 v[52:55], a[176:179], a[20:23], v[52:55]
 v_mfma_f32_16x16x32_bf16 v[56:59], a[176:179], a[24:27], v[56:59]
 ds_read_b64_tr_b16 a[164:165], v10 offset:59264
 v_mfma_f32_16x16x32_bf16 v[56:59], a[180:183], a[40:43], v[56:59]
 ds_read_b64_tr_b16 a[166:167], v10 offset:59520
 v_mfma_f32_16x16x32_bf16 v[60:63], a[180:183], a[44:47], v[60:63]
 buffer_load_dwordx4 v5, s[48:51], s65 offen offset:1056 lds
 v_mfma_f32_16x16x32_bf16 v[60:63], a[176:179], a[28:31], v[60:63]
 s_waitcnt lgkmcnt(4)
 v_mfma_f32_16x16x32_bf16 v[76:79], a[184:187], a[28:31], v[76:79]
 ds_read_b64_tr_b16 a[168:169], v10 offset:50848
 v_mfma_f32_16x16x32_bf16 v[76:79], a[188:191], a[44:47], v[76:79]
 ds_read_b64_tr_b16 a[170:171], v10 offset:51104
 v_mfma_f32_16x16x32_bf16 v[72:75], a[188:191], a[40:43], v[72:75]
 buffer_load_dwordx4 a[100:103], v240, s[16:19], s64 offen offset:1024
 v_mfma_f32_16x16x32_bf16 v[72:75], a[184:187], a[24:27], v[72:75]
 v_mfma_f32_16x16x32_bf16 v[68:71], a[184:187], a[20:23], v[68:71]
 ds_read_b64_tr_b16 a[172:173], v10 offset:59296
 v_mfma_f32_16x16x32_bf16 v[68:71], a[188:191], a[36:39], v[68:71]
 ds_read_b64_tr_b16 a[174:175], v10 offset:59552
 v_mfma_f32_16x16x32_bf16 v[64:67], a[188:191], a[32:35], v[64:67]
 v_mfma_f32_16x16x32_bf16 v[64:67], a[184:187], a[16:19], v[64:67]
 s_waitcnt lgkmcnt(4)
 v_mfma_f32_16x16x32_bf16 v[80:83], a[160:163], a[16:19], v[80:83]
 ds_read_b64_tr_b16 a[176:177], v10 offset:50880
 v_mfma_f32_16x16x32_bf16 v[80:83], a[164:167], a[32:35], v[80:83]
 ds_read_b64_tr_b16 a[178:179], v10 offset:51136
 v_mfma_f32_16x16x32_bf16 v[84:87], a[164:167], a[36:39], v[84:87]
 buffer_load_dwordx4 v6, s[48:51], s65 offen offset:2112 lds
 v_mfma_f32_16x16x32_bf16 v[84:87], a[160:163], a[20:23], v[84:87]
 v_mfma_f32_16x16x32_bf16 v[88:91], a[160:163], a[24:27], v[88:91]
 ds_read_b64_tr_b16 a[180:181], v10 offset:59328
 v_mfma_f32_16x16x32_bf16 v[88:91], a[164:167], a[40:43], v[88:91]
 ds_read_b64_tr_b16 a[182:183], v10 offset:59584
 v_mfma_f32_16x16x32_bf16 v[92:95], a[164:167], a[44:47], v[92:95]
 buffer_load_dwordx4 a[104:107], v240, s[16:19], s64 offen offset:2048
 v_mfma_f32_16x16x32_bf16 v[92:95], a[160:163], a[28:31], v[92:95]
 s_waitcnt lgkmcnt(4)
 v_mfma_f32_16x16x32_bf16 v[108:111], a[168:171], a[28:31], v[108:111]
 ds_read_b64_tr_b16 a[184:185], v10 offset:50912
 v_mfma_f32_16x16x32_bf16 v[108:111], a[172:175], a[44:47], v[108:111]
 ds_read_b64_tr_b16 a[186:187], v10 offset:51168
 v_mfma_f32_16x16x32_bf16 v[104:107], a[172:175], a[40:43], v[104:107]
 buffer_load_dwordx4 a[108:111], v240, s[16:19], s64 offen offset:3072
 v_mfma_f32_16x16x32_bf16 v[104:107], a[168:171], a[24:27], v[104:107]
 v_mfma_f32_16x16x32_bf16 v[100:103], a[168:171], a[20:23], v[100:103]
 ds_read_b64_tr_b16 a[188:189], v10 offset:59360
 v_mfma_f32_16x16x32_bf16 v[100:103], a[172:175], a[36:39], v[100:103]
 ds_read_b64_tr_b16 a[190:191], v10 offset:59616
 v_mfma_f32_16x16x32_bf16 v[96:99], a[172:175], a[32:35], v[96:99]
 buffer_load_dwordx4 v7, s[48:51], s65 offen offset:3168 lds
 v_mfma_f32_16x16x32_bf16 v[96:99], a[168:171], a[16:19], v[96:99]
 s_waitcnt lgkmcnt(4)
 v_mfma_f32_16x16x32_bf16 v[112:115], a[176:179], a[16:19], v[112:115]
 ds_read_b64_tr_b16 a[160:161], v9 offset:0
 v_mfma_f32_16x16x32_bf16 v[112:115], a[180:183], a[32:35], v[112:115]
 ds_read_b64_tr_b16 a[162:163], v9 offset:256
 s_add_u32 s64, s71, 73728
 v_mfma_f32_16x16x32_bf16 v[116:119], a[180:183], a[36:39], v[116:119]
 buffer_load_dwordx4 a[112:115], v8, s[16:19], s64 offen offset:0
 v_mfma_f32_16x16x32_bf16 v[116:119], a[176:179], a[20:23], v[116:119]
 v_mfma_f32_16x16x32_bf16 v[120:123], a[176:179], a[24:27], v[120:123]
 ds_read_b64_tr_b16 a[164:165], v9 offset:8448
 v_mfma_f32_16x16x32_bf16 v[120:123], a[180:183], a[40:43], v[120:123]
 ds_read_b64_tr_b16 a[166:167], v9 offset:8704
 v_mfma_f32_16x16x32_bf16 v[124:127], a[180:183], a[44:47], v[124:127]
 v_mfma_f32_16x16x32_bf16 v[124:127], a[176:179], a[28:31], v[124:127]
 s_add_u32 s65, s82, 1703936
 s_waitcnt lgkmcnt(4)
 v_mfma_f32_16x16x32_bf16 v[140:143], a[184:187], a[28:31], v[140:143]
 ds_read_b64_tr_b16 a[168:169], v9 offset:32
 v_mfma_f32_16x16x32_bf16 v[140:143], a[188:191], a[44:47], v[140:143]
 ds_read_b64_tr_b16 a[170:171], v9 offset:288
 v_mfma_f32_16x16x32_bf16 v[136:139], a[188:191], a[40:43], v[136:139]
 buffer_load_dwordx4 a[116:119], v8, s[16:19], s64 offen offset:1024
 v_mfma_f32_16x16x32_bf16 v[136:139], a[184:187], a[24:27], v[136:139]
 v_mfma_f32_16x16x32_bf16 v[132:135], a[184:187], a[20:23], v[132:135]
 ds_read_b64_tr_b16 a[172:173], v9 offset:8480
 v_mfma_f32_16x16x32_bf16 v[132:135], a[188:191], a[36:39], v[132:135]
 ds_read_b64_tr_b16 a[174:175], v9 offset:8736
 v_mfma_f32_16x16x32_bf16 v[128:131], a[188:191], a[32:35], v[128:131]
 buffer_load_dwordx4 a[120:123], v8, s[16:19], s64 offen offset:2048
 v_mfma_f32_16x16x32_bf16 v[128:131], a[184:187], a[16:19], v[128:131]
 s_waitcnt vmcnt(15) lgkmcnt(4)
 v_mfma_f32_16x16x32_bf16 v[16:19], a[160:163], a[48:51], v[16:19]
 ds_read_b64_tr_b16 a[176:177], v9 offset:64
 v_mfma_f32_16x16x32_bf16 v[16:19], a[164:167], a[64:67], v[16:19]
 ds_read_b64_tr_b16 a[178:179], v9 offset:320
 v_mfma_f32_16x16x32_bf16 v[20:23], a[164:167], a[68:71], v[20:23]
 buffer_load_dwordx4 a[124:127], v8, s[16:19], s64 offen offset:3072
 v_mfma_f32_16x16x32_bf16 v[20:23], a[160:163], a[52:55], v[20:23]
 s_add_u32 m0, s63, 101376
 v_mfma_f32_16x16x32_bf16 v[24:27], a[160:163], a[56:59], v[24:27]
 ds_read_b64_tr_b16 a[180:181], v9 offset:8512
 v_mfma_f32_16x16x32_bf16 v[24:27], a[164:167], a[72:75], v[24:27]
 ds_read_b64_tr_b16 a[182:183], v9 offset:8768
 v_mfma_f32_16x16x32_bf16 v[28:31], a[164:167], a[76:79], v[28:31]
 v_mfma_f32_16x16x32_bf16 v[28:31], a[160:163], a[60:63], v[28:31]
 s_waitcnt lgkmcnt(4)
 v_mfma_f32_16x16x32_bf16 v[44:47], a[168:171], a[60:63], v[44:47]
 ds_read_b64_tr_b16 a[184:185], v9 offset:96
 v_mfma_f32_16x16x32_bf16 v[44:47], a[172:175], a[76:79], v[44:47]
 ds_read_b64_tr_b16 a[186:187], v9 offset:352
 v_mfma_f32_16x16x32_bf16 v[40:43], a[172:175], a[72:75], v[40:43]
 buffer_load_dwordx4 v4, s[48:51], s65 offen offset:0 lds
 v_mfma_f32_16x16x32_bf16 v[40:43], a[168:171], a[56:59], v[40:43]
 v_mfma_f32_16x16x32_bf16 v[36:39], a[168:171], a[52:55], v[36:39]
 ds_read_b64_tr_b16 a[188:189], v9 offset:8544
 v_mfma_f32_16x16x32_bf16 v[36:39], a[172:175], a[68:71], v[36:39]
 ds_read_b64_tr_b16 a[190:191], v9 offset:8800
 v_mfma_f32_16x16x32_bf16 v[32:35], a[172:175], a[64:67], v[32:35]
 buffer_load_dwordx4 a[192:195], v240, s[16:19], s64 offen offset:0
 v_mfma_f32_16x16x32_bf16 v[32:35], a[168:171], a[48:51], v[32:35]
 s_waitcnt lgkmcnt(4)
 v_mfma_f32_16x16x32_bf16 v[48:51], a[176:179], a[48:51], v[48:51]
 ds_read_b64_tr_b16 a[160:161], v9 offset:128
 v_mfma_f32_16x16x32_bf16 v[48:51], a[180:183], a[64:67], v[48:51]
 ds_read_b64_tr_b16 a[162:163], v9 offset:384
 v_mfma_f32_16x16x32_bf16 v[52:55], a[180:183], a[68:71], v[52:55]
 buffer_load_dwordx4 a[196:199], v240, s[16:19], s64 offen offset:1024
 v_mfma_f32_16x16x32_bf16 v[52:55], a[176:179], a[52:55], v[52:55]
 v_mfma_f32_16x16x32_bf16 v[56:59], a[176:179], a[56:59], v[56:59]
 ds_read_b64_tr_b16 a[164:165], v9 offset:8576
 v_mfma_f32_16x16x32_bf16 v[56:59], a[180:183], a[72:75], v[56:59]
 ds_read_b64_tr_b16 a[166:167], v9 offset:8832
 v_mfma_f32_16x16x32_bf16 v[60:63], a[180:183], a[76:79], v[60:63]
 buffer_load_dwordx4 v5, s[48:51], s65 offen offset:1056 lds
 v_mfma_f32_16x16x32_bf16 v[60:63], a[176:179], a[60:63], v[60:63]
 s_waitcnt lgkmcnt(4)
 v_mfma_f32_16x16x32_bf16 v[76:79], a[184:187], a[60:63], v[76:79]
 ds_read_b64_tr_b16 a[168:169], v9 offset:160
 v_mfma_f32_16x16x32_bf16 v[76:79], a[188:191], a[76:79], v[76:79]
 ds_read_b64_tr_b16 a[170:171], v9 offset:416
 v_mfma_f32_16x16x32_bf16 v[72:75], a[188:191], a[72:75], v[72:75]
 buffer_load_dwordx4 a[200:203], v240, s[16:19], s64 offen offset:2048
 v_mfma_f32_16x16x32_bf16 v[72:75], a[184:187], a[56:59], v[72:75]
 v_mfma_f32_16x16x32_bf16 v[68:71], a[184:187], a[52:55], v[68:71]
 ds_read_b64_tr_b16 a[172:173], v9 offset:8608
 v_mfma_f32_16x16x32_bf16 v[68:71], a[188:191], a[68:71], v[68:71]
 ds_read_b64_tr_b16 a[174:175], v9 offset:8864
 v_mfma_f32_16x16x32_bf16 v[64:67], a[188:191], a[64:67], v[64:67]
 v_mfma_f32_16x16x32_bf16 v[64:67], a[184:187], a[48:51], v[64:67]
 s_waitcnt lgkmcnt(4)
 v_mfma_f32_16x16x32_bf16 v[80:83], a[160:163], a[48:51], v[80:83]
 ds_read_b64_tr_b16 a[176:177], v9 offset:192
 v_mfma_f32_16x16x32_bf16 v[80:83], a[164:167], a[64:67], v[80:83]
 ds_read_b64_tr_b16 a[178:179], v9 offset:448
 v_mfma_f32_16x16x32_bf16 v[84:87], a[164:167], a[68:71], v[84:87]
 buffer_load_dwordx4 v6, s[48:51], s65 offen offset:2112 lds
 v_mfma_f32_16x16x32_bf16 v[84:87], a[160:163], a[52:55], v[84:87]
 v_mfma_f32_16x16x32_bf16 v[88:91], a[160:163], a[56:59], v[88:91]
 ds_read_b64_tr_b16 a[180:181], v9 offset:8640
 v_mfma_f32_16x16x32_bf16 v[88:91], a[164:167], a[72:75], v[88:91]
 ds_read_b64_tr_b16 a[182:183], v9 offset:8896
 v_mfma_f32_16x16x32_bf16 v[92:95], a[164:167], a[76:79], v[92:95]
 buffer_load_dwordx4 a[204:207], v240, s[16:19], s64 offen offset:3072
 v_mfma_f32_16x16x32_bf16 v[92:95], a[160:163], a[60:63], v[92:95]
 s_waitcnt lgkmcnt(4)
 v_mfma_f32_16x16x32_bf16 v[108:111], a[168:171], a[60:63], v[108:111]
 ds_read_b64_tr_b16 a[184:185], v9 offset:224
 v_mfma_f32_16x16x32_bf16 v[108:111], a[172:175], a[76:79], v[108:111]
 ds_read_b64_tr_b16 a[186:187], v9 offset:480
 s_add_u32 s64, s71, 81920
 v_mfma_f32_16x16x32_bf16 v[104:107], a[172:175], a[72:75], v[104:107]
 buffer_load_dwordx4 a[208:211], v8, s[16:19], s64 offen offset:0
 v_mfma_f32_16x16x32_bf16 v[104:107], a[168:171], a[56:59], v[104:107]
 v_mfma_f32_16x16x32_bf16 v[100:103], a[168:171], a[52:55], v[100:103]
 ds_read_b64_tr_b16 a[188:189], v9 offset:8672
 v_mfma_f32_16x16x32_bf16 v[100:103], a[172:175], a[68:71], v[100:103]
 ds_read_b64_tr_b16 a[190:191], v9 offset:8928
 v_mfma_f32_16x16x32_bf16 v[96:99], a[172:175], a[64:67], v[96:99]
 s_branch L_pg15k
L_pg15:
L_ic3w3:
 s_branch L_pg19
L_pg15k:
 buffer_load_dwordx4 v7, s[48:51], s65 offen offset:3168 lds
 v_mfma_f32_16x16x32_bf16 v[96:99], a[168:171], a[48:51], v[96:99]
 s_waitcnt vmcnt(49)
 s_barrier
 s_waitcnt lgkmcnt(4)
 v_mfma_f32_16x16x32_bf16 v[112:115], a[176:179], a[48:51], v[112:115]
 ds_read_b64_tr_b16 a[160:161], v9 offset:16896
 v_mfma_f32_16x16x32_bf16 v[112:115], a[180:183], a[64:67], v[112:115]
 ds_read_b64_tr_b16 a[162:163], v9 offset:17152
 v_mfma_f32_16x16x32_bf16 v[116:119], a[180:183], a[68:71], v[116:119]
 buffer_load_dwordx4 a[212:215], v8, s[16:19], s64 offen offset:1024
 v_mfma_f32_16x16x32_bf16 v[116:119], a[176:179], a[52:55], v[116:119]
 v_mfma_f32_16x16x32_bf16 v[120:123], a[176:179], a[56:59], v[120:123]
 ds_read_b64_tr_b16 a[164:165], v9 offset:25344
 v_mfma_f32_16x16x32_bf16 v[120:123], a[180:183], a[72:75], v[120:123]
 ds_read_b64_tr_b16 a[166:167], v9 offset:25600
 v_mfma_f32_16x16x32_bf16 v[124:127], a[180:183], a[76:79], v[124:127]
 v_mfma_f32_16x16x32_bf16 v[124:127], a[176:179], a[60:63], v[124:127]
 s_add_u32 s65, s66, 0
 s_waitcnt lgkmcnt(4)
 v_mfma_f32_16x16x32_bf16 v[140:143], a[184:187], a[60:63], v[140:143]
 ds_read_b64_tr_b16 a[168:169], v9 offset:16928
 v_mfma_f32_16x16x32_bf16 v[140:143], a[188:191], a[76:79], v[140:143]
 ds_read_b64_tr_b16 a[170:171], v9 offset:17184
 v_mfma_f32_16x16x32_bf16 v[136:139], a[188:191], a[72:75], v[136:139]
 buffer_load_dwordx4 a[216:219], v8, s[16:19], s64 offen offset:2048
 v_mfma_f32_16x16x32_bf16 v[136:139], a[184:187], a[56:59], v[136:139]
 v_mfma_f32_16x16x32_bf16 v[132:135], a[184:187], a[52:55], v[132:135]
 ds_read_b64_tr_b16 a[172:173], v9 offset:25376
 v_mfma_f32_16x16x32_bf16 v[132:135], a[188:191], a[68:71], v[132:135]
 ds_read_b64_tr_b16 a[174:175], v9 offset:25632
 v_mfma_f32_16x16x32_bf16 v[128:131], a[188:191], a[64:67], v[128:131]
 buffer_load_dwordx4 a[220:223], v8, s[16:19], s64 offen offset:3072
 v_mfma_f32_16x16x32_bf16 v[128:131], a[184:187], a[48:51], v[128:131]
 s_waitcnt vmcnt(17) lgkmcnt(4)
 v_mfma_f32_16x16x32_bf16 v[16:19], a[160:163], a[80:83], v[16:19]
 ds_read_b64_tr_b16 a[176:177], v9 offset:16960
 v_mfma_f32_16x16x32_bf16 v[16:19], a[164:167], a[96:99], v[16:19]
 ds_read_b64_tr_b16 a[178:179], v9 offset:17216
 v_mfma_f32_16x16x32_bf16 v[20:23], a[164:167], a[100:103], v[20:23]
 buffer_load_dwordx4 a[224:227], v240, s[16:19], s64 offen offset:0
 v_mfma_f32_16x16x32_bf16 v[20:23], a[160:163], a[84:87], v[20:23]
 s_add_u32 m0, s63, 118272
 v_mfma_f32_16x16x32_bf16 v[24:27], a[160:163], a[88:91], v[24:27]
 ds_read_b64_tr_b16 a[180:181], v9 offset:25408
 v_mfma_f32_16x16x32_bf16 v[24:27], a[164:167], a[104:107], v[24:27]
 ds_read_b64_tr_b16 a[182:183], v9 offset:25664
 v_mfma_f32_16x16x32_bf16 v[28:31], a[164:167], a[108:111], v[28:31]
 v_mfma_f32_16x16x32_bf16 v[28:31], a[160:163], a[92:95], v[28:31]
 s_waitcnt lgkmcnt(4)
 v_mfma_f32_16x16x32_bf16 v[44:47], a[168:171], a[92:95], v[44:47]
 ds_read_b64_tr_b16 a[184:185], v9 offset:16992
 v_mfma_f32_16x16x32_bf16 v[44:47], a[172:175], a[108:111], v[44:47]
 ds_read_b64_tr_b16 a[186:187], v9 offset:17248
 v_mfma_f32_16x16x32_bf16 v[40:43], a[172:175], a[104:107], v[40:43]
 buffer_load_dwordx4 v4, s[44:47], s65 offen offset:0 lds
 v_mfma_f32_16x16x32_bf16 v[40:43], a[168:171], a[88:91], v[40:43]
 v_mfma_f32_16x16x32_bf16 v[36:39], a[168:171], a[84:87], v[36:39]
 ds_read_b64_tr_b16 a[188:189], v9 offset:25440
 v_mfma_f32_16x16x32_bf16 v[36:39], a[172:175], a[100:103], v[36:39]
 ds_read_b64_tr_b16 a[190:191], v9 offset:25696
 v_mfma_f32_16x16x32_bf16 v[32:35], a[172:175], a[96:99], v[32:35]
 buffer_load_dwordx4 a[228:231], v240, s[16:19], s64 offen offset:1024
 v_mfma_f32_16x16x32_bf16 v[32:35], a[168:171], a[80:83], v[32:35]
 s_waitcnt lgkmcnt(4)
 v_mfma_f32_16x16x32_bf16 v[48:51], a[176:179], a[80:83], v[48:51]
 ds_read_b64_tr_b16 a[160:161], v9 offset:17024
 v_mfma_f32_16x16x32_bf16 v[48:51], a[180:183], a[96:99], v[48:51]
 ds_read_b64_tr_b16 a[162:163], v9 offset:17280
 v_mfma_f32_16x16x32_bf16 v[52:55], a[180:183], a[100:103], v[52:55]
 buffer_load_dwordx4 a[232:235], v240, s[16:19], s64 offen offset:2048
 v_mfma_f32_16x16x32_bf16 v[52:55], a[176:179], a[84:87], v[52:55]
 v_mfma_f32_16x16x32_bf16 v[56:59], a[176:179], a[88:91], v[56:59]
 ds_read_b64_tr_b16 a[164:165], v9 offset:25472
 v_mfma_f32_16x16x32_bf16 v[56:59], a[180:183], a[104:107], v[56:59]
 ds_read_b64_tr_b16 a[166:167], v9 offset:25728
 v_mfma_f32_16x16x32_bf16 v[60:63], a[180:183], a[108:111], v[60:63]
 buffer_load_dwordx4 v5, s[44:47], s65 offen offset:1056 lds
 v_mfma_f32_16x16x32_bf16 v[60:63], a[176:179], a[92:95], v[60:63]
 s_waitcnt lgkmcnt(4)
 v_mfma_f32_16x16x32_bf16 v[76:79], a[184:187], a[92:95], v[76:79]
 ds_read_b64_tr_b16 a[168:169], v9 offset:17056
 v_mfma_f32_16x16x32_bf16 v[76:79], a[188:191], a[108:111], v[76:79]
 ds_read_b64_tr_b16 a[170:171], v9 offset:17312
 v_mfma_f32_16x16x32_bf16 v[72:75], a[188:191], a[104:107], v[72:75]
 buffer_load_dwordx4 a[236:239], v240, s[16:19], s64 offen offset:3072
 v_mfma_f32_16x16x32_bf16 v[72:75], a[184:187], a[88:91], v[72:75]
 v_mfma_f32_16x16x32_bf16 v[68:71], a[184:187], a[84:87], v[68:71]
 ds_read_b64_tr_b16 a[172:173], v9 offset:25504
 v_mfma_f32_16x16x32_bf16 v[68:71], a[188:191], a[100:103], v[68:71]
 ds_read_b64_tr_b16 a[174:175], v9 offset:25760
 v_mfma_f32_16x16x32_bf16 v[64:67], a[188:191], a[96:99], v[64:67]
 v_mfma_f32_16x16x32_bf16 v[64:67], a[184:187], a[80:83], v[64:67]
 s_waitcnt lgkmcnt(4)
 v_mfma_f32_16x16x32_bf16 v[80:83], a[160:163], a[80:83], v[80:83]
 ds_read_b64_tr_b16 a[176:177], v9 offset:17088
 v_mfma_f32_16x16x32_bf16 v[80:83], a[164:167], a[96:99], v[80:83]
 ds_read_b64_tr_b16 a[178:179], v9 offset:17344
 v_mfma_f32_16x16x32_bf16 v[84:87], a[164:167], a[100:103], v[84:87]
 buffer_load_dwordx4 v6, s[44:47], s65 offen offset:2112 lds
 v_mfma_f32_16x16x32_bf16 v[84:87], a[160:163], a[84:87], v[84:87]
 v_mfma_f32_16x16x32_bf16 v[88:91], a[160:163], a[88:91], v[88:91]
 ds_read_b64_tr_b16 a[180:181], v9 offset:25536
 v_mfma_f32_16x16x32_bf16 v[88:91], a[164:167], a[104:107], v[88:91]
 ds_read_b64_tr_b16 a[182:183], v9 offset:25792
 s_add_u32 s64, s71, 90112
 v_mfma_f32_16x16x32_bf16 v[92:95], a[164:167], a[108:111], v[92:95]
 buffer_load_dwordx4 a[240:243], v8, s[16:19], s64 offen offset:0
 v_mfma_f32_16x16x32_bf16 v[92:95], a[160:163], a[92:95], v[92:95]
 s_waitcnt lgkmcnt(4)
 v_mfma_f32_16x16x32_bf16 v[108:111], a[168:171], a[92:95], v[108:111]
 ds_read_b64_tr_b16 a[184:185], v9 offset:17120
 v_mfma_f32_16x16x32_bf16 v[108:111], a[172:175], a[108:111], v[108:111]
 ds_read_b64_tr_b16 a[186:187], v9 offset:17376
 v_mfma_f32_16x16x32_bf16 v[104:107], a[172:175], a[104:107], v[104:107]
 buffer_load_dwordx4 a[244:247], v8, s[16:19], s64 offen offset:1024
 v_mfma_f32_16x16x32_bf16 v[104:107], a[168:171], a[88:91], v[104:107]
 v_mfma_f32_16x16x32_bf16 v[100:103], a[168:171], a[84:87], v[100:103]
 ds_read_b64_tr_b16 a[188:189], v9 offset:25568
 v_mfma_f32_16x16x32_bf16 v[100:103], a[172:175], a[100:103], v[100:103]
 ds_read_b64_tr_b16 a[190:191], v9 offset:25824
 v_mfma_f32_16x16x32_bf16 v[96:99], a[172:175], a[96:99], v[96:99]
 buffer_load_dwordx4 v7, s[44:47], s65 offen offset:3168 lds
 v_mfma_f32_16x16x32_bf16 v[96:99], a[168:171], a[80:83], v[96:99]
 s_waitcnt lgkmcnt(4)
 v_mfma_f32_16x16x32_bf16 v[112:115], a[176:179], a[80:83], v[112:115]
 ds_read_b64_tr_b16 a[160:161], v9 offset:33792
 v_mfma_f32_16x16x32_bf16 v[112:115], a[180:183], a[96:99], v[112:115]
 ds_read_b64_tr_b16 a[162:163], v9 offset:34048
 v_mfma_f32_16x16x32_bf16 v[116:119], a[180:183], a[100:103], v[116:119]
 buffer_load_dwordx4 a[248:251], v8, s[16:19], s64 offen offset:2048
 v_mfma_f32_16x16x32_bf16 v[116:119], a[176:179], a[84:87], v[116:119]
 v_mfma_f32_16x16x32_bf16 v[120:123], a[176:179], a[88:91], v[120:123]
 ds_read_b64_tr_b16 a[164:165], v9 offset:42240
 v_mfma_f32_16x16x32_bf16 v[120:123], a[180:183], a[104:107], v[120:123]
 ds_read_b64_tr_b16 a[166:167], v9 offset:42496
 v_mfma_f32_16x16x32_bf16 v[124:127], a[180:183], a[108:111], v[124:127]
 v_mfma_f32_16x16x32_bf16 v[124:127], a[176:179], a[92:95], v[124:127]
 s_add_u32 s65, s66, 131072
 s_waitcnt lgkmcnt(4)
 v_mfma_f32_16x16x32_bf16 v[140:143], a[184:187], a[92:95], v[140:143]
 ds_read_b64_tr_b16 a[168:169], v9 offset:33824
 v_mfma_f32_16x16x32_bf16 v[140:143], a[188:191], a[108:111], v[140:143]
 ds_read_b64_tr_b16 a[170:171], v9 offset:34080
 v_mfma_f32_16x16x32_bf16 v[136:139], a[188:191], a[104:107], v[136:139]
 buffer_load_dwordx4 a[252:255], v8, s[16:19], s64 offen offset:3072
 v_mfma_f32_16x16x32_bf16 v[136:139], a[184:187], a[88:91], v[136:139]
 v_mfma_f32_16x16x32_bf16 v[132:135], a[184:187], a[84:87], v[132:135]
 ds_read_b64_tr_b16 a[172:173], v9 offset:42272
 v_mfma_f32_16x16x32_bf16 v[132:135], a[188:191], a[100:103], v[132:135]
 ds_read_b64_tr_b16 a[174:175], v9 offset:42528
 v_mfma_f32_16x16x32_bf16 v[128:131], a[188:191], a[96:99], v[128:131]
 buffer_load_dwordx4 a[128:131], v240, s[16:19], s64 offen offset:0
 v_mfma_f32_16x16x32_bf16 v[128:131], a[184:187], a[80:83], v[128:131]
 s_waitcnt vmcnt(18) lgkmcnt(4)
 v_mfma_f32_16x16x32_bf16 v[16:19], a[160:163], a[112:115], v[16:19]
 ds_read_b64_tr_b16 a[176:177], v9 offset:33856
 v_mfma_f32_16x16x32_bf16 v[16:19], a[164:167], a[192:195], v[16:19]
 ds_read_b64_tr_b16 a[178:179], v9 offset:34112
 v_mfma_f32_16x16x32_bf16 v[20:23], a[164:167], a[196:199], v[20:23]
 buffer_load_dwordx4 a[132:135], v240, s[16:19], s64 offen offset:1024
 v_mfma_f32_16x16x32_bf16 v[20:23], a[160:163], a[116:119], v[20:23]
 s_add_u32 m0, s63, 0
 v_mfma_f32_16x16x32_bf16 v[24:27], a[160:163], a[120:123], v[24:27]
 ds_read_b64_tr_b16 a[180:181], v9 offset:42304
 v_mfma_f32_16x16x32_bf16 v[24:27], a[164:167], a[200:203], v[24:27]
 ds_read_b64_tr_b16 a[182:183], v9 offset:42560
 v_mfma_f32_16x16x32_bf16 v[28:31], a[164:167], a[204:207], v[28:31]
 v_mfma_f32_16x16x32_bf16 v[28:31], a[160:163], a[124:127], v[28:31]
 s_waitcnt lgkmcnt(4)
 v_mfma_f32_16x16x32_bf16 v[44:47], a[168:171], a[124:127], v[44:47]
 ds_read_b64_tr_b16 a[184:185], v9 offset:33888
 v_mfma_f32_16x16x32_bf16 v[44:47], a[172:175], a[204:207], v[44:47]
 ds_read_b64_tr_b16 a[186:187], v9 offset:34144
 v_mfma_f32_16x16x32_bf16 v[40:43], a[172:175], a[200:203], v[40:43]
 buffer_load_dwordx4 v4, s[44:47], s65 offen offset:0 lds
 v_mfma_f32_16x16x32_bf16 v[40:43], a[168:171], a[120:123], v[40:43]
 v_mfma_f32_16x16x32_bf16 v[36:39], a[168:171], a[116:119], v[36:39]
 ds_read_b64_tr_b16 a[188:189], v9 offset:42336
 v_mfma_f32_16x16x32_bf16 v[36:39], a[172:175], a[196:199], v[36:39]
 ds_read_b64_tr_b16 a[190:191], v9 offset:42592
 v_mfma_f32_16x16x32_bf16 v[32:35], a[172:175], a[192:195], v[32:35]
 buffer_load_dwordx4 a[136:139], v240, s[16:19], s64 offen offset:2048
 v_mfma_f32_16x16x32_bf16 v[32:35], a[168:171], a[112:115], v[32:35]
 s_waitcnt lgkmcnt(4)
 v_mfma_f32_16x16x32_bf16 v[48:51], a[176:179], a[112:115], v[48:51]
 ds_read_b64_tr_b16 a[160:161], v9 offset:33920
 v_mfma_f32_16x16x32_bf16 v[48:51], a[180:183], a[192:195], v[48:51]
 ds_read_b64_tr_b16 a[162:163], v9 offset:34176
 v_mfma_f32_16x16x32_bf16 v[52:55], a[180:183], a[196:199], v[52:55]
 buffer_load_dwordx4 a[140:143], v240, s[16:19], s64 offen offset:3072
 v_mfma_f32_16x16x32_bf16 v[52:55], a[176:179], a[116:119], v[52:55]
 v_mfma_f32_16x16x32_bf16 v[56:59], a[176:179], a[120:123], v[56:59]
 ds_read_b64_tr_b16 a[164:165], v9 offset:42368
 v_mfma_f32_16x16x32_bf16 v[56:59], a[180:183], a[200:203], v[56:59]
 ds_read_b64_tr_b16 a[166:167], v9 offset:42624
 v_mfma_f32_16x16x32_bf16 v[60:63], a[180:183], a[204:207], v[60:63]
 buffer_load_dwordx4 v5, s[44:47], s65 offen offset:1056 lds
 v_mfma_f32_16x16x32_bf16 v[60:63], a[176:179], a[124:127], v[60:63]
 s_waitcnt lgkmcnt(4)
 v_mfma_f32_16x16x32_bf16 v[76:79], a[184:187], a[124:127], v[76:79]
 ds_read_b64_tr_b16 a[168:169], v9 offset:33952
 v_mfma_f32_16x16x32_bf16 v[76:79], a[188:191], a[204:207], v[76:79]
 ds_read_b64_tr_b16 a[170:171], v9 offset:34208
 s_add_u32 s64, s71, 98304
 v_mfma_f32_16x16x32_bf16 v[72:75], a[188:191], a[200:203], v[72:75]
 buffer_load_dwordx4 a[144:147], v8, s[16:19], s64 offen offset:0
 v_mfma_f32_16x16x32_bf16 v[72:75], a[184:187], a[120:123], v[72:75]
 v_mfma_f32_16x16x32_bf16 v[68:71], a[184:187], a[116:119], v[68:71]
 ds_read_b64_tr_b16 a[172:173], v9 offset:42400
 v_mfma_f32_16x16x32_bf16 v[68:71], a[188:191], a[196:199], v[68:71]
 ds_read_b64_tr_b16 a[174:175], v9 offset:42656
 v_mfma_f32_16x16x32_bf16 v[64:67], a[188:191], a[192:195], v[64:67]
 v_mfma_f32_16x16x32_bf16 v[64:67], a[184:187], a[112:115], v[64:67]
 s_waitcnt lgkmcnt(4)
 v_mfma_f32_16x16x32_bf16 v[80:83], a[160:163], a[112:115], v[80:83]
 ds_read_b64_tr_b16 a[176:177], v9 offset:33984
 v_mfma_f32_16x16x32_bf16 v[80:83], a[164:167], a[192:195], v[80:83]
 ds_read_b64_tr_b16 a[178:179], v9 offset:34240
 v_mfma_f32_16x16x32_bf16 v[84:87], a[164:167], a[196:199], v[84:87]
 buffer_load_dwordx4 v6, s[44:47], s65 offen offset:2112 lds
 v_mfma_f32_16x16x32_bf16 v[84:87], a[160:163], a[116:119], v[84:87]
 v_mfma_f32_16x16x32_bf16 v[88:91], a[160:163], a[120:123], v[88:91]
 ds_read_b64_tr_b16 a[180:181], v9 offset:42432
 v_mfma_f32_16x16x32_bf16 v[88:91], a[164:167], a[200:203], v[88:91]
 ds_read_b64_tr_b16 a[182:183], v9 offset:42688
 v_mfma_f32_16x16x32_bf16 v[92:95], a[164:167], a[204:207], v[92:95]
 buffer_load_dwordx4 a[148:151], v8, s[16:19], s64 offen offset:1024
 v_mfma_f32_16x16x32_bf16 v[92:95], a[160:163], a[124:127], v[92:95]
 s_waitcnt lgkmcnt(4)
 v_mfma_f32_16x16x32_bf16 v[108:111], a[168:171], a[124:127], v[108:111]
 ds_read_b64_tr_b16 a[184:185], v9 offset:34016
 v_mfma_f32_16x16x32_bf16 v[108:111], a[172:175], a[204:207], v[108:111]
 ds_read_b64_tr_b16 a[186:187], v9 offset:34272
 v_mfma_f32_16x16x32_bf16 v[104:107], a[172:175], a[200:203], v[104:107]
 buffer_load_dwordx4 a[152:155], v8, s[16:19], s64 offen offset:2048
 v_mfma_f32_16x16x32_bf16 v[104:107], a[168:171], a[120:123], v[104:107]
 v_mfma_f32_16x16x32_bf16 v[100:103], a[168:171], a[116:119], v[100:103]
 ds_read_b64_tr_b16 a[188:189], v9 offset:42464
 v_mfma_f32_16x16x32_bf16 v[100:103], a[172:175], a[196:199], v[100:103]
 ds_read_b64_tr_b16 a[190:191], v9 offset:42720
 v_mfma_f32_16x16x32_bf16 v[96:99], a[172:175], a[192:195], v[96:99]
 buffer_load_dwordx4 v7, s[44:47], s65 offen offset:3168 lds
 v_mfma_f32_16x16x32_bf16 v[96:99], a[168:171], a[112:115], v[96:99]
 s_waitcnt vmcnt(52)
 s_barrier
 s_waitcnt lgkmcnt(4)
 v_mfma_f32_16x16x32_bf16 v[112:115], a[176:179], a[112:115], v[112:115]
 ds_read_b64_tr_b16 a[160:161], v9 offset:50688
 v_mfma_f32_16x16x32_bf16 v[112:115], a[180:183], a[192:195], v[112:115]
 ds_read_b64_tr_b16 a[162:163], v9 offset:50944
 v_mfma_f32_16x16x32_bf16 v[116:119], a[180:183], a[196:199], v[116:119]
 buffer_load_dwordx4 a[156:159], v8, s[16:19], s64 offen offset:3072
 v_mfma_f32_16x16x32_bf16 v[116:119], a[176:179], a[116:119], v[116:119]
 v_mfma_f32_16x16x32_bf16 v[120:123], a[176:179], a[120:123], v[120:123]
 ds_read_b64_tr_b16 a[164:165], v9 offset:59136
 v_mfma_f32_16x16x32_bf16 v[120:123], a[180:183], a[200:203], v[120:123]
 ds_read_b64_tr_b16 a[166:167], v9 offset:59392
 v_mfma_f32_16x16x32_bf16 v[124:127], a[180:183], a[204:207], v[124:127]
 v_mfma_f32_16x16x32_bf16 v[124:127], a[176:179], a[124:127], v[124:127]
 s_add_u32 s65, s66, 262144
 s_waitcnt lgkmcnt(4)
 v_mfma_f32_16x16x32_bf16 v[140:143], a[184:187], a[124:127], v[140:143]
 ds_read_b64_tr_b16 a[168:169], v9 offset:50720
 v_mfma_f32_16x16x32_bf16 v[140:143], a[188:191], a[204:207], v[140:143]
 ds_read_b64_tr_b16 a[170:171], v9 offset:50976
 v_mfma_f32_16x16x32_bf16 v[136:139], a[188:191], a[200:203], v[136:139]
 buffer_load_dwordx4 a[16:19], v240, s[16:19], s64 offen offset:0
 v_mfma_f32_16x16x32_bf16 v[136:139], a[184:187], a[120:123], v[136:139]
 v_mfma_f32_16x16x32_bf16 v[132:135], a[184:187], a[116:119], v[132:135]
 ds_read_b64_tr_b16 a[172:173], v9 offset:59168
 v_mfma_f32_16x16x32_bf16 v[132:135], a[188:191], a[196:199], v[132:135]
 ds_read_b64_tr_b16 a[174:175], v9 offset:59424
 v_mfma_f32_16x16x32_bf16 v[128:131], a[188:191], a[192:195], v[128:131]
 buffer_load_dwordx4 a[20:23], v240, s[16:19], s64 offen offset:1024
 v_mfma_f32_16x16x32_bf16 v[128:131], a[184:187], a[112:115], v[128:131]
 s_waitcnt vmcnt(20) lgkmcnt(4)
 v_mfma_f32_16x16x32_bf16 v[16:19], a[160:163], a[208:211], v[16:19]
 ds_read_b64_tr_b16 a[176:177], v9 offset:50752
 v_mfma_f32_16x16x32_bf16 v[16:19], a[164:167], a[224:227], v[16:19]
 ds_read_b64_tr_b16 a[178:179], v9 offset:51008
 v_mfma_f32_16x16x32_bf16 v[20:23], a[164:167], a[228:231], v[20:23]
 buffer_load_dwordx4 a[24:27], v240, s[16:19], s64 offen offset:2048
 v_mfma_f32_16x16x32_bf16 v[20:23], a[160:163], a[212:215], v[20:23]
 s_add_u32 m0, s63, 16896
 v_mfma_f32_16x16x32_bf16 v[24:27], a[160:163], a[216:219], v[24:27]
 ds_read_b64_tr_b16 a[180:181], v9 offset:59200
 v_mfma_f32_16x16x32_bf16 v[24:27], a[164:167], a[232:235], v[24:27]
 ds_read_b64_tr_b16 a[182:183], v9 offset:59456
 v_mfma_f32_16x16x32_bf16 v[28:31], a[164:167], a[236:239], v[28:31]
 v_mfma_f32_16x16x32_bf16 v[28:31], a[160:163], a[220:223], v[28:31]
 s_waitcnt lgkmcnt(4)
 v_mfma_f32_16x16x32_bf16 v[44:47], a[168:171], a[220:223], v[44:47]
 ds_read_b64_tr_b16 a[184:185], v9 offset:50784
 v_mfma_f32_16x16x32_bf16 v[44:47], a[172:175], a[236:239], v[44:47]
 ds_read_b64_tr_b16 a[186:187], v9 offset:51040
 v_mfma_f32_16x16x32_bf16 v[40:43], a[172:175], a[232:235], v[40:43]
 buffer_load_dwordx4 v4, s[44:47], s65 offen offset:0 lds
 v_mfma_f32_16x16x32_bf16 v[40:43], a[168:171], a[216:219], v[40:43]
 buffer_load_dword v15, v14, s[16:19], s9 offen sc0 sc1
 v_mfma_f32_16x16x32_bf16 v[36:39], a[168:171], a[212:215], v[36:39]
 ds_read_b64_tr_b16 a[188:189], v9 offset:59232
 v_mfma_f32_16x16x32_bf16 v[36:39], a[172:175], a[228:231], v[36:39]
 ds_read_b64_tr_b16 a[190:191], v9 offset:59488
 v_mfma_f32_16x16x32_bf16 v[32:35], a[172:175], a[224:227], v[32:35]
 buffer_load_dwordx4 a[28:31], v240, s[16:19], s64 offen offset:3072
 v_mfma_f32_16x16x32_bf16 v[32:35], a[168:171], a[208:211], v[32:35]
 s_waitcnt lgkmcnt(4)
 v_mfma_f32_16x16x32_bf16 v[48:51], a[176:179], a[208:211], v[48:51]
 ds_read_b64_tr_b16 a[160:161], v9 offset:50816
 v_mfma_f32_16x16x32_bf16 v[48:51], a[180:183], a[224:227], v[48:51]
 ds_read_b64_tr_b16 a[162:163], v9 offset:51072
 s_add_u32 s64, s71, 106496
 v_mfma_f32_16x16x32_bf16 v[52:55], a[180:183], a[228:231], v[52:55]
 buffer_load_dwordx4 a[32:35], v8, s[16:19], s64 offen offset:0
 v_mfma_f32_16x16x32_bf16 v[52:55], a[176:179], a[212:215], v[52:55]
 v_mfma_f32_16x16x32_bf16 v[56:59], a[176:179], a[216:219], v[56:59]
 ds_read_b64_tr_b16 a[164:165], v9 offset:59264
 v_mfma_f32_16x16x32_bf16 v[56:59], a[180:183], a[232:235], v[56:59]
 ds_read_b64_tr_b16 a[166:167], v9 offset:59520
 v_mfma_f32_16x16x32_bf16 v[60:63], a[180:183], a[236:239], v[60:63]
 buffer_load_dwordx4 v5, s[44:47], s65 offen offset:1056 lds
 v_mfma_f32_16x16x32_bf16 v[60:63], a[176:179], a[220:223], v[60:63]
 s_waitcnt lgkmcnt(4)
 v_mfma_f32_16x16x32_bf16 v[76:79], a[184:187], a[220:223], v[76:79]
 ds_read_b64_tr_b16 a[168:169], v9 offset:50848
 v_mfma_f32_16x16x32_bf16 v[76:79], a[188:191], a[236:239], v[76:79]
 ds_read_b64_tr_b16 a[170:171], v9 offset:51104
 v_mfma_f32_16x16x32_bf16 v[72:75], a[188:191], a[232:235], v[72:75]
 buffer_load_dwordx4 a[36:39], v8, s[16:19], s64 offen offset:1024
 v_mfma_f32_16x16x32_bf16 v[72:75], a[184:187], a[216:219], v[72:75]
 v_mfma_f32_16x16x32_bf16 v[68:71], a[184:187], a[212:215], v[68:71]
 ds_read_b64_tr_b16 a[172:173], v9 offset:59296
 v_mfma_f32_16x16x32_bf16 v[68:71], a[188:191], a[228:231], v[68:71]
 ds_read_b64_tr_b16 a[174:175], v9 offset:59552
 v_mfma_f32_16x16x32_bf16 v[64:67], a[188:191], a[224:227], v[64:67]
 v_mfma_f32_16x16x32_bf16 v[64:67], a[184:187], a[208:211], v[64:67]
 s_waitcnt lgkmcnt(4)
 v_mfma_f32_16x16x32_bf16 v[80:83], a[160:163], a[208:211], v[80:83]
 ds_read_b64_tr_b16 a[176:177], v9 offset:50880
 v_mfma_f32_16x16x32_bf16 v[80:83], a[164:167], a[224:227], v[80:83]
 ds_read_b64_tr_b16 a[178:179], v9 offset:51136
 v_mfma_f32_16x16x32_bf16 v[84:87], a[164:167], a[228:231], v[84:87]
 buffer_load_dwordx4 v6, s[44:47], s65 offen offset:2112 lds
 v_mfma_f32_16x16x32_bf16 v[84:87], a[160:163], a[212:215], v[84:87]
 v_mfma_f32_16x16x32_bf16 v[88:91], a[160:163], a[216:219], v[88:91]
 ds_read_b64_tr_b16 a[180:181], v9 offset:59328
 v_mfma_f32_16x16x32_bf16 v[88:91], a[164:167], a[232:235], v[88:91]
 ds_read_b64_tr_b16 a[182:183], v9 offset:59584
 v_mfma_f32_16x16x32_bf16 v[92:95], a[164:167], a[236:239], v[92:95]
 buffer_load_dwordx4 a[40:43], v8, s[16:19], s64 offen offset:2048
 v_mfma_f32_16x16x32_bf16 v[92:95], a[160:163], a[220:223], v[92:95]
 s_waitcnt lgkmcnt(4)
 v_mfma_f32_16x16x32_bf16 v[108:111], a[168:171], a[220:223], v[108:111]
 ds_read_b64_tr_b16 a[184:185], v9 offset:50912
 v_mfma_f32_16x16x32_bf16 v[108:111], a[172:175], a[236:239], v[108:111]
 ds_read_b64_tr_b16 a[186:187], v9 offset:51168
 v_mfma_f32_16x16x32_bf16 v[104:107], a[172:175], a[232:235], v[104:107]
 buffer_load_dwordx4 a[44:47], v8, s[16:19], s64 offen offset:3072
 v_mfma_f32_16x16x32_bf16 v[104:107], a[168:171], a[216:219], v[104:107]
 v_mfma_f32_16x16x32_bf16 v[100:103], a[168:171], a[212:215], v[100:103]
 ds_read_b64_tr_b16 a[188:189], v9 offset:59360
 v_mfma_f32_16x16x32_bf16 v[100:103], a[172:175], a[228:231], v[100:103]
 ds_read_b64_tr_b16 a[190:191], v9 offset:59616
 v_mfma_f32_16x16x32_bf16 v[96:99], a[172:175], a[224:227], v[96:99]
 buffer_load_dwordx4 v7, s[44:47], s65 offen offset:3168 lds
 v_mfma_f32_16x16x32_bf16 v[96:99], a[168:171], a[208:211], v[96:99]
 s_waitcnt lgkmcnt(4)
 v_mfma_f32_16x16x32_bf16 v[112:115], a[176:179], a[208:211], v[112:115]
 ds_read_b64_tr_b16 a[160:161], v10 offset:0
 v_mfma_f32_16x16x32_bf16 v[112:115], a[180:183], a[224:227], v[112:115]
 ds_read_b64_tr_b16 a[162:163], v10 offset:256
 v_mfma_f32_16x16x32_bf16 v[116:119], a[180:183], a[228:231], v[116:119]
 buffer_load_dwordx4 a[48:51], v240, s[16:19], s64 offen offset:0
 v_mfma_f32_16x16x32_bf16 v[116:119], a[176:179], a[212:215], v[116:119]
 v_mfma_f32_16x16x32_bf16 v[120:123], a[176:179], a[216:219], v[120:123]
 ds_read_b64_tr_b16 a[164:165], v10 offset:8448
 v_mfma_f32_16x16x32_bf16 v[120:123], a[180:183], a[232:235], v[120:123]
 ds_read_b64_tr_b16 a[166:167], v10 offset:8704
 v_mfma_f32_16x16x32_bf16 v[124:127], a[180:183], a[236:239], v[124:127]
 v_mfma_f32_16x16x32_bf16 v[124:127], a[176:179], a[220:223], v[124:127]
 s_add_u32 s65, s66, 393216
 s_waitcnt lgkmcnt(4)
 v_mfma_f32_16x16x32_bf16 v[140:143], a[184:187], a[220:223], v[140:143]
 ds_read_b64_tr_b16 a[168:169], v10 offset:32
 v_mfma_f32_16x16x32_bf16 v[140:143], a[188:191], a[236:239], v[140:143]
 ds_read_b64_tr_b16 a[170:171], v10 offset:288
 v_mfma_f32_16x16x32_bf16 v[136:139], a[188:191], a[232:235], v[136:139]
 buffer_load_dwordx4 a[52:55], v240, s[16:19], s64 offen offset:1024
 v_mfma_f32_16x16x32_bf16 v[136:139], a[184:187], a[216:219], v[136:139]
 v_mfma_f32_16x16x32_bf16 v[132:135], a[184:187], a[212:215], v[132:135]
 ds_read_b64_tr_b16 a[172:173], v10 offset:8480
 v_mfma_f32_16x16x32_bf16 v[132:135], a[188:191], a[228:231], v[132:135]
 ds_read_b64_tr_b16 a[174:175], v10 offset:8736
 v_mfma_f32_16x16x32_bf16 v[128:131], a[188:191], a[224:227], v[128:131]
 buffer_load_dwordx4 a[56:59], v240, s[16:19], s64 offen offset:2048
 v_mfma_f32_16x16x32_bf16 v[128:131], a[184:187], a[208:211], v[128:131]
 s_waitcnt vmcnt(23) lgkmcnt(4)
 v_mfma_f32_16x16x32_bf16 v[16:19], a[160:163], a[240:243], v[16:19]
 ds_read_b64_tr_b16 a[176:177], v10 offset:64
 v_mfma_f32_16x16x32_bf16 v[16:19], a[164:167], a[128:131], v[16:19]
 ds_read_b64_tr_b16 a[178:179], v10 offset:320
 v_mfma_f32_16x16x32_bf16 v[20:23], a[164:167], a[132:135], v[20:23]
 buffer_load_dwordx4 a[60:63], v240, s[16:19], s64 offen offset:3072
 v_mfma_f32_16x16x32_bf16 v[20:23], a[160:163], a[244:247], v[20:23]
 s_add_u32 m0, s63, 33792
 v_mfma_f32_16x16x32_bf16 v[24:27], a[160:163], a[248:251], v[24:27]
 ds_read_b64_tr_b16 a[180:181], v10 offset:8512
 v_mfma_f32_16x16x32_bf16 v[24:27], a[164:167], a[136:139], v[24:27]
 ds_read_b64_tr_b16 a[182:183], v10 offset:8768
 v_mfma_f32_16x16x32_bf16 v[28:31], a[164:167], a[140:143], v[28:31]
 v_mfma_f32_16x16x32_bf16 v[28:31], a[160:163], a[252:255], v[28:31]
 s_waitcnt lgkmcnt(4)
 v_mfma_f32_16x16x32_bf16 v[44:47], a[168:171], a[252:255], v[44:47]
 ds_read_b64_tr_b16 a[184:185], v10 offset:96
 v_mfma_f32_16x16x32_bf16 v[44:47], a[172:175], a[140:143], v[44:47]
 ds_read_b64_tr_b16 a[186:187], v10 offset:352
 v_mfma_f32_16x16x32_bf16 v[40:43], a[172:175], a[136:139], v[40:43]
 buffer_load_dwordx4 v4, s[44:47], s65 offen offset:0 lds
 v_mfma_f32_16x16x32_bf16 v[40:43], a[168:171], a[248:251], v[40:43]
 s_waitcnt vmcnt(13)
 v_cmp_ne_u32 vcc, 1, v15
 v_mfma_f32_16x16x32_bf16 v[36:39], a[168:171], a[244:247], v[36:39]
 ds_read_b64_tr_b16 a[188:189], v10 offset:8544
 v_mfma_f32_16x16x32_bf16 v[36:39], a[172:175], a[132:135], v[36:39]
 ds_read_b64_tr_b16 a[190:191], v10 offset:8800
 s_add_u32 s64, s81, 0
 s_cbranch_vccnz L_oslow
L_ook:
 v_mfma_f32_16x16x32_bf16 v[32:35], a[172:175], a[128:131], v[32:35]
 buffer_load_dwordx4 a[64:67], v8, s[16:19], s64 offen offset:0
 v_mfma_f32_16x16x32_bf16 v[32:35], a[168:171], a[240:243], v[32:35]
 s_waitcnt lgkmcnt(4)
 v_mfma_f32_16x16x32_bf16 v[48:51], a[176:179], a[240:243], v[48:51]
 ds_read_b64_tr_b16 a[160:161], v10 offset:128
 v_mfma_f32_16x16x32_bf16 v[48:51], a[180:183], a[128:131], v[48:51]
 ds_read_b64_tr_b16 a[162:163], v10 offset:384
 v_mfma_f32_16x16x32_bf16 v[52:55], a[180:183], a[132:135], v[52:55]
 buffer_load_dwordx4 a[68:71], v8, s[16:19], s64 offen offset:1024
 v_mfma_f32_16x16x32_bf16 v[52:55], a[176:179], a[244:247], v[52:55]
 v_mfma_f32_16x16x32_bf16 v[56:59], a[176:179], a[248:251], v[56:59]
 ds_read_b64_tr_b16 a[164:165], v10 offset:8576
 v_mfma_f32_16x16x32_bf16 v[56:59], a[180:183], a[136:139], v[56:59]
 ds_read_b64_tr_b16 a[166:167], v10 offset:8832
 v_mfma_f32_16x16x32_bf16 v[60:63], a[180:183], a[140:143], v[60:63]
 buffer_load_dwordx4 v5, s[44:47], s65 offen offset:1056 lds
 v_mfma_f32_16x16x32_bf16 v[60:63], a[176:179], a[252:255], v[60:63]
 s_waitcnt lgkmcnt(4)
 v_mfma_f32_16x16x32_bf16 v[76:79], a[184:187], a[252:255], v[76:79]
 ds_read_b64_tr_b16 a[168:169], v10 offset:160
 v_mfma_f32_16x16x32_bf16 v[76:79], a[188:191], a[140:143], v[76:79]
 ds_read_b64_tr_b16 a[170:171], v10 offset:416
 v_mfma_f32_16x16x32_bf16 v[72:75], a[188:191], a[136:139], v[72:75]
 buffer_load_dwordx4 a[72:75], v8, s[16:19], s64 offen offset:2048
 v_mfma_f32_16x16x32_bf16 v[72:75], a[184:187], a[248:251], v[72:75]
 v_mfma_f32_16x16x32_bf16 v[68:71], a[184:187], a[244:247], v[68:71]
 ds_read_b64_tr_b16 a[172:173], v10 offset:8608
 v_mfma_f32_16x16x32_bf16 v[68:71], a[188:191], a[132:135], v[68:71]
 ds_read_b64_tr_b16 a[174:175], v10 offset:8864
 v_mfma_f32_16x16x32_bf16 v[64:67], a[188:191], a[128:131], v[64:67]
 v_mfma_f32_16x16x32_bf16 v[64:67], a[184:187], a[240:243], v[64:67]
 s_waitcnt lgkmcnt(4)
 v_mfma_f32_16x16x32_bf16 v[80:83], a[160:163], a[240:243], v[80:83]
 ds_read_b64_tr_b16 a[176:177], v10 offset:192
 v_mfma_f32_16x16x32_bf16 v[80:83], a[164:167], a[128:131], v[80:83]
 ds_read_b64_tr_b16 a[178:179], v10 offset:448
 v_mfma_f32_16x16x32_bf16 v[84:87], a[164:167], a[132:135], v[84:87]
 buffer_load_dwordx4 v6, s[44:47], s65 offen offset:2112 lds
 v_mfma_f32_16x16x32_bf16 v[84:87], a[160:163], a[244:247], v[84:87]
 v_mfma_f32_16x16x32_bf16 v[88:91], a[160:163], a[248:251], v[88:91]
 ds_read_b64_tr_b16 a[180:181], v10 offset:8640
 v_mfma_f32_16x16x32_bf16 v[88:91], a[164:167], a[136:139], v[88:91]
 ds_read_b64_tr_b16 a[182:183], v10 offset:8896
 v_mfma_f32_16x16x32_bf16 v[92:95], a[164:167], a[140:143], v[92:95]
 buffer_load_dwordx4 a[76:79], v8, s[16:19], s64 offen offset:3072
 v_mfma_f32_16x16x32_bf16 v[92:95], a[160:163], a[252:255], v[92:95]
 s_waitcnt lgkmcnt(4)
 v_mfma_f32_16x16x32_bf16 v[108:111], a[168:171], a[252:255], v[108:111]
 ds_read_b64_tr_b16 a[184:185], v10 offset:224
 v_mfma_f32_16x16x32_bf16 v[108:111], a[172:175], a[140:143], v[108:111]
 ds_read_b64_tr_b16 a[186:187], v10 offset:480
 v_mfma_f32_16x16x32_bf16 v[104:107], a[172:175], a[136:139], v[104:107]
 buffer_load_dwordx4 a[80:83], v240, s[16:19], s64 offen offset:0
 v_mfma_f32_16x16x32_bf16 v[104:107], a[168:171], a[248:251], v[104:107]
 v_mfma_f32_16x16x32_bf16 v[100:103], a[168:171], a[244:247], v[100:103]
 ds_read_b64_tr_b16 a[188:189], v10 offset:8672
 v_mfma_f32_16x16x32_bf16 v[100:103], a[172:175], a[132:135], v[100:103]
 ds_read_b64_tr_b16 a[190:191], v10 offset:8928
 v_mfma_f32_16x16x32_bf16 v[96:99], a[172:175], a[128:131], v[96:99]
 buffer_load_dwordx4 v7, s[44:47], s65 offen offset:3168 lds
 v_mfma_f32_16x16x32_bf16 v[96:99], a[168:171], a[240:243], v[96:99]
 s_waitcnt vmcnt(53)
 s_barrier
 s_waitcnt lgkmcnt(4)
 v_mfma_f32_16x16x32_bf16 v[112:115], a[176:179], a[240:243], v[112:115]
 ds_read_b64_tr_b16 a[160:161], v10 offset:16896
 v_mfma_f32_16x16x32_bf16 v[112:115], a[180:183], a[128:131], v[112:115]
 ds_read_b64_tr_b16 a[162:163], v10 offset:17152
 v_mfma_f32_16x16x32_bf16 v[116:119], a[180:183], a[132:135], v[116:119]
 buffer_load_dwordx4 a[84:87], v240, s[16:19], s64 offen offset:1024
 v_mfma_f32_16x16x32_bf16 v[116:119], a[176:179], a[244:247], v[116:119]
 v_mfma_f32_16x16x32_bf16 v[120:123], a[176:179], a[248:251], v[120:123]
 ds_read_b64_tr_b16 a[164:165], v10 offset:25344
 v_mfma_f32_16x16x32_bf16 v[120:123], a[180:183], a[136:139], v[120:123]
 ds_read_b64_tr_b16 a[166:167], v10 offset:25600
 v_mfma_f32_16x16x32_bf16 v[124:127], a[180:183], a[140:143], v[124:127]
 v_mfma_f32_16x16x32_bf16 v[124:127], a[176:179], a[252:255], v[124:127]
 s_add_u32 s65, s66, 524288
 s_waitcnt lgkmcnt(4)
 v_mfma_f32_16x16x32_bf16 v[140:143], a[184:187], a[252:255], v[140:143]
 ds_read_b64_tr_b16 a[168:169], v10 offset:16928
 v_mfma_f32_16x16x32_bf16 v[140:143], a[188:191], a[140:143], v[140:143]
 ds_read_b64_tr_b16 a[170:171], v10 offset:17184
 v_mfma_f32_16x16x32_bf16 v[136:139], a[188:191], a[136:139], v[136:139]
 buffer_load_dwordx4 a[88:91], v240, s[16:19], s64 offen offset:2048
 v_mfma_f32_16x16x32_bf16 v[136:139], a[184:187], a[248:251], v[136:139]
 v_mfma_f32_16x16x32_bf16 v[132:135], a[184:187], a[244:247], v[132:135]
 ds_read_b64_tr_b16 a[172:173], v10 offset:25376
 v_mfma_f32_16x16x32_bf16 v[132:135], a[188:191], a[132:135], v[132:135]
 ds_read_b64_tr_b16 a[174:175], v10 offset:25632
 v_mfma_f32_16x16x32_bf16 v[128:131], a[188:191], a[128:131], v[128:131]
 buffer_load_dwordx4 a[92:95], v240, s[16:19], s64 offen offset:3072
 v_mfma_f32_16x16x32_bf16 v[128:131], a[184:187], a[240:243], v[128:131]
 s_waitcnt vmcnt(23) lgkmcnt(4)
 v_mfma_f32_16x16x32_bf16 v[16:19], a[160:163], a[144:147], v[16:19]
 ds_read_b64_tr_b16 a[176:177], v10 offset:16960
 v_mfma_f32_16x16x32_bf16 v[16:19], a[164:167], a[16:19], v[16:19]
 ds_read_b64_tr_b16 a[178:179], v10 offset:17216
 s_add_u32 s64, s81, 8192
 v_mfma_f32_16x16x32_bf16 v[20:23], a[164:167], a[20:23], v[20:23]
 buffer_load_dwordx4 a[96:99], v8, s[16:19], s64 offen offset:0
 v_mfma_f32_16x16x32_bf16 v[20:23], a[160:163], a[148:151], v[20:23]
 s_add_u32 m0, s63, 50688
 v_mfma_f32_16x16x32_bf16 v[24:27], a[160:163], a[152:155], v[24:27]
 ds_read_b64_tr_b16 a[180:181], v10 offset:25408
 v_mfma_f32_16x16x32_bf16 v[24:27], a[164:167], a[24:27], v[24:27]
 s_branch L_pg16k
L_pg16:
L_ic3w2:
 s_branch L_pg20
L_pg16k:
 ds_read_b64_tr_b16 a[182:183], v10 offset:25664
 v_mfma_f32_16x16x32_bf16 v[28:31], a[164:167], a[28:31], v[28:31]
 v_mfma_f32_16x16x32_bf16 v[28:31], a[160:163], a[156:159], v[28:31]
 s_waitcnt lgkmcnt(4)
 v_mfma_f32_16x16x32_bf16 v[44:47], a[168:171], a[156:159], v[44:47]
 ds_read_b64_tr_b16 a[184:185], v10 offset:16992
 v_mfma_f32_16x16x32_bf16 v[44:47], a[172:175], a[28:31], v[44:47]
 ds_read_b64_tr_b16 a[186:187], v10 offset:17248
 v_mfma_f32_16x16x32_bf16 v[40:43], a[172:175], a[24:27], v[40:43]
 buffer_load_dwordx4 v4, s[44:47], s65 offen offset:0 lds
 v_mfma_f32_16x16x32_bf16 v[40:43], a[168:171], a[152:155], v[40:43]
 v_mfma_f32_16x16x32_bf16 v[36:39], a[168:171], a[148:151], v[36:39]
 ds_read_b64_tr_b16 a[188:189], v10 offset:25440
 v_mfma_f32_16x16x32_bf16 v[36:39], a[172:175], a[20:23], v[36:39]
 ds_read_b64_tr_b16 a[190:191], v10 offset:25696
 v_mfma_f32_16x16x32_bf16 v[32:35], a[172:175], a[16:19], v[32:35]
 buffer_load_dwordx4 a[100:103], v8, s[16:19], s64 offen offset:1024
 v_mfma_f32_16x16x32_bf16 v[32:35], a[168:171], a[144:147], v[32:35]
 s_waitcnt lgkmcnt(4)
 v_mfma_f32_16x16x32_bf16 v[48:51], a[176:179], a[144:147], v[48:51]
 ds_read_b64_tr_b16 a[160:161], v10 offset:17024
 v_mfma_f32_16x16x32_bf16 v[48:51], a[180:183], a[16:19], v[48:51]
 ds_read_b64_tr_b16 a[162:163], v10 offset:17280
 v_mfma_f32_16x16x32_bf16 v[52:55], a[180:183], a[20:23], v[52:55]
 buffer_load_dwordx4 a[104:107], v8, s[16:19], s64 offen offset:2048
 v_mfma_f32_16x16x32_bf16 v[52:55], a[176:179], a[148:151], v[52:55]
 v_mfma_f32_16x16x32_bf16 v[56:59], a[176:179], a[152:155], v[56:59]
 ds_read_b64_tr_b16 a[164:165], v10 offset:25472
 v_mfma_f32_16x16x32_bf16 v[56:59], a[180:183], a[24:27], v[56:59]
 ds_read_b64_tr_b16 a[166:167], v10 offset:25728
 v_mfma_f32_16x16x32_bf16 v[60:63], a[180:183], a[28:31], v[60:63]
 buffer_load_dwordx4 v5, s[44:47], s65 offen offset:1056 lds
 v_mfma_f32_16x16x32_bf16 v[60:63], a[176:179], a[156:159], v[60:63]
 s_waitcnt lgkmcnt(4)
 v_mfma_f32_16x16x32_bf16 v[76:79], a[184:187], a[156:159], v[76:79]
 ds_read_b64_tr_b16 a[168:169], v10 offset:17056
 v_mfma_f32_16x16x32_bf16 v[76:79], a[188:191], a[28:31], v[76:79]
 ds_read_b64_tr_b16 a[170:171], v10 offset:17312
 v_mfma_f32_16x16x32_bf16 v[72:75], a[188:191], a[24:27], v[72:75]
 buffer_load_dwordx4 a[108:111], v8, s[16:19], s64 offen offset:3072
 v_mfma_f32_16x16x32_bf16 v[72:75], a[184:187], a[152:155], v[72:75]
 v_mfma_f32_16x16x32_bf16 v[68:71], a[184:187], a[148:151], v[68:71]
 ds_read_b64_tr_b16 a[172:173], v10 offset:25504
 v_mfma_f32_16x16x32_bf16 v[68:71], a[188:191], a[20:23], v[68:71]
 ds_read_b64_tr_b16 a[174:175], v10 offset:25760
 v_mfma_f32_16x16x32_bf16 v[64:67], a[188:191], a[16:19], v[64:67]
 v_mfma_f32_16x16x32_bf16 v[64:67], a[184:187], a[144:147], v[64:67]
 s_waitcnt lgkmcnt(4)
 v_mfma_f32_16x16x32_bf16 v[80:83], a[160:163], a[144:147], v[80:83]
 ds_read_b64_tr_b16 a[176:177], v10 offset:17088
 v_mfma_f32_16x16x32_bf16 v[80:83], a[164:167], a[16:19], v[80:83]
 ds_read_b64_tr_b16 a[178:179], v10 offset:17344
 v_mfma_f32_16x16x32_bf16 v[84:87], a[164:167], a[20:23], v[84:87]
 buffer_load_dwordx4 v6, s[44:47], s65 offen offset:2112 lds
 v_mfma_f32_16x16x32_bf16 v[84:87], a[160:163], a[148:151], v[84:87]
 v_mfma_f32_16x16x32_bf16 v[88:91], a[160:163], a[152:155], v[88:91]
 ds_read_b64_tr_b16 a[180:181], v10 offset:25536
 v_mfma_f32_16x16x32_bf16 v[88:91], a[164:167], a[24:27], v[88:91]
 ds_read_b64_tr_b16 a[182:183], v10 offset:25792
 v_mfma_f32_16x16x32_bf16 v[92:95], a[164:167], a[28:31], v[92:95]
 buffer_load_dwordx4 a[112:115], v240, s[16:19], s64 offen offset:0
 v_mfma_f32_16x16x32_bf16 v[92:95], a[160:163], a[156:159], v[92:95]
 s_waitcnt lgkmcnt(4)
 v_mfma_f32_16x16x32_bf16 v[108:111], a[168:171], a[156:159], v[108:111]
 ds_read_b64_tr_b16 a[184:185], v10 offset:17120
 v_mfma_f32_16x16x32_bf16 v[108:111], a[172:175], a[28:31], v[108:111]
 ds_read_b64_tr_b16 a[186:187], v10 offset:17376
 v_mfma_f32_16x16x32_bf16 v[104:107], a[172:175], a[24:27], v[104:107]
 buffer_load_dwordx4 a[116:119], v240, s[16:19], s64 offen offset:1024
 v_mfma_f32_16x16x32_bf16 v[104:107], a[168:171], a[152:155], v[104:107]
 v_mfma_f32_16x16x32_bf16 v[100:103], a[168:171], a[148:151], v[100:103]
 ds_read_b64_tr_b16 a[188:189], v10 offset:25568
 v_mfma_f32_16x16x32_bf16 v[100:103], a[172:175], a[20:23], v[100:103]
 ds_read_b64_tr_b16 a[190:191], v10 offset:25824
 v_mfma_f32_16x16x32_bf16 v[96:99], a[172:175], a[16:19], v[96:99]
 buffer_load_dwordx4 v7, s[44:47], s65 offen offset:3168 lds
 v_mfma_f32_16x16x32_bf16 v[96:99], a[168:171], a[144:147], v[96:99]
 s_waitcnt lgkmcnt(4)
 v_mfma_f32_16x16x32_bf16 v[112:115], a[176:179], a[144:147], v[112:115]
 ds_read_b64_tr_b16 a[160:161], v10 offset:33792
 v_mfma_f32_16x16x32_bf16 v[112:115], a[180:183], a[16:19], v[112:115]
 ds_read_b64_tr_b16 a[162:163], v10 offset:34048
 v_mfma_f32_16x16x32_bf16 v[116:119], a[180:183], a[20:23], v[116:119]
 buffer_load_dwordx4 a[120:123], v240, s[16:19], s64 offen offset:2048
 v_mfma_f32_16x16x32_bf16 v[116:119], a[176:179], a[148:151], v[116:119]
 v_mfma_f32_16x16x32_bf16 v[120:123], a[176:179], a[152:155], v[120:123]
 ds_read_b64_tr_b16 a[164:165], v10 offset:42240
 v_mfma_f32_16x16x32_bf16 v[120:123], a[180:183], a[24:27], v[120:123]
 ds_read_b64_tr_b16 a[166:167], v10 offset:42496
 v_mfma_f32_16x16x32_bf16 v[124:127], a[180:183], a[28:31], v[124:127]
 v_mfma_f32_16x16x32_bf16 v[124:127], a[176:179], a[156:159], v[124:127]
 s_add_u32 s65, s66, 655360
 s_waitcnt lgkmcnt(4)
 v_mfma_f32_16x16x32_bf16 v[140:143], a[184:187], a[156:159], v[140:143]
 ds_read_b64_tr_b16 a[168:169], v10 offset:33824
 v_mfma_f32_16x16x32_bf16 v[140:143], a[188:191], a[28:31], v[140:143]
 ds_read_b64_tr_b16 a[170:171], v10 offset:34080
 v_mfma_f32_16x16x32_bf16 v[136:139], a[188:191], a[24:27], v[136:139]
 buffer_load_dwordx4 a[124:127], v240, s[16:19], s64 offen offset:3072
 v_mfma_f32_16x16x32_bf16 v[136:139], a[184:187], a[152:155], v[136:139]
 v_mfma_f32_16x16x32_bf16 v[132:135], a[184:187], a[148:151], v[132:135]
 ds_read_b64_tr_b16 a[172:173], v10 offset:42272
 v_mfma_f32_16x16x32_bf16 v[132:135], a[188:191], a[20:23], v[132:135]
 ds_read_b64_tr_b16 a[174:175], v10 offset:42528
 s_add_u32 s64, s81, 16384
 v_mfma_f32_16x16x32_bf16 v[128:131], a[188:191], a[16:19], v[128:131]
 buffer_load_dwordx4 a[192:195], v8, s[16:19], s64 offen offset:0
 v_mfma_f32_16x16x32_bf16 v[128:131], a[184:187], a[144:147], v[128:131]
 s_waitcnt vmcnt(25) lgkmcnt(4)
 v_mfma_f32_16x16x32_bf16 v[16:19], a[160:163], a[32:35], v[16:19]
 ds_read_b64_tr_b16 a[176:177], v10 offset:33856
 v_mfma_f32_16x16x32_bf16 v[16:19], a[164:167], a[48:51], v[16:19]
 ds_read_b64_tr_b16 a[178:179], v10 offset:34112
 v_mfma_f32_16x16x32_bf16 v[20:23], a[164:167], a[52:55], v[20:23]
 buffer_load_dwordx4 a[196:199], v8, s[16:19], s64 offen offset:1024
 v_mfma_f32_16x16x32_bf16 v[20:23], a[160:163], a[36:39], v[20:23]
 s_add_u32 m0, s63, 67584
 v_mfma_f32_16x16x32_bf16 v[24:27], a[160:163], a[40:43], v[24:27]
 ds_read_b64_tr_b16 a[180:181], v10 offset:42304
 v_mfma_f32_16x16x32_bf16 v[24:27], a[164:167], a[56:59], v[24:27]
 ds_read_b64_tr_b16 a[182:183], v10 offset:42560
 v_mfma_f32_16x16x32_bf16 v[28:31], a[164:167], a[60:63], v[28:31]
 v_mfma_f32_16x16x32_bf16 v[28:31], a[160:163], a[44:47], v[28:31]
 s_waitcnt lgkmcnt(4)
 v_mfma_f32_16x16x32_bf16 v[44:47], a[168:171], a[44:47], v[44:47]
 ds_read_b64_tr_b16 a[184:185], v10 offset:33888
 v_mfma_f32_16x16x32_bf16 v[44:47], a[172:175], a[60:63], v[44:47]
 ds_read_b64_tr_b16 a[186:187], v10 offset:34144
 v_mfma_f32_16x16x32_bf16 v[40:43], a[172:175], a[56:59], v[40:43]
 buffer_load_dwordx4 v4, s[44:47], s65 offen offset:0 lds
 v_mfma_f32_16x16x32_bf16 v[40:43], a[168:171], a[40:43], v[40:43]
 v_mfma_f32_16x16x32_bf16 v[36:39], a[168:171], a[36:39], v[36:39]
 ds_read_b64_tr_b16 a[188:189], v10 offset:42336
 v_mfma_f32_16x16x32_bf16 v[36:39], a[172:175], a[52:55], v[36:39]
 ds_read_b64_tr_b16 a[190:191], v10 offset:42592
 v_mfma_f32_16x16x32_bf16 v[32:35], a[172:175], a[48:51], v[32:35]
 buffer_load_dwordx4 a[200:203], v8, s[16:19], s64 offen offset:2048
 v_mfma_f32_16x16x32_bf16 v[32:35], a[168:171], a[32:35], v[32:35]
 s_waitcnt lgkmcnt(4)
 v_mfma_f32_16x16x32_bf16 v[48:51], a[176:179], a[32:35], v[48:51]
 ds_read_b64_tr_b16 a[160:161], v10 offset:33920
 v_mfma_f32_16x16x32_bf16 v[48:51], a[180:183], a[48:51], v[48:51]
 ds_read_b64_tr_b16 a[162:163], v10 offset:34176
 v_mfma_f32_16x16x32_bf16 v[52:55], a[180:183], a[52:55], v[52:55]
 buffer_load_dwordx4 a[204:207], v8, s[16:19], s64 offen offset:3072
 v_mfma_f32_16x16x32_bf16 v[52:55], a[176:179], a[36:39], v[52:55]
 v_mfma_f32_16x16x32_bf16 v[56:59], a[176:179], a[40:43], v[56:59]
 ds_read_b64_tr_b16 a[164:165], v10 offset:42368
 v_mfma_f32_16x16x32_bf16 v[56:59], a[180:183], a[56:59], v[56:59]
 ds_read_b64_tr_b16 a[166:167], v10 offset:42624
 v_mfma_f32_16x16x32_bf16 v[60:63], a[180:183], a[60:63], v[60:63]
 buffer_load_dwordx4 v5, s[44:47], s65 offen offset:1056 lds
 v_mfma_f32_16x16x32_bf16 v[60:63], a[176:179], a[44:47], v[60:63]
 s_waitcnt lgkmcnt(4)
 v_mfma_f32_16x16x32_bf16 v[76:79], a[184:187], a[44:47], v[76:79]
 ds_read_b64_tr_b16 a[168:169], v10 offset:33952
 v_mfma_f32_16x16x32_bf16 v[76:79], a[188:191], a[60:63], v[76:79]
 ds_read_b64_tr_b16 a[170:171], v10 offset:34208
 v_mfma_f32_16x16x32_bf16 v[72:75], a[188:191], a[56:59], v[72:75]
 buffer_load_dwordx4 a[208:211], v240, s[16:19], s64 offen offset:0
 v_mfma_f32_16x16x32_bf16 v[72:75], a[184:187], a[40:43], v[72:75]
 v_mfma_f32_16x16x32_bf16 v[68:71], a[184:187], a[36:39], v[68:71]
 ds_read_b64_tr_b16 a[172:173], v10 offset:42400
 v_mfma_f32_16x16x32_bf16 v[68:71], a[188:191], a[52:55], v[68:71]
 ds_read_b64_tr_b16 a[174:175], v10 offset:42656
 v_mfma_f32_16x16x32_bf16 v[64:67], a[188:191], a[48:51], v[64:67]
 v_mfma_f32_16x16x32_bf16 v[64:67], a[184:187], a[32:35], v[64:67]
 s_waitcnt lgkmcnt(4)
 v_mfma_f32_16x16x32_bf16 v[80:83], a[160:163], a[32:35], v[80:83]
 ds_read_b64_tr_b16 a[176:177], v10 offset:33984
 v_mfma_f32_16x16x32_bf16 v[80:83], a[164:167], a[48:51], v[80:83]
 ds_read_b64_tr_b16 a[178:179], v10 offset:34240
 v_mfma_f32_16x16x32_bf16 v[84:87], a[164:167], a[52:55], v[84:87]
 buffer_load_dwordx4 v6, s[44:47], s65 offen offset:2112 lds
 v_mfma_f32_16x16x32_bf16 v[84:87], a[160:163], a[36:39], v[84:87]
 v_cvt_pk_bf16_f32 v176, v48, v49
 v_cvt_pk_bf16_f32 v177, v50, v51
 v_mfma_f32_16x16x32_bf16 v[88:91], a[160:163], a[40:43], v[88:91]
 ds_read_b64_tr_b16 a[180:181], v10 offset:42432
 v_cvt_pk_bf16_f32 v178, v64, v65
 v_mfma_f32_16x16x32_bf16 v[88:91], a[164:167], a[56:59], v[88:91]
 ds_read_b64_tr_b16 a[182:183], v10 offset:42688
 v_cvt_pk_bf16_f32 v179, v66, v67
 v_mfma_f32_16x16x32_bf16 v[92:95], a[164:167], a[60:63], v[92:95]
 buffer_load_dwordx4 a[212:215], v240, s[16:19], s64 offen offset:1024
 v_cvt_pk_bf16_f32 v180, v52, v53
 v_mfma_f32_16x16x32_bf16 v[92:95], a[160:163], a[44:47], v[92:95]
 s_waitcnt lgkmcnt(4)
 v_cvt_pk_bf16_f32 v181, v54, v55
 v_cvt_pk_bf16_f32 v182, v68, v69
 v_mfma_f32_16x16x32_bf16 v[108:111], a[168:171], a[44:47], v[108:111]
 ds_read_b64_tr_b16 a[184:185], v10 offset:34016
 v_cvt_pk_bf16_f32 v183, v70, v71
 v_mfma_f32_16x16x32_bf16 v[108:111], a[172:175], a[60:63], v[108:111]
 ds_read_b64_tr_b16 a[186:187], v10 offset:34272
 v_cvt_pk_bf16_f32 v184, v56, v57
 v_mfma_f32_16x16x32_bf16 v[104:107], a[172:175], a[56:59], v[104:107]
 buffer_load_dwordx4 a[216:219], v240, s[16:19], s64 offen offset:2048
 v_cvt_pk_bf16_f32 v185, v58, v59
 v_mfma_f32_16x16x32_bf16 v[104:107], a[168:171], a[40:43], v[104:107]
 v_cvt_pk_bf16_f32 v186, v72, v73
 v_cvt_pk_bf16_f32 v187, v74, v75
 v_mfma_f32_16x16x32_bf16 v[100:103], a[168:171], a[36:39], v[100:103]
 ds_read_b64_tr_b16 a[188:189], v10 offset:42464
 v_cvt_pk_bf16_f32 v188, v60, v61
 v_mfma_f32_16x16x32_bf16 v[100:103], a[172:175], a[52:55], v[100:103]
 ds_read_b64_tr_b16 a[190:191], v10 offset:42720
 v_cvt_pk_bf16_f32 v189, v62, v63
 v_mfma_f32_16x16x32_bf16 v[96:99], a[172:175], a[48:51], v[96:99]
 buffer_load_dwordx4 v7, s[44:47], s65 offen offset:3168 lds
 v_cvt_pk_bf16_f32 v190, v76, v77
 v_mfma_f32_16x16x32_bf16 v[96:99], a[168:171], a[32:35], v[96:99]
 s_waitcnt vmcnt(53)
 s_barrier
 s_waitcnt lgkmcnt(4)
 v_mfma_f32_16x16x32_bf16 v[112:115], a[176:179], a[32:35], v[112:115]
 ds_read_b64_tr_b16 a[160:161], v10 offset:50688
 v_cvt_pk_bf16_f32 v191, v78, v79
 v_mfma_f32_16x16x32_bf16 v[112:115], a[180:183], a[48:51], v[112:115]
 ds_read_b64_tr_b16 a[162:163], v10 offset:50944
 v_mfma_f32_16x16x32_bf16 v[116:119], a[180:183], a[52:55], v[116:119]
 buffer_load_dwordx4 a[220:223], v240, s[16:19], s64 offen offset:3072
 v_mfma_f32_16x16x32_bf16 v[116:119], a[176:179], a[36:39], v[116:119]
 v_cvt_pk_bf16_f32 v192, v80, v81
 v_cvt_pk_bf16_f32 v193, v82, v83
 v_mfma_f32_16x16x32_bf16 v[120:123], a[176:179], a[40:43], v[120:123]
 ds_read_b64_tr_b16 a[164:165], v10 offset:59136
 v_cvt_pk_bf16_f32 v194, v96, v97
 v_mfma_f32_16x16x32_bf16 v[120:123], a[180:183], a[56:59], v[120:123]
 ds_read_b64_tr_b16 a[166:167], v10 offset:59392
 v_cvt_pk_bf16_f32 v195, v98, v99
 v_mfma_f32_16x16x32_bf16 v[124:127], a[180:183], a[60:63], v[124:127]
 v_cvt_pk_bf16_f32 v196, v84, v85
 v_cvt_pk_bf16_f32 v197, v86, v87
 v_mfma_f32_16x16x32_bf16 v[124:127], a[176:179], a[44:47], v[124:127]
 s_add_u32 s65, s66, 786432
 v_cvt_pk_bf16_f32 v198, v100, v101
 s_waitcnt lgkmcnt(4)
 v_mfma_f32_16x16x32_bf16 v[140:143], a[184:187], a[44:47], v[140:143]
 ds_read_b64_tr_b16 a[168:169], v10 offset:50720
 v_cvt_pk_bf16_f32 v199, v102, v103
 v_mfma_f32_16x16x32_bf16 v[140:143], a[188:191], a[60:63], v[140:143]
 ds_read_b64_tr_b16 a[170:171], v10 offset:50976
 s_add_u32 s64, s81, 24576
 v_mfma_f32_16x16x32_bf16 v[136:139], a[188:191], a[56:59], v[136:139]
 buffer_load_dwordx4 a[224:227], v8, s[16:19], s64 offen offset:0
 v_cvt_pk_bf16_f32 v200, v88, v89
 v_mfma_f32_16x16x32_bf16 v[136:139], a[184:187], a[40:43], v[136:139]
 v_cvt_pk_bf16_f32 v201, v90, v91
 v_cvt_pk_bf16_f32 v202, v104, v105
 v_mfma_f32_16x16x32_bf16 v[132:135], a[184:187], a[36:39], v[132:135]
 ds_read_b64_tr_b16 a[172:173], v10 offset:59168
 v_cvt_pk_bf16_f32 v203, v106, v107
 v_mfma_f32_16x16x32_bf16 v[132:135], a[188:191], a[52:55], v[132:135]
 ds_read_b64_tr_b16 a[174:175], v10 offset:59424
 v_cvt_pk_bf16_f32 v204, v92, v93
 v_mfma_f32_16x16x32_bf16 v[128:131], a[188:191], a[48:51], v[128:131]
 buffer_load_dwordx4 a[228:231], v8, s[16:19], s64 offen offset:1024
 v_cvt_pk_bf16_f32 v205, v94, v95
 v_mfma_f32_16x16x32_bf16 v[128:131], a[184:187], a[32:35], v[128:131]
 s_waitcnt vmcnt(26) lgkmcnt(4)
 v_cvt_pk_bf16_f32 v206, v108, v109
 v_cvt_pk_bf16_f32 v207, v110, v111
 v_mfma_f32_16x16x32_bf16 v[144:147], a[160:163], a[64:67], 0
 ds_read_b64_tr_b16 a[176:177], v10 offset:50752
 v_mfma_f32_16x16x32_bf16 v[144:147], a[164:167], a[80:83], v[144:147]
 ds_read_b64_tr_b16 a[178:179], v10 offset:51008
 v_mfma_f32_16x16x32_bf16 v[148:151], a[164:167], a[84:87], 0
 buffer_load_dwordx4 a[232:235], v8, s[16:19], s64 offen offset:2048
 v_mfma_f32_16x16x32_bf16 v[148:151], a[160:163], a[68:71], v[148:151]
 s_add_u32 m0, s63, 84480
 buffer_store_dwordx4 v[176:179], v8, s[16:19], s36 offen offset:0 sc0 sc1
 v_cvt_pk_bf16_f32 v208, v112, v113
 v_mfma_f32_16x16x32_bf16 v[152:155], a[160:163], a[72:75], 0
 ds_read_b64_tr_b16 a[180:181], v10 offset:59200
 v_cvt_pk_bf16_f32 v209, v114, v115
 v_mfma_f32_16x16x32_bf16 v[152:155], a[164:167], a[88:91], v[152:155]
 ds_read_b64_tr_b16 a[182:183], v10 offset:59456
 v_cvt_pk_bf16_f32 v210, v128, v129
 v_mfma_f32_16x16x32_bf16 v[156:159], a[164:167], a[92:95], 0
 v_cvt_pk_bf16_f32 v211, v130, v131
 v_cvt_pk_bf16_f32 v212, v116, v117
 v_mfma_f32_16x16x32_bf16 v[156:159], a[160:163], a[76:79], v[156:159]
 s_waitcnt lgkmcnt(4)
 v_cvt_pk_bf16_f32 v213, v118, v119
 v_cvt_pk_bf16_f32 v214, v132, v133
 v_mfma_f32_16x16x32_bf16 v[172:175], a[168:171], a[76:79], 0
 ds_read_b64_tr_b16 a[184:185], v10 offset:50784
 v_cvt_pk_bf16_f32 v215, v134, v135
 v_mfma_f32_16x16x32_bf16 v[172:175], a[172:175], a[92:95], v[172:175]
 ds_read_b64_tr_b16 a[186:187], v10 offset:51040
 v_cvt_pk_bf16_f32 v216, v120, v121
 v_mfma_f32_16x16x32_bf16 v[168:171], a[172:175], a[88:91], 0
 buffer_load_dwordx4 v4, s[44:47], s65 offen offset:0 lds
 v_cvt_pk_bf16_f32 v217, v122, v123
 v_mfma_f32_16x16x32_bf16 v[168:171], a[168:171], a[72:75], v[168:171]
 v_cvt_pk_bf16_f32 v218, v136, v137
 v_cvt_pk_bf16_f32 v219, v138, v139
 v_mfma_f32_16x16x32_bf16 v[164:167], a[168:171], a[68:71], 0
 ds_read_b64_tr_b16 a[188:189], v10 offset:59232
 v_cvt_pk_bf16_f32 v220, v124, v125
 v_mfma_f32_16x16x32_bf16 v[164:167], a[172:175], a[84:87], v[164:167]
 ds_read_b64_tr_b16 a[190:191], v10 offset:59488
 v_cvt_pk_bf16_f32 v221, v126, v127
 v_mfma_f32_16x16x32_bf16 v[160:163], a[172:175], a[80:83], 0
 buffer_load_dwordx4 a[236:239], v8, s[16:19], s64 offen offset:3072
 v_cvt_pk_bf16_f32 v222, v140, v141
 v_mfma_f32_16x16x32_bf16 v[160:163], a[168:171], a[64:67], v[160:163]
 s_waitcnt lgkmcnt(4)
 v_cvt_pk_bf16_f32 v223, v142, v143
 v_mfma_f32_16x16x32_bf16 v[48:51], a[176:179], a[64:67], 0
 ds_read_b64_tr_b16 a[160:161], v10 offset:50816
 v_mfma_f32_16x16x32_bf16 v[48:51], a[180:183], a[80:83], v[48:51]
 ds_read_b64_tr_b16 a[162:163], v10 offset:51072
 v_mfma_f32_16x16x32_bf16 v[52:55], a[180:183], a[84:87], 0
 v_mfma_f32_16x16x32_bf16 v[52:55], a[176:179], a[68:71], v[52:55]
 v_mfma_f32_16x16x32_bf16 v[56:59], a[176:179], a[72:75], 0
 ds_read_b64_tr_b16 a[164:165], v10 offset:59264
 v_mfma_f32_16x16x32_bf16 v[56:59], a[180:183], a[88:91], v[56:59]
 ds_read_b64_tr_b16 a[166:167], v10 offset:59520
 v_mfma_f32_16x16x32_bf16 v[60:63], a[180:183], a[92:95], 0
 buffer_load_dwordx4 v5, s[44:47], s65 offen offset:1056 lds
 v_mfma_f32_16x16x32_bf16 v[60:63], a[176:179], a[76:79], v[60:63]
 s_waitcnt lgkmcnt(4)
 v_mfma_f32_16x16x32_bf16 v[76:79], a[184:187], a[76:79], 0
 ds_read_b64_tr_b16 a[168:169], v10 offset:50848
 v_mfma_f32_16x16x32_bf16 v[76:79], a[188:191], a[92:95], v[76:79]
 ds_read_b64_tr_b16 a[170:171], v10 offset:51104
 v_mfma_f32_16x16x32_bf16 v[72:75], a[188:191], a[88:91], 0
 buffer_load_dwordx4 a[128:131], v240, s[16:19], s64 offen offset:0
 v_mfma_f32_16x16x32_bf16 v[72:75], a[184:187], a[72:75], v[72:75]
 v_mfma_f32_16x16x32_bf16 v[68:71], a[184:187], a[68:71], 0
 ds_read_b64_tr_b16 a[172:173], v10 offset:59296
 v_mfma_f32_16x16x32_bf16 v[68:71], a[188:191], a[84:87], v[68:71]
 ds_read_b64_tr_b16 a[174:175], v10 offset:59552
 v_mfma_f32_16x16x32_bf16 v[64:67], a[188:191], a[80:83], 0
 v_mfma_f32_16x16x32_bf16 v[64:67], a[184:187], a[64:67], v[64:67]
 s_waitcnt lgkmcnt(4)
 v_mfma_f32_16x16x32_bf16 v[80:83], a[160:163], a[64:67], 0
 ds_read_b64_tr_b16 a[176:177], v10 offset:50880
 v_mfma_f32_16x16x32_bf16 v[80:83], a[164:167], a[80:83], v[80:83]
 ds_read_b64_tr_b16 a[178:179], v10 offset:51136
 v_mfma_f32_16x16x32_bf16 v[84:87], a[164:167], a[84:87], 0
 buffer_load_dwordx4 v6, s[44:47], s65 offen offset:2112 lds
 v_mfma_f32_16x16x32_bf16 v[84:87], a[160:163], a[68:71], v[84:87]
 v_mfma_f32_16x16x32_bf16 v[88:91], a[160:163], a[72:75], 0
 ds_read_b64_tr_b16 a[180:181], v10 offset:59328
 v_mfma_f32_16x16x32_bf16 v[88:91], a[164:167], a[88:91], v[88:91]
 ds_read_b64_tr_b16 a[182:183], v10 offset:59584
 v_mfma_f32_16x16x32_bf16 v[92:95], a[164:167], a[92:95], 0
 buffer_load_dwordx4 a[132:135], v240, s[16:19], s64 offen offset:1024
 v_mfma_f32_16x16x32_bf16 v[92:95], a[160:163], a[76:79], v[92:95]
 buffer_store_dwordx4 v[180:183], v8, s[16:19], s36 offen offset:1024 sc0 sc1
 s_waitcnt lgkmcnt(4)
 v_mfma_f32_16x16x32_bf16 v[108:111], a[168:171], a[76:79], 0
 ds_read_b64_tr_b16 a[184:185], v10 offset:50912
 v_mfma_f32_16x16x32_bf16 v[108:111], a[172:175], a[92:95], v[108:111]
 ds_read_b64_tr_b16 a[186:187], v10 offset:51168
 v_mfma_f32_16x16x32_bf16 v[104:107], a[172:175], a[88:91], 0
 buffer_load_dwordx4 a[136:139], v240, s[16:19], s64 offen offset:2048
 v_mfma_f32_16x16x32_bf16 v[104:107], a[168:171], a[72:75], v[104:107]
 s_getpc_b64 s[100:101]
L_pc2:
 s_add_u32 s100, s100, L_pc2-L_pc2+2048
 s_addc_u32 s101, s101, 0
 v_mfma_f32_16x16x32_bf16 v[100:103], a[168:171], a[68:71], 0
 ds_read_b64_tr_b16 a[188:189], v10 offset:59360
 v_min_u32 v250, 15, v1
 v_mfma_f32_16x16x32_bf16 v[100:103], a[172:175], a[84:87], v[100:103]
 ds_read_b64_tr_b16 a[190:191], v10 offset:59616
 v_lshlrev_b32 v250, 7, v250
 v_mfma_f32_16x16x32_bf16 v[96:99], a[172:175], a[80:83], 0
 buffer_load_dwordx4 v7, s[44:47], s65 offen offset:3168 lds
 v_add_u32 v250, s68, v250
 v_mfma_f32_16x16x32_bf16 v[96:99], a[168:171], a[64:67], v[96:99]
 s_waitcnt lgkmcnt(4)
 v_min_u32 v250, L_chk_slow-L_pc2-2048-4, v250
 v_mov_b32 v251, s101
 v_mfma_f32_16x16x32_bf16 v[112:115], a[176:179], a[64:67], 0
 ds_read_b64_tr_b16 a[160:161], v9 offset:0
 v_mfma_f32_16x16x32_bf16 v[112:115], a[180:183], a[80:83], v[112:115]
 ds_read_b64_tr_b16 a[162:163], v9 offset:256
 v_mfma_f32_16x16x32_bf16 v[116:119], a[180:183], a[84:87], 0
 v_add_co_u32 v250, vcc, s100, v250
 v_addc_co_u32 v251, vcc, 0, v251, vcc
 v_mfma_f32_16x16x32_bf16 v[116:119], a[176:179], a[68:71], v[116:119]
 global_load_dword v249, v[250:251], off
 v_mfma_f32_16x16x32_bf16 v[120:123], a[176:179], a[72:75], 0
 ds_read_b64_tr_b16 a[164:165], v9 offset:8448
 v_mfma_f32_16x16x32_bf16 v[120:123], a[180:183], a[88:91], v[120:123]
 ds_read_b64_tr_b16 a[166:167], v9 offset:8704
 v_mfma_f32_16x16x32_bf16 v[124:127], a[180:183], a[92:95], 0
 buffer_load_dwordx4 a[140:143], v240, s[16:19], s64 offen offset:3072
 v_mfma_f32_16x16x32_bf16 v[124:127], a[176:179], a[76:79], v[124:127]
 s_add_u32 s65, s66, 917504
 s_waitcnt lgkmcnt(4)
 v_mfma_f32_16x16x32_bf16 v[140:143], a[184:187], a[76:79], 0
 ds_read_b64_tr_b16 a[168:169], v9 offset:32
 v_mfma_f32_16x16x32_bf16 v[140:143], a[188:191], a[92:95], v[140:143]
 ds_read_b64_tr_b16 a[170:171], v9 offset:288
 v_mfma_f32_16x16x32_bf16 v[136:139], a[188:191], a[88:91], 0
 v_mfma_f32_16x16x32_bf16 v[136:139], a[184:187], a[72:75], v[136:139]
 v_mfma_f32_16x16x32_bf16 v[132:135], a[184:187], a[68:71], 0
 ds_read_b64_tr_b16 a[172:173], v9 offset:8480
 v_mfma_f32_16x16x32_bf16 v[132:135], a[188:191], a[84:87], v[132:135]
 ds_read_b64_tr_b16 a[174:175], v9 offset:8736
 s_add_u32 s64, s81, 32768
 v_mfma_f32_16x16x32_bf16 v[128:131], a[188:191], a[80:83], 0
 buffer_load_dwordx4 a[240:243], v8, s[16:19], s64 offen offset:0
 v_mfma_f32_16x16x32_bf16 v[128:131], a[184:187], a[64:67], v[128:131]
 s_waitcnt vmcnt(28) lgkmcnt(4)
 v_mfma_f32_16x16x32_bf16 v[144:147], a[160:163], a[96:99], v[144:147]
 ds_read_b64_tr_b16 a[176:177], v9 offset:64
 v_mfma_f32_16x16x32_bf16 v[144:147], a[164:167], a[112:115], v[144:147]
 ds_read_b64_tr_b16 a[178:179], v9 offset:320
 v_mfma_f32_16x16x32_bf16 v[148:151], a[164:167], a[116:119], v[148:151]
 buffer_load_dwordx4 a[244:247], v8, s[16:19], s64 offen offset:1024
 v_mfma_f32_16x16x32_bf16 v[148:151], a[160:163], a[100:103], v[148:151]
 s_add_u32 m0, s63, 101376
 v_mfma_f32_16x16x32_bf16 v[152:155], a[160:163], a[104:107], v[152:155]
 ds_read_b64_tr_b16 a[180:181], v9 offset:8512
 v_mfma_f32_16x16x32_bf16 v[152:155], a[164:167], a[120:123], v[152:155]
 ds_read_b64_tr_b16 a[182:183], v9 offset:8768
 v_mfma_f32_16x16x32_bf16 v[156:159], a[164:167], a[124:127], v[156:159]
 v_mfma_f32_16x16x32_bf16 v[156:159], a[160:163], a[108:111], v[156:159]
 s_waitcnt lgkmcnt(4)
 v_mfma_f32_16x16x32_bf16 v[172:175], a[168:171], a[108:111], v[172:175]
 ds_read_b64_tr_b16 a[184:185], v9 offset:96
 v_mfma_f32_16x16x32_bf16 v[172:175], a[172:175], a[124:127], v[172:175]
 ds_read_b64_tr_b16 a[186:187], v9 offset:352
 v_mfma_f32_16x16x32_bf16 v[168:171], a[172:175], a[120:123], v[168:171]
 buffer_load_dwordx4 v4, s[44:47], s65 offen offset:0 lds
 v_mfma_f32_16x16x32_bf16 v[168:171], a[168:171], a[104:107], v[168:171]
 buffer_store_dwordx4 v[184:187], v8, s[16:19], s36 offen offset:2048 sc0 sc1
 v_mfma_f32_16x16x32_bf16 v[164:167], a[168:171], a[100:103], v[164:167]
 ds_read_b64_tr_b16 a[188:189], v9 offset:8544
 v_mfma_f32_16x16x32_bf16 v[164:167], a[172:175], a[116:119], v[164:167]
 ds_read_b64_tr_b16 a[190:191], v9 offset:8800
 v_mfma_f32_16x16x32_bf16 v[160:163], a[172:175], a[112:115], v[160:163]
 buffer_load_dwordx4 a[248:251], v8, s[16:19], s64 offen offset:2048
 v_mfma_f32_16x16x32_bf16 v[160:163], a[168:171], a[96:99], v[160:163]
 s_waitcnt lgkmcnt(4)
 v_mfma_f32_16x16x32_bf16 v[48:51], a[176:179], a[96:99], v[48:51]
 ds_read_b64_tr_b16 a[160:161], v9 offset:128
 v_mfma_f32_16x16x32_bf16 v[48:51], a[180:183], a[112:115], v[48:51]
 ds_read_b64_tr_b16 a[162:163], v9 offset:384
 v_mfma_f32_16x16x32_bf16 v[52:55], a[180:183], a[116:119], v[52:55]
 v_mfma_f32_16x16x32_bf16 v[52:55], a[176:179], a[100:103], v[52:55]
 v_mfma_f32_16x16x32_bf16 v[56:59], a[176:179], a[104:107], v[56:59]
 ds_read_b64_tr_b16 a[164:165], v9 offset:8576
 v_mfma_f32_16x16x32_bf16 v[56:59], a[180:183], a[120:123], v[56:59]
 ds_read_b64_tr_b16 a[166:167], v9 offset:8832
 v_mfma_f32_16x16x32_bf16 v[60:63], a[180:183], a[124:127], v[60:63]
 buffer_load_dwordx4 v5, s[44:47], s65 offen offset:1056 lds
 v_mfma_f32_16x16x32_bf16 v[60:63], a[176:179], a[108:111], v[60:63]
 s_waitcnt lgkmcnt(4)
 v_mfma_f32_16x16x32_bf16 v[76:79], a[184:187], a[108:111], v[76:79]
 ds_read_b64_tr_b16 a[168:169], v9 offset:160
 v_mfma_f32_16x16x32_bf16 v[76:79], a[188:191], a[124:127], v[76:79]
 ds_read_b64_tr_b16 a[170:171], v9 offset:416
 v_mfma_f32_16x16x32_bf16 v[72:75], a[188:191], a[120:123], v[72:75]
 buffer_load_dwordx4 a[252:255], v8, s[16:19], s64 offen offset:3072
 v_mfma_f32_16x16x32_bf16 v[72:75], a[184:187], a[104:107], v[72:75]
 v_mfma_f32_16x16x32_bf16 v[68:71], a[184:187], a[100:103], v[68:71]
 ds_read_b64_tr_b16 a[172:173], v9 offset:8608
 v_mfma_f32_16x16x32_bf16 v[68:71], a[188:191], a[116:119], v[68:71]
 ds_read_b64_tr_b16 a[174:175], v9 offset:8864
 v_mfma_f32_16x16x32_bf16 v[64:67], a[188:191], a[112:115], v[64:67]
 v_mfma_f32_16x16x32_bf16 v[64:67], a[184:187], a[96:99], v[64:67]
 s_waitcnt lgkmcnt(4)
 v_mfma_f32_16x16x32_bf16 v[80:83], a[160:163], a[96:99], v[80:83]
 ds_read_b64_tr_b16 a[176:177], v9 offset:192
 v_mfma_f32_16x16x32_bf16 v[80:83], a[164:167], a[112:115], v[80:83]
 ds_read_b64_tr_b16 a[178:179], v9 offset:448
 v_mfma_f32_16x16x32_bf16 v[84:87], a[164:167], a[116:119], v[84:87]
 buffer_load_dwordx4 v6, s[44:47], s65 offen offset:2112 lds
 v_mfma_f32_16x16x32_bf16 v[84:87], a[160:163], a[100:103], v[84:87]
 v_mfma_f32_16x16x32_bf16 v[88:91], a[160:163], a[104:107], v[88:91]
 ds_read_b64_tr_b16 a[180:181], v9 offset:8640
 v_mfma_f32_16x16x32_bf16 v[88:91], a[164:167], a[120:123], v[88:91]
 ds_read_b64_tr_b16 a[182:183], v9 offset:8896
 v_mfma_f32_16x16x32_bf16 v[92:95], a[164:167], a[124:127], v[92:95]
 buffer_load_dwordx4 a[16:19], v240, s[16:19], s64 offen offset:0
 v_mfma_f32_16x16x32_bf16 v[92:95], a[160:163], a[108:111], v[92:95]
 s_waitcnt lgkmcnt(4)
 v_mfma_f32_16x16x32_bf16 v[108:111], a[168:171], a[108:111], v[108:111]
 ds_read_b64_tr_b16 a[184:185], v9 offset:224
 v_mfma_f32_16x16x32_bf16 v[108:111], a[172:175], a[124:127], v[108:111]
 ds_read_b64_tr_b16 a[186:187], v9 offset:480
 v_mfma_f32_16x16x32_bf16 v[104:107], a[172:175], a[120:123], v[104:107]
 buffer_load_dwordx4 a[20:23], v240, s[16:19], s64 offen offset:1024
 v_mfma_f32_16x16x32_bf16 v[104:107], a[168:171], a[104:107], v[104:107]
 v_mfma_f32_16x16x32_bf16 v[100:103], a[168:171], a[100:103], v[100:103]
 ds_read_b64_tr_b16 a[188:189], v9 offset:8672
 v_mfma_f32_16x16x32_bf16 v[100:103], a[172:175], a[116:119], v[100:103]
 ds_read_b64_tr_b16 a[190:191], v9 offset:8928
 v_mfma_f32_16x16x32_bf16 v[96:99], a[172:175], a[112:115], v[96:99]
 buffer_load_dwordx4 v7, s[44:47], s65 offen offset:3168 lds
 v_mfma_f32_16x16x32_bf16 v[96:99], a[168:171], a[96:99], v[96:99]
 s_waitcnt vmcnt(53)
 s_barrier
 buffer_store_dwordx4 v[188:191], v8, s[16:19], s36 offen offset:3072 sc0 sc1
 s_waitcnt lgkmcnt(4)
 v_mfma_f32_16x16x32_bf16 v[112:115], a[176:179], a[96:99], v[112:115]
 ds_read_b64_tr_b16 a[160:161], v9 offset:16896
 v_mfma_f32_16x16x32_bf16 v[112:115], a[180:183], a[112:115], v[112:115]
 ds_read_b64_tr_b16 a[162:163], v9 offset:17152
 v_mfma_f32_16x16x32_bf16 v[116:119], a[180:183], a[116:119], v[116:119]
 v_mfma_f32_16x16x32_bf16 v[116:119], a[176:179], a[100:103], v[116:119]
 v_mfma_f32_16x16x32_bf16 v[120:123], a[176:179], a[104:107], v[120:123]
 ds_read_b64_tr_b16 a[164:165], v9 offset:25344
 v_mfma_f32_16x16x32_bf16 v[120:123], a[180:183], a[120:123], v[120:123]
 ds_read_b64_tr_b16 a[166:167], v9 offset:25600
 v_mfma_f32_16x16x32_bf16 v[124:127], a[180:183], a[124:127], v[124:127]
 buffer_load_dwordx4 a[24:27], v240, s[16:19], s64 offen offset:2048
 v_mfma_f32_16x16x32_bf16 v[124:127], a[176:179], a[108:111], v[124:127]
 s_add_u32 s65, s66, 1048576
 s_waitcnt lgkmcnt(4)
 v_mfma_f32_16x16x32_bf16 v[140:143], a[184:187], a[108:111], v[140:143]
 ds_read_b64_tr_b16 a[168:169], v9 offset:16928
 v_mfma_f32_16x16x32_bf16 v[140:143], a[188:191], a[124:127], v[140:143]
 ds_read_b64_tr_b16 a[170:171], v9 offset:17184
 v_mfma_f32_16x16x32_bf16 v[136:139], a[188:191], a[120:123], v[136:139]
 v_mfma_f32_16x16x32_bf16 v[136:139], a[184:187], a[104:107], v[136:139]
 v_mfma_f32_16x16x32_bf16 v[132:135], a[184:187], a[100:103], v[132:135]
 ds_read_b64_tr_b16 a[172:173], v9 offset:25376
 v_mfma_f32_16x16x32_bf16 v[132:135], a[188:191], a[116:119], v[132:135]
 ds_read_b64_tr_b16 a[174:175], v9 offset:25632
 v_mfma_f32_16x16x32_bf16 v[128:131], a[188:191], a[112:115], v[128:131]
 buffer_load_dwordx4 a[28:31], v240, s[16:19], s64 offen offset:3072
 v_mfma_f32_16x16x32_bf16 v[128:131], a[184:187], a[96:99], v[128:131]
 s_waitcnt vmcnt(29) lgkmcnt(4)
 v_mfma_f32_16x16x32_bf16 v[144:147], a[160:163], a[192:195], v[144:147]
 s_branch L_pg17k
L_pg17:
L_ic3w1:
 s_branch L_ic3r
L_pg17k:
 ds_read_b64_tr_b16 a[176:177], v9 offset:16960
 v_mfma_f32_16x16x32_bf16 v[144:147], a[164:167], a[208:211], v[144:147]
 ds_read_b64_tr_b16 a[178:179], v9 offset:17216
 s_add_u32 s64, s81, 40960
 v_mfma_f32_16x16x32_bf16 v[148:151], a[164:167], a[212:215], v[148:151]
 buffer_load_dwordx4 a[144:147], v8, s[16:19], s64 offen offset:0
 v_mfma_f32_16x16x32_bf16 v[148:151], a[160:163], a[196:199], v[148:151]
 s_add_u32 m0, s63, 118272
 v_mfma_f32_16x16x32_bf16 v[152:155], a[160:163], a[200:203], v[152:155]
 ds_read_b64_tr_b16 a[180:181], v9 offset:25408
 v_mfma_f32_16x16x32_bf16 v[152:155], a[164:167], a[216:219], v[152:155]
 ds_read_b64_tr_b16 a[182:183], v9 offset:25664
 v_mfma_f32_16x16x32_bf16 v[156:159], a[164:167], a[220:223], v[156:159]
 v_mfma_f32_16x16x32_bf16 v[156:159], a[160:163], a[204:207], v[156:159]
 s_waitcnt lgkmcnt(4)
 v_mfma_f32_16x16x32_bf16 v[172:175], a[168:171], a[204:207], v[172:175]
 ds_read_b64_tr_b16 a[184:185], v9 offset:16992
 v_mfma_f32_16x16x32_bf16 v[172:175], a[172:175], a[220:223], v[172:175]
 ds_read_b64_tr_b16 a[186:187], v9 offset:17248
 v_mfma_f32_16x16x32_bf16 v[168:171], a[172:175], a[216:219], v[168:171]
 buffer_load_dwordx4 v4, s[44:47], s65 offen offset:0 lds
 v_mfma_f32_16x16x32_bf16 v[168:171], a[168:171], a[200:203], v[168:171]
 v_mfma_f32_16x16x32_bf16 v[164:167], a[168:171], a[196:199], v[164:167]
 ds_read_b64_tr_b16 a[188:189], v9 offset:25440
 v_mfma_f32_16x16x32_bf16 v[164:167], a[172:175], a[212:215], v[164:167]
 ds_read_b64_tr_b16 a[190:191], v9 offset:25696
 v_mfma_f32_16x16x32_bf16 v[160:163], a[172:175], a[208:211], v[160:163]
 buffer_load_dwordx4 a[148:151], v8, s[16:19], s64 offen offset:1024
 v_mfma_f32_16x16x32_bf16 v[160:163], a[168:171], a[192:195], v[160:163]
 s_waitcnt lgkmcnt(4)
 v_mfma_f32_16x16x32_bf16 v[48:51], a[176:179], a[192:195], v[48:51]
 ds_read_b64_tr_b16 a[160:161], v9 offset:17024
 v_mfma_f32_16x16x32_bf16 v[48:51], a[180:183], a[208:211], v[48:51]
 ds_read_b64_tr_b16 a[162:163], v9 offset:17280
 v_mfma_f32_16x16x32_bf16 v[52:55], a[180:183], a[212:215], v[52:55]
 v_mfma_f32_16x16x32_bf16 v[52:55], a[176:179], a[196:199], v[52:55]
 buffer_store_dwordx4 v[192:195], v8, s[16:19], s37 offen offset:0 sc0 sc1
 v_mfma_f32_16x16x32_bf16 v[56:59], a[176:179], a[200:203], v[56:59]
 ds_read_b64_tr_b16 a[164:165], v9 offset:25472
 v_mfma_f32_16x16x32_bf16 v[56:59], a[180:183], a[216:219], v[56:59]
 ds_read_b64_tr_b16 a[166:167], v9 offset:25728
 v_mfma_f32_16x16x32_bf16 v[60:63], a[180:183], a[220:223], v[60:63]
 buffer_load_dwordx4 v5, s[44:47], s65 offen offset:1056 lds
 v_mfma_f32_16x16x32_bf16 v[60:63], a[176:179], a[204:207], v[60:63]
 s_waitcnt lgkmcnt(4)
 v_mfma_f32_16x16x32_bf16 v[76:79], a[184:187], a[204:207], v[76:79]
 ds_read_b64_tr_b16 a[168:169], v9 offset:17056
 v_mfma_f32_16x16x32_bf16 v[76:79], a[188:191], a[220:223], v[76:79]
 ds_read_b64_tr_b16 a[170:171], v9 offset:17312
 v_mfma_f32_16x16x32_bf16 v[72:75], a[188:191], a[216:219], v[72:75]
 buffer_load_dwordx4 a[152:155], v8, s[16:19], s64 offen offset:2048
 v_mfma_f32_16x16x32_bf16 v[72:75], a[184:187], a[200:203], v[72:75]
 v_mfma_f32_16x16x32_bf16 v[68:71], a[184:187], a[196:199], v[68:71]
 ds_read_b64_tr_b16 a[172:173], v9 offset:25504
 v_mfma_f32_16x16x32_bf16 v[68:71], a[188:191], a[212:215], v[68:71]
 ds_read_b64_tr_b16 a[174:175], v9 offset:25760
 v_mfma_f32_16x16x32_bf16 v[64:67], a[188:191], a[208:211], v[64:67]
 v_mfma_f32_16x16x32_bf16 v[64:67], a[184:187], a[192:195], v[64:67]
 s_waitcnt lgkmcnt(4)
 v_mfma_f32_16x16x32_bf16 v[80:83], a[160:163], a[192:195], v[80:83]
 ds_read_b64_tr_b16 a[176:177], v9 offset:17088
 v_mfma_f32_16x16x32_bf16 v[80:83], a[164:167], a[208:211], v[80:83]
 ds_read_b64_tr_b16 a[178:179], v9 offset:17344
 v_mfma_f32_16x16x32_bf16 v[84:87], a[164:167], a[212:215], v[84:87]
 buffer_load_dwordx4 v6, s[44:47], s65 offen offset:2112 lds
 v_mfma_f32_16x16x32_bf16 v[84:87], a[160:163], a[196:199], v[84:87]
 v_mfma_f32_16x16x32_bf16 v[88:91], a[160:163], a[200:203], v[88:91]
 ds_read_b64_tr_b16 a[180:181], v9 offset:25536
 v_mfma_f32_16x16x32_bf16 v[88:91], a[164:167], a[216:219], v[88:91]
 ds_read_b64_tr_b16 a[182:183], v9 offset:25792
 v_mfma_f32_16x16x32_bf16 v[92:95], a[164:167], a[220:223], v[92:95]
 buffer_load_dwordx4 a[156:159], v8, s[16:19], s64 offen offset:3072
 v_mfma_f32_16x16x32_bf16 v[92:95], a[160:163], a[204:207], v[92:95]
 s_waitcnt lgkmcnt(4)
 v_mfma_f32_16x16x32_bf16 v[108:111], a[168:171], a[204:207], v[108:111]
 ds_read_b64_tr_b16 a[184:185], v9 offset:17120
 v_mfma_f32_16x16x32_bf16 v[108:111], a[172:175], a[220:223], v[108:111]
 ds_read_b64_tr_b16 a[186:187], v9 offset:17376
 v_mfma_f32_16x16x32_bf16 v[104:107], a[172:175], a[216:219], v[104:107]
 buffer_load_dwordx4 a[32:35], v240, s[16:19], s64 offen offset:0
 v_mfma_f32_16x16x32_bf16 v[104:107], a[168:171], a[200:203], v[104:107]
 v_mfma_f32_16x16x32_bf16 v[100:103], a[168:171], a[196:199], v[100:103]
 ds_read_b64_tr_b16 a[188:189], v9 offset:25568
 v_mfma_f32_16x16x32_bf16 v[100:103], a[172:175], a[212:215], v[100:103]
 ds_read_b64_tr_b16 a[190:191], v9 offset:25824
 v_mfma_f32_16x16x32_bf16 v[96:99], a[172:175], a[208:211], v[96:99]
 buffer_load_dwordx4 v7, s[44:47], s65 offen offset:3168 lds
 v_mfma_f32_16x16x32_bf16 v[96:99], a[168:171], a[192:195], v[96:99]
 s_waitcnt lgkmcnt(4)
 v_mfma_f32_16x16x32_bf16 v[112:115], a[176:179], a[192:195], v[112:115]
 ds_read_b64_tr_b16 a[160:161], v9 offset:33792
 v_mfma_f32_16x16x32_bf16 v[112:115], a[180:183], a[208:211], v[112:115]
 ds_read_b64_tr_b16 a[162:163], v9 offset:34048
 v_mfma_f32_16x16x32_bf16 v[116:119], a[180:183], a[212:215], v[116:119]
 v_mfma_f32_16x16x32_bf16 v[116:119], a[176:179], a[196:199], v[116:119]
 v_mfma_f32_16x16x32_bf16 v[120:123], a[176:179], a[200:203], v[120:123]
 ds_read_b64_tr_b16 a[164:165], v9 offset:42240
 v_mfma_f32_16x16x32_bf16 v[120:123], a[180:183], a[216:219], v[120:123]
 ds_read_b64_tr_b16 a[166:167], v9 offset:42496
 v_mfma_f32_16x16x32_bf16 v[124:127], a[180:183], a[220:223], v[124:127]
 buffer_load_dwordx4 a[36:39], v240, s[16:19], s64 offen offset:1024
 v_mfma_f32_16x16x32_bf16 v[124:127], a[176:179], a[204:207], v[124:127]
 s_add_u32 s65, s66, 1179648
 buffer_store_dwordx4 v[196:199], v8, s[16:19], s37 offen offset:1024 sc0 sc1
 s_waitcnt lgkmcnt(4)
 v_mfma_f32_16x16x32_bf16 v[140:143], a[184:187], a[204:207], v[140:143]
 ds_read_b64_tr_b16 a[168:169], v9 offset:33824
 v_mfma_f32_16x16x32_bf16 v[140:143], a[188:191], a[220:223], v[140:143]
 ds_read_b64_tr_b16 a[170:171], v9 offset:34080
 v_mfma_f32_16x16x32_bf16 v[136:139], a[188:191], a[216:219], v[136:139]
 v_mfma_f32_16x16x32_bf16 v[136:139], a[184:187], a[200:203], v[136:139]
 v_mfma_f32_16x16x32_bf16 v[132:135], a[184:187], a[196:199], v[132:135]
 ds_read_b64_tr_b16 a[172:173], v9 offset:42272
 v_mfma_f32_16x16x32_bf16 v[132:135], a[188:191], a[212:215], v[132:135]
 ds_read_b64_tr_b16 a[174:175], v9 offset:42528
 v_mfma_f32_16x16x32_bf16 v[128:131], a[188:191], a[208:211], v[128:131]
 buffer_load_dwordx4 a[40:43], v240, s[16:19], s64 offen offset:2048
 v_mfma_f32_16x16x32_bf16 v[128:131], a[184:187], a[192:195], v[128:131]
 s_waitcnt vmcnt(27) lgkmcnt(4)
 v_mfma_f32_16x16x32_bf16 v[144:147], a[160:163], a[224:227], v[144:147]
 ds_read_b64_tr_b16 a[176:177], v9 offset:33856
 v_mfma_f32_16x16x32_bf16 v[144:147], a[164:167], a[128:131], v[144:147]
 ds_read_b64_tr_b16 a[178:179], v9 offset:34112
 v_mfma_f32_16x16x32_bf16 v[148:151], a[164:167], a[132:135], v[148:151]
 buffer_load_dwordx4 a[44:47], v240, s[16:19], s64 offen offset:3072
 v_mfma_f32_16x16x32_bf16 v[148:151], a[160:163], a[228:231], v[148:151]
 s_add_u32 m0, s63, 0
 v_mfma_f32_16x16x32_bf16 v[152:155], a[160:163], a[232:235], v[152:155]
 ds_read_b64_tr_b16 a[180:181], v9 offset:42304
 v_mfma_f32_16x16x32_bf16 v[152:155], a[164:167], a[136:139], v[152:155]
 ds_read_b64_tr_b16 a[182:183], v9 offset:42560
 v_mfma_f32_16x16x32_bf16 v[156:159], a[164:167], a[140:143], v[156:159]
 v_mfma_f32_16x16x32_bf16 v[156:159], a[160:163], a[236:239], v[156:159]
 s_waitcnt lgkmcnt(4)
 v_mfma_f32_16x16x32_bf16 v[172:175], a[168:171], a[236:239], v[172:175]
 ds_read_b64_tr_b16 a[184:185], v9 offset:33888
 v_mfma_f32_16x16x32_bf16 v[172:175], a[172:175], a[140:143], v[172:175]
 ds_read_b64_tr_b16 a[186:187], v9 offset:34144
 v_mfma_f32_16x16x32_bf16 v[168:171], a[172:175], a[136:139], v[168:171]
 buffer_load_dwordx4 v4, s[44:47], s65 offen offset:0 lds
 v_mfma_f32_16x16x32_bf16 v[168:171], a[168:171], a[232:235], v[168:171]
 v_mfma_f32_16x16x32_bf16 v[164:167], a[168:171], a[228:231], v[164:167]
 ds_read_b64_tr_b16 a[188:189], v9 offset:42336
 v_mfma_f32_16x16x32_bf16 v[164:167], a[172:175], a[132:135], v[164:167]
 ds_read_b64_tr_b16 a[190:191], v9 offset:42592
 s_add_u32 s64, s81, 49152
 v_mfma_f32_16x16x32_bf16 v[160:163], a[172:175], a[128:131], v[160:163]
 buffer_load_dwordx4 a[48:51], v8, s[16:19], s64 offen offset:0
 v_mfma_f32_16x16x32_bf16 v[160:163], a[168:171], a[224:227], v[160:163]
 s_waitcnt lgkmcnt(4)
 v_mfma_f32_16x16x32_bf16 v[48:51], a[176:179], a[224:227], v[48:51]
 ds_read_b64_tr_b16 a[160:161], v9 offset:33920
 v_mfma_f32_16x16x32_bf16 v[48:51], a[180:183], a[128:131], v[48:51]
 ds_read_b64_tr_b16 a[162:163], v9 offset:34176
 v_mfma_f32_16x16x32_bf16 v[52:55], a[180:183], a[132:135], v[52:55]
 v_mfma_f32_16x16x32_bf16 v[52:55], a[176:179], a[228:231], v[52:55]
 v_mfma_f32_16x16x32_bf16 v[56:59], a[176:179], a[232:235], v[56:59]
 ds_read_b64_tr_b16 a[164:165], v9 offset:42368
 v_mfma_f32_16x16x32_bf16 v[56:59], a[180:183], a[136:139], v[56:59]
 ds_read_b64_tr_b16 a[166:167], v9 offset:42624
 v_mfma_f32_16x16x32_bf16 v[60:63], a[180:183], a[140:143], v[60:63]
 buffer_load_dwordx4 v5, s[44:47], s65 offen offset:1056 lds
 v_mfma_f32_16x16x32_bf16 v[60:63], a[176:179], a[236:239], v[60:63]
 s_waitcnt lgkmcnt(4)
 v_mfma_f32_16x16x32_bf16 v[76:79], a[184:187], a[236:239], v[76:79]
 ds_read_b64_tr_b16 a[168:169], v9 offset:33952
 v_mfma_f32_16x16x32_bf16 v[76:79], a[188:191], a[140:143], v[76:79]
 ds_read_b64_tr_b16 a[170:171], v9 offset:34208
 v_mfma_f32_16x16x32_bf16 v[72:75], a[188:191], a[136:139], v[72:75]
 buffer_load_dwordx4 a[52:55], v8, s[16:19], s64 offen offset:1024
 v_mfma_f32_16x16x32_bf16 v[72:75], a[184:187], a[232:235], v[72:75]
 buffer_store_dwordx4 v[200:203], v8, s[16:19], s37 offen offset:2048 sc0 sc1
 v_mfma_f32_16x16x32_bf16 v[68:71], a[184:187], a[228:231], v[68:71]
 ds_read_b64_tr_b16 a[172:173], v9 offset:42400
 v_mfma_f32_16x16x32_bf16 v[68:71], a[188:191], a[132:135], v[68:71]
 ds_read_b64_tr_b16 a[174:175], v9 offset:42656
 v_mfma_f32_16x16x32_bf16 v[64:67], a[188:191], a[128:131], v[64:67]
 v_mfma_f32_16x16x32_bf16 v[64:67], a[184:187], a[224:227], v[64:67]
 s_waitcnt lgkmcnt(4)
 v_mfma_f32_16x16x32_bf16 v[80:83], a[160:163], a[224:227], v[80:83]
 ds_read_b64_tr_b16 a[176:177], v9 offset:33984
 v_mfma_f32_16x16x32_bf16 v[80:83], a[164:167], a[128:131], v[80:83]
 ds_read_b64_tr_b16 a[178:179], v9 offset:34240
 v_mfma_f32_16x16x32_bf16 v[84:87], a[164:167], a[132:135], v[84:87]
 buffer_load_dwordx4 v6, s[44:47], s65 offen offset:2112 lds
 v_mfma_f32_16x16x32_bf16 v[84:87], a[160:163], a[228:231], v[84:87]
 v_mfma_f32_16x16x32_bf16 v[88:91], a[160:163], a[232:235], v[88:91]
 ds_read_b64_tr_b16 a[180:181], v9 offset:42432
 v_mfma_f32_16x16x32_bf16 v[88:91], a[164:167], a[136:139], v[88:91]
 ds_read_b64_tr_b16 a[182:183], v9 offset:42688
 v_mfma_f32_16x16x32_bf16 v[92:95], a[164:167], a[140:143], v[92:95]
 buffer_load_dwordx4 a[56:59], v8, s[16:19], s64 offen offset:2048
 v_mfma_f32_16x16x32_bf16 v[92:95], a[160:163], a[236:239], v[92:95]
 s_waitcnt lgkmcnt(4)
 v_mfma_f32_16x16x32_bf16 v[108:111], a[168:171], a[236:239], v[108:111]
 ds_read_b64_tr_b16 a[184:185], v9 offset:34016
 v_mfma_f32_16x16x32_bf16 v[108:111], a[172:175], a[140:143], v[108:111]
 ds_read_b64_tr_b16 a[186:187], v9 offset:34272
 v_mfma_f32_16x16x32_bf16 v[104:107], a[172:175], a[136:139], v[104:107]
 buffer_load_dwordx4 a[60:63], v8, s[16:19], s64 offen offset:3072
 v_mfma_f32_16x16x32_bf16 v[104:107], a[168:171], a[232:235], v[104:107]
 v_mfma_f32_16x16x32_bf16 v[100:103], a[168:171], a[228:231], v[100:103]
 ds_read_b64_tr_b16 a[188:189], v9 offset:42464
 v_mfma_f32_16x16x32_bf16 v[100:103], a[172:175], a[132:135], v[100:103]
 ds_read_b64_tr_b16 a[190:191], v9 offset:42720
 v_mfma_f32_16x16x32_bf16 v[96:99], a[172:175], a[128:131], v[96:99]
 buffer_load_dwordx4 v7, s[44:47], s65 offen offset:3168 lds
 v_mfma_f32_16x16x32_bf16 v[96:99], a[168:171], a[224:227], v[96:99]
 s_waitcnt vmcnt(53)
 s_barrier
 s_waitcnt lgkmcnt(4)
 v_mfma_f32_16x16x32_bf16 v[112:115], a[176:179], a[224:227], v[112:115]
 ds_read_b64_tr_b16 a[160:161], v9 offset:50688
 v_mfma_f32_16x16x32_bf16 v[112:115], a[180:183], a[128:131], v[112:115]
 ds_read_b64_tr_b16 a[162:163], v9 offset:50944
 v_mfma_f32_16x16x32_bf16 v[116:119], a[180:183], a[132:135], v[116:119]
 v_mfma_f32_16x16x32_bf16 v[116:119], a[176:179], a[228:231], v[116:119]
 v_mfma_f32_16x16x32_bf16 v[120:123], a[176:179], a[232:235], v[120:123]
 ds_read_b64_tr_b16 a[164:165], v9 offset:59136
 v_mfma_f32_16x16x32_bf16 v[120:123], a[180:183], a[136:139], v[120:123]
 ds_read_b64_tr_b16 a[166:167], v9 offset:59392
 v_mfma_f32_16x16x32_bf16 v[124:127], a[180:183], a[140:143], v[124:127]
 buffer_load_dwordx4 a[64:67], v240, s[16:19], s64 offen offset:0
 v_mfma_f32_16x16x32_bf16 v[124:127], a[176:179], a[236:239], v[124:127]
 s_add_u32 s65, s66, 1310720
 s_waitcnt lgkmcnt(4)
 v_mfma_f32_16x16x32_bf16 v[140:143], a[184:187], a[236:239], v[140:143]
 ds_read_b64_tr_b16 a[168:169], v9 offset:50720
 v_mfma_f32_16x16x32_bf16 v[140:143], a[188:191], a[140:143], v[140:143]
 ds_read_b64_tr_b16 a[170:171], v9 offset:50976
 v_mfma_f32_16x16x32_bf16 v[136:139], a[188:191], a[136:139], v[136:139]
 v_mfma_f32_16x16x32_bf16 v[136:139], a[184:187], a[232:235], v[136:139]
 v_mfma_f32_16x16x32_bf16 v[132:135], a[184:187], a[228:231], v[132:135]
 ds_read_b64_tr_b16 a[172:173], v9 offset:59168
 v_mfma_f32_16x16x32_bf16 v[132:135], a[188:191], a[132:135], v[132:135]
 ds_read_b64_tr_b16 a[174:175], v9 offset:59424
 v_mfma_f32_16x16x32_bf16 v[128:131], a[188:191], a[128:131], v[128:131]
 buffer_load_dwordx4 a[68:71], v240, s[16:19], s64 offen offset:1024
 v_mfma_f32_16x16x32_bf16 v[128:131], a[184:187], a[224:227], v[128:131]
 buffer_store_dwordx4 v[204:207], v8, s[16:19], s37 offen offset:3072 sc0 sc1
 s_waitcnt vmcnt(26) lgkmcnt(4)
 v_mfma_f32_16x16x32_bf16 v[144:147], a[160:163], a[240:243], v[144:147]
 ds_read_b64_tr_b16 a[176:177], v9 offset:50752
 v_mfma_f32_16x16x32_bf16 v[144:147], a[164:167], a[16:19], v[144:147]
 ds_read_b64_tr_b16 a[178:179], v9 offset:51008
 v_mfma_f32_16x16x32_bf16 v[148:151], a[164:167], a[20:23], v[148:151]
 buffer_load_dwordx4 a[72:75], v240, s[16:19], s64 offen offset:2048
 v_mfma_f32_16x16x32_bf16 v[148:151], a[160:163], a[244:247], v[148:151]
 s_add_u32 m0, s63, 16896
 v_mfma_f32_16x16x32_bf16 v[152:155], a[160:163], a[248:251], v[152:155]
 ds_read_b64_tr_b16 a[180:181], v9 offset:59200
 v_mfma_f32_16x16x32_bf16 v[152:155], a[164:167], a[24:27], v[152:155]
 ds_read_b64_tr_b16 a[182:183], v9 offset:59456
 v_mfma_f32_16x16x32_bf16 v[156:159], a[164:167], a[28:31], v[156:159]
 v_mfma_f32_16x16x32_bf16 v[156:159], a[160:163], a[252:255], v[156:159]
 s_waitcnt lgkmcnt(4)
 v_mfma_f32_16x16x32_bf16 v[172:175], a[168:171], a[252:255], v[172:175]
 ds_read_b64_tr_b16 a[184:185], v9 offset:50784
 v_mfma_f32_16x16x32_bf16 v[172:175], a[172:175], a[28:31], v[172:175]
 ds_read_b64_tr_b16 a[186:187], v9 offset:51040
 v_mfma_f32_16x16x32_bf16 v[168:171], a[172:175], a[24:27], v[168:171]
 buffer_load_dwordx4 v4, s[44:47], s65 offen offset:0 lds
 v_mfma_f32_16x16x32_bf16 v[168:171], a[168:171], a[248:251], v[168:171]
 v_mfma_f32_16x16x32_bf16 v[164:167], a[168:171], a[244:247], v[164:167]
 ds_read_b64_tr_b16 a[188:189], v9 offset:59232
 v_mfma_f32_16x16x32_bf16 v[164:167], a[172:175], a[20:23], v[164:167]
 ds_read_b64_tr_b16 a[190:191], v9 offset:59488
 v_mfma_f32_16x16x32_bf16 v[160:163], a[172:175], a[16:19], v[160:163]
 buffer_load_dwordx4 a[76:79], v240, s[16:19], s64 offen offset:3072
 v_mfma_f32_16x16x32_bf16 v[160:163], a[168:171], a[240:243], v[160:163]
 s_waitcnt lgkmcnt(4)
 v_mfma_f32_16x16x32_bf16 v[48:51], a[176:179], a[240:243], v[48:51]
 ds_read_b64_tr_b16 a[160:161], v9 offset:50816
 v_mfma_f32_16x16x32_bf16 v[48:51], a[180:183], a[16:19], v[48:51]
 ds_read_b64_tr_b16 a[162:163], v9 offset:51072
 v_mfma_f32_16x16x32_bf16 v[52:55], a[180:183], a[20:23], v[52:55]
 v_mfma_f32_16x16x32_bf16 v[52:55], a[176:179], a[244:247], v[52:55]
 v_mfma_f32_16x16x32_bf16 v[56:59], a[176:179], a[248:251], v[56:59]
 ds_read_b64_tr_b16 a[164:165], v9 offset:59264
 v_mfma_f32_16x16x32_bf16 v[56:59], a[180:183], a[24:27], v[56:59]
 ds_read_b64_tr_b16 a[166:167], v9 offset:59520
 v_mfma_f32_16x16x32_bf16 v[60:63], a[180:183], a[28:31], v[60:63]
 buffer_load_dwordx4 v5, s[44:47], s65 offen offset:1056 lds
 v_mfma_f32_16x16x32_bf16 v[60:63], a[176:179], a[252:255], v[60:63]
 s_waitcnt lgkmcnt(4)
 v_mfma_f32_16x16x32_bf16 v[76:79], a[184:187], a[252:255], v[76:79]
 ds_read_b64_tr_b16 a[168:169], v9 offset:50848
 v_mfma_f32_16x16x32_bf16 v[76:79], a[188:191], a[28:31], v[76:79]
 ds_read_b64_tr_b16 a[170:171], v9 offset:51104
 s_add_u32 s64, s81, 57344
 v_mfma_f32_16x16x32_bf16 v[72:75], a[188:191], a[24:27], v[72:75]
 buffer_load_dwordx4 a[80:83], v8, s[16:19], s64 offen offset:0
 v_mfma_f32_16x16x32_bf16 v[72:75], a[184:187], a[248:251], v[72:75]
 v_mfma_f32_16x16x32_bf16 v[68:71], a[184:187], a[244:247], v[68:71]
 ds_read_b64_tr_b16 a[172:173], v9 offset:59296
 v_mfma_f32_16x16x32_bf16 v[68:71], a[188:191], a[20:23], v[68:71]
 ds_read_b64_tr_b16 a[174:175], v9 offset:59552
 v_mfma_f32_16x16x32_bf16 v[64:67], a[188:191], a[16:19], v[64:67]
 v_mfma_f32_16x16x32_bf16 v[64:67], a[184:187], a[240:243], v[64:67]
 s_waitcnt lgkmcnt(4)
 v_mfma_f32_16x16x32_bf16 v[80:83], a[160:163], a[240:243], v[80:83]
 ds_read_b64_tr_b16 a[176:177], v9 offset:50880
 v_mfma_f32_16x16x32_bf16 v[80:83], a[164:167], a[16:19], v[80:83]
 ds_read_b64_tr_b16 a[178:179], v9 offset:51136
 v_mfma_f32_16x16x32_bf16 v[84:87], a[164:167], a[20:23], v[84:87]
 buffer_load_dwordx4 v6, s[44:47], s65 offen offset:2112 lds
 v_mfma_f32_16x16x32_bf16 v[84:87], a[160:163], a[244:247], v[84:87]
 buffer_store_dwordx4 v[208:211], v8, s[16:19], s38 offen offset:0 sc0 sc1
 v_mfma_f32_16x16x32_bf16 v[88:91], a[160:163], a[248:251], v[88:91]
 ds_read_b64_tr_b16 a[180:181], v9 offset:59328
 v_mfma_f32_16x16x32_bf16 v[88:91], a[164:167], a[24:27], v[88:91]
 ds_read_b64_tr_b16 a[182:183], v9 offset:59584
 v_mfma_f32_16x16x32_bf16 v[92:95], a[164:167], a[28:31], v[92:95]
 buffer_load_dwordx4 a[84:87], v8, s[16:19], s64 offen offset:1024
 v_mfma_f32_16x16x32_bf16 v[92:95], a[160:163], a[252:255], v[92:95]
 s_waitcnt lgkmcnt(4)
 v_mfma_f32_16x16x32_bf16 v[108:111], a[168:171], a[252:255], v[108:111]
 ds_read_b64_tr_b16 a[184:185], v9 offset:50912
 v_mfma_f32_16x16x32_bf16 v[108:111], a[172:175], a[28:31], v[108:111]
 ds_read_b64_tr_b16 a[186:187], v9 offset:51168
 v_mfma_f32_16x16x32_bf16 v[104:107], a[172:175], a[24:27], v[104:107]
 buffer_load_dwordx4 a[88:91], v8, s[16:19], s64 offen offset:2048
 v_mfma_f32_16x16x32_bf16 v[104:107], a[168:171], a[248:251], v[104:107]
 v_mfma_f32_16x16x32_bf16 v[100:103], a[168:171], a[244:247], v[100:103]
 ds_read_b64_tr_b16 a[188:189], v9 offset:59360
 v_mfma_f32_16x16x32_bf16 v[100:103], a[172:175], a[20:23], v[100:103]
 ds_read_b64_tr_b16 a[190:191], v9 offset:59616
 v_mfma_f32_16x16x32_bf16 v[96:99], a[172:175], a[16:19], v[96:99]
 buffer_load_dwordx4 v7, s[44:47], s65 offen offset:3168 lds
 v_mfma_f32_16x16x32_bf16 v[96:99], a[168:171], a[240:243], v[96:99]
 s_waitcnt lgkmcnt(4)
 v_mfma_f32_16x16x32_bf16 v[112:115], a[176:179], a[240:243], v[112:115]
 ds_read_b64_tr_b16 a[160:161], v10 offset:0
 v_mfma_f32_16x16x32_bf16 v[112:115], a[180:183], a[16:19], v[112:115]
 ds_read_b64_tr_b16 a[162:163], v10 offset:256
 v_mfma_f32_16x16x32_bf16 v[116:119], a[180:183], a[20:23], v[116:119]
 v_mfma_f32_16x16x32_bf16 v[116:119], a[176:179], a[244:247], v[116:119]
 v_mfma_f32_16x16x32_bf16 v[120:123], a[176:179], a[248:251], v[120:123]
 ds_read_b64_tr_b16 a[164:165], v10 offset:8448
 v_mfma_f32_16x16x32_bf16 v[120:123], a[180:183], a[24:27], v[120:123]
 ds_read_b64_tr_b16 a[166:167], v10 offset:8704
 v_mfma_f32_16x16x32_bf16 v[124:127], a[180:183], a[28:31], v[124:127]
 buffer_load_dwordx4 a[92:95], v8, s[16:19], s64 offen offset:3072
 v_mfma_f32_16x16x32_bf16 v[124:127], a[176:179], a[252:255], v[124:127]
 s_add_u32 s65, s66, 1441792
 s_waitcnt lgkmcnt(4)
 v_mfma_f32_16x16x32_bf16 v[140:143], a[184:187], a[252:255], v[140:143]
 ds_read_b64_tr_b16 a[168:169], v10 offset:32
 v_mfma_f32_16x16x32_bf16 v[140:143], a[188:191], a[28:31], v[140:143]
 ds_read_b64_tr_b16 a[170:171], v10 offset:288
 v_mfma_f32_16x16x32_bf16 v[136:139], a[188:191], a[24:27], v[136:139]
 v_mfma_f32_16x16x32_bf16 v[136:139], a[184:187], a[248:251], v[136:139]
 v_mfma_f32_16x16x32_bf16 v[132:135], a[184:187], a[244:247], v[132:135]
 ds_read_b64_tr_b16 a[172:173], v10 offset:8480
 v_mfma_f32_16x16x32_bf16 v[132:135], a[188:191], a[20:23], v[132:135]
 ds_read_b64_tr_b16 a[174:175], v10 offset:8736
 v_mfma_f32_16x16x32_bf16 v[128:131], a[188:191], a[16:19], v[128:131]
 buffer_load_dwordx4 a[96:99], v240, s[16:19], s64 offen offset:0
 v_mfma_f32_16x16x32_bf16 v[128:131], a[184:187], a[240:243], v[128:131]
 s_waitcnt vmcnt(24) lgkmcnt(4)
 v_mfma_f32_16x16x32_bf16 v[144:147], a[160:163], a[144:147], v[144:147]
 ds_read_b64_tr_b16 a[176:177], v10 offset:64
 v_mfma_f32_16x16x32_bf16 v[144:147], a[164:167], a[32:35], v[144:147]
 ds_read_b64_tr_b16 a[178:179], v10 offset:320
 v_mfma_f32_16x16x32_bf16 v[148:151], a[164:167], a[36:39], v[148:151]
 buffer_load_dwordx4 a[100:103], v240, s[16:19], s64 offen offset:1024
 v_mfma_f32_16x16x32_bf16 v[148:151], a[160:163], a[148:151], v[148:151]
 s_add_u32 m0, s63, 33792
 v_mfma_f32_16x16x32_bf16 v[152:155], a[160:163], a[152:155], v[152:155]
 ds_read_b64_tr_b16 a[180:181], v10 offset:8512
 v_mfma_f32_16x16x32_bf16 v[152:155], a[164:167], a[40:43], v[152:155]
 ds_read_b64_tr_b16 a[182:183], v10 offset:8768
 v_mfma_f32_16x16x32_bf16 v[156:159], a[164:167], a[44:47], v[156:159]
 v_mfma_f32_16x16x32_bf16 v[156:159], a[160:163], a[156:159], v[156:159]
 buffer_store_dwordx4 v[212:215], v8, s[16:19], s38 offen offset:1024 sc0 sc1
 s_waitcnt lgkmcnt(4)
 v_mfma_f32_16x16x32_bf16 v[172:175], a[168:171], a[156:159], v[172:175]
 ds_read_b64_tr_b16 a[184:185], v10 offset:96
 v_mfma_f32_16x16x32_bf16 v[172:175], a[172:175], a[44:47], v[172:175]
 ds_read_b64_tr_b16 a[186:187], v10 offset:352
 v_mfma_f32_16x16x32_bf16 v[168:171], a[172:175], a[40:43], v[168:171]
 buffer_load_dwordx4 v4, s[44:47], s65 offen offset:0 lds
 v_mfma_f32_16x16x32_bf16 v[168:171], a[168:171], a[152:155], v[168:171]
 v_mfma_f32_16x16x32_bf16 v[164:167], a[168:171], a[148:151], v[164:167]
 ds_read_b64_tr_b16 a[188:189], v10 offset:8544
 v_mfma_f32_16x16x32_bf16 v[164:167], a[172:175], a[36:39], v[164:167]
 ds_read_b64_tr_b16 a[190:191], v10 offset:8800
 v_mfma_f32_16x16x32_bf16 v[160:163], a[172:175], a[32:35], v[160:163]
 buffer_load_dwordx4 a[104:107], v240, s[16:19], s64 offen offset:2048
 v_mfma_f32_16x16x32_bf16 v[160:163], a[168:171], a[144:147], v[160:163]
 s_waitcnt lgkmcnt(4)
 v_mfma_f32_16x16x32_bf16 v[48:51], a[176:179], a[144:147], v[48:51]
 ds_read_b64_tr_b16 a[160:161], v10 offset:128
 v_mfma_f32_16x16x32_bf16 v[48:51], a[180:183], a[32:35], v[48:51]
 ds_read_b64_tr_b16 a[162:163], v10 offset:384
 v_mfma_f32_16x16x32_bf16 v[52:55], a[180:183], a[36:39], v[52:55]
 v_mfma_f32_16x16x32_bf16 v[52:55], a[176:179], a[148:151], v[52:55]
 v_mfma_f32_16x16x32_bf16 v[56:59], a[176:179], a[152:155], v[56:59]
 ds_read_b64_tr_b16 a[164:165], v10 offset:8576
 v_mfma_f32_16x16x32_bf16 v[56:59], a[180:183], a[40:43], v[56:59]
 ds_read_b64_tr_b16 a[166:167], v10 offset:8832
 v_mfma_f32_16x16x32_bf16 v[60:63], a[180:183], a[44:47], v[60:63]
 buffer_load_dwordx4 v5, s[44:47], s65 offen offset:1056 lds
 v_mfma_f32_16x16x32_bf16 v[60:63], a[176:179], a[156:159], v[60:63]
 s_waitcnt lgkmcnt(4)
 v_mfma_f32_16x16x32_bf16 v[76:79], a[184:187], a[156:159], v[76:79]
 ds_read_b64_tr_b16 a[168:169], v10 offset:160
 v_mfma_f32_16x16x32_bf16 v[76:79], a[188:191], a[44:47], v[76:79]
 ds_read_b64_tr_b16 a[170:171], v10 offset:416
 v_mfma_f32_16x16x32_bf16 v[72:75], a[188:191], a[40:43], v[72:75]
 buffer_load_dwordx4 a[108:111], v240, s[16:19], s64 offen offset:3072
 v_mfma_f32_16x16x32_bf16 v[72:75], a[184:187], a[152:155], v[72:75]
 v_mfma_f32_16x16x32_bf16 v[68:71], a[184:187], a[148:151], v[68:71]
 ds_read_b64_tr_b16 a[172:173], v10 offset:8608
 v_mfma_f32_16x16x32_bf16 v[68:71], a[188:191], a[36:39], v[68:71]
 ds_read_b64_tr_b16 a[174:175], v10 offset:8864
 v_mfma_f32_16x16x32_bf16 v[64:67], a[188:191], a[32:35], v[64:67]
 v_mfma_f32_16x16x32_bf16 v[64:67], a[184:187], a[144:147], v[64:67]
 s_waitcnt lgkmcnt(4)
 v_mfma_f32_16x16x32_bf16 v[80:83], a[160:163], a[144:147], v[80:83]
 ds_read_b64_tr_b16 a[176:177], v10 offset:192
 v_mfma_f32_16x16x32_bf16 v[80:83], a[164:167], a[32:35], v[80:83]
 ds_read_b64_tr_b16 a[178:179], v10 offset:448
 v_mfma_f32_16x16x32_bf16 v[84:87], a[164:167], a[36:39], v[84:87]
 buffer_load_dwordx4 v6, s[44:47], s65 offen offset:2112 lds
 v_mfma_f32_16x16x32_bf16 v[84:87], a[160:163], a[148:151], v[84:87]
 v_mfma_f32_16x16x32_bf16 v[88:91], a[160:163], a[152:155], v[88:91]
 ds_read_b64_tr_b16 a[180:181], v10 offset:8640
 v_mfma_f32_16x16x32_bf16 v[88:91], a[164:167], a[40:43], v[88:91]
 ds_read_b64_tr_b16 a[182:183], v10 offset:8896
 s_add_u32 s64, s81, 65536
 v_mfma_f32_16x16x32_bf16 v[92:95], a[164:167], a[44:47], v[92:95]
 buffer_load_dwordx4 a[112:115], v8, s[16:19], s64 offen offset:0
 v_mfma_f32_16x16x32_bf16 v[92:95], a[160:163], a[156:159], v[92:95]
 s_waitcnt lgkmcnt(4)
 v_mfma_f32_16x16x32_bf16 v[108:111], a[168:171], a[156:159], v[108:111]
 ds_read_b64_tr_b16 a[184:185], v10 offset:224
 v_mfma_f32_16x16x32_bf16 v[108:111], a[172:175], a[44:47], v[108:111]
 ds_read_b64_tr_b16 a[186:187], v10 offset:480
 v_mfma_f32_16x16x32_bf16 v[104:107], a[172:175], a[40:43], v[104:107]
 buffer_load_dwordx4 a[116:119], v8, s[16:19], s64 offen offset:1024
 v_mfma_f32_16x16x32_bf16 v[104:107], a[168:171], a[152:155], v[104:107]
 buffer_store_dwordx4 v[216:219], v8, s[16:19], s38 offen offset:2048 sc0 sc1
 v_mfma_f32_16x16x32_bf16 v[100:103], a[168:171], a[148:151], v[100:103]
 ds_read_b64_tr_b16 a[188:189], v10 offset:8672
 v_mfma_f32_16x16x32_bf16 v[100:103], a[172:175], a[36:39], v[100:103]
 ds_read_b64_tr_b16 a[190:191], v10 offset:8928
 v_mfma_f32_16x16x32_bf16 v[96:99], a[172:175], a[32:35], v[96:99]
 buffer_load_dwordx4 v7, s[44:47], s65 offen offset:3168 lds
 v_mfma_f32_16x16x32_bf16 v[96:99], a[168:171], a[144:147], v[96:99]
 s_waitcnt vmcnt(52)
 s_barrier
 s_waitcnt lgkmcnt(4)
 v_mfma_f32_16x16x32_bf16 v[112:115], a[176:179], a[144:147], v[112:115]
 ds_read_b64_tr_b16 a[160:161], v10 offset:16896
 v_mfma_f32_16x16x32_bf16 v[112:115], a[180:183], a[32:35], v[112:115]
 ds_read_b64_tr_b16 a[162:163], v10 offset:17152
 v_mfma_f32_16x16x32_bf16 v[116:119], a[180:183], a[36:39], v[116:119]
 v_mfma_f32_16x16x32_bf16 v[116:119], a[176:179], a[148:151], v[116:119]
 v_mfma_f32_16x16x32_bf16 v[120:123], a[176:179], a[152:155], v[120:123]
 ds_read_b64_tr_b16 a[164:165], v10 offset:25344
 v_mfma_f32_16x16x32_bf16 v[120:123], a[180:183], a[40:43], v[120:123]
 ds_read_b64_tr_b16 a[166:167], v10 offset:25600
 v_mfma_f32_16x16x32_bf16 v[124:127], a[180:183], a[44:47], v[124:127]
 buffer_load_dwordx4 a[120:123], v8, s[16:19], s64 offen offset:2048
 v_mfma_f32_16x16x32_bf16 v[124:127], a[176:179], a[156:159], v[124:127]
 s_add_u32 s65, s66, 1572864
 s_waitcnt lgkmcnt(4)
 v_mfma_f32_16x16x32_bf16 v[140:143], a[184:187], a[156:159], v[140:143]
 ds_read_b64_tr_b16 a[168:169], v10 offset:16928
 v_mfma_f32_16x16x32_bf16 v[140:143], a[188:191], a[44:47], v[140:143]
 ds_read_b64_tr_b16 a[170:171], v10 offset:17184
 v_mfma_f32_16x16x32_bf16 v[136:139], a[188:191], a[40:43], v[136:139]
 v_mfma_f32_16x16x32_bf16 v[136:139], a[184:187], a[152:155], v[136:139]
 v_mfma_f32_16x16x32_bf16 v[132:135], a[184:187], a[148:151], v[132:135]
 ds_read_b64_tr_b16 a[172:173], v10 offset:25376
 v_mfma_f32_16x16x32_bf16 v[132:135], a[188:191], a[36:39], v[132:135]
 ds_read_b64_tr_b16 a[174:175], v10 offset:25632
 v_mfma_f32_16x16x32_bf16 v[128:131], a[188:191], a[32:35], v[128:131]
 buffer_load_dwordx4 a[124:127], v8, s[16:19], s64 offen offset:3072
 v_mfma_f32_16x16x32_bf16 v[128:131], a[184:187], a[144:147], v[128:131]
 s_waitcnt vmcnt(22) lgkmcnt(4)
 v_mfma_f32_16x16x32_bf16 v[144:147], a[160:163], a[48:51], v[144:147]
 ds_read_b64_tr_b16 a[176:177], v10 offset:16960
 v_mfma_f32_16x16x32_bf16 v[144:147], a[164:167], a[64:67], v[144:147]
 ds_read_b64_tr_b16 a[178:179], v10 offset:17216
 v_mfma_f32_16x16x32_bf16 v[148:151], a[164:167], a[68:71], v[148:151]
 buffer_load_dwordx4 a[192:195], v240, s[16:19], s64 offen offset:0
 v_mfma_f32_16x16x32_bf16 v[148:151], a[160:163], a[52:55], v[148:151]
 s_add_u32 m0, s63, 50688
 v_mfma_f32_16x16x32_bf16 v[152:155], a[160:163], a[56:59], v[152:155]
 ds_read_b64_tr_b16 a[180:181], v10 offset:25408
 v_mfma_f32_16x16x32_bf16 v[152:155], a[164:167], a[72:75], v[152:155]
 ds_read_b64_tr_b16 a[182:183], v10 offset:25664
 v_mfma_f32_16x16x32_bf16 v[156:159], a[164:167], a[76:79], v[156:159]
 v_mfma_f32_16x16x32_bf16 v[156:159], a[160:163], a[60:63], v[156:159]
 s_waitcnt lgkmcnt(4)
 v_mfma_f32_16x16x32_bf16 v[172:175], a[168:171], a[60:63], v[172:175]
 ds_read_b64_tr_b16 a[184:185], v10 offset:16992
 v_mfma_f32_16x16x32_bf16 v[172:175], a[172:175], a[76:79], v[172:175]
 ds_read_b64_tr_b16 a[186:187], v10 offset:17248
 v_mfma_f32_16x16x32_bf16 v[168:171], a[172:175], a[72:75], v[168:171]
 buffer_load_dwordx4 v4, s[44:47], s65 offen offset:0 lds
 v_mfma_f32_16x16x32_bf16 v[168:171], a[168:171], a[56:59], v[168:171]
 v_mfma_f32_16x16x32_bf16 v[164:167], a[168:171], a[52:55], v[164:167]
 ds_read_b64_tr_b16 a[188:189], v10 offset:25440
 v_mfma_f32_16x16x32_bf16 v[164:167], a[172:175], a[68:71], v[164:167]
 ds_read_b64_tr_b16 a[190:191], v10 offset:25696
 v_mfma_f32_16x16x32_bf16 v[160:163], a[172:175], a[64:67], v[160:163]
 buffer_load_dwordx4 a[196:199], v240, s[16:19], s64 offen offset:1024
 v_mfma_f32_16x16x32_bf16 v[160:163], a[168:171], a[48:51], v[160:163]
 buffer_store_dwordx4 v[220:223], v8, s[16:19], s38 offen offset:3072 sc0 sc1
 s_waitcnt lgkmcnt(4)
 v_mfma_f32_16x16x32_bf16 v[48:51], a[176:179], a[48:51], v[48:51]
 ds_read_b64_tr_b16 a[160:161], v10 offset:17024
 v_mfma_f32_16x16x32_bf16 v[48:51], a[180:183], a[64:67], v[48:51]
 ds_read_b64_tr_b16 a[162:163], v10 offset:17280
 v_mfma_f32_16x16x32_bf16 v[52:55], a[180:183], a[68:71], v[52:55]
 v_mfma_f32_16x16x32_bf16 v[52:55], a[176:179], a[52:55], v[52:55]
 v_mfma_f32_16x16x32_bf16 v[56:59], a[176:179], a[56:59], v[56:59]
 ds_read_b64_tr_b16 a[164:165], v10 offset:25472
 v_mfma_f32_16x16x32_bf16 v[56:59], a[180:183], a[72:75], v[56:59]
 ds_read_b64_tr_b16 a[166:167], v10 offset:25728
 v_mfma_f32_16x16x32_bf16 v[60:63], a[180:183], a[76:79], v[60:63]
 buffer_load_dwordx4 v5, s[44:47], s65 offen offset:1056 lds
 v_mfma_f32_16x16x32_bf16 v[60:63], a[176:179], a[60:63], v[60:63]
 s_waitcnt lgkmcnt(4)
 v_mfma_f32_16x16x32_bf16 v[76:79], a[184:187], a[60:63], v[76:79]
 ds_read_b64_tr_b16 a[168:169], v10 offset:17056
 v_mfma_f32_16x16x32_bf16 v[76:79], a[188:191], a[76:79], v[76:79]
 ds_read_b64_tr_b16 a[170:171], v10 offset:17312
 v_mfma_f32_16x16x32_bf16 v[72:75], a[188:191], a[72:75], v[72:75]
 s_branch L_pg18k
L_pg18:
L_ic3w0:
 s_branch L_ic3r
L_pg18k:
 buffer_load_dwordx4 a[200:203], v240, s[16:19], s64 offen offset:2048
 v_mfma_f32_16x16x32_bf16 v[72:75], a[184:187], a[56:59], v[72:75]
 v_mfma_f32_16x16x32_bf16 v[68:71], a[184:187], a[52:55], v[68:71]
 ds_read_b64_tr_b16 a[172:173], v10 offset:25504
 v_mfma_f32_16x16x32_bf16 v[68:71], a[188:191], a[68:71], v[68:71]
 ds_read_b64_tr_b16 a[174:175], v10 offset:25760
 v_mfma_f32_16x16x32_bf16 v[64:67], a[188:191], a[64:67], v[64:67]
 v_mfma_f32_16x16x32_bf16 v[64:67], a[184:187], a[48:51], v[64:67]
 s_waitcnt lgkmcnt(4)
 v_mfma_f32_16x16x32_bf16 v[80:83], a[160:163], a[48:51], v[80:83]
 ds_read_b64_tr_b16 a[176:177], v10 offset:17088
 v_mfma_f32_16x16x32_bf16 v[80:83], a[164:167], a[64:67], v[80:83]
 ds_read_b64_tr_b16 a[178:179], v10 offset:17344
 v_mfma_f32_16x16x32_bf16 v[84:87], a[164:167], a[68:71], v[84:87]
 buffer_load_dwordx4 v6, s[44:47], s65 offen offset:2112 lds
 v_mfma_f32_16x16x32_bf16 v[84:87], a[160:163], a[52:55], v[84:87]
 v_mfma_f32_16x16x32_bf16 v[88:91], a[160:163], a[56:59], v[88:91]
 ds_read_b64_tr_b16 a[180:181], v10 offset:25536
 v_mfma_f32_16x16x32_bf16 v[88:91], a[164:167], a[72:75], v[88:91]
 ds_read_b64_tr_b16 a[182:183], v10 offset:25792
 v_mfma_f32_16x16x32_bf16 v[92:95], a[164:167], a[76:79], v[92:95]
 buffer_load_dwordx4 a[204:207], v240, s[16:19], s64 offen offset:3072
 v_mfma_f32_16x16x32_bf16 v[92:95], a[160:163], a[60:63], v[92:95]
 s_waitcnt lgkmcnt(4)
 v_mfma_f32_16x16x32_bf16 v[108:111], a[168:171], a[60:63], v[108:111]
 ds_read_b64_tr_b16 a[184:185], v10 offset:17120
 v_mfma_f32_16x16x32_bf16 v[108:111], a[172:175], a[76:79], v[108:111]
 ds_read_b64_tr_b16 a[186:187], v10 offset:17376
 s_add_u32 s64, s81, 73728
 v_mfma_f32_16x16x32_bf16 v[104:107], a[172:175], a[72:75], v[104:107]
 buffer_load_dwordx4 a[208:211], v8, s[16:19], s64 offen offset:0
 v_mfma_f32_16x16x32_bf16 v[104:107], a[168:171], a[56:59], v[104:107]
 v_mfma_f32_16x16x32_bf16 v[100:103], a[168:171], a[52:55], v[100:103]
 ds_read_b64_tr_b16 a[188:189], v10 offset:25568
 v_mfma_f32_16x16x32_bf16 v[100:103], a[172:175], a[68:71], v[100:103]
 ds_read_b64_tr_b16 a[190:191], v10 offset:25824
 v_mfma_f32_16x16x32_bf16 v[96:99], a[172:175], a[64:67], v[96:99]
 buffer_load_dwordx4 v7, s[44:47], s65 offen offset:3168 lds
 v_mfma_f32_16x16x32_bf16 v[96:99], a[168:171], a[48:51], v[96:99]
 s_waitcnt lgkmcnt(4)
 v_mfma_f32_16x16x32_bf16 v[112:115], a[176:179], a[48:51], v[112:115]
 ds_read_b64_tr_b16 a[160:161], v10 offset:33792
 v_mfma_f32_16x16x32_bf16 v[112:115], a[180:183], a[64:67], v[112:115]
 ds_read_b64_tr_b16 a[162:163], v10 offset:34048
 v_mfma_f32_16x16x32_bf16 v[116:119], a[180:183], a[68:71], v[116:119]
 v_mfma_f32_16x16x32_bf16 v[116:119], a[176:179], a[52:55], v[116:119]
 v_mfma_f32_16x16x32_bf16 v[120:123], a[176:179], a[56:59], v[120:123]
 ds_read_b64_tr_b16 a[164:165], v10 offset:42240
 v_mfma_f32_16x16x32_bf16 v[120:123], a[180:183], a[72:75], v[120:123]
 ds_read_b64_tr_b16 a[166:167], v10 offset:42496
 v_mfma_f32_16x16x32_bf16 v[124:127], a[180:183], a[76:79], v[124:127]
 buffer_load_dwordx4 a[212:215], v8, s[16:19], s64 offen offset:1024
 v_mfma_f32_16x16x32_bf16 v[124:127], a[176:179], a[60:63], v[124:127]
 s_add_u32 s65, s66, 1703936
 s_waitcnt lgkmcnt(4)
 v_mfma_f32_16x16x32_bf16 v[140:143], a[184:187], a[60:63], v[140:143]
 ds_read_b64_tr_b16 a[168:169], v10 offset:33824
 v_mfma_f32_16x16x32_bf16 v[140:143], a[188:191], a[76:79], v[140:143]
 ds_read_b64_tr_b16 a[170:171], v10 offset:34080
 v_mfma_f32_16x16x32_bf16 v[136:139], a[188:191], a[72:75], v[136:139]
 v_mfma_f32_16x16x32_bf16 v[136:139], a[184:187], a[56:59], v[136:139]
 v_mfma_f32_16x16x32_bf16 v[132:135], a[184:187], a[52:55], v[132:135]
 ds_read_b64_tr_b16 a[172:173], v10 offset:42272
 v_mfma_f32_16x16x32_bf16 v[132:135], a[188:191], a[68:71], v[132:135]
 ds_read_b64_tr_b16 a[174:175], v10 offset:42528
 v_mfma_f32_16x16x32_bf16 v[128:131], a[188:191], a[64:67], v[128:131]
 buffer_load_dwordx4 a[216:219], v8, s[16:19], s64 offen offset:2048
 v_mfma_f32_16x16x32_bf16 v[128:131], a[184:187], a[48:51], v[128:131]
 s_waitcnt vmcnt(19) lgkmcnt(4)
 v_mfma_f32_16x16x32_bf16 v[144:147], a[160:163], a[80:83], v[144:147]
 ds_read_b64_tr_b16 a[176:177], v10 offset:33856
 v_mfma_f32_16x16x32_bf16 v[144:147], a[164:167], a[96:99], v[144:147]
 ds_read_b64_tr_b16 a[178:179], v10 offset:34112
 v_mfma_f32_16x16x32_bf16 v[148:151], a[164:167], a[100:103], v[148:151]
 buffer_load_dwordx4 a[220:223], v8, s[16:19], s64 offen offset:3072
 v_mfma_f32_16x16x32_bf16 v[148:151], a[160:163], a[84:87], v[148:151]
 s_add_u32 m0, s63, 67584
 v_mfma_f32_16x16x32_bf16 v[152:155], a[160:163], a[88:91], v[152:155]
 ds_read_b64_tr_b16 a[180:181], v10 offset:42304
 v_mfma_f32_16x16x32_bf16 v[152:155], a[164:167], a[104:107], v[152:155]
 ds_read_b64_tr_b16 a[182:183], v10 offset:42560
 v_mfma_f32_16x16x32_bf16 v[156:159], a[164:167], a[108:111], v[156:159]
 buffer_load_dwordx4 a[128:131], v240, s[16:19], s64 offen offset:0
 v_mfma_f32_16x16x32_bf16 v[156:159], a[160:163], a[92:95], v[156:159]
 s_waitcnt lgkmcnt(4)
 v_mfma_f32_16x16x32_bf16 v[172:175], a[168:171], a[92:95], v[172:175]
 ds_read_b64_tr_b16 a[184:185], v10 offset:33888
 v_mfma_f32_16x16x32_bf16 v[172:175], a[172:175], a[108:111], v[172:175]
 ds_read_b64_tr_b16 a[186:187], v10 offset:34144
 v_mfma_f32_16x16x32_bf16 v[168:171], a[172:175], a[104:107], v[168:171]
 buffer_load_dwordx4 v4, s[44:47], s65 offen offset:0 lds
 v_mfma_f32_16x16x32_bf16 v[168:171], a[168:171], a[88:91], v[168:171]
 v_mfma_f32_16x16x32_bf16 v[164:167], a[168:171], a[84:87], v[164:167]
 ds_read_b64_tr_b16 a[188:189], v10 offset:42336
 v_mfma_f32_16x16x32_bf16 v[164:167], a[172:175], a[100:103], v[164:167]
 ds_read_b64_tr_b16 a[190:191], v10 offset:42592
 v_mfma_f32_16x16x32_bf16 v[160:163], a[172:175], a[96:99], v[160:163]
 buffer_load_dwordx4 a[132:135], v240, s[16:19], s64 offen offset:1024
 v_mfma_f32_16x16x32_bf16 v[160:163], a[168:171], a[80:83], v[160:163]
 s_waitcnt lgkmcnt(4)
 v_mfma_f32_16x16x32_bf16 v[48:51], a[176:179], a[80:83], v[48:51]
 ds_read_b64_tr_b16 a[160:161], v10 offset:33920
 v_mfma_f32_16x16x32_bf16 v[48:51], a[180:183], a[96:99], v[48:51]
 ds_read_b64_tr_b16 a[162:163], v10 offset:34176
 v_mfma_f32_16x16x32_bf16 v[52:55], a[180:183], a[100:103], v[52:55]
 buffer_load_dwordx4 a[136:139], v240, s[16:19], s64 offen offset:2048
 v_mfma_f32_16x16x32_bf16 v[52:55], a[176:179], a[84:87], v[52:55]
 v_mfma_f32_16x16x32_bf16 v[56:59], a[176:179], a[88:91], v[56:59]
 ds_read_b64_tr_b16 a[164:165], v10 offset:42368
 v_mfma_f32_16x16x32_bf16 v[56:59], a[180:183], a[104:107], v[56:59]
 ds_read_b64_tr_b16 a[166:167], v10 offset:42624
 v_mfma_f32_16x16x32_bf16 v[60:63], a[180:183], a[108:111], v[60:63]
 buffer_load_dwordx4 v5, s[44:47], s65 offen offset:1056 lds
 v_mfma_f32_16x16x32_bf16 v[60:63], a[176:179], a[92:95], v[60:63]
 s_waitcnt lgkmcnt(4)
 v_mfma_f32_16x16x32_bf16 v[76:79], a[184:187], a[92:95], v[76:79]
 ds_read_b64_tr_b16 a[168:169], v10 offset:33952
 v_mfma_f32_16x16x32_bf16 v[76:79], a[188:191], a[108:111], v[76:79]
 ds_read_b64_tr_b16 a[170:171], v10 offset:34208
 v_mfma_f32_16x16x32_bf16 v[72:75], a[188:191], a[104:107], v[72:75]
 buffer_load_dwordx4 a[140:143], v240, s[16:19], s64 offen offset:3072
 v_mfma_f32_16x16x32_bf16 v[72:75], a[184:187], a[88:91], v[72:75]
 v_mfma_f32_16x16x32_bf16 v[68:71], a[184:187], a[84:87], v[68:71]
 ds_read_b64_tr_b16 a[172:173], v10 offset:42400
 v_mfma_f32_16x16x32_bf16 v[68:71], a[188:191], a[100:103], v[68:71]
 ds_read_b64_tr_b16 a[174:175], v10 offset:42656
 s_add_u32 s64, s81, 81920
 v_mfma_f32_16x16x32_bf16 v[64:67], a[188:191], a[96:99], v[64:67]
 buffer_load_dwordx4 a[224:227], v8, s[16:19], s64 offen offset:0
 v_mfma_f32_16x16x32_bf16 v[64:67], a[184:187], a[80:83], v[64:67]
 s_waitcnt lgkmcnt(4)
 v_mfma_f32_16x16x32_bf16 v[80:83], a[160:163], a[80:83], v[80:83]
 ds_read_b64_tr_b16 a[176:177], v10 offset:33984
 v_mfma_f32_16x16x32_bf16 v[80:83], a[164:167], a[96:99], v[80:83]
 ds_read_b64_tr_b16 a[178:179], v10 offset:34240
 v_mfma_f32_16x16x32_bf16 v[84:87], a[164:167], a[100:103], v[84:87]
 buffer_load_dwordx4 v6, s[44:47], s65 offen offset:2112 lds
 v_mfma_f32_16x16x32_bf16 v[84:87], a[160:163], a[84:87], v[84:87]
 v_mfma_f32_16x16x32_bf16 v[88:91], a[160:163], a[88:91], v[88:91]
 ds_read_b64_tr_b16 a[180:181], v10 offset:42432
 v_mfma_f32_16x16x32_bf16 v[88:91], a[164:167], a[104:107], v[88:91]
 ds_read_b64_tr_b16 a[182:183], v10 offset:42688
 v_mfma_f32_16x16x32_bf16 v[92:95], a[164:167], a[108:111], v[92:95]
 buffer_load_dwordx4 a[228:231], v8, s[16:19], s64 offen offset:1024
 v_mfma_f32_16x16x32_bf16 v[92:95], a[160:163], a[92:95], v[92:95]
 s_waitcnt lgkmcnt(4)
 v_mfma_f32_16x16x32_bf16 v[108:111], a[168:171], a[92:95], v[108:111]
 ds_read_b64_tr_b16 a[184:185], v10 offset:34016
 v_mfma_f32_16x16x32_bf16 v[108:111], a[172:175], a[108:111], v[108:111]
 ds_read_b64_tr_b16 a[186:187], v10 offset:34272
 v_mfma_f32_16x16x32_bf16 v[104:107], a[172:175], a[104:107], v[104:107]
 buffer_load_dwordx4 a[232:235], v8, s[16:19], s64 offen offset:2048
 v_mfma_f32_16x16x32_bf16 v[104:107], a[168:171], a[88:91], v[104:107]
 v_mfma_f32_16x16x32_bf16 v[100:103], a[168:171], a[84:87], v[100:103]
 ds_read_b64_tr_b16 a[188:189], v10 offset:42464
 v_mfma_f32_16x16x32_bf16 v[100:103], a[172:175], a[100:103], v[100:103]
 ds_read_b64_tr_b16 a[190:191], v10 offset:42720
 v_mfma_f32_16x16x32_bf16 v[96:99], a[172:175], a[96:99], v[96:99]
 buffer_load_dwordx4 v7, s[44:47], s65 offen offset:3168 lds
 v_mfma_f32_16x16x32_bf16 v[96:99], a[168:171], a[80:83], v[96:99]
 s_waitcnt vmcnt(52)
 s_barrier
 s_waitcnt lgkmcnt(4)
 v_mfma_f32_16x16x32_bf16 v[112:115], a[176:179], a[80:83], v[112:115]
 ds_read_b64_tr_b16 a[160:161], v10 offset:50688
 v_mfma_f32_16x16x32_bf16 v[112:115], a[180:183], a[96:99], v[112:115]
 ds_read_b64_tr_b16 a[162:163], v10 offset:50944
 v_mfma_f32_16x16x32_bf16 v[116:119], a[180:183], a[100:103], v[116:119]
 buffer_load_dwordx4 a[236:239], v8, s[16:19], s64 offen offset:3072
 v_mfma_f32_16x16x32_bf16 v[116:119], a[176:179], a[84:87], v[116:119]
 v_mfma_f32_16x16x32_bf16 v[120:123], a[176:179], a[88:91], v[120:123]
 ds_read_b64_tr_b16 a[164:165], v10 offset:59136
 v_mfma_f32_16x16x32_bf16 v[120:123], a[180:183], a[104:107], v[120:123]
 ds_read_b64_tr_b16 a[166:167], v10 offset:59392
 v_mfma_f32_16x16x32_bf16 v[124:127], a[180:183], a[108:111], v[124:127]
 buffer_load_dwordx4 a[16:19], v240, s[16:19], s64 offen offset:0
 v_mfma_f32_16x16x32_bf16 v[124:127], a[176:179], a[92:95], v[124:127]
 s_add_u32 s65, s66, 1835008
 s_waitcnt lgkmcnt(4)
 v_mfma_f32_16x16x32_bf16 v[140:143], a[184:187], a[92:95], v[140:143]
 ds_read_b64_tr_b16 a[168:169], v10 offset:50720
 v_mfma_f32_16x16x32_bf16 v[140:143], a[188:191], a[108:111], v[140:143]
 ds_read_b64_tr_b16 a[170:171], v10 offset:50976
 v_mfma_f32_16x16x32_bf16 v[136:139], a[188:191], a[104:107], v[136:139]
 buffer_load_dwordx4 a[20:23], v240, s[16:19], s64 offen offset:1024
 v_mfma_f32_16x16x32_bf16 v[136:139], a[184:187], a[88:91], v[136:139]
 v_mfma_f32_16x16x32_bf16 v[132:135], a[184:187], a[84:87], v[132:135]
 ds_read_b64_tr_b16 a[172:173], v10 offset:59168
 v_mfma_f32_16x16x32_bf16 v[132:135], a[188:191], a[100:103], v[132:135]
 ds_read_b64_tr_b16 a[174:175], v10 offset:59424
 v_mfma_f32_16x16x32_bf16 v[128:131], a[188:191], a[96:99], v[128:131]
 buffer_load_dwordx4 a[24:27], v240, s[16:19], s64 offen offset:2048
 v_mfma_f32_16x16x32_bf16 v[128:131], a[184:187], a[80:83], v[128:131]
 s_waitcnt vmcnt(20) lgkmcnt(4)
 v_mfma_f32_16x16x32_bf16 v[144:147], a[160:163], a[112:115], v[144:147]
 ds_read_b64_tr_b16 a[176:177], v10 offset:50752
 v_mfma_f32_16x16x32_bf16 v[144:147], a[164:167], a[192:195], v[144:147]
 ds_read_b64_tr_b16 a[178:179], v10 offset:51008
 v_mfma_f32_16x16x32_bf16 v[148:151], a[164:167], a[196:199], v[148:151]
 buffer_load_dwordx4 a[28:31], v240, s[16:19], s64 offen offset:3072
 v_mfma_f32_16x16x32_bf16 v[148:151], a[160:163], a[116:119], v[148:151]
 s_add_u32 m0, s63, 84480
 v_mfma_f32_16x16x32_bf16 v[152:155], a[160:163], a[120:123], v[152:155]
 ds_read_b64_tr_b16 a[180:181], v10 offset:59200
 v_mfma_f32_16x16x32_bf16 v[152:155], a[164:167], a[200:203], v[152:155]
 ds_read_b64_tr_b16 a[182:183], v10 offset:59456
 s_add_u32 s64, s81, 90112
 v_mfma_f32_16x16x32_bf16 v[156:159], a[164:167], a[204:207], v[156:159]
 buffer_load_dwordx4 a[240:243], v8, s[16:19], s64 offen offset:0
 v_mfma_f32_16x16x32_bf16 v[156:159], a[160:163], a[124:127], v[156:159]
 s_waitcnt lgkmcnt(4)
 v_mfma_f32_16x16x32_bf16 v[172:175], a[168:171], a[124:127], v[172:175]
 ds_read_b64_tr_b16 a[184:185], v10 offset:50784
 v_mfma_f32_16x16x32_bf16 v[172:175], a[172:175], a[204:207], v[172:175]
 ds_read_b64_tr_b16 a[186:187], v10 offset:51040
 v_mfma_f32_16x16x32_bf16 v[168:171], a[172:175], a[200:203], v[168:171]
 buffer_load_dwordx4 v4, s[44:47], s65 offen offset:0 lds
 v_mfma_f32_16x16x32_bf16 v[168:171], a[168:171], a[120:123], v[168:171]
 v_mfma_f32_16x16x32_bf16 v[164:167], a[168:171], a[116:119], v[164:167]
 ds_read_b64_tr_b16 a[188:189], v10 offset:59232
 v_mfma_f32_16x16x32_bf16 v[164:167], a[172:175], a[196:199], v[164:167]
 ds_read_b64_tr_b16 a[190:191], v10 offset:59488
 v_mfma_f32_16x16x32_bf16 v[160:163], a[172:175], a[192:195], v[160:163]
 buffer_load_dwordx4 a[244:247], v8, s[16:19], s64 offen offset:1024
 v_mfma_f32_16x16x32_bf16 v[160:163], a[168:171], a[112:115], v[160:163]
 s_waitcnt lgkmcnt(4)
 v_mfma_f32_16x16x32_bf16 v[48:51], a[176:179], a[112:115], v[48:51]
 ds_read_b64_tr_b16 a[160:161], v10 offset:50816
 v_mfma_f32_16x16x32_bf16 v[48:51], a[180:183], a[192:195], v[48:51]
 ds_read_b64_tr_b16 a[162:163], v10 offset:51072
 v_mfma_f32_16x16x32_bf16 v[52:55], a[180:183], a[196:199], v[52:55]
 buffer_load_dwordx4 a[248:251], v8, s[16:19], s64 offen offset:2048
 v_mfma_f32_16x16x32_bf16 v[52:55], a[176:179], a[116:119], v[52:55]
 v_mfma_f32_16x16x32_bf16 v[56:59], a[176:179], a[120:123], v[56:59]
 ds_read_b64_tr_b16 a[164:165], v10 offset:59264
 v_mfma_f32_16x16x32_bf16 v[56:59], a[180:183], a[200:203], v[56:59]
 ds_read_b64_tr_b16 a[166:167], v10 offset:59520
 v_mfma_f32_16x16x32_bf16 v[60:63], a[180:183], a[204:207], v[60:63]
 buffer_load_dwordx4 v5, s[44:47], s65 offen offset:1056 lds
 v_mfma_f32_16x16x32_bf16 v[60:63], a[176:179], a[124:127], v[60:63]
 s_waitcnt lgkmcnt(4)
 v_mfma_f32_16x16x32_bf16 v[76:79], a[184:187], a[124:127], v[76:79]
 ds_read_b64_tr_b16 a[168:169], v10 offset:50848
 v_mfma_f32_16x16x32_bf16 v[76:79], a[188:191], a[204:207], v[76:79]
 ds_read_b64_tr_b16 a[170:171], v10 offset:51104
 v_mfma_f32_16x16x32_bf16 v[72:75], a[188:191], a[200:203], v[72:75]
 buffer_load_dwordx4 a[252:255], v8, s[16:19], s64 offen offset:3072
 v_mfma_f32_16x16x32_bf16 v[72:75], a[184:187], a[120:123], v[72:75]
 v_mfma_f32_16x16x32_bf16 v[68:71], a[184:187], a[116:119], v[68:71]
 ds_read_b64_tr_b16 a[172:173], v10 offset:59296
 v_mfma_f32_16x16x32_bf16 v[68:71], a[188:191], a[196:199], v[68:71]
 ds_read_b64_tr_b16 a[174:175], v10 offset:59552
 v_mfma_f32_16x16x32_bf16 v[64:67], a[188:191], a[192:195], v[64:67]
 buffer_load_dwordx4 a[32:35], v240, s[16:19], s64 offen offset:0
 v_mfma_f32_16x16x32_bf16 v[64:67], a[184:187], a[112:115], v[64:67]
 s_waitcnt lgkmcnt(4)
 v_mfma_f32_16x16x32_bf16 v[80:83], a[160:163], a[112:115], v[80:83]
 ds_read_b64_tr_b16 a[176:177], v10 offset:50880
 v_mfma_f32_16x16x32_bf16 v[80:83], a[164:167], a[192:195], v[80:83]
 ds_read_b64_tr_b16 a[178:179], v10 offset:51136
 v_mfma_f32_16x16x32_bf16 v[84:87], a[164:167], a[196:199], v[84:87]
 buffer_load_dwordx4 v6, s[44:47], s65 offen offset:2112 lds
 v_mfma_f32_16x16x32_bf16 v[84:87], a[160:163], a[116:119], v[84:87]
 v_mfma_f32_16x16x32_bf16 v[88:91], a[160:163], a[120:123], v[88:91]
 ds_read_b64_tr_b16 a[180:181], v10 offset:59328
 v_mfma_f32_16x16x32_bf16 v[88:91], a[164:167], a[200:203], v[88:91]
 ds_read_b64_tr_b16 a[182:183], v10 offset:59584
 v_mfma_f32_16x16x32_bf16 v[92:95], a[164:167], a[204:207], v[92:95]
 buffer_load_dwordx4 a[36:39], v240, s[16:19], s64 offen offset:1024
 v_mfma_f32_16x16x32_bf16 v[92:95], a[160:163], a[124:127], v[92:95]
 s_waitcnt lgkmcnt(4)
 v_mfma_f32_16x16x32_bf16 v[108:111], a[168:171], a[124:127], v[108:111]
 ds_read_b64_tr_b16 a[184:185], v10 offset:50912
 v_mfma_f32_16x16x32_bf16 v[108:111], a[172:175], a[204:207], v[108:111]
 ds_read_b64_tr_b16 a[186:187], v10 offset:51168
 v_mfma_f32_16x16x32_bf16 v[104:107], a[172:175], a[200:203], v[104:107]
 buffer_load_dwordx4 a[40:43], v240, s[16:19], s64 offen offset:2048
 v_mfma_f32_16x16x32_bf16 v[104:107], a[168:171], a[120:123], v[104:107]
 v_mfma_f32_16x16x32_bf16 v[100:103], a[168:171], a[116:119], v[100:103]
 ds_read_b64_tr_b16 a[188:189], v10 offset:59360
 v_mfma_f32_16x16x32_bf16 v[100:103], a[172:175], a[196:199], v[100:103]
 ds_read_b64_tr_b16 a[190:191], v10 offset:59616
 v_mfma_f32_16x16x32_bf16 v[96:99], a[172:175], a[192:195], v[96:99]
 buffer_load_dwordx4 v7, s[44:47], s65 offen offset:3168 lds
 v_mfma_f32_16x16x32_bf16 v[96:99], a[168:171], a[112:115], v[96:99]
 s_waitcnt lgkmcnt(4)
 v_mfma_f32_16x16x32_bf16 v[112:115], a[176:179], a[112:115], v[112:115]
 ds_read_b64_tr_b16 a[160:161], v9 offset:0
 v_mfma_f32_16x16x32_bf16 v[112:115], a[180:183], a[192:195], v[112:115]
 ds_read_b64_tr_b16 a[162:163], v9 offset:256
 v_mfma_f32_16x16x32_bf16 v[116:119], a[180:183], a[196:199], v[116:119]
 buffer_load_dwordx4 a[44:47], v240, s[16:19], s64 offen offset:3072
 v_mfma_f32_16x16x32_bf16 v[116:119], a[176:179], a[116:119], v[116:119]
 v_mfma_f32_16x16x32_bf16 v[120:123], a[176:179], a[120:123], v[120:123]
 ds_read_b64_tr_b16 a[164:165], v9 offset:8448
 v_mfma_f32_16x16x32_bf16 v[120:123], a[180:183], a[200:203], v[120:123]
 ds_read_b64_tr_b16 a[166:167], v9 offset:8704
 s_add_u32 s64, s81, 98304
 v_mfma_f32_16x16x32_bf16 v[124:127], a[180:183], a[204:207], v[124:127]
 buffer_load_dwordx4 a[144:147], v8, s[16:19], s64 offen offset:0
 v_mfma_f32_16x16x32_bf16 v[124:127], a[176:179], a[124:127], v[124:127]
 s_add_u32 s65, s66, 1966080
 s_waitcnt lgkmcnt(4)
 v_mfma_f32_16x16x32_bf16 v[140:143], a[184:187], a[124:127], v[140:143]
 ds_read_b64_tr_b16 a[168:169], v9 offset:32
 v_mfma_f32_16x16x32_bf16 v[140:143], a[188:191], a[204:207], v[140:143]
 ds_read_b64_tr_b16 a[170:171], v9 offset:288
 v_mfma_f32_16x16x32_bf16 v[136:139], a[188:191], a[200:203], v[136:139]
 buffer_load_dwordx4 a[148:151], v8, s[16:19], s64 offen offset:1024
 v_mfma_f32_16x16x32_bf16 v[136:139], a[184:187], a[120:123], v[136:139]
 v_mfma_f32_16x16x32_bf16 v[132:135], a[184:187], a[116:119], v[132:135]
 ds_read_b64_tr_b16 a[172:173], v9 offset:8480
 v_mfma_f32_16x16x32_bf16 v[132:135], a[188:191], a[196:199], v[132:135]
 ds_read_b64_tr_b16 a[174:175], v9 offset:8736
 v_mfma_f32_16x16x32_bf16 v[128:131], a[188:191], a[192:195], v[128:131]
 buffer_load_dwordx4 a[152:155], v8, s[16:19], s64 offen offset:2048
 v_mfma_f32_16x16x32_bf16 v[128:131], a[184:187], a[112:115], v[128:131]
 s_waitcnt vmcnt(40)
 buffer_store_dword v3, v2, s[16:19], s15 offen offset:0 sc0 sc1
 s_waitcnt vmcnt(26) lgkmcnt(4)
 v_mfma_f32_16x16x32_bf16 v[144:147], a[160:163], a[208:211], v[144:147]
 s_add_u32 s36, s36, 16777216
 ds_read_b64_tr_b16 a[176:177], v9 offset:64
 v_mfma_f32_16x16x32_bf16 v[144:147], a[164:167], a[128:131], v[144:147]
 s_add_u32 s37, s37, 16777216
 ds_read_b64_tr_b16 a[178:179], v9 offset:320
 v_mfma_f32_16x16x32_bf16 v[148:151], a[164:167], a[132:135], v[148:151]
 s_add_u32 s38, s38, 16777216
 buffer_load_dwordx4 a[156:159], v8, s[16:19], s64 offen offset:3072
 v_mfma_f32_16x16x32_bf16 v[148:151], a[160:163], a[212:215], v[148:151]
 s_add_u32 s4, s39, 0
 s_add_u32 m0, s63, 101376
 v_mfma_f32_16x16x32_bf16 v[152:155], a[160:163], a[216:219], v[152:155]
 s_add_u32 s5, s39, 4096
 ds_read_b64_tr_b16 a[180:181], v9 offset:8512
 v_mfma_f32_16x16x32_bf16 v[152:155], a[164:167], a[136:139], v[152:155]
 s_add_u32 s6, s39, 8192
 ds_read_b64_tr_b16 a[182:183], v9 offset:8768
 v_mfma_f32_16x16x32_bf16 v[156:159], a[164:167], a[140:143], v[156:159]
 buffer_load_dwordx4 a[48:51], v240, s[16:19], s64 offen offset:0
 v_mfma_f32_16x16x32_bf16 v[156:159], a[160:163], a[220:223], v[156:159]
 s_waitcnt lgkmcnt(4)
 v_mfma_f32_16x16x32_bf16 v[172:175], a[168:171], a[220:223], v[172:175]
 ds_read_b64_tr_b16 a[184:185], v9 offset:96
 v_mfma_f32_16x16x32_bf16 v[172:175], a[172:175], a[140:143], v[172:175]
 ds_read_b64_tr_b16 a[186:187], v9 offset:352
 v_mfma_f32_16x16x32_bf16 v[168:171], a[172:175], a[136:139], v[168:171]
 buffer_load_dwordx4 v4, s[44:47], s65 offen offset:0 lds
 v_mfma_f32_16x16x32_bf16 v[168:171], a[168:171], a[216:219], v[168:171]
 v_mfma_f32_16x16x32_bf16 v[164:167], a[168:171], a[212:215], v[164:167]
 ds_read_b64_tr_b16 a[188:189], v9 offset:8544
 v_mfma_f32_16x16x32_bf16 v[164:167], a[172:175], a[132:135], v[164:167]
 ds_read_b64_tr_b16 a[190:191], v9 offset:8800
 v_mfma_f32_16x16x32_bf16 v[160:163], a[172:175], a[128:131], v[160:163]
 buffer_load_dwordx4 a[52:55], v240, s[16:19], s64 offen offset:1024
 v_mfma_f32_16x16x32_bf16 v[160:163], a[168:171], a[208:211], v[160:163]
 s_waitcnt lgkmcnt(4)
 v_mfma_f32_16x16x32_bf16 v[48:51], a[176:179], a[208:211], v[48:51]
 ds_read_b64_tr_b16 a[160:161], v9 offset:128
 v_mfma_f32_16x16x32_bf16 v[48:51], a[180:183], a[128:131], v[48:51]
 ds_read_b64_tr_b16 a[162:163], v9 offset:384
 v_mfma_f32_16x16x32_bf16 v[52:55], a[180:183], a[132:135], v[52:55]
 buffer_load_dwordx4 a[56:59], v240, s[16:19], s64 offen offset:2048
 v_mfma_f32_16x16x32_bf16 v[52:55], a[176:179], a[212:215], v[52:55]
 v_mfma_f32_16x16x32_bf16 v[56:59], a[176:179], a[216:219], v[56:59]
 ds_read_b64_tr_b16 a[164:165], v9 offset:8576
 v_mfma_f32_16x16x32_bf16 v[56:59], a[180:183], a[136:139], v[56:59]
 ds_read_b64_tr_b16 a[166:167], v9 offset:8832
 v_mfma_f32_16x16x32_bf16 v[60:63], a[180:183], a[140:143], v[60:63]
 buffer_load_dwordx4 v5, s[44:47], s65 offen offset:1056 lds
 v_mfma_f32_16x16x32_bf16 v[60:63], a[176:179], a[220:223], v[60:63]
 s_waitcnt lgkmcnt(4)
 v_mfma_f32_16x16x32_bf16 v[76:79], a[184:187], a[220:223], v[76:79]
 ds_read_b64_tr_b16 a[168:169], v9 offset:160
 v_mfma_f32_16x16x32_bf16 v[76:79], a[188:191], a[140:143], v[76:79]
 ds_read_b64_tr_b16 a[170:171], v9 offset:416
 v_mfma_f32_16x16x32_bf16 v[72:75], a[188:191], a[136:139], v[72:75]
 buffer_load_dwordx4 a[60:63], v240, s[16:19], s64 offen offset:3072
 v_mfma_f32_16x16x32_bf16 v[72:75], a[184:187], a[216:219], v[72:75]
 v_mfma_f32_16x16x32_bf16 v[68:71], a[184:187], a[212:215], v[68:71]
 ds_read_b64_tr_b16 a[172:173], v9 offset:8608
 v_mfma_f32_16x16x32_bf16 v[68:71], a[188:191], a[132:135], v[68:71]
 ds_read_b64_tr_b16 a[174:175], v9 offset:8864
 s_add_u32 s64, s81, 106496
 v_mfma_f32_16x16x32_bf16 v[64:67], a[188:191], a[128:131], v[64:67]
 buffer_load_dwordx4 a[64:67], v8, s[16:19], s64 offen offset:0
 v_mfma_f32_16x16x32_bf16 v[64:67], a[184:187], a[208:211], v[64:67]
 s_waitcnt lgkmcnt(4)
 v_mfma_f32_16x16x32_bf16 v[80:83], a[160:163], a[208:211], v[80:83]
 ds_read_b64_tr_b16 a[176:177], v9 offset:192
 v_mfma_f32_16x16x32_bf16 v[80:83], a[164:167], a[128:131], v[80:83]
 ds_read_b64_tr_b16 a[178:179], v9 offset:448
 v_mfma_f32_16x16x32_bf16 v[84:87], a[164:167], a[132:135], v[84:87]
 buffer_load_dwordx4 v6, s[44:47], s65 offen offset:2112 lds
 v_mfma_f32_16x16x32_bf16 v[84:87], a[160:163], a[212:215], v[84:87]
 v_mfma_f32_16x16x32_bf16 v[88:91], a[160:163], a[216:219], v[88:91]
 ds_read_b64_tr_b16 a[180:181], v9 offset:8640
 v_mfma_f32_16x16x32_bf16 v[88:91], a[164:167], a[136:139], v[88:91]
 ds_read_b64_tr_b16 a[182:183], v9 offset:8896
 v_mfma_f32_16x16x32_bf16 v[92:95], a[164:167], a[140:143], v[92:95]
 buffer_load_dwordx4 a[68:71], v8, s[16:19], s64 offen offset:1024
 v_mfma_f32_16x16x32_bf16 v[92:95], a[160:163], a[220:223], v[92:95]
 s_waitcnt lgkmcnt(4)
 v_mfma_f32_16x16x32_bf16 v[108:111], a[168:171], a[220:223], v[108:111]
 ds_read_b64_tr_b16 a[184:185], v9 offset:224
 v_mfma_f32_16x16x32_bf16 v[108:111], a[172:175], a[140:143], v[108:111]
 ds_read_b64_tr_b16 a[186:187], v9 offset:480
 v_mfma_f32_16x16x32_bf16 v[104:107], a[172:175], a[136:139], v[104:107]
 buffer_load_dwordx4 a[72:75], v8, s[16:19], s64 offen offset:2048
 v_mfma_f32_16x16x32_bf16 v[104:107], a[168:171], a[216:219], v[104:107]
 v_mfma_f32_16x16x32_bf16 v[100:103], a[168:171], a[212:215], v[100:103]
 ds_read_b64_tr_b16 a[188:189], v9 offset:8672
 v_mfma_f32_16x16x32_bf16 v[100:103], a[172:175], a[132:135], v[100:103]
 ds_read_b64_tr_b16 a[190:191], v9 offset:8928
 v_mfma_f32_16x16x32_bf16 v[96:99], a[172:175], a[128:131], v[96:99]
 buffer_load_dwordx4 v7, s[44:47], s65 offen offset:3168 lds
 v_mfma_f32_16x16x32_bf16 v[96:99], a[168:171], a[208:211], v[96:99]
 s_waitcnt vmcnt(59)
 s_barrier
 s_waitcnt lgkmcnt(4)
 v_mfma_f32_16x16x32_bf16 v[112:115], a[176:179], a[208:211], v[112:115]
 ds_read_b64_tr_b16 a[160:161], v9 offset:16960
 v_mfma_f32_16x16x32_bf16 v[112:115], a[180:183], a[128:131], v[112:115]
 ds_read_b64_tr_b16 a[162:163], v9 offset:17216
 v_lshrrev_b32 v253, 2, v1
 v_mfma_f32_16x16x32_bf16 v[116:119], a[180:183], a[132:135], v[116:119]
 buffer_load_dwordx4 a[76:79], v8, s[16:19], s64 offen offset:3072
 v_lshlrev_b32 v253, 11, v253
 v_mfma_f32_16x16x32_bf16 v[116:119], a[176:179], a[212:215], v[116:119]
 v_lshrrev_b32 v250, 4, v1
 v_xor_b32 v250, v250, v1
 v_mfma_f32_16x16x32_bf16 v[120:123], a[176:179], a[216:219], v[120:123]
 ds_read_b64_tr_b16 a[164:165], v9 offset:25408
 v_and_b32 v250, 3, v250
 v_mfma_f32_16x16x32_bf16 v[120:123], a[180:183], a[136:139], v[120:123]
 ds_read_b64_tr_b16 a[166:167], v9 offset:25664
 v_lshl_add_u32 v253, v250, 4, v253
 v_mfma_f32_16x16x32_bf16 v[124:127], a[180:183], a[140:143], v[124:127]
 buffer_load_dwordx4 a[80:83], v240, s[16:19], s64 offen offset:0
 v_lshrrev_b32 v250, 5, v1
 v_mfma_f32_16x16x32_bf16 v[124:127], a[176:179], a[220:223], v[124:127]
 s_waitcnt lgkmcnt(4)
 v_bfe_u32 v251, v1, 2, 2
 v_xor_b32 v250, v250, v251
 v_mfma_f32_16x16x32_bf16 v[140:143], a[184:187], a[220:223], v[140:143]
 ds_read_b64_tr_b16 a[168:169], v9 offset:16992
 v_lshlrev_b32 v250, 4, v250
 v_mfma_f32_16x16x32_bf16 v[140:143], a[188:191], a[140:143], v[140:143]
 ds_read_b64_tr_b16 a[170:171], v9 offset:17248
 v_and_b32 v251, 15, v1
 v_mfma_f32_16x16x32_bf16 v[136:139], a[188:191], a[136:139], v[136:139]
 buffer_load_dwordx4 a[84:87], v240, s[16:19], s64 offen offset:1024
 v_lshl_add_u32 v250, v251, 6, v250
 v_mfma_f32_16x16x32_bf16 v[136:139], a[184:187], a[216:219], v[136:139]
 v_bfe_u32 v251, v1, 4, 1
 v_lshl_add_u32 v250, v251, 3, v250
 v_mfma_f32_16x16x32_bf16 v[132:135], a[184:187], a[212:215], v[132:135]
 ds_read_b64_tr_b16 a[172:173], v9 offset:25440
 v_mfma_f32_16x16x32_bf16 v[132:135], a[188:191], a[132:135], v[132:135]
 ds_read_b64_tr_b16 a[174:175], v9 offset:25696
 v_mfma_f32_16x16x32_bf16 v[128:131], a[188:191], a[128:131], v[128:131]
 buffer_load_dwordx4 a[88:91], v240, s[16:19], s64 offen offset:2048
 v_mfma_f32_16x16x32_bf16 v[128:131], a[184:187], a[208:211], v[128:131]
 s_add_u32 s7, s62, 135168
 v_add_u32 v250, s7, v250
 s_waitcnt vmcnt(32) lgkmcnt(4)
 v_mfma_f32_16x16x32_bf16 v[48:51], a[160:163], a[224:227], v[48:51]
 ds_read_b64_tr_b16 a[176:177], v9 offset:17024
 v_xor_b32 v251, 32, v250
 v_mfma_f32_16x16x32_bf16 v[48:51], a[164:167], a[16:19], v[48:51]
 ds_read_b64_tr_b16 a[178:179], v9 offset:17280
 v_mfma_f32_16x16x32_bf16 v[52:55], a[164:167], a[20:23], v[52:55]
 buffer_load_dwordx4 a[92:95], v240, s[16:19], s64 offen offset:3072
 v_mfma_f32_16x16x32_bf16 v[52:55], a[160:163], a[228:231], v[52:55]
 s_add_u32 s7, s62, 135168
 v_add_u32 v14, s7, v8
 v_mfma_f32_16x16x32_bf16 v[56:59], a[160:163], a[232:235], v[56:59]
 ds_read_b64_tr_b16 a[180:181], v9 offset:25472
 v_mfma_f32_16x16x32_bf16 v[56:59], a[164:167], a[24:27], v[56:59]
 ds_read_b64_tr_b16 a[182:183], v9 offset:25728
 s_add_u32 s64, s81, 114688
 v_mfma_f32_16x16x32_bf16 v[60:63], a[164:167], a[28:31], v[60:63]
 buffer_load_dwordx4 a[96:99], v8, s[16:19], s64 offen offset:0
 v_mfma_f32_16x16x32_bf16 v[60:63], a[160:163], a[236:239], v[60:63]
 s_waitcnt lgkmcnt(4)
 v_mfma_f32_16x16x32_bf16 v[76:79], a[168:171], a[236:239], v[76:79]
 ds_read_b64_tr_b16 a[184:185], v9 offset:17056
 v_mfma_f32_16x16x32_bf16 v[76:79], a[172:175], a[28:31], v[76:79]
 ds_read_b64_tr_b16 a[186:187], v9 offset:17312
 v_mfma_f32_16x16x32_bf16 v[72:75], a[172:175], a[24:27], v[72:75]
 buffer_load_dwordx4 a[100:103], v8, s[16:19], s64 offen offset:1024
 v_mfma_f32_16x16x32_bf16 v[72:75], a[168:171], a[232:235], v[72:75]
 buffer_load_dword v15, v255, s[16:19], s10 offen offset:0 sc0 sc1
 v_mfma_f32_16x16x32_bf16 v[68:71], a[168:171], a[228:231], v[68:71]
 ds_read_b64_tr_b16 a[188:189], v9 offset:25504
 v_mfma_f32_16x16x32_bf16 v[68:71], a[172:175], a[20:23], v[68:71]
 ds_read_b64_tr_b16 a[190:191], v9 offset:25760
 v_mfma_f32_16x16x32_bf16 v[64:67], a[172:175], a[16:19], v[64:67]
 buffer_load_dwordx4 a[104:107], v8, s[16:19], s64 offen offset:2048
 v_mfma_f32_16x16x32_bf16 v[64:67], a[168:171], a[224:227], v[64:67]
 buffer_load_dwordx2 v[244:245], v254, s[52:55], 0 offen offset:0
 s_waitcnt lgkmcnt(4)
 v_mfma_f32_16x16x32_bf16 v[80:83], a[176:179], a[224:227], v[80:83]
 ds_read_b64_tr_b16 a[160:161], v9 offset:17088
 v_mfma_f32_16x16x32_bf16 v[80:83], a[180:183], a[16:19], v[80:83]
 ds_read_b64_tr_b16 a[162:163], v9 offset:17344
 v_mfma_f32_16x16x32_bf16 v[84:87], a[180:183], a[20:23], v[84:87]
 buffer_load_dwordx4 a[108:111], v8, s[16:19], s64 offen offset:3072
 v_mfma_f32_16x16x32_bf16 v[84:87], a[176:179], a[228:231], v[84:87]
 buffer_load_dwordx2 v[246:247], v254, s[52:55], 0 offen offset:32
 v_mfma_f32_16x16x32_bf16 v[88:91], a[176:179], a[232:235], v[88:91]
 ds_read_b64_tr_b16 a[164:165], v9 offset:25536
 v_mfma_f32_16x16x32_bf16 v[88:91], a[180:183], a[24:27], v[88:91]
 ds_read_b64_tr_b16 a[166:167], v9 offset:25792
 v_mfma_f32_16x16x32_bf16 v[92:95], a[180:183], a[28:31], v[92:95]
 buffer_load_dwordx4 a[112:115], v240, s[16:19], s64 offen offset:0
 v_mfma_f32_16x16x32_bf16 v[92:95], a[176:179], a[236:239], v[92:95]
 s_waitcnt lgkmcnt(4)
 v_mfma_f32_16x16x32_bf16 v[108:111], a[184:187], a[236:239], v[108:111]
 ds_read_b64_tr_b16 a[168:169], v9 offset:17120
 v_mfma_f32_16x16x32_bf16 v[108:111], a[188:191], a[28:31], v[108:111]
 ds_read_b64_tr_b16 a[170:171], v9 offset:17376
 v_mfma_f32_16x16x32_bf16 v[104:107], a[188:191], a[24:27], v[104:107]
 buffer_load_dwordx4 a[116:119], v240, s[16:19], s64 offen offset:1024
 v_mfma_f32_16x16x32_bf16 v[104:107], a[184:187], a[232:235], v[104:107]
 v_mfma_f32_16x16x32_bf16 v[100:103], a[184:187], a[228:231], v[100:103]
 ds_read_b64_tr_b16 a[172:173], v9 offset:25568
 v_mfma_f32_16x16x32_bf16 v[100:103], a[188:191], a[20:23], v[100:103]
 ds_read_b64_tr_b16 a[174:175], v9 offset:25824
 v_mfma_f32_16x16x32_bf16 v[96:99], a[188:191], a[16:19], v[96:99]
 buffer_load_dwordx4 a[120:123], v240, s[16:19], s64 offen offset:2048
 v_mfma_f32_16x16x32_bf16 v[96:99], a[184:187], a[224:227], v[96:99]
 s_waitcnt lgkmcnt(4)
 v_mfma_f32_16x16x32_bf16 v[112:115], a[160:163], a[224:227], v[112:115]
 ds_read_b64_tr_b16 a[176:177], v9 offset:33856
 v_mfma_f32_16x16x32_bf16 v[112:115], a[164:167], a[16:19], v[112:115]
 s_branch L_pg19k
L_pg19:
 s_branch L_ic3r
L_pg19k:
 ds_read_b64_tr_b16 a[178:179], v9 offset:34112
 v_mfma_f32_16x16x32_bf16 v[116:119], a[164:167], a[20:23], v[116:119]
 buffer_load_dwordx4 a[124:127], v240, s[16:19], s64 offen offset:3072
 v_mfma_f32_16x16x32_bf16 v[116:119], a[160:163], a[228:231], v[116:119]
 v_mfma_f32_16x16x32_bf16 v[120:123], a[160:163], a[232:235], v[120:123]
 ds_read_b64_tr_b16 a[180:181], v9 offset:42304
 v_mfma_f32_16x16x32_bf16 v[120:123], a[164:167], a[24:27], v[120:123]
 ds_read_b64_tr_b16 a[182:183], v9 offset:42560
 s_add_u32 s64, s81, 122880
 v_mfma_f32_16x16x32_bf16 v[124:127], a[164:167], a[28:31], v[124:127]
 buffer_load_dwordx4 a[192:195], v8, s[16:19], s64 offen offset:0
 v_mfma_f32_16x16x32_bf16 v[124:127], a[160:163], a[236:239], v[124:127]
 s_waitcnt lgkmcnt(4)
 v_mfma_f32_16x16x32_bf16 v[140:143], a[168:171], a[236:239], v[140:143]
 ds_read_b64_tr_b16 a[184:185], v9 offset:33888
 v_mfma_f32_16x16x32_bf16 v[140:143], a[172:175], a[28:31], v[140:143]
 ds_read_b64_tr_b16 a[186:187], v9 offset:34144
 v_mfma_f32_16x16x32_bf16 v[136:139], a[172:175], a[24:27], v[136:139]
 buffer_load_dwordx4 a[196:199], v8, s[16:19], s64 offen offset:1024
 v_mfma_f32_16x16x32_bf16 v[136:139], a[168:171], a[232:235], v[136:139]
 v_mfma_f32_16x16x32_bf16 v[132:135], a[168:171], a[228:231], v[132:135]
 ds_read_b64_tr_b16 a[188:189], v9 offset:42336
 v_mfma_f32_16x16x32_bf16 v[132:135], a[172:175], a[20:23], v[132:135]
 ds_read_b64_tr_b16 a[190:191], v9 offset:42592
 v_mfma_f32_16x16x32_bf16 v[128:131], a[172:175], a[16:19], v[128:131]
 buffer_load_dwordx4 a[200:203], v8, s[16:19], s64 offen offset:2048
 v_mfma_f32_16x16x32_bf16 v[128:131], a[168:171], a[224:227], v[128:131]
 s_waitcnt vmcnt(35) lgkmcnt(4)
 v_mfma_f32_16x16x32_bf16 v[48:51], a[176:179], a[240:243], v[48:51]
 ds_read_b64_tr_b16 a[160:161], v9 offset:33920
 v_mfma_f32_16x16x32_bf16 v[48:51], a[180:183], a[32:35], v[48:51]
 ds_read_b64_tr_b16 a[162:163], v9 offset:34176
 v_mfma_f32_16x16x32_bf16 v[52:55], a[180:183], a[36:39], v[52:55]
 buffer_load_dwordx4 a[204:207], v8, s[16:19], s64 offen offset:3072
 v_mfma_f32_16x16x32_bf16 v[52:55], a[176:179], a[244:247], v[52:55]
 v_mfma_f32_16x16x32_bf16 v[56:59], a[176:179], a[248:251], v[56:59]
 ds_read_b64_tr_b16 a[164:165], v9 offset:42368
 v_mfma_f32_16x16x32_bf16 v[56:59], a[180:183], a[40:43], v[56:59]
 ds_read_b64_tr_b16 a[166:167], v9 offset:42624
 v_mfma_f32_16x16x32_bf16 v[60:63], a[180:183], a[44:47], v[60:63]
 buffer_load_dwordx4 a[128:131], v240, s[16:19], s64 offen offset:0
 v_mfma_f32_16x16x32_bf16 v[60:63], a[176:179], a[252:255], v[60:63]
 s_waitcnt lgkmcnt(4)
 v_mfma_f32_16x16x32_bf16 v[76:79], a[184:187], a[252:255], v[76:79]
 ds_read_b64_tr_b16 a[168:169], v9 offset:33952
 v_mfma_f32_16x16x32_bf16 v[76:79], a[188:191], a[44:47], v[76:79]
 ds_read_b64_tr_b16 a[170:171], v9 offset:34208
 v_mfma_f32_16x16x32_bf16 v[72:75], a[188:191], a[40:43], v[72:75]
 buffer_load_dwordx4 a[132:135], v240, s[16:19], s64 offen offset:1024
 v_mfma_f32_16x16x32_bf16 v[72:75], a[184:187], a[248:251], v[72:75]
 v_mfma_f32_16x16x32_bf16 v[68:71], a[184:187], a[244:247], v[68:71]
 ds_read_b64_tr_b16 a[172:173], v9 offset:42400
 v_mfma_f32_16x16x32_bf16 v[68:71], a[188:191], a[36:39], v[68:71]
 ds_read_b64_tr_b16 a[174:175], v9 offset:42656
 v_mfma_f32_16x16x32_bf16 v[64:67], a[188:191], a[32:35], v[64:67]
 buffer_load_dwordx4 a[136:139], v240, s[16:19], s64 offen offset:2048
 v_mfma_f32_16x16x32_bf16 v[64:67], a[184:187], a[240:243], v[64:67]
 s_waitcnt lgkmcnt(4)
 v_mfma_f32_16x16x32_bf16 v[80:83], a[160:163], a[240:243], v[80:83]
 ds_read_b64_tr_b16 a[176:177], v9 offset:33984
 v_mfma_f32_16x16x32_bf16 v[80:83], a[164:167], a[32:35], v[80:83]
 ds_read_b64_tr_b16 a[178:179], v9 offset:34240
 v_mfma_f32_16x16x32_bf16 v[84:87], a[164:167], a[36:39], v[84:87]
 buffer_load_dwordx4 a[140:143], v240, s[16:19], s64 offen offset:3072
 v_mfma_f32_16x16x32_bf16 v[84:87], a[160:163], a[244:247], v[84:87]
 v_mfma_f32_16x16x32_bf16 v[88:91], a[160:163], a[248:251], v[88:91]
 ds_read_b64_tr_b16 a[180:181], v9 offset:42432
 v_mfma_f32_16x16x32_bf16 v[88:91], a[164:167], a[40:43], v[88:91]
 ds_read_b64_tr_b16 a[182:183], v9 offset:42688
 v_mfma_f32_16x16x32_bf16 v[92:95], a[164:167], a[44:47], v[92:95]
 v_mfma_f32_16x16x32_bf16 v[92:95], a[160:163], a[252:255], v[92:95]
 s_waitcnt lgkmcnt(4)
 v_mfma_f32_16x16x32_bf16 v[108:111], a[168:171], a[252:255], v[108:111]
 ds_read_b64_tr_b16 a[184:185], v9 offset:34016
 v_mfma_f32_16x16x32_bf16 v[108:111], a[172:175], a[44:47], v[108:111]
 ds_read_b64_tr_b16 a[186:187], v9 offset:34272
 v_mfma_f32_16x16x32_bf16 v[104:107], a[172:175], a[40:43], v[104:107]
 v_mfma_f32_16x16x32_bf16 v[104:107], a[168:171], a[248:251], v[104:107]
 s_waitcnt vmcnt(16)
 v_cmp_ne_u32 vcc, 1, v15
 v_mfma_f32_16x16x32_bf16 v[100:103], a[168:171], a[244:247], v[100:103]
 ds_read_b64_tr_b16 a[188:189], v9 offset:42464
 v_mfma_f32_16x16x32_bf16 v[100:103], a[172:175], a[36:39], v[100:103]
 ds_read_b64_tr_b16 a[190:191], v9 offset:42720
 s_cbranch_vccnz L_gslow
L_gok:
 v_mfma_f32_16x16x32_bf16 v[96:99], a[172:175], a[32:35], v[96:99]
 buffer_load_dwordx4 v[176:179], v8, s[16:19], s4 offen offset:0 sc0 sc1
 v_mfma_f32_16x16x32_bf16 v[96:99], a[168:171], a[240:243], v[96:99]
 s_waitcnt vmcnt(58)
 s_barrier
 s_waitcnt lgkmcnt(4)
 v_mfma_f32_16x16x32_bf16 v[112:115], a[176:179], a[240:243], v[112:115]
 ds_read_b64_tr_b16 a[160:161], v9 offset:50752
 v_mfma_f32_16x16x32_bf16 v[112:115], a[180:183], a[32:35], v[112:115]
 ds_read_b64_tr_b16 a[162:163], v9 offset:51008
 v_mfma_f32_16x16x32_bf16 v[116:119], a[180:183], a[36:39], v[116:119]
 buffer_load_dwordx4 v[180:183], v8, s[16:19], s4 offen offset:1024 sc0 sc1
 v_mfma_f32_16x16x32_bf16 v[116:119], a[176:179], a[244:247], v[116:119]
 v_mfma_f32_16x16x32_bf16 v[120:123], a[176:179], a[248:251], v[120:123]
 ds_read_b64_tr_b16 a[164:165], v9 offset:59200
 v_mfma_f32_16x16x32_bf16 v[120:123], a[180:183], a[40:43], v[120:123]
 ds_read_b64_tr_b16 a[166:167], v9 offset:59456
 v_mfma_f32_16x16x32_bf16 v[124:127], a[180:183], a[44:47], v[124:127]
 buffer_load_dwordx4 v[184:187], v8, s[16:19], s4 offen offset:2048 sc0 sc1
 v_mfma_f32_16x16x32_bf16 v[124:127], a[176:179], a[252:255], v[124:127]
 s_waitcnt lgkmcnt(4)
 v_mfma_f32_16x16x32_bf16 v[140:143], a[184:187], a[252:255], v[140:143]
 ds_read_b64_tr_b16 a[168:169], v9 offset:50784
 v_mfma_f32_16x16x32_bf16 v[140:143], a[188:191], a[44:47], v[140:143]
 ds_read_b64_tr_b16 a[170:171], v9 offset:51040
 v_mfma_f32_16x16x32_bf16 v[136:139], a[188:191], a[40:43], v[136:139]
 buffer_load_dwordx4 v[188:191], v8, s[16:19], s4 offen offset:3072 sc0 sc1
 v_mfma_f32_16x16x32_bf16 v[136:139], a[184:187], a[248:251], v[136:139]
 v_mfma_f32_16x16x32_bf16 v[132:135], a[184:187], a[244:247], v[132:135]
 ds_read_b64_tr_b16 a[172:173], v9 offset:59232
 v_mfma_f32_16x16x32_bf16 v[132:135], a[188:191], a[36:39], v[132:135]
 ds_read_b64_tr_b16 a[174:175], v9 offset:59488
 v_mfma_f32_16x16x32_bf16 v[128:131], a[188:191], a[32:35], v[128:131]
 buffer_load_dwordx4 v[192:195], v8, s[16:19], s5 offen offset:0 sc0 sc1
 v_mfma_f32_16x16x32_bf16 v[128:131], a[184:187], a[240:243], v[128:131]
 s_waitcnt vmcnt(34) lgkmcnt(4)
 v_mfma_f32_16x16x32_bf16 v[48:51], a[160:163], a[144:147], v[48:51]
 ds_read_b64_tr_b16 a[176:177], v10 offset:64
 v_mfma_f32_16x16x32_bf16 v[48:51], a[164:167], a[48:51], v[48:51]
 ds_read_b64_tr_b16 a[178:179], v10 offset:320
 v_mfma_f32_16x16x32_bf16 v[52:55], a[164:167], a[52:55], v[52:55]
 buffer_load_dwordx4 v[196:199], v8, s[16:19], s5 offen offset:1024 sc0 sc1
 v_mfma_f32_16x16x32_bf16 v[52:55], a[160:163], a[148:151], v[52:55]
 v_mfma_f32_16x16x32_bf16 v[56:59], a[160:163], a[152:155], v[56:59]
 ds_read_b64_tr_b16 a[180:181], v10 offset:8512
 v_mfma_f32_16x16x32_bf16 v[56:59], a[164:167], a[56:59], v[56:59]
 ds_read_b64_tr_b16 a[182:183], v10 offset:8768
 v_mfma_f32_16x16x32_bf16 v[60:63], a[164:167], a[60:63], v[60:63]
 buffer_load_dwordx4 v[200:203], v8, s[16:19], s5 offen offset:2048 sc0 sc1
 v_mfma_f32_16x16x32_bf16 v[60:63], a[160:163], a[156:159], v[60:63]
 s_waitcnt lgkmcnt(4)
 v_mfma_f32_16x16x32_bf16 v[76:79], a[168:171], a[156:159], v[76:79]
 ds_read_b64_tr_b16 a[184:185], v10 offset:96
 v_mfma_f32_16x16x32_bf16 v[76:79], a[172:175], a[60:63], v[76:79]
 ds_read_b64_tr_b16 a[186:187], v10 offset:352
 v_mfma_f32_16x16x32_bf16 v[72:75], a[172:175], a[56:59], v[72:75]
 buffer_load_dwordx4 v[204:207], v8, s[16:19], s5 offen offset:3072 sc0 sc1
 v_mfma_f32_16x16x32_bf16 v[72:75], a[168:171], a[152:155], v[72:75]
 v_mfma_f32_16x16x32_bf16 v[68:71], a[168:171], a[148:151], v[68:71]
 ds_read_b64_tr_b16 a[188:189], v10 offset:8544
 v_mfma_f32_16x16x32_bf16 v[68:71], a[172:175], a[52:55], v[68:71]
 ds_read_b64_tr_b16 a[190:191], v10 offset:8800
 v_mfma_f32_16x16x32_bf16 v[64:67], a[172:175], a[48:51], v[64:67]
 buffer_load_dwordx4 v[208:211], v8, s[16:19], s6 offen offset:0 sc0 sc1
 v_mfma_f32_16x16x32_bf16 v[64:67], a[168:171], a[144:147], v[64:67]
 s_waitcnt vmcnt(33)
 s_barrier
 s_waitcnt vmcnt(28) lgkmcnt(4)
 v_mfma_f32_16x16x32_bf16 v[48:51], a[176:179], a[64:67], v[48:51]
 ds_read_b64_tr_b16 a[160:161], v10 offset:16960
 v_mfma_f32_16x16x32_bf16 v[48:51], a[180:183], a[80:83], v[48:51]
 ds_read_b64_tr_b16 a[162:163], v10 offset:17216
 v_mfma_f32_16x16x32_bf16 v[52:55], a[180:183], a[84:87], v[52:55]
 buffer_load_dwordx4 v[212:215], v8, s[16:19], s6 offen offset:1024 sc0 sc1
 v_mfma_f32_16x16x32_bf16 v[52:55], a[176:179], a[68:71], v[52:55]
 v_mfma_f32_16x16x32_bf16 v[56:59], a[176:179], a[72:75], v[56:59]
 ds_read_b64_tr_b16 a[164:165], v10 offset:25408
 v_mfma_f32_16x16x32_bf16 v[56:59], a[180:183], a[88:91], v[56:59]
 ds_read_b64_tr_b16 a[166:167], v10 offset:25664
 v_mfma_f32_16x16x32_bf16 v[60:63], a[180:183], a[92:95], v[60:63]
 buffer_load_dwordx4 v[216:219], v8, s[16:19], s6 offen offset:2048 sc0 sc1
 v_mfma_f32_16x16x32_bf16 v[60:63], a[176:179], a[76:79], v[60:63]
 s_waitcnt lgkmcnt(4)
 v_mfma_f32_16x16x32_bf16 v[76:79], a[184:187], a[76:79], v[76:79]
 ds_read_b64_tr_b16 a[168:169], v10 offset:16992
 v_mfma_f32_16x16x32_bf16 v[76:79], a[188:191], a[92:95], v[76:79]
 ds_read_b64_tr_b16 a[170:171], v10 offset:17248
 v_mfma_f32_16x16x32_bf16 v[72:75], a[188:191], a[88:91], v[72:75]
 buffer_load_dwordx4 v[220:223], v8, s[16:19], s6 offen offset:3072 sc0 sc1
 v_mfma_f32_16x16x32_bf16 v[72:75], a[184:187], a[72:75], v[72:75]
 v_mfma_f32_16x16x32_bf16 v[68:71], a[184:187], a[68:71], v[68:71]
 s_add_u32 s4, s39, 16777216
 ds_read_b64_tr_b16 a[172:173], v10 offset:25440
 v_mfma_f32_16x16x32_bf16 v[68:71], a[188:191], a[84:87], v[68:71]
 s_add_u32 s5, s39, 16781312
 ds_read_b64_tr_b16 a[174:175], v10 offset:25696
 v_mfma_f32_16x16x32_bf16 v[64:67], a[188:191], a[80:83], v[64:67]
 s_add_u32 s6, s39, 16785408
 v_mfma_f32_16x16x32_bf16 v[64:67], a[184:187], a[64:67], v[64:67]
 s_mov_b64 s[76:77], -1
 s_waitcnt vmcnt(20) lgkmcnt(4)
 v_mfma_f32_16x16x32_bf16 v[48:51], a[160:163], a[96:99], v[48:51]
 ds_read_b64_tr_b16 a[176:177], v10 offset:33856
 v_mfma_f32_16x16x32_bf16 v[48:51], a[164:167], a[112:115], v[48:51]
 ds_read_b64_tr_b16 a[178:179], v10 offset:34112
 v_mfma_f32_16x16x32_bf16 v[52:55], a[164:167], a[116:119], v[52:55]
 v_mfma_f32_16x16x32_bf16 v[52:55], a[160:163], a[100:103], v[52:55]
 v_mfma_f32_16x16x32_bf16 v[56:59], a[160:163], a[104:107], v[56:59]
 ds_read_b64_tr_b16 a[180:181], v10 offset:42304
 v_mfma_f32_16x16x32_bf16 v[56:59], a[164:167], a[120:123], v[56:59]
 ds_read_b64_tr_b16 a[182:183], v10 offset:42560
 v_mfma_f32_16x16x32_bf16 v[60:63], a[164:167], a[124:127], v[60:63]
 v_mfma_f32_16x16x32_bf16 v[60:63], a[160:163], a[108:111], v[60:63]
 s_waitcnt lgkmcnt(4)
 v_mfma_f32_16x16x32_bf16 v[76:79], a[168:171], a[108:111], v[76:79]
 ds_read_b64_tr_b16 a[184:185], v10 offset:33888
 v_mfma_f32_16x16x32_bf16 v[76:79], a[172:175], a[124:127], v[76:79]
 ds_read_b64_tr_b16 a[186:187], v10 offset:34144
 v_mfma_f32_16x16x32_bf16 v[72:75], a[172:175], a[120:123], v[72:75]
 v_mfma_f32_16x16x32_bf16 v[72:75], a[168:171], a[104:107], v[72:75]
 v_mfma_f32_16x16x32_bf16 v[68:71], a[168:171], a[100:103], v[68:71]
 ds_read_b64_tr_b16 a[188:189], v10 offset:42336
 v_mfma_f32_16x16x32_bf16 v[68:71], a[172:175], a[116:119], v[68:71]
 ds_read_b64_tr_b16 a[190:191], v10 offset:42592
 v_mfma_f32_16x16x32_bf16 v[64:67], a[172:175], a[112:115], v[64:67]
 v_mfma_f32_16x16x32_bf16 v[64:67], a[168:171], a[96:99], v[64:67]
 s_waitcnt vmcnt(12) lgkmcnt(4)
 v_mfma_f32_16x16x32_bf16 v[48:51], a[176:179], a[192:195], v[48:51]
 ds_read_b64_tr_b16 a[160:161], v9 offset:50816
 v_mfma_f32_16x16x32_bf16 v[48:51], a[180:183], a[128:131], v[48:51]
 ds_read_b64_tr_b16 a[162:163], v9 offset:51072
 v_mfma_f32_16x16x32_bf16 v[52:55], a[180:183], a[132:135], v[52:55]
 v_mfma_f32_16x16x32_bf16 v[52:55], a[176:179], a[196:199], v[52:55]
 v_mfma_f32_16x16x32_bf16 v[56:59], a[176:179], a[200:203], v[56:59]
 ds_read_b64_tr_b16 a[164:165], v9 offset:59264
 v_mfma_f32_16x16x32_bf16 v[56:59], a[180:183], a[136:139], v[56:59]
 ds_read_b64_tr_b16 a[166:167], v9 offset:59520
 v_mfma_f32_16x16x32_bf16 v[60:63], a[180:183], a[140:143], v[60:63]
 v_mfma_f32_16x16x32_bf16 v[60:63], a[176:179], a[204:207], v[60:63]
 s_waitcnt lgkmcnt(4)
 v_mfma_f32_16x16x32_bf16 v[76:79], a[184:187], a[204:207], v[76:79]
 ds_read_b64_tr_b16 a[168:169], v9 offset:50848
 v_mfma_f32_16x16x32_bf16 v[76:79], a[188:191], a[140:143], v[76:79]
 ds_read_b64_tr_b16 a[170:171], v9 offset:51104
 v_mfma_f32_16x16x32_bf16 v[72:75], a[188:191], a[136:139], v[72:75]
 v_mfma_f32_16x16x32_bf16 v[72:75], a[184:187], a[200:203], v[72:75]
 v_mfma_f32_16x16x32_bf16 v[68:71], a[184:187], a[196:199], v[68:71]
 ds_read_b64_tr_b16 a[172:173], v9 offset:59296
 v_mfma_f32_16x16x32_bf16 v[68:71], a[188:191], a[132:135], v[68:71]
 ds_read_b64_tr_b16 a[174:175], v9 offset:59552
 v_mfma_f32_16x16x32_bf16 v[64:67], a[188:191], a[128:131], v[64:67]
 v_mfma_f32_16x16x32_bf16 v[64:67], a[184:187], a[192:195], v[64:67]
 s_waitcnt lgkmcnt(4)
 v_mfma_f32_16x16x32_bf16 v[80:83], a[160:163], a[144:147], v[80:83]
 ds_read_b64_tr_b16 a[176:177], v10 offset:128
 v_mfma_f32_16x16x32_bf16 v[80:83], a[164:167], a[48:51], v[80:83]
 ds_read_b64_tr_b16 a[178:179], v10 offset:384
 v_mfma_f32_16x16x32_bf16 v[84:87], a[164:167], a[52:55], v[84:87]
 v_mfma_f32_16x16x32_bf16 v[84:87], a[160:163], a[148:151], v[84:87]
 v_cvt_pk_bf16_f32 v48, v48, v49
 v_cvt_pk_bf16_f32 v49, v50, v51
 v_mfma_f32_16x16x32_bf16 v[88:91], a[160:163], a[152:155], v[88:91]
 ds_read_b64_tr_b16 a[180:181], v10 offset:8576
 v_min_u32 v48, -2, v48
 v_mfma_f32_16x16x32_bf16 v[88:91], a[164:167], a[56:59], v[88:91]
 ds_read_b64_tr_b16 a[182:183], v10 offset:8832
 v_cvt_pk_bf16_f32 v50, v64, v65
 v_mfma_f32_16x16x32_bf16 v[92:95], a[164:167], a[60:63], v[92:95]
 v_cvt_pk_bf16_f32 v51, v66, v67
 v_cvt_pk_bf16_f32 v52, v52, v53
 v_mfma_f32_16x16x32_bf16 v[92:95], a[160:163], a[156:159], v[92:95]
 buffer_store_dwordx4 v[48:51], v8, s[16:19], s36 offen offset:0 sc0 sc1
 s_waitcnt lgkmcnt(4)
 v_mfma_f32_16x16x32_bf16 v[108:111], a[168:171], a[156:159], v[108:111]
 ds_read_b64_tr_b16 a[184:185], v10 offset:160
 v_cvt_pk_bf16_f32 v53, v54, v55
 v_mfma_f32_16x16x32_bf16 v[108:111], a[172:175], a[60:63], v[108:111]
 ds_read_b64_tr_b16 a[186:187], v10 offset:416
 v_min_u32 v52, -2, v52
 v_mfma_f32_16x16x32_bf16 v[104:107], a[172:175], a[56:59], v[104:107]
 v_cvt_pk_bf16_f32 v54, v68, v69
 v_cvt_pk_bf16_f32 v55, v70, v71
 v_mfma_f32_16x16x32_bf16 v[104:107], a[168:171], a[152:155], v[104:107]
 buffer_store_dwordx4 v[52:55], v8, s[16:19], s36 offen offset:1024 sc0 sc1
 v_cvt_pk_bf16_f32 v56, v56, v57
 v_mfma_f32_16x16x32_bf16 v[100:103], a[168:171], a[148:151], v[100:103]
 ds_read_b64_tr_b16 a[188:189], v10 offset:8608
 v_cvt_pk_bf16_f32 v57, v58, v59
 v_mfma_f32_16x16x32_bf16 v[100:103], a[172:175], a[52:55], v[100:103]
 ds_read_b64_tr_b16 a[190:191], v10 offset:8864
 v_min_u32 v56, -2, v56
 v_mfma_f32_16x16x32_bf16 v[96:99], a[172:175], a[48:51], v[96:99]
 v_cvt_pk_bf16_f32 v58, v72, v73
 v_cvt_pk_bf16_f32 v59, v74, v75
 v_mfma_f32_16x16x32_bf16 v[96:99], a[168:171], a[144:147], v[96:99]
 buffer_store_dwordx4 v[56:59], v8, s[16:19], s36 offen offset:2048 sc0 sc1
 s_waitcnt lgkmcnt(4)
 v_mfma_f32_16x16x32_bf16 v[80:83], a[176:179], a[64:67], v[80:83]
 ds_read_b64_tr_b16 a[160:161], v10 offset:17024
 v_cvt_pk_bf16_f32 v60, v60, v61
 v_mfma_f32_16x16x32_bf16 v[80:83], a[180:183], a[80:83], v[80:83]
 ds_read_b64_tr_b16 a[162:163], v10 offset:17280
 v_cvt_pk_bf16_f32 v61, v62, v63
 v_mfma_f32_16x16x32_bf16 v[84:87], a[180:183], a[84:87], v[84:87]
 v_min_u32 v60, -2, v60
 v_cvt_pk_bf16_f32 v62, v76, v77
 v_mfma_f32_16x16x32_bf16 v[84:87], a[176:179], a[68:71], v[84:87]
 v_cvt_pk_bf16_f32 v63, v78, v79
 v_mfma_f32_16x16x32_bf16 v[88:91], a[176:179], a[72:75], v[88:91]
 buffer_store_dwordx4 v[60:63], v8, s[16:19], s36 offen offset:3072 sc0 sc1
 ds_read_b64_tr_b16 a[164:165], v10 offset:25472
 v_mfma_f32_16x16x32_bf16 v[88:91], a[180:183], a[88:91], v[88:91]
 ds_read_b64_tr_b16 a[166:167], v10 offset:25728
 v_mfma_f32_16x16x32_bf16 v[92:95], a[180:183], a[92:95], v[92:95]
 v_mfma_f32_16x16x32_bf16 v[92:95], a[176:179], a[76:79], v[92:95]
 s_waitcnt lgkmcnt(4)
 v_mfma_f32_16x16x32_bf16 v[108:111], a[184:187], a[76:79], v[108:111]
 ds_read_b64_tr_b16 a[168:169], v10 offset:17056
 v_mfma_f32_16x16x32_bf16 v[108:111], a[188:191], a[92:95], v[108:111]
 ds_read_b64_tr_b16 a[170:171], v10 offset:17312
 v_mfma_f32_16x16x32_bf16 v[104:107], a[188:191], a[88:91], v[104:107]
 v_mfma_f32_16x16x32_bf16 v[104:107], a[184:187], a[72:75], v[104:107]
 v_mfma_f32_16x16x32_bf16 v[100:103], a[184:187], a[68:71], v[100:103]
 ds_read_b64_tr_b16 a[172:173], v10 offset:25504
 v_mfma_f32_16x16x32_bf16 v[100:103], a[188:191], a[84:87], v[100:103]
 ds_read_b64_tr_b16 a[174:175], v10 offset:25760
 v_mfma_f32_16x16x32_bf16 v[96:99], a[188:191], a[80:83], v[96:99]
 v_mfma_f32_16x16x32_bf16 v[96:99], a[184:187], a[64:67], v[96:99]
 s_waitcnt vmcnt(4)
 v_mfma_f32_16x16x32_bf16 v[16:19], v[226:229], v[244:247], v[16:19]
 v_mfma_f32_16x16x32_bf16 v[32:35], v[224:227], v[244:247], v[32:35]
 v_mfma_f32_16x16x32_bf16 v[20:23], v[226:229], v[244:247], v[20:23]
 v_mfma_f32_16x16x32_bf16 v[36:39], v[224:227], v[244:247], v[36:39]
 v_mfma_f32_16x16x32_bf16 v[24:27], v[226:229], v[244:247], v[24:27]
 v_mfma_f32_16x16x32_bf16 v[40:43], v[224:227], v[244:247], v[40:43]
 v_mfma_f32_16x16x32_bf16 v[28:31], v[226:229], v[244:247], v[28:31]
 v_mfma_f32_16x16x32_bf16 v[44:47], v[224:227], v[244:247], v[44:47]
 v_mfma_f32_16x16x32_bf16 v[16:19], v[226:229], v[176:179], v[16:19]
 v_mfma_f32_16x16x32_bf16 v[32:35], v[224:227], v[176:179], v[32:35]
 v_mfma_f32_16x16x32_bf16 v[20:23], v[226:229], v[180:183], v[20:23]
 v_mfma_f32_16x16x32_bf16 v[36:39], v[224:227], v[180:183], v[36:39]
 v_mfma_f32_16x16x32_bf16 v[24:27], v[226:229], v[184:187], v[24:27]
 v_mfma_f32_16x16x32_bf16 v[40:43], v[224:227], v[184:187], v[40:43]
 v_mfma_f32_16x16x32_bf16 v[28:31], v[226:229], v[188:191], v[28:31]
 v_mfma_f32_16x16x32_bf16 v[44:47], v[224:227], v[188:191], v[44:47]
 v_mfma_f32_16x16x32_bf16 v[16:19], v[226:229], v[192:195], v[16:19]
 v_mfma_f32_16x16x32_bf16 v[32:35], v[224:227], v[192:195], v[32:35]
 v_mfma_f32_16x16x32_bf16 v[20:23], v[226:229], v[196:199], v[20:23]
 v_mfma_f32_16x16x32_bf16 v[36:39], v[224:227], v[196:199], v[36:39]
 v_mfma_f32_16x16x32_bf16 v[24:27], v[226:229], v[200:203], v[24:27]
 v_mfma_f32_16x16x32_bf16 v[40:43], v[224:227], v[200:203], v[40:43]
 v_mfma_f32_16x16x32_bf16 v[28:31], v[226:229], v[204:207], v[28:31]
 v_mfma_f32_16x16x32_bf16 v[44:47], v[224:227], v[204:207], v[44:47]
 v_mfma_f32_16x16x32_bf16 v[16:19], v[226:229], v[208:211], v[16:19]
 v_mfma_f32_16x16x32_bf16 v[32:35], v[224:227], v[208:211], v[32:35]
 v_mfma_f32_16x16x32_bf16 v[20:23], v[226:229], v[212:215], v[20:23]
 v_mfma_f32_16x16x32_bf16 v[36:39], v[224:227], v[212:215], v[36:39]
 v_mfma_f32_16x16x32_bf16 v[24:27], v[226:229], v[216:219], v[24:27]
 v_mfma_f32_16x16x32_bf16 v[40:43], v[224:227], v[216:219], v[40:43]
 v_mfma_f32_16x16x32_bf16 v[28:31], v[226:229], v[220:223], v[28:31]
 v_mfma_f32_16x16x32_bf16 v[44:47], v[224:227], v[220:223], v[44:47]
 s_waitcnt lgkmcnt(4)
 v_mfma_f32_16x16x32_bf16 v[80:83], a[160:163], a[96:99], v[80:83]
 ds_read_b64_tr_b16 a[176:177], v10 offset:33920
 v_mfma_f32_16x16x32_bf16 v[80:83], a[164:167], a[112:115], v[80:83]
 ds_read_b64_tr_b16 a[178:179], v10 offset:34176
 v_mfma_f32_16x16x32_bf16 v[84:87], a[164:167], a[116:119], v[84:87]
 v_mul_f32 v230, s86, v16
 v_mul_f32 v231, s86, v17
 v_mfma_f32_16x16x32_bf16 v[84:87], a[160:163], a[100:103], v[84:87]
 v_exp_f32 v230, v230
 v_mfma_f32_16x16x32_bf16 v[88:91], a[160:163], a[104:107], v[88:91]
 ds_read_b64_tr_b16 a[180:181], v10 offset:42368
 v_mul_f32 v232, s86, v20
 v_mfma_f32_16x16x32_bf16 v[88:91], a[164:167], a[120:123], v[88:91]
 ds_read_b64_tr_b16 a[182:183], v10 offset:42624
 v_mul_f32 v233, s86, v21
 v_mfma_f32_16x16x32_bf16 v[92:95], a[164:167], a[124:127], v[92:95]
 v_exp_f32 v231, v231
 v_mfma_f32_16x16x32_bf16 v[92:95], a[160:163], a[108:111], v[92:95]
 s_waitcnt lgkmcnt(4)
 v_add_f32 v230, 1.0, v230
 v_add_f32 v231, 1.0, v231
 v_mfma_f32_16x16x32_bf16 v[108:111], a[168:171], a[108:111], v[108:111]
 ds_read_b64_tr_b16 a[184:185], v10 offset:33952
 v_mul_f32 v234, s86, v24
 v_mfma_f32_16x16x32_bf16 v[108:111], a[172:175], a[124:127], v[108:111]
 ds_read_b64_tr_b16 a[186:187], v10 offset:34208
 v_mul_f32 v235, s86, v25
 v_mfma_f32_16x16x32_bf16 v[104:107], a[172:175], a[120:123], v[104:107]
 v_rcp_f32 v230, v230
 v_mfma_f32_16x16x32_bf16 v[104:107], a[168:171], a[104:107], v[104:107]
 v_rcp_f32 v231, v231
 v_mfma_f32_16x16x32_bf16 v[100:103], a[168:171], a[100:103], v[100:103]
 ds_read_b64_tr_b16 a[188:189], v10 offset:42400
 v_mul_f32 v16, v230, v16
 v_mfma_f32_16x16x32_bf16 v[100:103], a[172:175], a[116:119], v[100:103]
 ds_read_b64_tr_b16 a[190:191], v10 offset:42656
 v_mul_f32 v17, v231, v17
 v_mfma_f32_16x16x32_bf16 v[96:99], a[172:175], a[112:115], v[96:99]
 v_mul_f32 v230, s86, v18
 v_mul_f32 v231, s86, v19
 v_mfma_f32_16x16x32_bf16 v[96:99], a[168:171], a[96:99], v[96:99]
 s_waitcnt lgkmcnt(4)
 v_exp_f32 v230, v230
 v_mfma_f32_16x16x32_bf16 v[80:83], a[176:179], a[192:195], v[80:83]
 ds_read_b64_tr_b16 a[160:161], v9 offset:50880
 v_mul_f32 v236, s86, v28
 v_mfma_f32_16x16x32_bf16 v[80:83], a[180:183], a[128:131], v[80:83]
 ds_read_b64_tr_b16 a[162:163], v9 offset:51136
 v_mul_f32 v237, s86, v29
 v_mfma_f32_16x16x32_bf16 v[84:87], a[180:183], a[132:135], v[84:87]
 v_exp_f32 v231, v231
 v_mfma_f32_16x16x32_bf16 v[84:87], a[176:179], a[196:199], v[84:87]
 v_add_f32 v230, 1.0, v230
 v_add_f32 v231, 1.0, v231
 v_mfma_f32_16x16x32_bf16 v[88:91], a[176:179], a[200:203], v[88:91]
 ds_read_b64_tr_b16 a[164:165], v9 offset:59328
 v_mul_f32 v238, s86, v32
 v_mfma_f32_16x16x32_bf16 v[88:91], a[180:183], a[136:139], v[88:91]
 ds_read_b64_tr_b16 a[166:167], v9 offset:59584
 v_mul_f32 v239, s86, v33
 v_mfma_f32_16x16x32_bf16 v[92:95], a[180:183], a[140:143], v[92:95]
 buffer_load_dwordx4 v[64:67], v8, s[16:19], s4 offen offset:0 sc0 sc1
 v_mul_f32 v241, s86, v36
 v_mfma_f32_16x16x32_bf16 v[92:95], a[176:179], a[204:207], v[92:95]
 buffer_load_dwordx4 v[68:71], v8, s[16:19], s4 offen offset:1024 sc0 sc1
 s_waitcnt lgkmcnt(4)
 v_mfma_f32_16x16x32_bf16 v[108:111], a[184:187], a[204:207], v[108:111]
 buffer_load_dwordx4 v[72:75], v8, s[16:19], s4 offen offset:2048 sc0 sc1
 ds_read_b64_tr_b16 a[168:169], v9 offset:50912
 v_mfma_f32_16x16x32_bf16 v[108:111], a[188:191], a[140:143], v[108:111]
 buffer_load_dwordx4 v[76:79], v8, s[16:19], s4 offen offset:3072 sc0 sc1
 ds_read_b64_tr_b16 a[170:171], v9 offset:51168
 v_mfma_f32_16x16x32_bf16 v[104:107], a[188:191], a[136:139], v[104:107]
 v_rcp_f32 v230, v230
 v_mfma_f32_16x16x32_bf16 v[104:107], a[184:187], a[200:203], v[104:107]
 v_rcp_f32 v231, v231
 v_mfma_f32_16x16x32_bf16 v[100:103], a[184:187], a[196:199], v[100:103]
 ds_read_b64_tr_b16 a[172:173], v9 offset:59360
 v_mul_f32 v18, v230, v18
 v_mfma_f32_16x16x32_bf16 v[100:103], a[188:191], a[132:135], v[100:103]
 ds_read_b64_tr_b16 a[174:175], v9 offset:59616
 v_mul_f32 v19, v231, v19
 v_mfma_f32_16x16x32_bf16 v[96:99], a[188:191], a[128:131], v[96:99]
 v_exp_f32 v232, v232
 v_mfma_f32_16x16x32_bf16 v[96:99], a[184:187], a[192:195], v[96:99]
 s_waitcnt lgkmcnt(4)
 v_exp_f32 v233, v233
 v_mfma_f32_16x16x32_bf16 v[112:115], a[160:163], a[144:147], v[112:115]
 ds_read_b64_tr_b16 a[176:177], v10 offset:192
 v_add_f32 v232, 1.0, v232
 v_mfma_f32_16x16x32_bf16 v[112:115], a[164:167], a[48:51], v[112:115]
 ds_read_b64_tr_b16 a[178:179], v10 offset:448
 v_add_f32 v233, 1.0, v233
 v_mfma_f32_16x16x32_bf16 v[116:119], a[164:167], a[52:55], v[116:119]
 v_rcp_f32 v232, v232
 v_mfma_f32_16x16x32_bf16 v[116:119], a[160:163], a[148:151], v[116:119]
 v_cvt_pk_bf16_f32 v80, v80, v81
 v_cvt_pk_bf16_f32 v81, v82, v83
 v_mfma_f32_16x16x32_bf16 v[120:123], a[160:163], a[152:155], v[120:123]
 ds_read_b64_tr_b16 a[180:181], v10 offset:8640
 v_min_u32 v80, -2, v80
 v_mfma_f32_16x16x32_bf16 v[120:123], a[164:167], a[56:59], v[120:123]
 ds_read_b64_tr_b16 a[182:183], v10 offset:8896
 v_cvt_pk_bf16_f32 v82, v96, v97
 v_mfma_f32_16x16x32_bf16 v[124:127], a[164:167], a[60:63], v[124:127]
 v_cvt_pk_bf16_f32 v83, v98, v99
 v_cvt_pk_bf16_f32 v84, v84, v85
 v_mfma_f32_16x16x32_bf16 v[124:127], a[160:163], a[156:159], v[124:127]
 buffer_store_dwordx4 v[80:83], v8, s[16:19], s37 offen offset:0 sc0 sc1
 s_waitcnt lgkmcnt(4)
 v_mfma_f32_16x16x32_bf16 v[140:143], a[168:171], a[156:159], v[140:143]
 ds_read_b64_tr_b16 a[184:185], v10 offset:224
 v_cvt_pk_bf16_f32 v85, v86, v87
 v_mfma_f32_16x16x32_bf16 v[140:143], a[172:175], a[60:63], v[140:143]
 ds_read_b64_tr_b16 a[186:187], v10 offset:480
 v_min_u32 v84, -2, v84
 v_mfma_f32_16x16x32_bf16 v[136:139], a[172:175], a[56:59], v[136:139]
 v_cvt_pk_bf16_f32 v86, v100, v101
 v_cvt_pk_bf16_f32 v87, v102, v103
 v_mfma_f32_16x16x32_bf16 v[136:139], a[168:171], a[152:155], v[136:139]
 buffer_store_dwordx4 v[84:87], v8, s[16:19], s37 offen offset:1024 sc0 sc1
 v_cvt_pk_bf16_f32 v88, v88, v89
 v_mfma_f32_16x16x32_bf16 v[132:135], a[168:171], a[148:151], v[132:135]
 ds_read_b64_tr_b16 a[188:189], v10 offset:8672
 v_cvt_pk_bf16_f32 v89, v90, v91
 v_mfma_f32_16x16x32_bf16 v[132:135], a[172:175], a[52:55], v[132:135]
 ds_read_b64_tr_b16 a[190:191], v10 offset:8928
 v_min_u32 v88, -2, v88
 v_mfma_f32_16x16x32_bf16 v[128:131], a[172:175], a[48:51], v[128:131]
 v_cvt_pk_bf16_f32 v90, v104, v105
 v_cvt_pk_bf16_f32 v91, v106, v107
 v_mfma_f32_16x16x32_bf16 v[128:131], a[168:171], a[144:147], v[128:131]
 buffer_store_dwordx4 v[88:91], v8, s[16:19], s37 offen offset:2048 sc0 sc1
 s_waitcnt lgkmcnt(4)
 v_mfma_f32_16x16x32_bf16 v[112:115], a[176:179], a[64:67], v[112:115]
 ds_read_b64_tr_b16 a[160:161], v10 offset:17088
 v_cvt_pk_bf16_f32 v92, v92, v93
 v_mfma_f32_16x16x32_bf16 v[112:115], a[180:183], a[80:83], v[112:115]
 ds_read_b64_tr_b16 a[162:163], v10 offset:17344
 v_cvt_pk_bf16_f32 v93, v94, v95
 v_mfma_f32_16x16x32_bf16 v[116:119], a[180:183], a[84:87], v[116:119]
 v_min_u32 v92, -2, v92
 v_cvt_pk_bf16_f32 v94, v108, v109
 v_mfma_f32_16x16x32_bf16 v[116:119], a[176:179], a[68:71], v[116:119]
 v_cvt_pk_bf16_f32 v95, v110, v111
 v_mul_f32 v242, s86, v37
 v_mfma_f32_16x16x32_bf16 v[120:123], a[176:179], a[72:75], v[120:123]
 buffer_store_dwordx4 v[92:95], v8, s[16:19], s37 offen offset:3072 sc0 sc1
 ds_read_b64_tr_b16 a[164:165], v10 offset:25536
 v_mfma_f32_16x16x32_bf16 v[120:123], a[180:183], a[88:91], v[120:123]
 ds_read_b64_tr_b16 a[166:167], v10 offset:25792
 v_mul_f32 v243, s86, v40
 v_mfma_f32_16x16x32_bf16 v[124:127], a[180:183], a[92:95], v[124:127]
 v_rcp_f32 v233, v233
 v_mfma_f32_16x16x32_bf16 v[124:127], a[176:179], a[76:79], v[124:127]
 s_waitcnt lgkmcnt(4)
 v_mul_f32 v20, v232, v20
 v_mul_f32 v21, v233, v21
 v_mfma_f32_16x16x32_bf16 v[140:143], a[184:187], a[76:79], v[140:143]
 ds_read_b64_tr_b16 a[168:169], v10 offset:17120
 v_mul_f32 v232, s86, v22
 v_mfma_f32_16x16x32_bf16 v[140:143], a[188:191], a[92:95], v[140:143]
 ds_read_b64_tr_b16 a[170:171], v10 offset:17376
 v_mul_f32 v233, s86, v23
 v_mfma_f32_16x16x32_bf16 v[136:139], a[188:191], a[88:91], v[136:139]
 v_exp_f32 v232, v232
 v_mfma_f32_16x16x32_bf16 v[136:139], a[184:187], a[72:75], v[136:139]
 v_exp_f32 v233, v233
 v_mfma_f32_16x16x32_bf16 v[132:135], a[184:187], a[68:71], v[132:135]
 ds_read_b64_tr_b16 a[172:173], v10 offset:25568
 v_add_f32 v232, 1.0, v232
 v_mfma_f32_16x16x32_bf16 v[132:135], a[188:191], a[84:87], v[132:135]
 ds_read_b64_tr_b16 a[174:175], v10 offset:25824
 v_add_f32 v233, 1.0, v233
 v_mfma_f32_16x16x32_bf16 v[128:131], a[188:191], a[80:83], v[128:131]
 v_rcp_f32 v232, v232
 v_mfma_f32_16x16x32_bf16 v[128:131], a[184:187], a[64:67], v[128:131]
 s_waitcnt lgkmcnt(4)
 v_rcp_f32 v233, v233
 v_mfma_f32_16x16x32_bf16 v[112:115], a[160:163], a[96:99], v[112:115]
 ds_read_b64_tr_b16 a[176:177], v10 offset:33984
 v_mul_f32 v22, v232, v22
 v_mfma_f32_16x16x32_bf16 v[112:115], a[164:167], a[112:115], v[112:115]
 ds_read_b64_tr_b16 a[178:179], v10 offset:34240
 v_mul_f32 v23, v233, v23
 v_mfma_f32_16x16x32_bf16 v[116:119], a[164:167], a[116:119], v[116:119]
 v_exp_f32 v234, v234
 v_mfma_f32_16x16x32_bf16 v[116:119], a[160:163], a[100:103], v[116:119]
 v_exp_f32 v235, v235
 v_mfma_f32_16x16x32_bf16 v[120:123], a[160:163], a[104:107], v[120:123]
 ds_read_b64_tr_b16 a[180:181], v10 offset:42432
 v_add_f32 v234, 1.0, v234
 v_mfma_f32_16x16x32_bf16 v[120:123], a[164:167], a[120:123], v[120:123]
 ds_read_b64_tr_b16 a[182:183], v10 offset:42688
 v_add_f32 v235, 1.0, v235
 v_mfma_f32_16x16x32_bf16 v[124:127], a[164:167], a[124:127], v[124:127]
 v_rcp_f32 v234, v234
 v_mfma_f32_16x16x32_bf16 v[124:127], a[160:163], a[108:111], v[124:127]
 s_waitcnt lgkmcnt(4)
 v_rcp_f32 v235, v235
 v_mfma_f32_16x16x32_bf16 v[140:143], a[168:171], a[108:111], v[140:143]
 ds_read_b64_tr_b16 a[184:185], v10 offset:34016
 v_mul_f32 v24, v234, v24
 v_mfma_f32_16x16x32_bf16 v[140:143], a[172:175], a[124:127], v[140:143]
 ds_read_b64_tr_b16 a[186:187], v10 offset:34272
 v_mul_f32 v25, v235, v25
 v_mfma_f32_16x16x32_bf16 v[136:139], a[172:175], a[120:123], v[136:139]
 v_mul_f32 v234, s86, v26
 v_mul_f32 v235, s86, v27
 v_mfma_f32_16x16x32_bf16 v[136:139], a[168:171], a[104:107], v[136:139]
 v_exp_f32 v234, v234
 v_mfma_f32_16x16x32_bf16 v[132:135], a[168:171], a[100:103], v[132:135]
 ds_read_b64_tr_b16 a[188:189], v10 offset:42464
 v_mul_f32 v249, s86, v41
 v_mfma_f32_16x16x32_bf16 v[132:135], a[172:175], a[116:119], v[132:135]
 ds_read_b64_tr_b16 a[190:191], v10 offset:42720
 v_mul_f32 v11, s86, v44
 v_mfma_f32_16x16x32_bf16 v[128:131], a[172:175], a[112:115], v[128:131]
 s_branch L_pg20k
L_pg20:
 s_branch L_ic3r
L_pg20k:
 v_exp_f32 v235, v235
 v_mfma_f32_16x16x32_bf16 v[128:131], a[168:171], a[96:99], v[128:131]
 s_waitcnt lgkmcnt(4)
 v_add_f32 v234, 1.0, v234
 v_add_f32 v235, 1.0, v235
 v_mfma_f32_16x16x32_bf16 v[112:115], a[176:179], a[192:195], v[112:115]
 ds_read_b64_tr_b16 a[160:161], v9 offset:16896
 v_mul_f32 v12, s86, v45
 v_mfma_f32_16x16x32_bf16 v[112:115], a[180:183], a[128:131], v[112:115]
 ds_read_b64_tr_b16 a[162:163], v9 offset:17152
 v_mfma_f32_16x16x32_bf16 v[116:119], a[180:183], a[132:135], v[116:119]
 v_rcp_f32 v234, v234
 v_mfma_f32_16x16x32_bf16 v[116:119], a[176:179], a[196:199], v[116:119]
 v_rcp_f32 v235, v235
 v_mfma_f32_16x16x32_bf16 v[120:123], a[176:179], a[200:203], v[120:123]
 ds_read_b64_tr_b16 a[164:165], v9 offset:25344
 v_mul_f32 v26, v234, v26
 v_mfma_f32_16x16x32_bf16 v[120:123], a[180:183], a[136:139], v[120:123]
 ds_read_b64_tr_b16 a[166:167], v9 offset:25600
 v_mul_f32 v27, v235, v27
 v_mfma_f32_16x16x32_bf16 v[124:127], a[180:183], a[140:143], v[124:127]
 v_exp_f32 v236, v236
 v_mfma_f32_16x16x32_bf16 v[124:127], a[176:179], a[204:207], v[124:127]
 s_waitcnt lgkmcnt(4)
 v_exp_f32 v237, v237
 v_mfma_f32_16x16x32_bf16 v[140:143], a[184:187], a[204:207], v[140:143]
 ds_read_b64_tr_b16 a[168:169], v9 offset:16928
 v_add_f32 v236, 1.0, v236
 v_mfma_f32_16x16x32_bf16 v[140:143], a[188:191], a[140:143], v[140:143]
 ds_read_b64_tr_b16 a[170:171], v9 offset:17184
 v_add_f32 v237, 1.0, v237
 v_mfma_f32_16x16x32_bf16 v[136:139], a[188:191], a[136:139], v[136:139]
 v_rcp_f32 v236, v236
 v_mfma_f32_16x16x32_bf16 v[136:139], a[184:187], a[200:203], v[136:139]
 v_rcp_f32 v237, v237
 v_mfma_f32_16x16x32_bf16 v[132:135], a[184:187], a[196:199], v[132:135]
 ds_read_b64_tr_b16 a[172:173], v9 offset:25376
 v_mul_f32 v28, v236, v28
 v_mfma_f32_16x16x32_bf16 v[132:135], a[188:191], a[132:135], v[132:135]
 ds_read_b64_tr_b16 a[174:175], v9 offset:25632
 v_mul_f32 v29, v237, v29
 v_mfma_f32_16x16x32_bf16 v[128:131], a[188:191], a[128:131], v[128:131]
 v_mul_f32 v236, s86, v30
 v_mul_f32 v237, s86, v31
 v_mfma_f32_16x16x32_bf16 v[128:131], a[184:187], a[192:195], v[128:131]
 s_waitcnt lgkmcnt(4)
 v_exp_f32 v236, v236
 v_mfma_f32_16x16x32_bf16 v[144:147], a[160:163], a[224:227], v[144:147]
 ds_read_b64_tr_b16 a[176:177], v9 offset:33792
 v_mfma_f32_16x16x32_bf16 v[144:147], a[164:167], a[16:19], v[144:147]
 ds_read_b64_tr_b16 a[178:179], v9 offset:34048
 v_mfma_f32_16x16x32_bf16 v[148:151], a[164:167], a[20:23], v[148:151]
 v_exp_f32 v237, v237
 v_mfma_f32_16x16x32_bf16 v[148:151], a[160:163], a[228:231], v[148:151]
 v_cvt_pk_bf16_f32 v112, v112, v113
 v_cvt_pk_bf16_f32 v113, v114, v115
 v_mfma_f32_16x16x32_bf16 v[152:155], a[160:163], a[232:235], v[152:155]
 ds_read_b64_tr_b16 a[180:181], v9 offset:42240
 v_min_u32 v112, -2, v112
 v_mfma_f32_16x16x32_bf16 v[152:155], a[164:167], a[24:27], v[152:155]
 ds_read_b64_tr_b16 a[182:183], v9 offset:42496
 v_cvt_pk_bf16_f32 v114, v128, v129
 v_mfma_f32_16x16x32_bf16 v[156:159], a[164:167], a[28:31], v[156:159]
 v_cvt_pk_bf16_f32 v115, v130, v131
 v_cvt_pk_bf16_f32 v116, v116, v117
 v_mfma_f32_16x16x32_bf16 v[156:159], a[160:163], a[236:239], v[156:159]
 buffer_store_dwordx4 v[112:115], v8, s[16:19], s38 offen offset:0 sc0 sc1
 s_waitcnt lgkmcnt(4)
 v_mfma_f32_16x16x32_bf16 v[172:175], a[168:171], a[236:239], v[172:175]
 ds_read_b64_tr_b16 a[184:185], v9 offset:33824
 v_cvt_pk_bf16_f32 v117, v118, v119
 v_mfma_f32_16x16x32_bf16 v[172:175], a[172:175], a[28:31], v[172:175]
 ds_read_b64_tr_b16 a[186:187], v9 offset:34080
 v_min_u32 v116, -2, v116
 v_mfma_f32_16x16x32_bf16 v[168:171], a[172:175], a[24:27], v[168:171]
 v_cvt_pk_bf16_f32 v118, v132, v133
 v_cvt_pk_bf16_f32 v119, v134, v135
 v_mfma_f32_16x16x32_bf16 v[168:171], a[168:171], a[232:235], v[168:171]
 buffer_store_dwordx4 v[116:119], v8, s[16:19], s38 offen offset:1024 sc0 sc1
 v_cvt_pk_bf16_f32 v120, v120, v121
 v_mfma_f32_16x16x32_bf16 v[164:167], a[168:171], a[228:231], v[164:167]
 ds_read_b64_tr_b16 a[188:189], v9 offset:42272
 v_cvt_pk_bf16_f32 v121, v122, v123
 v_mfma_f32_16x16x32_bf16 v[164:167], a[172:175], a[20:23], v[164:167]
 ds_read_b64_tr_b16 a[190:191], v9 offset:42528
 v_min_u32 v120, -2, v120
 v_mfma_f32_16x16x32_bf16 v[160:163], a[172:175], a[16:19], v[160:163]
 v_cvt_pk_bf16_f32 v122, v136, v137
 v_cvt_pk_bf16_f32 v123, v138, v139
 v_mfma_f32_16x16x32_bf16 v[160:163], a[168:171], a[224:227], v[160:163]
 buffer_store_dwordx4 v[120:123], v8, s[16:19], s38 offen offset:2048 sc0 sc1
 s_waitcnt lgkmcnt(4)
 v_mfma_f32_16x16x32_bf16 v[144:147], a[176:179], a[240:243], v[144:147]
 ds_read_b64_tr_b16 a[160:161], v9 offset:50688
 v_cvt_pk_bf16_f32 v124, v124, v125
 v_mfma_f32_16x16x32_bf16 v[144:147], a[180:183], a[32:35], v[144:147]
 ds_read_b64_tr_b16 a[162:163], v9 offset:50944
 v_cvt_pk_bf16_f32 v125, v126, v127
 v_mfma_f32_16x16x32_bf16 v[148:151], a[180:183], a[36:39], v[148:151]
 v_min_u32 v124, -2, v124
 v_cvt_pk_bf16_f32 v126, v140, v141
 v_mfma_f32_16x16x32_bf16 v[148:151], a[176:179], a[244:247], v[148:151]
 v_cvt_pk_bf16_f32 v127, v142, v143
 v_add_f32 v236, 1.0, v236
 v_mfma_f32_16x16x32_bf16 v[152:155], a[176:179], a[248:251], v[152:155]
 buffer_store_dwordx4 v[124:127], v8, s[16:19], s38 offen offset:3072 sc0 sc1
 ds_read_b64_tr_b16 a[164:165], v9 offset:59136
 v_mfma_f32_16x16x32_bf16 v[152:155], a[180:183], a[40:43], v[152:155]
 ds_read_b64_tr_b16 a[166:167], v9 offset:59392
 v_add_f32 v237, 1.0, v237
 v_mfma_f32_16x16x32_bf16 v[156:159], a[180:183], a[44:47], v[156:159]
 v_rcp_f32 v236, v236
 v_mfma_f32_16x16x32_bf16 v[156:159], a[176:179], a[252:255], v[156:159]
 s_waitcnt lgkmcnt(4)
 v_rcp_f32 v237, v237
 v_mfma_f32_16x16x32_bf16 v[172:175], a[184:187], a[252:255], v[172:175]
 ds_read_b64_tr_b16 a[168:169], v9 offset:50720
 v_mul_f32 v30, v236, v30
 v_mfma_f32_16x16x32_bf16 v[172:175], a[188:191], a[44:47], v[172:175]
 ds_read_b64_tr_b16 a[170:171], v9 offset:50976
 v_mul_f32 v31, v237, v31
 v_mfma_f32_16x16x32_bf16 v[168:171], a[188:191], a[40:43], v[168:171]
 buffer_load_dwordx4 v[96:99], v8, s[16:19], s5 offen offset:0 sc0 sc1
 v_mfma_f32_16x16x32_bf16 v[168:171], a[184:187], a[248:251], v[168:171]
 buffer_load_dwordx4 v[100:103], v8, s[16:19], s5 offen offset:1024 sc0 sc1
 v_mfma_f32_16x16x32_bf16 v[164:167], a[184:187], a[244:247], v[164:167]
 buffer_load_dwordx4 v[104:107], v8, s[16:19], s5 offen offset:2048 sc0 sc1
 ds_read_b64_tr_b16 a[172:173], v9 offset:59168
 v_mfma_f32_16x16x32_bf16 v[164:167], a[188:191], a[36:39], v[164:167]
 buffer_load_dwordx4 v[108:111], v8, s[16:19], s5 offen offset:3072 sc0 sc1
 ds_read_b64_tr_b16 a[174:175], v9 offset:59424
 v_mfma_f32_16x16x32_bf16 v[160:163], a[188:191], a[32:35], v[160:163]
 v_exp_f32 v238, v238
 v_mfma_f32_16x16x32_bf16 v[160:163], a[184:187], a[240:243], v[160:163]
 s_waitcnt lgkmcnt(4)
 v_exp_f32 v239, v239
 v_mfma_f32_16x16x32_bf16 v[144:147], a[160:163], a[144:147], v[144:147]
 ds_read_b64_tr_b16 a[176:177], v10 offset:0
 v_add_f32 v238, 1.0, v238
 v_mfma_f32_16x16x32_bf16 v[144:147], a[164:167], a[48:51], v[144:147]
 ds_read_b64_tr_b16 a[178:179], v10 offset:256
 v_add_f32 v239, 1.0, v239
 v_mfma_f32_16x16x32_bf16 v[148:151], a[164:167], a[52:55], v[148:151]
 v_rcp_f32 v238, v238
 v_mfma_f32_16x16x32_bf16 v[148:151], a[160:163], a[148:151], v[148:151]
 v_rcp_f32 v239, v239
 v_mfma_f32_16x16x32_bf16 v[152:155], a[160:163], a[152:155], v[152:155]
 ds_read_b64_tr_b16 a[180:181], v10 offset:8448
 v_mul_f32 v32, v238, v32
 v_mfma_f32_16x16x32_bf16 v[152:155], a[164:167], a[56:59], v[152:155]
 ds_read_b64_tr_b16 a[182:183], v10 offset:8704
 v_mul_f32 v33, v239, v33
 v_mfma_f32_16x16x32_bf16 v[156:159], a[164:167], a[60:63], v[156:159]
 v_mul_f32 v238, s86, v34
 v_mul_f32 v239, s86, v35
 v_mfma_f32_16x16x32_bf16 v[156:159], a[160:163], a[156:159], v[156:159]
 s_waitcnt lgkmcnt(4)
 v_exp_f32 v238, v238
 v_mfma_f32_16x16x32_bf16 v[172:175], a[168:171], a[156:159], v[172:175]
 ds_read_b64_tr_b16 a[184:185], v10 offset:32
 v_mfma_f32_16x16x32_bf16 v[172:175], a[172:175], a[60:63], v[172:175]
 ds_read_b64_tr_b16 a[186:187], v10 offset:288
 v_mfma_f32_16x16x32_bf16 v[168:171], a[172:175], a[56:59], v[168:171]
 v_exp_f32 v239, v239
 v_mfma_f32_16x16x32_bf16 v[168:171], a[168:171], a[152:155], v[168:171]
 v_add_f32 v238, 1.0, v238
 v_add_f32 v239, 1.0, v239
 v_mfma_f32_16x16x32_bf16 v[164:167], a[168:171], a[148:151], v[164:167]
 ds_read_b64_tr_b16 a[188:189], v10 offset:8480
 v_mfma_f32_16x16x32_bf16 v[164:167], a[172:175], a[52:55], v[164:167]
 ds_read_b64_tr_b16 a[190:191], v10 offset:8736
 v_mfma_f32_16x16x32_bf16 v[160:163], a[172:175], a[48:51], v[160:163]
 v_rcp_f32 v238, v238
 v_mfma_f32_16x16x32_bf16 v[160:163], a[168:171], a[144:147], v[160:163]
 s_waitcnt lgkmcnt(4)
 v_rcp_f32 v239, v239
 v_mfma_f32_16x16x32_bf16 v[144:147], a[176:179], a[64:67], v[144:147]
 ds_read_b64_tr_b16 a[160:161], v10 offset:16896
 v_mul_f32 v34, v238, v34
 v_mfma_f32_16x16x32_bf16 v[144:147], a[180:183], a[80:83], v[144:147]
 ds_read_b64_tr_b16 a[162:163], v10 offset:17152
 v_mul_f32 v35, v239, v35
 v_mfma_f32_16x16x32_bf16 v[148:151], a[180:183], a[84:87], v[148:151]
 v_exp_f32 v241, v241
 v_mfma_f32_16x16x32_bf16 v[148:151], a[176:179], a[68:71], v[148:151]
 v_exp_f32 v242, v242
 v_mfma_f32_16x16x32_bf16 v[152:155], a[176:179], a[72:75], v[152:155]
 ds_read_b64_tr_b16 a[164:165], v10 offset:25344
 v_add_f32 v241, 1.0, v241
 v_mfma_f32_16x16x32_bf16 v[152:155], a[180:183], a[88:91], v[152:155]
 ds_read_b64_tr_b16 a[166:167], v10 offset:25600
 v_add_f32 v242, 1.0, v242
 v_mfma_f32_16x16x32_bf16 v[156:159], a[180:183], a[92:95], v[156:159]
 v_rcp_f32 v241, v241
 v_mfma_f32_16x16x32_bf16 v[156:159], a[176:179], a[76:79], v[156:159]
 s_waitcnt lgkmcnt(4)
 v_rcp_f32 v242, v242
 v_mfma_f32_16x16x32_bf16 v[172:175], a[184:187], a[76:79], v[172:175]
 buffer_load_dwordx4 v[128:131], v8, s[16:19], s6 offen offset:0 sc0 sc1
 ds_read_b64_tr_b16 a[168:169], v10 offset:16928
 v_mfma_f32_16x16x32_bf16 v[172:175], a[188:191], a[92:95], v[172:175]
 buffer_load_dwordx4 v[132:135], v8, s[16:19], s6 offen offset:1024 sc0 sc1
 ds_read_b64_tr_b16 a[170:171], v10 offset:17184
 v_mfma_f32_16x16x32_bf16 v[168:171], a[188:191], a[88:91], v[168:171]
 buffer_load_dwordx4 v[136:139], v8, s[16:19], s6 offen offset:2048 sc0 sc1
 v_mul_f32 v36, v241, v36
 v_mfma_f32_16x16x32_bf16 v[168:171], a[184:187], a[72:75], v[168:171]
 buffer_load_dwordx4 v[140:143], v8, s[16:19], s6 offen offset:3072 sc0 sc1
 v_mul_f32 v37, v242, v37
 v_mfma_f32_16x16x32_bf16 v[164:167], a[184:187], a[68:71], v[164:167]
 ds_read_b64_tr_b16 a[172:173], v10 offset:25376
 v_mul_f32 v241, s86, v38
 v_mfma_f32_16x16x32_bf16 v[164:167], a[188:191], a[84:87], v[164:167]
 ds_read_b64_tr_b16 a[174:175], v10 offset:25632
 v_mul_f32 v242, s86, v39
 v_mfma_f32_16x16x32_bf16 v[160:163], a[188:191], a[80:83], v[160:163]
 v_exp_f32 v241, v241
 v_mfma_f32_16x16x32_bf16 v[160:163], a[184:187], a[64:67], v[160:163]
 s_waitcnt lgkmcnt(4)
 v_exp_f32 v242, v242
 v_mfma_f32_16x16x32_bf16 v[144:147], a[160:163], a[96:99], v[144:147]
 ds_read_b64_tr_b16 a[176:177], v10 offset:33792
 v_add_f32 v241, 1.0, v241
 v_mfma_f32_16x16x32_bf16 v[144:147], a[164:167], a[112:115], v[144:147]
 ds_read_b64_tr_b16 a[178:179], v10 offset:34048
 v_add_f32 v242, 1.0, v242
 v_mfma_f32_16x16x32_bf16 v[148:151], a[164:167], a[116:119], v[148:151]
 v_rcp_f32 v241, v241
 v_mfma_f32_16x16x32_bf16 v[148:151], a[160:163], a[100:103], v[148:151]
 v_rcp_f32 v242, v242
 v_mfma_f32_16x16x32_bf16 v[152:155], a[160:163], a[104:107], v[152:155]
 ds_read_b64_tr_b16 a[180:181], v10 offset:42240
 v_mul_f32 v38, v241, v38
 v_mfma_f32_16x16x32_bf16 v[152:155], a[164:167], a[120:123], v[152:155]
 ds_read_b64_tr_b16 a[182:183], v10 offset:42496
 v_mul_f32 v39, v242, v39
 v_mfma_f32_16x16x32_bf16 v[156:159], a[164:167], a[124:127], v[156:159]
 v_exp_f32 v243, v243
 v_mfma_f32_16x16x32_bf16 v[156:159], a[160:163], a[108:111], v[156:159]
 s_waitcnt lgkmcnt(4)
 v_exp_f32 v249, v249
 v_mfma_f32_16x16x32_bf16 v[172:175], a[168:171], a[108:111], v[172:175]
 ds_read_b64_tr_b16 a[184:185], v10 offset:33824
 v_add_f32 v243, 1.0, v243
 v_mfma_f32_16x16x32_bf16 v[172:175], a[172:175], a[124:127], v[172:175]
 ds_read_b64_tr_b16 a[186:187], v10 offset:34080
 v_add_f32 v249, 1.0, v249
 v_mfma_f32_16x16x32_bf16 v[168:171], a[172:175], a[120:123], v[168:171]
 v_rcp_f32 v243, v243
 v_mfma_f32_16x16x32_bf16 v[168:171], a[168:171], a[104:107], v[168:171]
 v_rcp_f32 v249, v249
 v_mfma_f32_16x16x32_bf16 v[164:167], a[168:171], a[100:103], v[164:167]
 ds_read_b64_tr_b16 a[188:189], v10 offset:42272
 v_mul_f32 v40, v243, v40
 v_mfma_f32_16x16x32_bf16 v[164:167], a[172:175], a[116:119], v[164:167]
 ds_read_b64_tr_b16 a[190:191], v10 offset:42528
 v_mul_f32 v41, v249, v41
 v_mfma_f32_16x16x32_bf16 v[160:163], a[172:175], a[112:115], v[160:163]
 v_mul_f32 v243, s86, v42
 v_mul_f32 v249, s86, v43
 v_mfma_f32_16x16x32_bf16 v[160:163], a[168:171], a[96:99], v[160:163]
 s_waitcnt lgkmcnt(4)
 v_exp_f32 v243, v243
 v_mfma_f32_16x16x32_bf16 v[144:147], a[176:179], a[192:195], v[144:147]
 v_exp_f32 v249, v249
 v_mfma_f32_16x16x32_bf16 v[144:147], a[180:183], a[128:131], v[144:147]
 v_add_f32 v243, 1.0, v243
 v_add_f32 v249, 1.0, v249
 v_mfma_f32_16x16x32_bf16 v[148:151], a[180:183], a[132:135], v[148:151]
 v_rcp_f32 v243, v243
 v_mfma_f32_16x16x32_bf16 v[148:151], a[176:179], a[196:199], v[148:151]
 v_rcp_f32 v249, v249
 v_mfma_f32_16x16x32_bf16 v[152:155], a[176:179], a[200:203], v[152:155]
 v_mul_f32 v42, v243, v42
 v_mul_f32 v43, v249, v43
 v_mfma_f32_16x16x32_bf16 v[152:155], a[180:183], a[136:139], v[152:155]
 v_exp_f32 v11, v11
 v_mfma_f32_16x16x32_bf16 v[156:159], a[180:183], a[140:143], v[156:159]
 v_exp_f32 v12, v12
 v_mfma_f32_16x16x32_bf16 v[156:159], a[176:179], a[204:207], v[156:159]
 s_waitcnt lgkmcnt(0)
 v_add_f32 v11, 1.0, v11
 v_add_f32 v12, 1.0, v12
 v_mfma_f32_16x16x32_bf16 v[172:175], a[184:187], a[204:207], v[172:175]
 v_rcp_f32 v11, v11
 v_mfma_f32_16x16x32_bf16 v[172:175], a[188:191], a[140:143], v[172:175]
 v_rcp_f32 v12, v12
 v_mfma_f32_16x16x32_bf16 v[168:171], a[188:191], a[136:139], v[168:171]
 v_mul_f32 v44, v11, v44
 v_mul_f32 v45, v12, v45
 v_mfma_f32_16x16x32_bf16 v[168:171], a[184:187], a[200:203], v[168:171]
 v_mul_f32 v11, s86, v46
 v_mul_f32 v12, s86, v47
 v_mfma_f32_16x16x32_bf16 v[164:167], a[184:187], a[196:199], v[164:167]
 v_exp_f32 v11, v11
 v_mfma_f32_16x16x32_bf16 v[164:167], a[188:191], a[132:135], v[164:167]
 v_exp_f32 v12, v12
 v_mfma_f32_16x16x32_bf16 v[160:163], a[188:191], a[128:131], v[160:163]
 v_add_f32 v11, 1.0, v11
 v_add_f32 v12, 1.0, v12
 v_mfma_f32_16x16x32_bf16 v[160:163], a[184:187], a[192:195], v[160:163]
 v_rcp_f32 v11, v11
 v_rcp_f32 v12, v12
 v_mul_f32 v46, v11, v46
 v_mul_f32 v47, v12, v47
L_last:
 s_waitcnt vmcnt(0) lgkmcnt(0)
 v_max3_u32 v230, v64, v68, v72
 v_max3_u32 v230, v230, v76, v96
 v_max3_u32 v230, v230, v100, v104
 v_max3_u32 v230, v230, v108, v128
 v_max3_u32 v230, v230, v132, v136
 v_max_u32 v230, v230, v140
 v_cmp_eq_u32 vcc, -1, v230
 s_nop 4
 s_cbranch_vccnz L_slow
 v_mfma_f32_16x16x32_bf16 v[144:147], v[226:229], v[64:67], v[144:147]
 v_accvgpr_read_b32 v208, a0
 v_accvgpr_read_b32 v209, a1
 v_mfma_f32_16x16x32_bf16 v[160:163], v[224:227], v[64:67], v[160:163]
 v_accvgpr_read_b32 v210, a2
 v_accvgpr_read_b32 v211, a3
 v_mfma_f32_16x16x32_bf16 v[148:151], v[226:229], v[68:71], v[148:151]
 v_accvgpr_read_b32 v212, a4
 v_accvgpr_read_b32 v213, a5
 v_mfma_f32_16x16x32_bf16 v[164:167], v[224:227], v[68:71], v[164:167]
 v_accvgpr_read_b32 v214, a6
 v_accvgpr_read_b32 v215, a7
 v_mfma_f32_16x16x32_bf16 v[152:155], v[226:229], v[72:75], v[152:155]
 v_accvgpr_read_b32 v216, a8
 v_accvgpr_read_b32 v217, a9
 v_mfma_f32_16x16x32_bf16 v[168:171], v[224:227], v[72:75], v[168:171]
 v_accvgpr_read_b32 v218, a10
 v_accvgpr_read_b32 v219, a11
 v_mfma_f32_16x16x32_bf16 v[156:159], v[226:229], v[76:79], v[156:159]
 v_accvgpr_read_b32 v220, a12
 v_accvgpr_read_b32 v221, a13
 v_mfma_f32_16x16x32_bf16 v[172:175], v[224:227], v[76:79], v[172:175]
 v_accvgpr_read_b32 v222, a14
 v_accvgpr_read_b32 v223, a15
 v_mfma_f32_16x16x32_bf16 v[144:147], v[226:229], v[96:99], v[144:147]
 v_lshlrev_b32 v176, 16, v208
 v_and_b32 v177, 0xffff0000, v208
 v_mfma_f32_16x16x32_bf16 v[160:163], v[224:227], v[96:99], v[160:163]
 v_lshlrev_b32 v178, 16, v209
 v_and_b32 v179, 0xffff0000, v209
 v_mfma_f32_16x16x32_bf16 v[148:151], v[226:229], v[100:103], v[148:151]
 v_lshlrev_b32 v180, 16, v210
 v_and_b32 v181, 0xffff0000, v210
 v_mfma_f32_16x16x32_bf16 v[164:167], v[224:227], v[100:103], v[164:167]
 v_lshlrev_b32 v182, 16, v211
 v_and_b32 v183, 0xffff0000, v211
 v_mfma_f32_16x16x32_bf16 v[152:155], v[226:229], v[104:107], v[152:155]
 v_lshlrev_b32 v184, 16, v212
 v_and_b32 v185, 0xffff0000, v212
 v_mfma_f32_16x16x32_bf16 v[168:171], v[224:227], v[104:107], v[168:171]
 v_lshlrev_b32 v186, 16, v213
 v_and_b32 v187, 0xffff0000, v213
 v_mfma_f32_16x16x32_bf16 v[156:159], v[226:229], v[108:111], v[156:159]
 v_lshlrev_b32 v188, 16, v214
 v_and_b32 v189, 0xffff0000, v214
 v_mfma_f32_16x16x32_bf16 v[172:175], v[224:227], v[108:111], v[172:175]
 v_lshlrev_b32 v190, 16, v215
 v_and_b32 v191, 0xffff0000, v215
 v_mfma_f32_16x16x32_bf16 v[144:147], v[226:229], v[128:131], v[144:147]
 v_lshlrev_b32 v192, 16, v216
 v_and_b32 v193, 0xffff0000, v216
 v_mfma_f32_16x16x32_bf16 v[160:163], v[224:227], v[128:131], v[160:163]
 v_lshlrev_b32 v194, 16, v217
 v_and_b32 v195, 0xffff0000, v217
 v_mfma_f32_16x16x32_bf16 v[148:151], v[226:229], v[132:135], v[148:151]
 v_lshlrev_b32 v196, 16, v218
 v_and_b32 v197, 0xffff0000, v218
 v_mfma_f32_16x16x32_bf16 v[164:167], v[224:227], v[132:135], v[164:167]
 v_lshlrev_b32 v198, 16, v219
 v_and_b32 v199, 0xffff0000, v219
 v_mfma_f32_16x16x32_bf16 v[152:155], v[226:229], v[136:139], v[152:155]
 v_lshlrev_b32 v200, 16, v220
 v_and_b32 v201, 0xffff0000, v220
 v_mfma_f32_16x16x32_bf16 v[168:171], v[224:227], v[136:139], v[168:171]
 v_lshlrev_b32 v202, 16, v221
 v_and_b32 v203, 0xffff0000, v221
 v_mfma_f32_16x16x32_bf16 v[156:159], v[226:229], v[140:143], v[156:159]
 v_lshlrev_b32 v204, 16, v222
 v_and_b32 v205, 0xffff0000, v222
 v_mfma_f32_16x16x32_bf16 v[172:175], v[224:227], v[140:143], v[172:175]
 v_lshlrev_b32 v206, 16, v223
 v_and_b32 v207, 0xffff0000, v223
L_fin:
 s_nop 0
 v_pk_fma_f32 v[144:145], v[144:145], v[16:17], v[176:177]
 v_pk_fma_f32 v[146:147], v[146:147], v[18:19], v[178:179]
 v_pk_fma_f32 v[160:161], v[160:161], v[32:33], v[180:181]
 v_pk_fma_f32 v[162:163], v[162:163], v[34:35], v[182:183]
 v_cvt_pk_bf16_f32 v208, v144, v145
 v_cvt_pk_bf16_f32 v209, v146, v147
 v_cvt_pk_bf16_f32 v210, v160, v161
 v_cvt_pk_bf16_f32 v211, v162, v163
 ds_write_b64 v250, v[208:209] offset:0
 ds_write_b64 v251, v[210:211] offset:0
 ds_read_b128 v[176:179], v14 offset:0
 v_pk_fma_f32 v[148:149], v[148:149], v[20:21], v[184:185]
 v_pk_fma_f32 v[150:151], v[150:151], v[22:23], v[186:187]
 v_pk_fma_f32 v[164:165], v[164:165], v[36:37], v[188:189]
 v_pk_fma_f32 v[166:167], v[166:167], v[38:39], v[190:191]
 v_cvt_pk_bf16_f32 v212, v148, v149
 v_cvt_pk_bf16_f32 v213, v150, v151
 v_cvt_pk_bf16_f32 v214, v164, v165
 v_cvt_pk_bf16_f32 v215, v166, v167
 ds_write_b64 v250, v[212:213] offset:1024
 ds_write_b64 v251, v[214:215] offset:1024
 ds_read_b128 v[184:187], v14 offset:1024
 v_pk_fma_f32 v[152:153], v[152:153], v[24:25], v[192:193]
 v_pk_fma_f32 v[154:155], v[154:155], v[26:27], v[194:195]
 v_pk_fma_f32 v[168:169], v[168:169], v[40:41], v[196:197]
 v_pk_fma_f32 v[170:171], v[170:171], v[42:43], v[198:199]
 v_cvt_pk_bf16_f32 v216, v152, v153
 v_cvt_pk_bf16_f32 v217, v154, v155
 v_cvt_pk_bf16_f32 v218, v168, v169
 v_cvt_pk_bf16_f32 v219, v170, v171
 ds_write_b64 v250, v[216:217] offset:2048
 ds_write_b64 v251, v[218:219] offset:2048
 ds_read_b128 v[192:195], v14 offset:2048
 s_waitcnt lgkmcnt(6)
 s_nop 0
 buffer_store_dwordx4 v[176:179], v253, s[32:35], s11 offen offset:0 sc1
 v_pk_fma_f32 v[156:157], v[156:157], v[28:29], v[200:201]
 v_pk_fma_f32 v[158:159], v[158:159], v[30:31], v[202:203]
 v_pk_fma_f32 v[172:173], v[172:173], v[44:45], v[204:205]
 v_pk_fma_f32 v[174:175], v[174:175], v[46:47], v[206:207]
 v_cvt_pk_bf16_f32 v220, v156, v157
 v_cvt_pk_bf16_f32 v221, v158, v159
 v_cvt_pk_bf16_f32 v222, v172, v173
 v_cvt_pk_bf16_f32 v223, v174, v175
 ds_write_b64 v250, v[220:221] offset:3072
 ds_write_b64 v251, v[222:223] offset:3072
 ds_read_b128 v[200:203], v14 offset:3072
 s_waitcnt lgkmcnt(6)
 buffer_store_dwordx4 v[184:187], v253, s[32:35], s12 offen offset:0 sc1
 s_waitcnt lgkmcnt(3)
 buffer_store_dwordx4 v[192:195], v253, s[32:35], s13 offen offset:0 sc1
 s_waitcnt lgkmcnt(0)
 buffer_store_dwordx4 v[200:203], v253, s[32:35], s14 offen offset:0 sc1
L_end:
 s_endpgm
L_slow:
 s_mov_b32 s7, 15
 s_mov_b32 s91, 0
L_sl:
 v_max3_u32 v230, v64, v68, v72
 v_max3_u32 v231, v96, v100, v104
 v_max3_u32 v232, v128, v132, v136
 v_max_u32 v230, v230, v76
 v_max_u32 v231, v231, v108
 v_max_u32 v232, v232, v140
 v_cmp_eq_u32 s[72:73], -1, v230
 v_cmp_eq_u32 s[74:75], -1, v231
 v_cmp_eq_u32 s[76:77], -1, v232
 s_add_u32 s91, s91, 1
 s_cmp_lt_u32 s91, 0x40000
 s_cselect_b64 s[78:79], -1, 0
 s_nop 1
 s_and_b64 s[76:77], s[76:77], s[78:79]
 s_cbranch_scc0 L_sn2
 buffer_load_dwordx4 v[128:131], v8, s[16:19], s6 offen offset:0 sc0 sc1
 buffer_load_dwordx4 v[132:135], v8, s[16:19], s6 offen offset:1024 sc0 sc1
 buffer_load_dwordx4 v[136:139], v8, s[16:19], s6 offen offset:2048 sc0 sc1
 buffer_load_dwordx4 v[140:143], v8, s[16:19], s6 offen offset:3072 sc0 sc1
L_sn2:
 s_and_b64 s[74:75], s[74:75], s[78:79]
 s_cbranch_scc0 L_sn1
 buffer_load_dwordx4 v[96:99], v8, s[16:19], s5 offen offset:0 sc0 sc1
 buffer_load_dwordx4 v[100:103], v8, s[16:19], s5 offen offset:1024 sc0 sc1
 buffer_load_dwordx4 v[104:107], v8, s[16:19], s5 offen offset:2048 sc0 sc1
 buffer_load_dwordx4 v[108:111], v8, s[16:19], s5 offen offset:3072 sc0 sc1
L_sn1:
 s_and_b64 s[72:73], s[72:73], s[78:79]
 s_cbranch_scc0 L_sn0
 buffer_load_dwordx4 v[64:67], v8, s[16:19], s4 offen offset:0 sc0 sc1
 buffer_load_dwordx4 v[68:71], v8, s[16:19], s4 offen offset:1024 sc0 sc1
 buffer_load_dwordx4 v[72:75], v8, s[16:19], s4 offen offset:2048 sc0 sc1
 buffer_load_dwordx4 v[76:79], v8, s[16:19], s4 offen offset:3072 sc0 sc1
L_sn0:
 s_bitcmp0_b32 s7, 0
 s_cbranch_scc1 L_su
 s_bitset0_b32 s7, 0
 s_nop 0
 v_accvgpr_read_b32 v208, a0
 v_accvgpr_read_b32 v209, a1
 v_accvgpr_read_b32 v210, a2
 v_accvgpr_read_b32 v211, a3
 v_accvgpr_read_b32 v212, a4
 v_accvgpr_read_b32 v213, a5
 v_accvgpr_read_b32 v214, a6
 v_accvgpr_read_b32 v215, a7
 v_accvgpr_read_b32 v216, a8
 v_accvgpr_read_b32 v217, a9
 v_accvgpr_read_b32 v218, a10
 v_accvgpr_read_b32 v219, a11
 v_accvgpr_read_b32 v220, a12
 v_accvgpr_read_b32 v221, a13
 v_accvgpr_read_b32 v222, a14
 v_accvgpr_read_b32 v223, a15
 v_lshlrev_b32 v176, 16, v208
 v_and_b32 v177, 0xffff0000, v208
 v_lshlrev_b32 v178, 16, v209
 v_and_b32 v179, 0xffff0000, v209
 v_lshlrev_b32 v180, 16, v210
 v_and_b32 v181, 0xffff0000, v210
 v_lshlrev_b32 v182, 16, v211
 v_and_b32 v183, 0xffff0000, v211
 v_lshlrev_b32 v184, 16, v212
 v_and_b32 v185, 0xffff0000, v212
 v_lshlrev_b32 v186, 16, v213
 v_and_b32 v187, 0xffff0000, v213
 v_lshlrev_b32 v188, 16, v214
 v_and_b32 v189, 0xffff0000, v214
 v_lshlrev_b32 v190, 16, v215
 v_and_b32 v191, 0xffff0000, v215
 v_lshlrev_b32 v192, 16, v216
 v_and_b32 v193, 0xffff0000, v216
 v_lshlrev_b32 v194, 16, v217
 v_and_b32 v195, 0xffff0000, v217
 v_lshlrev_b32 v196, 16, v218
 v_and_b32 v197, 0xffff0000, v218
 v_lshlrev_b32 v198, 16, v219
 v_and_b32 v199, 0xffff0000, v219
 v_lshlrev_b32 v200, 16, v220
 v_and_b32 v201, 0xffff0000, v220
 v_lshlrev_b32 v202, 16, v221
 v_and_b32 v203, 0xffff0000, v221
 v_lshlrev_b32 v204, 16, v222
 v_and_b32 v205, 0xffff0000, v222
 v_lshlrev_b32 v206, 16, v223
 v_and_b32 v207, 0xffff0000, v223
L_su:
 s_bitcmp0_b32 s7, 1
 s_cbranch_scc1 L_sa0
 s_cmp_lg_u64 s[72:73], 0
 s_cbranch_scc1 L_sa2
 s_bitset0_b32 s7, 1
 v_mfma_f32_16x16x32_bf16 v[144:147], v[226:229], v[64:67], v[144:147]
 v_mfma_f32_16x16x32_bf16 v[160:163], v[224:227], v[64:67], v[160:163]
 v_mfma_f32_16x16x32_bf16 v[148:151], v[226:229], v[68:71], v[148:151]
 v_mfma_f32_16x16x32_bf16 v[164:167], v[224:227], v[68:71], v[164:167]
 v_mfma_f32_16x16x32_bf16 v[152:155], v[226:229], v[72:75], v[152:155]
 v_mfma_f32_16x16x32_bf16 v[168:171], v[224:227], v[72:75], v[168:171]
 v_mfma_f32_16x16x32_bf16 v[156:159], v[226:229], v[76:79], v[156:159]
 v_mfma_f32_16x16x32_bf16 v[172:175], v[224:227], v[76:79], v[172:175]
L_sa0:
 s_bitcmp0_b32 s7, 2
 s_cbranch_scc1 L_sa1
 s_cmp_lg_u64 s[74:75], 0
 s_cbranch_scc1 L_sa2
 s_bitset0_b32 s7, 2
 v_mfma_f32_16x16x32_bf16 v[144:147], v[226:229], v[96:99], v[144:147]
 v_mfma_f32_16x16x32_bf16 v[160:163], v[224:227], v[96:99], v[160:163]
 v_mfma_f32_16x16x32_bf16 v[148:151], v[226:229], v[100:103], v[148:151]
 v_mfma_f32_16x16x32_bf16 v[164:167], v[224:227], v[100:103], v[164:167]
 v_mfma_f32_16x16x32_bf16 v[152:155], v[226:229], v[104:107], v[152:155]
 v_mfma_f32_16x16x32_bf16 v[168:171], v[224:227], v[104:107], v[168:171]
 v_mfma_f32_16x16x32_bf16 v[156:159], v[226:229], v[108:111], v[156:159]
 v_mfma_f32_16x16x32_bf16 v[172:175], v[224:227], v[108:111], v[172:175]
L_sa1:
 s_bitcmp0_b32 s7, 3
 s_cbranch_scc1 L_sa2
 s_cmp_lg_u64 s[76:77], 0
 s_cbranch_scc1 L_sa2
 s_bitset0_b32 s7, 3
 v_mfma_f32_16x16x32_bf16 v[144:147], v[226:229], v[128:131], v[144:147]
 v_mfma_f32_16x16x32_bf16 v[160:163], v[224:227], v[128:131], v[160:163]
 v_mfma_f32_16x16x32_bf16 v[148:151], v[226:229], v[132:135], v[148:151]
 v_mfma_f32_16x16x32_bf16 v[164:167], v[224:227], v[132:135], v[164:167]
 v_mfma_f32_16x16x32_bf16 v[152:155], v[226:229], v[136:139], v[152:155]
 v_mfma_f32_16x16x32_bf16 v[168:171], v[224:227], v[136:139], v[168:171]
 v_mfma_f32_16x16x32_bf16 v[156:159], v[226:229], v[140:143], v[156:159]
 v_mfma_f32_16x16x32_bf16 v[172:175], v[224:227], v[140:143], v[172:175]
L_sa2:
 s_cmp_eq_u32 s7, 0
 s_cbranch_scc1 L_fin
 s_waitcnt vmcnt(0)
 s_branch L_sl
L_chk_slow:
 s_mov_b32 s91, 0
L_chks_l:
 buffer_load_dword v2, v3, s[36:39], 0 offen sc0 sc1
 s_waitcnt vmcnt(0)
 v_cmp_ne_u32 vcc, s94, v2
 s_cbranch_vccz L_chks_d
 s_add_u32 s91, s91, 1
 s_cmp_ge_u32 s91, 0x40000
 s_cbranch_scc1 L_chks_d
 s_sleep 1
 s_branch L_chks_l
L_chks_d:
 s_branch L_chk_ret
L_xslow:
 v_accvgpr_write_b32 a212, v13
 v_accvgpr_write_b32 a213, v15
 s_mov_b32 s91, 0
 s_mov_b32 s5, 0x01010101
 s_lshl_b32 s6, s58, 3
 v_and_b32 v13, 1, v1
 v_lshlrev_b32 v13, 2, v13
 v_min_u32 v15, 1, v1
 v_lshlrev_b32 v15, 31, v15
 v_add_u32 v15, s2, v15
 v_mov_b32 v12, 1
L_xs_l:
 buffer_load_dword v11, v3, s[16:19], 0 offen sc0 sc1
 s_waitcnt vmcnt(0)
 v_cmp_eq_u32 vcc, v2, v11
 s_cbranch_vccz L_xs_x
 s_add_u32 s91, s91, 1
 s_and_b32 s7, s91, 31
 s_cmp_lg_u32 s7, 0
 s_cbranch_scc1 L_xs_n
 buffer_store_byte v12, v15, s[36:39], 0 offen sc0 sc1
 buffer_load_dword v11, v13, s[36:39], s6 offen sc0 sc1
 s_waitcnt vmcnt(0)
 v_and_b32 v11, s5, v11
 v_cmp_ne_u32 vcc, s5, v11
 s_cbranch_vccz L_xs_x
 s_cmp_ge_u32 s91, 0x40000
 s_cbranch_scc1 L_xs_x
L_xs_n:
 s_sleep 1
 s_branch L_xs_l
L_xs_x:
 v_accvgpr_read_b32 v13, a212
 v_accvgpr_read_b32 v15, a213
 s_branch L_xok
L_tr0:
 s_call_b64 s[92:93], L_rare0
 s_branch L_ret0
L_tr1:
 s_call_b64 s[92:93], L_rare1
 s_branch L_ret1
L_tr2:
 s_call_b64 s[92:93], L_rare0
 s_branch L_ret2
L_tr3:
 s_call_b64 s[92:93], L_rare1
 s_branch L_ret3
L_tr4:
 s_call_b64 s[92:93], L_rare0
 s_branch L_ret4
L_tr5:
 s_call_b64 s[92:93], L_rare1
 s_branch L_ret5
L_tr6:
 s_call_b64 s[92:93], L_rare0
 s_branch L_ret6
L_tr7:
 s_call_b64 s[92:93], L_rare1
 s_branch L_ret7
L_tr8:
 s_call_b64 s[92:93], L_rare0
 s_branch L_ret8
L_tr9:
 s_call_b64 s[92:93], L_rare1
 s_branch L_ret9
L_tr10:
 s_call_b64 s[92:93], L_rare0
 s_branch L_ret10
L_tr11:
 s_call_b64 s[92:93], L_rare1
 s_branch L_ret11
L_tr12:
 s_call_b64 s[92:93], L_rare0
 s_branch L_ret12
L_tr13:
 s_call_b64 s[92:93], L_rare1
 s_branch L_ret13
L_tr14:
 s_call_b64 s[92:93], L_rare0
 s_branch L_ret14
L_tr15:
 s_call_b64 s[92:93], L_rare1
 s_branch L_ret15
L_tr16:
 s_call_b64 s[92:93], L_rare0
 s_branch L_ret16
L_tr17:
 s_call_b64 s[92:93], L_rare1
 s_branch L_ret17
L_tr18:
 s_call_b64 s[92:93], L_rare0
 s_branch L_ret18
L_tr19:
 s_call_b64 s[92:93], L_rare1
 s_branch L_ret19
L_tr20:
 s_call_b64 s[92:93], L_rare0
 s_branch L_ret20
L_tr21:
 s_call_b64 s[92:93], L_rare1
 s_branch L_ret21
L_tr22:
 s_call_b64 s[92:93], L_rare0
 s_branch L_ret22
L_tr23:
 s_call_b64 s[92:93], L_rare1
 s_branch L_ret23
L_tr24:
 s_call_b64 s[92:93], L_rare0
 s_branch L_ret24
L_tr25:
 s_call_b64 s[92:93], L_rare1
 s_branch L_ret25
L_tr26:
 s_call_b64 s[92:93], L_rare0
 s_branch L_ret26
L_tr27:
 s_call_b64 s[92:93], L_rare1
 s_branch L_ret27
L_tr28:
 s_call_b64 s[92:93], L_rare0
 s_branch L_ret28
L_tr29:
 s_call_b64 s[92:93], L_rare1
 s_branch L_ret29
L_hslow:
 s_add_u32 s7, s9, 65536
 s_mov_b32 s91, 0
L_hs_l:
 buffer_load_dword v15, v14, s[16:19], s7 offen sc0 sc1
 s_waitcnt vmcnt(0)
 v_cmp_ne_u32 vcc, 1, v15
 s_cbranch_vccz L_hs_d
 s_add_u32 s91, s91, 1
 s_cmp_ge_u32 s91, 0x40000
 s_cbranch_scc1 L_hs_d
 s_sleep 1
 s_branch L_hs_l
L_hs_d:
 s_branch L_hok
L_oslow:
 s_mov_b32 s91, 0
L_os_l:
 buffer_load_dword v15, v14, s[16:19], s9 offen sc0 sc1
 s_waitcnt vmcnt(0)
 v_cmp_ne_u32 vcc, 1, v15
 s_cbranch_vccz L_os_d
 s_add_u32 s91, s91, 1
 s_cmp_ge_u32 s91, 0x40000
 s_cbranch_scc1 L_os_d
 s_sleep 1
 s_branch L_os_l
L_os_d:
 s_branch L_ook
L_gslow:
 s_mov_b32 s91, 0
L_gs_l:
 buffer_load_dword v15, v255, s[16:19], s10 offen offset:0 sc0 sc1
 s_waitcnt vmcnt(0)
 v_cmp_ne_u32 vcc, 1, v15
 s_cbranch_vccz L_gs_d
 s_add_u32 s91, s91, 1
 s_cmp_ge_u32 s91, 0x40000
 s_cbranch_scc1 L_gs_d
 s_sleep 1
 s_branch L_gs_l
L_gs_d:
 s_branch L_gok
L_rare0:
 s_nop 15
 s_nop 15
 v_max3_f32 v105, v16, v17, v18
 v_max3_f32 v105, v105, v19, v20
 v_max3_f32 v105, v105, v21, v22
 v_max3_f32 v105, v105, v23, 0
 v_max3_f32 v106, v28, v29, v30
 v_max3_f32 v106, v106, v31, v24
 v_max3_f32 v106, v106, v25, v26
 v_max3_f32 v106, v106, v27, 0
 s_nop 1
 v_permlane32_swap_b32 v105, v106
 s_nop 1
 v_max_f32 v105, v105, v106
 v_mov_b32 v106, v105
 s_nop 1
 v_permlane16_swap_b32 v105, v106
 s_nop 1
 v_max_f32 v105, v105, v106
 v_mov_b32 v106, v105
 s_nop 1
 v_permlane32_swap_b32 v105, v106
 s_nop 1
 v_exp_f32 v109, -v105
 s_nop 0
 v_mul_f32 v120, v120, v109
 v_accvgpr_read_b32 v96, a0
 s_nop 0
 v_mul_f32 v96, v96, v109
 s_nop 0
 v_accvgpr_write_b32 a0, v96
 v_accvgpr_read_b32 v96, a1
 s_nop 0
 v_mul_f32 v96, v96, v109
 s_nop 0
 v_accvgpr_write_b32 a1, v96
 v_accvgpr_read_b32 v96, a2
 s_nop 0
 v_mul_f32 v96, v96, v109
 s_nop 0
 v_accvgpr_write_b32 a2, v96
 v_accvgpr_read_b32 v96, a3
 s_nop 0
 v_mul_f32 v96, v96, v109
 s_nop 0
 v_accvgpr_write_b32 a3, v96
 v_accvgpr_read_b32 v96, a4
 s_nop 0
 v_mul_f32 v96, v96, v109
 s_nop 0
 v_accvgpr_write_b32 a4, v96
 v_accvgpr_read_b32 v96, a5
 s_nop 0
 v_mul_f32 v96, v96, v109
 s_nop 0
 v_accvgpr_write_b32 a5, v96
 v_accvgpr_read_b32 v96, a6
 s_nop 0
 v_mul_f32 v96, v96, v109
 s_nop 0
 v_accvgpr_write_b32 a6, v96
 v_accvgpr_read_b32 v96, a7
 s_nop 0
 v_mul_f32 v96, v96, v109
 s_nop 0
 v_accvgpr_write_b32 a7, v96
 v_accvgpr_read_b32 v96, a8
 s_nop 0
 v_mul_f32 v96, v96, v109
 s_nop 0
 v_accvgpr_write_b32 a8, v96
 v_accvgpr_read_b32 v96, a9
 s_nop 0
 v_mul_f32 v96, v96, v109
 s_nop 0
 v_accvgpr_write_b32 a9, v96
 v_accvgpr_read_b32 v96, a10
 s_nop 0
 v_mul_f32 v96, v96, v109
 s_nop 0
 v_accvgpr_write_b32 a10, v96
 v_accvgpr_read_b32 v96, a11
 s_nop 0
 v_mul_f32 v96, v96, v109
 s_nop 0
 v_accvgpr_write_b32 a11, v96
 v_accvgpr_read_b32 v96, a12
 s_nop 0
 v_mul_f32 v96, v96, v109
 s_nop 0
 v_accvgpr_write_b32 a12, v96
 v_accvgpr_read_b32 v96, a13
 s_nop 0
 v_mul_f32 v96, v96, v109
 s_nop 0
 v_accvgpr_write_b32 a13, v96
 v_accvgpr_read_b32 v96, a14
 s_nop 0
 v_mul_f32 v96, v96, v109
 s_nop 0
 v_accvgpr_write_b32 a14, v96
 v_accvgpr_read_b32 v96, a15
 s_nop 0
 v_mul_f32 v96, v96, v109
 s_nop 0
 v_accvgpr_write_b32 a15, v96
 v_accvgpr_read_b32 v96, a16
 s_nop 0
 v_mul_f32 v96, v96, v109
 s_nop 0
 v_accvgpr_write_b32 a16, v96
 v_accvgpr_read_b32 v96, a17
 s_nop 0
 v_mul_f32 v96, v96, v109
 s_nop 0
 v_accvgpr_write_b32 a17, v96
 v_accvgpr_read_b32 v96, a18
 s_nop 0
 v_mul_f32 v96, v96, v109
 s_nop 0
 v_accvgpr_write_b32 a18, v96
 v_accvgpr_read_b32 v96, a19
 s_nop 0
 v_mul_f32 v96, v96, v109
 s_nop 0
 v_accvgpr_write_b32 a19, v96
 v_accvgpr_read_b32 v96, a20
 s_nop 0
 v_mul_f32 v96, v96, v109
 s_nop 0
 v_accvgpr_write_b32 a20, v96
 v_accvgpr_read_b32 v96, a21
 s_nop 0
 v_mul_f32 v96, v96, v109
 s_nop 0
 v_accvgpr_write_b32 a21, v96
 v_accvgpr_read_b32 v96, a22
 s_nop 0
 v_mul_f32 v96, v96, v109
 s_nop 0
 v_accvgpr_write_b32 a22, v96
 v_accvgpr_read_b32 v96, a23
 s_nop 0
 v_mul_f32 v96, v96, v109
 s_nop 0
 v_accvgpr_write_b32 a23, v96
 v_accvgpr_read_b32 v96, a24
 s_nop 0
 v_mul_f32 v96, v96, v109
 s_nop 0
 v_accvgpr_write_b32 a24, v96
 v_accvgpr_read_b32 v96, a25
 s_nop 0
 v_mul_f32 v96, v96, v109
 s_nop 0
 v_accvgpr_write_b32 a25, v96
 v_accvgpr_read_b32 v96, a26
 s_nop 0
 v_mul_f32 v96, v96, v109
 s_nop 0
 v_accvgpr_write_b32 a26, v96
 v_accvgpr_read_b32 v96, a27
 s_nop 0
 v_mul_f32 v96, v96, v109
 s_nop 0
 v_accvgpr_write_b32 a27, v96
 v_accvgpr_read_b32 v96, a28
 s_nop 0
 v_mul_f32 v96, v96, v109
 s_nop 0
 v_accvgpr_write_b32 a28, v96
 v_accvgpr_read_b32 v96, a29
 s_nop 0
 v_mul_f32 v96, v96, v109
 s_nop 0
 v_accvgpr_write_b32 a29, v96
 v_accvgpr_read_b32 v96, a30
 s_nop 0
 v_mul_f32 v96, v96, v109
 s_nop 0
 v_accvgpr_write_b32 a30, v96
 v_accvgpr_read_b32 v96, a31
 s_nop 0
 v_mul_f32 v96, v96, v109
 s_nop 0
 v_accvgpr_write_b32 a31, v96
 v_sub_f32 v48, v48, v105
 v_sub_f32 v49, v49, v105
 v_sub_f32 v50, v50, v105
 v_sub_f32 v51, v51, v105
 v_sub_f32 v16, v16, v105
 v_sub_f32 v17, v17, v105
 v_sub_f32 v18, v18, v105
 v_sub_f32 v19, v19, v105
 v_sub_f32 v20, v20, v105
 v_sub_f32 v21, v21, v105
 v_sub_f32 v22, v22, v105
 v_sub_f32 v23, v23, v105
 v_exp_f32 v110, -v106
 s_nop 0
 v_mul_f32 v121, v121, v110
 v_accvgpr_read_b32 v96, a32
 s_nop 0
 v_mul_f32 v96, v96, v110
 s_nop 0
 v_accvgpr_write_b32 a32, v96
 v_accvgpr_read_b32 v96, a33
 s_nop 0
 v_mul_f32 v96, v96, v110
 s_nop 0
 v_accvgpr_write_b32 a33, v96
 v_accvgpr_read_b32 v96, a34
 s_nop 0
 v_mul_f32 v96, v96, v110
 s_nop 0
 v_accvgpr_write_b32 a34, v96
 v_accvgpr_read_b32 v96, a35
 s_nop 0
 v_mul_f32 v96, v96, v110
 s_nop 0
 v_accvgpr_write_b32 a35, v96
 v_accvgpr_read_b32 v96, a36
 s_nop 0
 v_mul_f32 v96, v96, v110
 s_nop 0
 v_accvgpr_write_b32 a36, v96
 v_accvgpr_read_b32 v96, a37
 s_nop 0
 v_mul_f32 v96, v96, v110
 s_nop 0
 v_accvgpr_write_b32 a37, v96
 v_accvgpr_read_b32 v96, a38
 s_nop 0
 v_mul_f32 v96, v96, v110
 s_nop 0
 v_accvgpr_write_b32 a38, v96
 v_accvgpr_read_b32 v96, a39
 s_nop 0
 v_mul_f32 v96, v96, v110
 s_nop 0
 v_accvgpr_write_b32 a39, v96
 v_accvgpr_read_b32 v96, a40
 s_nop 0
 v_mul_f32 v96, v96, v110
 s_nop 0
 v_accvgpr_write_b32 a40, v96
 v_accvgpr_read_b32 v96, a41
 s_nop 0
 v_mul_f32 v96, v96, v110
 s_nop 0
 v_accvgpr_write_b32 a41, v96
 v_accvgpr_read_b32 v96, a42
 s_nop 0
 v_mul_f32 v96, v96, v110
 s_nop 0
 v_accvgpr_write_b32 a42, v96
 v_accvgpr_read_b32 v96, a43
 s_nop 0
 v_mul_f32 v96, v96, v110
 s_nop 0
 v_accvgpr_write_b32 a43, v96
 v_accvgpr_read_b32 v96, a44
 s_nop 0
 v_mul_f32 v96, v96, v110
 s_nop 0
 v_accvgpr_write_b32 a44, v96
 v_accvgpr_read_b32 v96, a45
 s_nop 0
 v_mul_f32 v96, v96, v110
 s_nop 0
 v_accvgpr_write_b32 a45, v96
 v_accvgpr_read_b32 v96, a46
 s_nop 0
 v_mul_f32 v96, v96, v110
 s_nop 0
 v_accvgpr_write_b32 a46, v96
 v_accvgpr_read_b32 v96, a47
 s_nop 0
 v_mul_f32 v96, v96, v110
 s_nop 0
 v_accvgpr_write_b32 a47, v96
 v_accvgpr_read_b32 v96, a48
 s_nop 0
 v_mul_f32 v96, v96, v110
 s_nop 0
 v_accvgpr_write_b32 a48, v96
 v_accvgpr_read_b32 v96, a49
 s_nop 0
 v_mul_f32 v96, v96, v110
 s_nop 0
 v_accvgpr_write_b32 a49, v96
 v_accvgpr_read_b32 v96, a50
 s_nop 0
 v_mul_f32 v96, v96, v110
 s_nop 0
 v_accvgpr_write_b32 a50, v96
 v_accvgpr_read_b32 v96, a51
 s_nop 0
 v_mul_f32 v96, v96, v110
 s_nop 0
 v_accvgpr_write_b32 a51, v96
 v_accvgpr_read_b32 v96, a52
 s_nop 0
 v_mul_f32 v96, v96, v110
 s_nop 0
 v_accvgpr_write_b32 a52, v96
 v_accvgpr_read_b32 v96, a53
 s_nop 0
 v_mul_f32 v96, v96, v110
 s_nop 0
 v_accvgpr_write_b32 a53, v96
 v_accvgpr_read_b32 v96, a54
 s_nop 0
 v_mul_f32 v96, v96, v110
 s_nop 0
 v_accvgpr_write_b32 a54, v96
 v_accvgpr_read_b32 v96, a55
 s_nop 0
 v_mul_f32 v96, v96, v110
 s_nop 0
 v_accvgpr_write_b32 a55, v96
 v_accvgpr_read_b32 v96, a56
 s_nop 0
 v_mul_f32 v96, v96, v110
 s_nop 0
 v_accvgpr_write_b32 a56, v96
 v_accvgpr_read_b32 v96, a57
 s_nop 0
 v_mul_f32 v96, v96, v110
 s_nop 0
 v_accvgpr_write_b32 a57, v96
 v_accvgpr_read_b32 v96, a58
 s_nop 0
 v_mul_f32 v96, v96, v110
 s_nop 0
 v_accvgpr_write_b32 a58, v96
 v_accvgpr_read_b32 v96, a59
 s_nop 0
 v_mul_f32 v96, v96, v110
 s_nop 0
 v_accvgpr_write_b32 a59, v96
 v_accvgpr_read_b32 v96, a60
 s_nop 0
 v_mul_f32 v96, v96, v110
 s_nop 0
 v_accvgpr_write_b32 a60, v96
 v_accvgpr_read_b32 v96, a61
 s_nop 0
 v_mul_f32 v96, v96, v110
 s_nop 0
 v_accvgpr_write_b32 a61, v96
 v_accvgpr_read_b32 v96, a62
 s_nop 0
 v_mul_f32 v96, v96, v110
 s_nop 0
 v_accvgpr_write_b32 a62, v96
 v_accvgpr_read_b32 v96, a63
 s_nop 0
 v_mul_f32 v96, v96, v110
 s_nop 0
 v_accvgpr_write_b32 a63, v96
 v_sub_f32 v52, v52, v106
 v_sub_f32 v53, v53, v106
 v_sub_f32 v54, v54, v106
 v_sub_f32 v55, v55, v106
 v_sub_f32 v24, v24, v106
 v_sub_f32 v25, v25, v106
 v_sub_f32 v26, v26, v106
 v_sub_f32 v27, v27, v106
 v_sub_f32 v28, v28, v106
 v_sub_f32 v29, v29, v106
 v_sub_f32 v30, v30, v106
 v_sub_f32 v31, v31, v106
 v_exp_f32 v96, v16
 v_exp_f32 v97, v17
 v_exp_f32 v98, v18
 v_cvt_pk_bf16_f32 v80, v96, v97
 v_exp_f32 v99, v19
 v_exp_f32 v96, v20
 v_cvt_pk_bf16_f32 v81, v98, v99
 v_exp_f32 v97, v21
 v_exp_f32 v98, v22
 v_cvt_pk_bf16_f32 v82, v96, v97
 v_exp_f32 v99, v23
 v_exp_f32 v96, v28
 v_cvt_pk_bf16_f32 v83, v98, v99
 v_exp_f32 v97, v29
 v_exp_f32 v98, v30
 v_cvt_pk_bf16_f32 v86, v96, v97
 v_exp_f32 v99, v31
 v_exp_f32 v96, v24
 v_cvt_pk_bf16_f32 v87, v98, v99
 v_exp_f32 v97, v25
 v_exp_f32 v98, v26
 v_cvt_pk_bf16_f32 v84, v96, v97
 v_exp_f32 v99, v27
 s_nop 0
 v_cvt_pk_bf16_f32 v85, v98, v99
 s_nop 3
 v_mfma_f32_16x16x32_bf16 v[104:107], v[124:127], v[80:83], 0
 v_mfma_f32_16x16x32_bf16 v[108:111], v[124:127], v[84:87], 0
 s_nop 15
 s_setpc_b64 s[92:93]
L_rare1:
 s_nop 15
 s_nop 15
 v_max3_f32 v105, v32, v33, v34
 v_max3_f32 v105, v105, v35, v36
 v_max3_f32 v105, v105, v37, v38
 v_max3_f32 v105, v105, v39, 0
 v_max3_f32 v106, v44, v45, v46
 v_max3_f32 v106, v106, v47, v40
 v_max3_f32 v106, v106, v41, v42
 v_max3_f32 v106, v106, v43, 0
 s_nop 1
 v_permlane32_swap_b32 v105, v106
 s_nop 1
 v_max_f32 v105, v105, v106
 v_mov_b32 v106, v105
 s_nop 1
 v_permlane16_swap_b32 v105, v106
 s_nop 1
 v_max_f32 v105, v105, v106
 v_mov_b32 v106, v105
 s_nop 1
 v_permlane32_swap_b32 v105, v106
 s_nop 1
 v_exp_f32 v109, -v105
 s_nop 0
 v_mul_f32 v122, v122, v109
 v_accvgpr_read_b32 v100, a64
 s_nop 0
 v_mul_f32 v100, v100, v109
 s_nop 0
 v_accvgpr_write_b32 a64, v100
 v_accvgpr_read_b32 v100, a65
 s_nop 0
 v_mul_f32 v100, v100, v109
 s_nop 0
 v_accvgpr_write_b32 a65, v100
 v_accvgpr_read_b32 v100, a66
 s_nop 0
 v_mul_f32 v100, v100, v109
 s_nop 0
 v_accvgpr_write_b32 a66, v100
 v_accvgpr_read_b32 v100, a67
 s_nop 0
 v_mul_f32 v100, v100, v109
 s_nop 0
 v_accvgpr_write_b32 a67, v100
 v_accvgpr_read_b32 v100, a68
 s_nop 0
 v_mul_f32 v100, v100, v109
 s_nop 0
 v_accvgpr_write_b32 a68, v100
 v_accvgpr_read_b32 v100, a69
 s_nop 0
 v_mul_f32 v100, v100, v109
 s_nop 0
 v_accvgpr_write_b32 a69, v100
 v_accvgpr_read_b32 v100, a70
 s_nop 0
 v_mul_f32 v100, v100, v109
 s_nop 0
 v_accvgpr_write_b32 a70, v100
 v_accvgpr_read_b32 v100, a71
 s_nop 0
 v_mul_f32 v100, v100, v109
 s_nop 0
 v_accvgpr_write_b32 a71, v100
 v_accvgpr_read_b32 v100, a72
 s_nop 0
 v_mul_f32 v100, v100, v109
 s_nop 0
 v_accvgpr_write_b32 a72, v100
 v_accvgpr_read_b32 v100, a73
 s_nop 0
 v_mul_f32 v100, v100, v109
 s_nop 0
 v_accvgpr_write_b32 a73, v100
 v_accvgpr_read_b32 v100, a74
 s_nop 0
 v_mul_f32 v100, v100, v109
 s_nop 0
 v_accvgpr_write_b32 a74, v100
 v_accvgpr_read_b32 v100, a75
 s_nop 0
 v_mul_f32 v100, v100, v109
 s_nop 0
 v_accvgpr_write_b32 a75, v100
 v_accvgpr_read_b32 v100, a76
 s_nop 0
 v_mul_f32 v100, v100, v109
 s_nop 0
 v_accvgpr_write_b32 a76, v100
 v_accvgpr_read_b32 v100, a77
 s_nop 0
 v_mul_f32 v100, v100, v109
 s_nop 0
 v_accvgpr_write_b32 a77, v100
 v_accvgpr_read_b32 v100, a78
 s_nop 0
 v_mul_f32 v100, v100, v109
 s_nop 0
 v_accvgpr_write_b32 a78, v100
 v_accvgpr_read_b32 v100, a79
 s_nop 0
 v_mul_f32 v100, v100, v109
 s_nop 0
 v_accvgpr_write_b32 a79, v100
 v_accvgpr_read_b32 v100, a80
 s_nop 0
 v_mul_f32 v100, v100, v109
 s_nop 0
 v_accvgpr_write_b32 a80, v100
 v_accvgpr_read_b32 v100, a81
 s_nop 0
 v_mul_f32 v100, v100, v109
 s_nop 0
 v_accvgpr_write_b32 a81, v100
 v_accvgpr_read_b32 v100, a82
 s_nop 0
 v_mul_f32 v100, v100, v109
 s_nop 0
 v_accvgpr_write_b32 a82, v100
 v_accvgpr_read_b32 v100, a83
 s_nop 0
 v_mul_f32 v100, v100, v109
 s_nop 0
 v_accvgpr_write_b32 a83, v100
 v_accvgpr_read_b32 v100, a84
 s_nop 0
 v_mul_f32 v100, v100, v109
 s_nop 0
 v_accvgpr_write_b32 a84, v100
 v_accvgpr_read_b32 v100, a85
 s_nop 0
 v_mul_f32 v100, v100, v109
 s_nop 0
 v_accvgpr_write_b32 a85, v100
 v_accvgpr_read_b32 v100, a86
 s_nop 0
 v_mul_f32 v100, v100, v109
 s_nop 0
 v_accvgpr_write_b32 a86, v100
 v_accvgpr_read_b32 v100, a87
 s_nop 0
 v_mul_f32 v100, v100, v109
 s_nop 0
 v_accvgpr_write_b32 a87, v100
 v_accvgpr_read_b32 v100, a88
 s_nop 0
 v_mul_f32 v100, v100, v109
 s_nop 0
 v_accvgpr_write_b32 a88, v100
 v_accvgpr_read_b32 v100, a89
 s_nop 0
 v_mul_f32 v100, v100, v109
 s_nop 0
 v_accvgpr_write_b32 a89, v100
 v_accvgpr_read_b32 v100, a90
 s_nop 0
 v_mul_f32 v100, v100, v109
 s_nop 0
 v_accvgpr_write_b32 a90, v100
 v_accvgpr_read_b32 v100, a91
 s_nop 0
 v_mul_f32 v100, v100, v109
 s_nop 0
 v_accvgpr_write_b32 a91, v100
 v_accvgpr_read_b32 v100, a92
 s_nop 0
 v_mul_f32 v100, v100, v109
 s_nop 0
 v_accvgpr_write_b32 a92, v100
 v_accvgpr_read_b32 v100, a93
 s_nop 0
 v_mul_f32 v100, v100, v109
 s_nop 0
 v_accvgpr_write_b32 a93, v100
 v_accvgpr_read_b32 v100, a94
 s_nop 0
 v_mul_f32 v100, v100, v109
 s_nop 0
 v_accvgpr_write_b32 a94, v100
 v_accvgpr_read_b32 v100, a95
 s_nop 0
 v_mul_f32 v100, v100, v109
 s_nop 0
 v_accvgpr_write_b32 a95, v100
 v_sub_f32 v56, v56, v105
 v_sub_f32 v57, v57, v105
 v_sub_f32 v58, v58, v105
 v_sub_f32 v59, v59, v105
 v_sub_f32 v32, v32, v105
 v_sub_f32 v33, v33, v105
 v_sub_f32 v34, v34, v105
 v_sub_f32 v35, v35, v105
 v_sub_f32 v36, v36, v105
 v_sub_f32 v37, v37, v105
 v_sub_f32 v38, v38, v105
 v_sub_f32 v39, v39, v105
 v_exp_f32 v110, -v106
 s_nop 0
 v_mul_f32 v123, v123, v110
 v_accvgpr_read_b32 v100, a96
 s_nop 0
 v_mul_f32 v100, v100, v110
 s_nop 0
 v_accvgpr_write_b32 a96, v100
 v_accvgpr_read_b32 v100, a97
 s_nop 0
 v_mul_f32 v100, v100, v110
 s_nop 0
 v_accvgpr_write_b32 a97, v100
 v_accvgpr_read_b32 v100, a98
 s_nop 0
 v_mul_f32 v100, v100, v110
 s_nop 0
 v_accvgpr_write_b32 a98, v100
 v_accvgpr_read_b32 v100, a99
 s_nop 0
 v_mul_f32 v100, v100, v110
 s_nop 0
 v_accvgpr_write_b32 a99, v100
 v_accvgpr_read_b32 v100, a100
 s_nop 0
 v_mul_f32 v100, v100, v110
 s_nop 0
 v_accvgpr_write_b32 a100, v100
 v_accvgpr_read_b32 v100, a101
 s_nop 0
 v_mul_f32 v100, v100, v110
 s_nop 0
 v_accvgpr_write_b32 a101, v100
 v_accvgpr_read_b32 v100, a102
 s_nop 0
 v_mul_f32 v100, v100, v110
 s_nop 0
 v_accvgpr_write_b32 a102, v100
 v_accvgpr_read_b32 v100, a103
 s_nop 0
 v_mul_f32 v100, v100, v110
 s_nop 0
 v_accvgpr_write_b32 a103, v100
 v_accvgpr_read_b32 v100, a104
 s_nop 0
 v_mul_f32 v100, v100, v110
 s_nop 0
 v_accvgpr_write_b32 a104, v100
 v_accvgpr_read_b32 v100, a105
 s_nop 0
 v_mul_f32 v100, v100, v110
 s_nop 0
 v_accvgpr_write_b32 a105, v100
 v_accvgpr_read_b32 v100, a106
 s_nop 0
 v_mul_f32 v100, v100, v110
 s_nop 0
 v_accvgpr_write_b32 a106, v100
 v_accvgpr_read_b32 v100, a107
 s_nop 0
 v_mul_f32 v100, v100, v110
 s_nop 0
 v_accvgpr_write_b32 a107, v100
 v_accvgpr_read_b32 v100, a108
 s_nop 0
 v_mul_f32 v100, v100, v110
 s_nop 0
 v_accvgpr_write_b32 a108, v100
 v_accvgpr_read_b32 v100, a109
 s_nop 0
 v_mul_f32 v100, v100, v110
 s_nop 0
 v_accvgpr_write_b32 a109, v100
 v_accvgpr_read_b32 v100, a110
 s_nop 0
 v_mul_f32 v100, v100, v110
 s_nop 0
 v_accvgpr_write_b32 a110, v100
 v_accvgpr_read_b32 v100, a111
 s_nop 0
 v_mul_f32 v100, v100, v110
 s_nop 0
 v_accvgpr_write_b32 a111, v100
 v_accvgpr_read_b32 v100, a112
 s_nop 0
 v_mul_f32 v100, v100, v110
 s_nop 0
 v_accvgpr_write_b32 a112, v100
 v_accvgpr_read_b32 v100, a113
 s_nop 0
 v_mul_f32 v100, v100, v110
 s_nop 0
 v_accvgpr_write_b32 a113, v100
 v_accvgpr_read_b32 v100, a114
 s_nop 0
 v_mul_f32 v100, v100, v110
 s_nop 0
 v_accvgpr_write_b32 a114, v100
 v_accvgpr_read_b32 v100, a115
 s_nop 0
 v_mul_f32 v100, v100, v110
 s_nop 0
 v_accvgpr_write_b32 a115, v100
 v_accvgpr_read_b32 v100, a116
 s_nop 0
 v_mul_f32 v100, v100, v110
 s_nop 0
 v_accvgpr_write_b32 a116, v100
 v_accvgpr_read_b32 v100, a117
 s_nop 0
 v_mul_f32 v100, v100, v110
 s_nop 0
 v_accvgpr_write_b32 a117, v100
 v_accvgpr_read_b32 v100, a118
 s_nop 0
 v_mul_f32 v100, v100, v110
 s_nop 0
 v_accvgpr_write_b32 a118, v100
 v_accvgpr_read_b32 v100, a119
 s_nop 0
 v_mul_f32 v100, v100, v110
 s_nop 0
 v_accvgpr_write_b32 a119, v100
 v_accvgpr_read_b32 v100, a120
 s_nop 0
 v_mul_f32 v100, v100, v110
 s_nop 0
 v_accvgpr_write_b32 a120, v100
 v_accvgpr_read_b32 v100, a121
 s_nop 0
 v_mul_f32 v100, v100, v110
 s_nop 0
 v_accvgpr_write_b32 a121, v100
 v_accvgpr_read_b32 v100, a122
 s_nop 0
 v_mul_f32 v100, v100, v110
 s_nop 0
 v_accvgpr_write_b32 a122, v100
 v_accvgpr_read_b32 v100, a123
 s_nop 0
 v_mul_f32 v100, v100, v110
 s_nop 0
 v_accvgpr_write_b32 a123, v100
 v_accvgpr_read_b32 v100, a124
 s_nop 0
 v_mul_f32 v100, v100, v110
 s_nop 0
 v_accvgpr_write_b32 a124, v100
 v_accvgpr_read_b32 v100, a125
 s_nop 0
 v_mul_f32 v100, v100, v110
 s_nop 0
 v_accvgpr_write_b32 a125, v100
 v_accvgpr_read_b32 v100, a126
 s_nop 0
 v_mul_f32 v100, v100, v110
 s_nop 0
 v_accvgpr_write_b32 a126, v100
 v_accvgpr_read_b32 v100, a127
 s_nop 0
 v_mul_f32 v100, v100, v110
 s_nop 0
 v_accvgpr_write_b32 a127, v100
 v_sub_f32 v60, v60, v106
 v_sub_f32 v61, v61, v106
 v_sub_f32 v62, v62, v106
 v_sub_f32 v63, v63, v106
 v_sub_f32 v40, v40, v106
 v_sub_f32 v41, v41, v106
 v_sub_f32 v42, v42, v106
 v_sub_f32 v43, v43, v106
 v_sub_f32 v44, v44, v106
 v_sub_f32 v45, v45, v106
 v_sub_f32 v46, v46, v106
 v_sub_f32 v47, v47, v106
 v_exp_f32 v100, v32
 v_exp_f32 v101, v33
 v_exp_f32 v102, v34
 v_cvt_pk_bf16_f32 v88, v100, v101
 v_exp_f32 v103, v35
 v_exp_f32 v100, v36
 v_cvt_pk_bf16_f32 v89, v102, v103
 v_exp_f32 v101, v37
 v_exp_f32 v102, v38
 v_cvt_pk_bf16_f32 v90, v100, v101
 v_exp_f32 v103, v39
 v_exp_f32 v100, v44
 v_cvt_pk_bf16_f32 v91, v102, v103
 v_exp_f32 v101, v45
 v_exp_f32 v102, v46
 v_cvt_pk_bf16_f32 v94, v100, v101
 v_exp_f32 v103, v47
 v_exp_f32 v100, v40
 v_cvt_pk_bf16_f32 v95, v102, v103
 v_exp_f32 v101, v41
 v_exp_f32 v102, v42
 v_cvt_pk_bf16_f32 v92, v100, v101
 v_exp_f32 v103, v43
 s_nop 0
 v_cvt_pk_bf16_f32 v93, v102, v103
 s_nop 3
 v_mfma_f32_16x16x32_bf16 v[104:107], v[124:127], v[88:91], 0
 v_mfma_f32_16x16x32_bf16 v[108:111], v[124:127], v[92:95], 0
 s_nop 15
 s_setpc_b64 s[92:93]
.section .rodata,"a"
.p2align 6
.amdhsa_kernel recurrent_scan__sliding_block_cached__dense_activation_gelu__prompt_kernel
  .amdhsa_next_free_vgpr 512
  .amdhsa_next_free_sgpr 102
  .amdhsa_accum_offset 256
  .amdhsa_group_segment_fixed_size 0
  .amdhsa_kernarg_size 104
  .amdhsa_user_sgpr_count 2
  .amdhsa_user_sgpr_kernarg_segment_ptr 1
  .amdhsa_system_sgpr_workgroup_id_x 1
.end_amdhsa_kernel
```
